```python
import torch

def _softmax(x, axis=-1):
    return torch.softmax(x, dim=axis)
def _gelu(x):
    return torch.nn.functional.gelu(x, approximate="tanh")
def _silu(x):
    return torch.nn.functional.silu(x)
def _sigmoid(x):
    return torch.sigmoid(x)
def _layernorm(x, axis=-1, eps=1e-5):
    m = x.mean(dim=axis, keepdim=True)
    v = x.var(dim=axis, keepdim=True, unbiased=False)
    return (x - m) / torch.sqrt(v + eps)
def _scatter_add(tgt, idx, src, axis=0):
    return tgt.clone().index_add_(axis, idx, src)
def _segment_sum(src, seg, n):
    out = torch.zeros((n,) + src.shape[1:], dtype=src.dtype)
    return out.index_add_(0, seg, src)
def _pad(x, pw):
    flat = tuple(v for pair in reversed(pw) for v in pair)
    return torch.nn.functional.pad(x, flat)

kernel_name = 'recurrent_scan__gqa_block_cached__glu_gated_swiglu__prompt'

def setup_inputs():

    _w = (lambda a: (lambda t: t.to(torch.bfloat16) if t.is_floating_point() else t)(torch.as_tensor(a)))
    def _A_setup():
        B, Sq, D = 1, 2048, 640
        Hq, Hkv, Sk, Dh = 32, 32, 2048, 128
        assert Hq % Hkv == 0, (Hq, Hkv)
        return {
            "x": _w((lambda *s: torch.randn(*s, dtype=torch.bfloat16) * 0.05)(B, Sq, D)),
            "k_cache": _w((lambda *s: torch.randn(*s, dtype=torch.bfloat16) * 1.6)(B, Hkv, Sk, Dh)),
            "v_cache": _w((lambda *s: torch.randn(*s, dtype=torch.bfloat16) * 1.6)(B, Hkv, Sk, Dh)),
            "wq": _w((lambda *s: torch.randn(*s, dtype=torch.bfloat16) * 1.6)(D, Hq * Dh) * (D ** -0.5)),
            "wo": _w((lambda *s: torch.randn(*s, dtype=torch.bfloat16) * 1.6)(Hq * Dh, D) * ((Hq * Dh) ** -0.5)),
        }
    _A_in = _A_setup()

    def _B_setup():
        B, S, D, F = 1, 2048, 640, 1728
        return {
            "x": _w((lambda *s: torch.randn(*s, dtype=torch.bfloat16) * 0.05)(B, S, D)),
            "w1": _w((lambda *s: torch.randn(*s, dtype=torch.bfloat16) * 0.2)(D, F) * (2.0 / D) ** 0.5),
            "w3": _w((lambda *s: torch.randn(*s, dtype=torch.bfloat16) * 0.2)(D, F) * (2.0 / D) ** 0.5),
            "w2": _w((lambda *s: torch.randn(*s, dtype=torch.bfloat16) * 0.2)(F, D) * (2.0 / F) ** 0.5),
        }
    _B_in = _B_setup()

    return {
        "A_x": _A_in["x"],
        "A_k_cache": _A_in["k_cache"],
        "A_v_cache": _A_in["v_cache"],
        "A_wq": _A_in["wq"],
        "A_wo": _A_in["wo"],
        "B_x": _B_in["x"],
        "B_w1": _B_in["w1"],
        "B_w3": _B_in["w3"],
        "B_w2": _B_in["w2"],
    }

def reference(A_x, A_k_cache, A_v_cache, A_wq, A_wo, B_x, B_w1, B_w3, B_w2):
    def _A_ref(x, k_cache, v_cache, wq, wo):
        B, Sq, D = x.shape
        Hq, Dh = 32, 128
        Hkv = k_cache.shape[1]
        rep = Hq // Hkv
        q = (lambda x, *d: x.permute(*d))((x @ wq).reshape(B, Sq, Hq, Dh), 0, 2, 1, 3)
        k = (lambda x, n, axis: torch.repeat_interleave(x, n, dim=axis))(k_cache, rep, axis=1)
        v = (lambda x, n, axis: torch.repeat_interleave(x, n, dim=axis))(v_cache, rep, axis=1)
        scores = torch.einsum("bhqd,bhkd->bhqk", q, k) * (Dh ** -0.5)
        p = _softmax(scores, axis=-1)
        o = torch.einsum("bhqk,bhkd->bhqd", p, v)
        return (lambda x, *d: x.permute(*d))(o, 0, 2, 1, 3).reshape(B, Sq, Hq * Dh) @ wo

    def _B_ref(x, w1, w3, w2):
        gate = torch.einsum("bsd,df->bsf", x, w1)
        up = torch.einsum("bsd,df->bsf", x, w3)
        h = _silu(gate) * up
        out = torch.einsum("bsf,fd->bsd", h, w2)
        return out

    x = A_x
    xn = _layernorm(x, axis=-1)
    s = _A_ref(xn, A_k_cache, A_v_cache, A_wq, A_wo)
    g = _silu(_B_ref(xn, B_w1, B_w3, B_w2))
    return x + s * g
```

```asm
; @launch grid=(256,1,1) block=(256,1,1) lds=163840
.amdgcn_target "amdgcn-amd-amdhsa--gfx950"
.text
.globl recurrent_scan__gqa_block_cached__glu_gated_swiglu__prompt_kernel
.p2align 12
.p2align 8
.type recurrent_scan__gqa_block_cached__glu_gated_swiglu__prompt_kernel,@function
recurrent_scan__gqa_block_cached__glu_gated_swiglu__prompt_kernel:
    s_cmp_ge_u32 s2, 256
    s_cbranch_scc1 L_a_end
    s_load_dwordx2 s[94:95], s[0:1], 0
    s_load_dwordx2 s[82:83], s[0:1], 88
    s_load_dwordx4 s[68:71], s[0:1], 8
    s_load_dwordx4 s[72:75], s[0:1], 24
    s_load_dwordx4 s[76:79], s[0:1], 48
    s_load_dwordx2 s[80:81], s[0:1], 64
    s_load_dwordx4 s[96:99], s[0:1], 72
    s_getpc_b64 s[60:61]
L_pc_a:
    s_sub_u32 s60, s60, L_pc_a-recurrent_scan__gqa_block_cached__glu_gated_swiglu__prompt_kernel
    s_subb_u32 s61, s61, 0
    s_mov_b32 s62, L_code_end-recurrent_scan__gqa_block_cached__glu_gated_swiglu__prompt_kernel
    s_mov_b32 s63, 0x20000
    s_lshr_b32 s3, s2, 3
    s_lshl_b32 s3, s3, 12
    v_and_b32 v253, 7, v0
    v_lshrrev_b32 v254, 6, v0
    v_lshl_add_u32 v253, v254, 3, v253
    v_lshlrev_b32 v253, 7, v253
    buffer_load_dword v254, v253, s[60:63], s3 offen
    v_lshrrev_b32 v1, 6, v0
    v_and_b32 v2, 63, v0
    v_readfirstlane_b32 s4, v1
    s_and_b32 s5, s2, 7
    s_lshl_b32 s5, s5, 2
    s_bfe_u32 s6, s2, 0x20003
    s_add_u32 s5, s5, s6
    s_lshr_b32 s6, s2, 5
    s_and_b32 s44, s2, 31
    s_lshl_b32 s40, s4, 10
    v_and_b32 v4, 3, v0
    v_bfe_u32 v5, v0, 6, 1
    v_lshl_add_u32 v4, v5, 2, v4
    v_bfe_u32 v5, v0, 2, 4
    v_mul_u32_u24 v126, 1280, v4
    v_lshl_add_u32 v126, v5, 4, v126
    v_lshlrev_b32 v127, 7, v5
    v_lshl_add_u32 v127, v4, 4, v127
    v_lshlrev_b32 v3, 4, v2
    v_lshrrev_b32 v4, 3, v0
    v_bfe_u32 v5, v0, 4, 1
    v_bfe_u32 v6, v0, 6, 1
    v_lshl_add_u32 v5, v6, 1, v5
    v_lshlrev_b32 v5, 1, v5
    v_and_b32 v6, 7, v0
    v_xor_b32 v5, v5, v6
    v_lshlrev_b32 v5, 4, v5
    v_lshl_add_u32 v240, v4, 13, v5
    v_mul_u32_u24 v241, 3456, v4
    v_add_u32 v241, v241, v5
    v_mul_u32_u24 v239, 81920, v1
    v_bfe_u32 v4, v2, 3, 1
    v_mul_u32_u24 v4, 10240, v4
    v_lshrrev_b32 v5, 4, v2
    v_lshl_add_u32 v4, v5, 7, v4
    v_lshl_add_u32 v4, v6, 4, v4
    v_add_u32 v239, v239, v4
    s_waitcnt lgkmcnt(0)
    s_mul_i32 s7, s2, 10240
    s_add_u32 s32, s94, s7
    s_addc_u32 s33, s95, 0
    s_mov_b32 s34, 0x2800
    s_mov_b32 s35, 0x20000
    s_cmp_lt_u32 s4, 2
    s_cbranch_scc0 L_x_skip
    buffer_load_dwordx4 v[128:131], v126, s[32:35], 0 offen offset:0
    buffer_load_dwordx4 v[132:135], v126, s[32:35], 0 offen offset:256
    buffer_load_dwordx4 v[136:139], v126, s[32:35], 0 offen offset:512
    buffer_load_dwordx4 v[140:143], v126, s[32:35], 0 offen offset:768
    buffer_load_dwordx4 v[144:147], v126, s[32:35], 0 offen offset:1024
L_x_skip:
    s_lshl_b32 s7, s6, 7
    s_add_u32 s7, s7, 0x2200000
    s_load_dwordx2 s[92:93], s[82:83], s7
    s_mul_i32 s7, s6, 4*81920
    s_add_u32 s28, s82, s7
    s_addc_u32 s29, s83, 0
    s_mov_b32 s30, 0x50000
    s_mov_b32 s31, 0x20000
    s_lshl_b32 s7, s5, 8
    s_add_u32 s16, s72, s7
    s_addc_u32 s17, s73, 0
    s_sub_u32 s18, 5242880, s7
    s_mov_b32 s19, 0x20000
    s_bfe_u32 s7, s2, 0x20001
    s_lshl_b32 s7, s7, 2
    s_bfe_u32 s3, s2, 0x20003
    s_add_u32 s7, s7, s3
    s_mov_b32 s50, s7
    s_mul_i32 s3, s7, 96
    s_add_u32 s3, s3, 2048
    s_cmp_eq_u32 s7, 15
    s_cselect_b32 s3, 3328, s3
    s_andn2_b32 s3, s3, 63
    s_lshl_b32 s7, s7, 7
    s_bitcmp1_b32 s2, 0
    s_cselect_b32 s7, s3, s7
    s_add_u32 s20, s76, s7
    s_addc_u32 s21, s77, 0
    s_sub_u32 s22, 2211840, s7
    s_mov_b32 s23, 0x20000
    s_add_u32 s24, s78, s7
    s_addc_u32 s25, s79, 0
    s_sub_u32 s26, 2211840, s7
    s_mov_b32 s27, 0x20000
    s_mov_b32 s60, s6
    s_cmp_ge_u32 s60, 5
    s_cselect_b32 s7, 5, 0
    s_sub_u32 s60, s60, s7
    s_add_u32 s61, s60, 1
    s_cmp_eq_u32 s61, 5
    s_cselect_b32 s61, 0, s61
    s_add_u32 s62, s61, 1
    s_cmp_eq_u32 s62, 5
    s_cselect_b32 s62, 0, s62
    s_add_u32 s63, s62, 1
    s_cmp_eq_u32 s63, 5
    s_cselect_b32 s63, 0, s63
    s_add_u32 s64, s63, 1
    s_cmp_eq_u32 s64, 5
    s_cselect_b32 s64, 0, s64
    s_lshl_b32 s65, s60, 20
    s_lshl_b32 s7, s2, 1
    s_add_u32 s7, s7, s4
    s_lshl_b32 s7, s7, 7
    s_add_u32 s7, s7, 4096
    s_lshr_b32 s3, s4, 1
    s_lshl_b32 s3, s3, 20
    s_add_u32 s56, s7, s3
    s_add_u32 s84, s82, 0x2200000
    s_addc_u32 s85, s83, 0
    s_mov_b32 s86, 0x60000
    s_mov_b32 s87, 0x20000
    v_and_b32 v125, 0x380, v3
    v_lshl_add_u32 v125, v125, 17, v3
    s_cmp_lt_u32 s4, 2
    s_cbranch_scc0 L_ln_skip
    s_mul_i32 s7, s44, 10240
    s_mov_b32 s3, 0xffff0000
    s_waitcnt vmcnt(4)
    v_lshlrev_b32 v148, 16, v128
    v_and_b32 v149, s3, v128
    v_lshlrev_b32 v150, 16, v129
    v_and_b32 v151, s3, v129
    v_lshlrev_b32 v152, 16, v130
    v_and_b32 v153, s3, v130
    v_lshlrev_b32 v154, 16, v131
    v_and_b32 v155, s3, v131
    s_waitcnt vmcnt(3)
    v_lshlrev_b32 v156, 16, v132
    v_and_b32 v157, s3, v132
    v_lshlrev_b32 v158, 16, v133
    v_and_b32 v159, s3, v133
    v_lshlrev_b32 v160, 16, v134
    v_and_b32 v161, s3, v134
    v_lshlrev_b32 v162, 16, v135
    v_and_b32 v163, s3, v135
    s_waitcnt vmcnt(2)
    v_lshlrev_b32 v164, 16, v136
    v_and_b32 v165, s3, v136
    v_lshlrev_b32 v166, 16, v137
    v_and_b32 v167, s3, v137
    v_lshlrev_b32 v168, 16, v138
    v_and_b32 v169, s3, v138
    v_lshlrev_b32 v170, 16, v139
    v_and_b32 v171, s3, v139
    s_waitcnt vmcnt(1)
    v_lshlrev_b32 v172, 16, v140
    v_and_b32 v173, s3, v140
    v_lshlrev_b32 v174, 16, v141
    v_and_b32 v175, s3, v141
    v_lshlrev_b32 v176, 16, v142
    v_and_b32 v177, s3, v142
    v_lshlrev_b32 v178, 16, v143
    v_and_b32 v179, s3, v143
    s_waitcnt vmcnt(0)
    v_lshlrev_b32 v180, 16, v144
    v_and_b32 v181, s3, v144
    v_lshlrev_b32 v182, 16, v145
    v_and_b32 v183, s3, v145
    v_lshlrev_b32 v184, 16, v146
    v_and_b32 v185, s3, v146
    v_lshlrev_b32 v186, 16, v147
    v_and_b32 v187, s3, v147
    v_pk_add_f32 v[188:189], v[148:149], v[150:151]
    v_pk_add_f32 v[190:191], v[168:169], v[170:171]
    v_pk_add_f32 v[188:189], v[188:189], v[152:153]
    v_pk_add_f32 v[190:191], v[190:191], v[172:173]
    v_pk_add_f32 v[188:189], v[188:189], v[154:155]
    v_pk_add_f32 v[190:191], v[190:191], v[174:175]
    v_pk_add_f32 v[188:189], v[188:189], v[156:157]
    v_pk_add_f32 v[190:191], v[190:191], v[176:177]
    v_pk_add_f32 v[188:189], v[188:189], v[158:159]
    v_pk_add_f32 v[190:191], v[190:191], v[178:179]
    v_pk_add_f32 v[188:189], v[188:189], v[160:161]
    v_pk_add_f32 v[190:191], v[190:191], v[180:181]
    v_pk_add_f32 v[188:189], v[188:189], v[162:163]
    v_pk_add_f32 v[190:191], v[190:191], v[182:183]
    v_pk_add_f32 v[188:189], v[188:189], v[164:165]
    v_pk_add_f32 v[190:191], v[190:191], v[184:185]
    v_pk_add_f32 v[188:189], v[188:189], v[166:167]
    v_pk_add_f32 v[190:191], v[190:191], v[186:187]
    v_pk_add_f32 v[188:189], v[188:189], v[190:191]
    v_add_f32 v188, v188, v189
    s_nop 1
    v_add_f32_dpp v188, v188, v188 row_ror:4 row_mask:0xf bank_mask:0xf
    s_nop 1
    v_add_f32_dpp v188, v188, v188 row_ror:8 row_mask:0xf bank_mask:0xf
    v_mov_b32 v189, v188
    s_nop 1
    v_permlane16_swap_b32 v188, v189
    v_add_f32 v188, v188, v189
    v_mov_b32 v189, v188
    s_nop 1
    v_permlane32_swap_b32 v188, v189
    v_add_f32 v188, v188, v189
    v_mul_f32 v188, 0xbacccccd, v188
    v_mov_b32 v189, v188
    v_pk_add_f32 v[148:149], v[148:149], v[188:189]
    v_pk_add_f32 v[150:151], v[150:151], v[188:189]
    v_pk_add_f32 v[152:153], v[152:153], v[188:189]
    v_pk_add_f32 v[154:155], v[154:155], v[188:189]
    v_pk_add_f32 v[156:157], v[156:157], v[188:189]
    v_pk_add_f32 v[158:159], v[158:159], v[188:189]
    v_pk_add_f32 v[160:161], v[160:161], v[188:189]
    v_pk_add_f32 v[162:163], v[162:163], v[188:189]
    v_pk_add_f32 v[164:165], v[164:165], v[188:189]
    v_pk_add_f32 v[166:167], v[166:167], v[188:189]
    v_pk_add_f32 v[168:169], v[168:169], v[188:189]
    v_pk_add_f32 v[170:171], v[170:171], v[188:189]
    v_pk_add_f32 v[172:173], v[172:173], v[188:189]
    v_pk_add_f32 v[174:175], v[174:175], v[188:189]
    v_pk_add_f32 v[176:177], v[176:177], v[188:189]
    v_pk_add_f32 v[178:179], v[178:179], v[188:189]
    v_pk_add_f32 v[180:181], v[180:181], v[188:189]
    v_pk_add_f32 v[182:183], v[182:183], v[188:189]
    v_pk_add_f32 v[184:185], v[184:185], v[188:189]
    v_pk_add_f32 v[186:187], v[186:187], v[188:189]
    v_pk_mul_f32 v[188:189], v[148:149], v[148:149]
    v_pk_fma_f32 v[188:189], v[150:151], v[150:151], v[188:189]
    v_pk_mul_f32 v[190:191], v[168:169], v[168:169]
    v_pk_fma_f32 v[190:191], v[170:171], v[170:171], v[190:191]
    v_pk_fma_f32 v[188:189], v[152:153], v[152:153], v[188:189]
    v_pk_fma_f32 v[190:191], v[172:173], v[172:173], v[190:191]
    v_pk_fma_f32 v[188:189], v[154:155], v[154:155], v[188:189]
    v_pk_fma_f32 v[190:191], v[174:175], v[174:175], v[190:191]
    v_pk_fma_f32 v[188:189], v[156:157], v[156:157], v[188:189]
    v_pk_fma_f32 v[190:191], v[176:177], v[176:177], v[190:191]
    v_pk_fma_f32 v[188:189], v[158:159], v[158:159], v[188:189]
    v_pk_fma_f32 v[190:191], v[178:179], v[178:179], v[190:191]
    v_pk_fma_f32 v[188:189], v[160:161], v[160:161], v[188:189]
    v_pk_fma_f32 v[190:191], v[180:181], v[180:181], v[190:191]
    v_pk_fma_f32 v[188:189], v[162:163], v[162:163], v[188:189]
    v_pk_fma_f32 v[190:191], v[182:183], v[182:183], v[190:191]
    v_pk_fma_f32 v[188:189], v[164:165], v[164:165], v[188:189]
    v_pk_fma_f32 v[190:191], v[184:185], v[184:185], v[190:191]
    v_pk_fma_f32 v[188:189], v[166:167], v[166:167], v[188:189]
    v_pk_fma_f32 v[190:191], v[186:187], v[186:187], v[190:191]
    v_pk_add_f32 v[188:189], v[188:189], v[190:191]
    v_add_f32 v188, v188, v189
    s_nop 1
    v_add_f32_dpp v188, v188, v188 row_ror:4 row_mask:0xf bank_mask:0xf
    s_nop 1
    v_add_f32_dpp v188, v188, v188 row_ror:8 row_mask:0xf bank_mask:0xf
    v_mov_b32 v189, v188
    s_nop 1
    v_permlane16_swap_b32 v188, v189
    v_add_f32 v188, v188, v189
    v_mov_b32 v189, v188
    s_nop 1
    v_permlane32_swap_b32 v188, v189
    v_add_f32 v188, v188, v189
    v_mov_b32 v189, 0x3727c5ac
    v_fmac_f32 v189, 0x3acccccd, v188
    v_rsq_f32 v188, v189
    s_nop 0
    v_mul_f32 v188, 0x3e0293ee, v188
    v_mov_b32 v189, v188
    v_pk_mul_f32 v[148:149], v[148:149], v[188:189]
    v_pk_mul_f32 v[150:151], v[150:151], v[188:189]
    v_pk_mul_f32 v[152:153], v[152:153], v[188:189]
    v_pk_mul_f32 v[154:155], v[154:155], v[188:189]
    v_cvt_pk_bf16_f32 v128, v148, v149
    v_cvt_pk_bf16_f32 v129, v150, v151
    v_cvt_pk_bf16_f32 v130, v152, v153
    v_cvt_pk_bf16_f32 v131, v154, v155
    s_add_u32 s3, s7, 0
    buffer_store_dwordx4 v[128:131], v127, s[28:31], s3 offen offset:0 sc1
    v_pk_mul_f32 v[156:157], v[156:157], v[188:189]
    v_pk_mul_f32 v[158:159], v[158:159], v[188:189]
    v_pk_mul_f32 v[160:161], v[160:161], v[188:189]
    v_pk_mul_f32 v[162:163], v[162:163], v[188:189]
    v_cvt_pk_bf16_f32 v132, v156, v157
    v_cvt_pk_bf16_f32 v133, v158, v159
    v_cvt_pk_bf16_f32 v134, v160, v161
    v_cvt_pk_bf16_f32 v135, v162, v163
    buffer_store_dwordx4 v[132:135], v127, s[28:31], s3 offen offset:2048 sc1
    v_pk_mul_f32 v[164:165], v[164:165], v[188:189]
    v_pk_mul_f32 v[166:167], v[166:167], v[188:189]
    v_pk_mul_f32 v[168:169], v[168:169], v[188:189]
    v_pk_mul_f32 v[170:171], v[170:171], v[188:189]
    v_cvt_pk_bf16_f32 v136, v164, v165
    v_cvt_pk_bf16_f32 v137, v166, v167
    v_cvt_pk_bf16_f32 v138, v168, v169
    v_cvt_pk_bf16_f32 v139, v170, v171
    s_add_u32 s3, s7, 4096
    buffer_store_dwordx4 v[136:139], v127, s[28:31], s3 offen offset:0 sc1
    v_pk_mul_f32 v[172:173], v[172:173], v[188:189]
    v_pk_mul_f32 v[174:175], v[174:175], v[188:189]
    v_pk_mul_f32 v[176:177], v[176:177], v[188:189]
    v_pk_mul_f32 v[178:179], v[178:179], v[188:189]
    v_cvt_pk_bf16_f32 v140, v172, v173
    v_cvt_pk_bf16_f32 v141, v174, v175
    v_cvt_pk_bf16_f32 v142, v176, v177
    v_cvt_pk_bf16_f32 v143, v178, v179
    buffer_store_dwordx4 v[140:143], v127, s[28:31], s3 offen offset:2048 sc1
    v_pk_mul_f32 v[180:181], v[180:181], v[188:189]
    v_pk_mul_f32 v[182:183], v[182:183], v[188:189]
    v_pk_mul_f32 v[184:185], v[184:185], v[188:189]
    v_pk_mul_f32 v[186:187], v[186:187], v[188:189]
    v_cvt_pk_bf16_f32 v144, v180, v181
    v_cvt_pk_bf16_f32 v145, v182, v183
    v_cvt_pk_bf16_f32 v146, v184, v185
    v_cvt_pk_bf16_f32 v147, v186, v187
    s_add_u32 s3, s7, 8192
    buffer_store_dwordx4 v[144:147], v127, s[28:31], s3 offen offset:0 sc1
L_ln_skip:
    s_cmp_lt_u32 s4, 2
    s_cbranch_scc1 L_w01_skip
    v_subrev_u32 v9, 131072, v240
    s_add_u32 m0, s40, 96256
    s_add_u32 s41, s65, 0
    buffer_load_dwordx4 v9, s[16:19], s41 offen lds
    s_add_u32 m0, s40, 98304
    s_add_u32 s41, s65, 131072
    buffer_load_dwordx4 v9, s[16:19], s41 offen lds
    s_add_u32 m0, s40, 100352
    s_add_u32 s41, s65, 262144
    buffer_load_dwordx4 v9, s[16:19], s41 offen lds
    s_add_u32 m0, s40, 102400
    s_add_u32 s41, s65, 393216
    buffer_load_dwordx4 v9, s[16:19], s41 offen lds
    s_add_u32 m0, s40, 104448
    s_add_u32 s41, s65, 524288
    buffer_load_dwordx4 v9, s[16:19], s41 offen lds
    s_add_u32 m0, s40, 106496
    s_add_u32 s41, s65, 655360
    buffer_load_dwordx4 v9, s[16:19], s41 offen lds
    s_add_u32 m0, s40, 108544
    s_add_u32 s41, s65, 786432
    buffer_load_dwordx4 v9, s[16:19], s41 offen lds
    s_add_u32 m0, s40, 110592
    s_add_u32 s41, s65, 917504
    buffer_load_dwordx4 v9, s[16:19], s41 offen lds
L_w01_skip:
    s_mov_b32 s45, 4096
    s_mov_b32 s46, 8192
    s_mov_b32 s47, 12288
    s_lshl_b32 s7, s5, 19
    s_add_u32 s8, s68, s7
    s_addc_u32 s9, s69, 0
    s_mov_b32 s10, 0x80000
    s_mov_b32 s11, 0x20000
    s_add_u32 s12, s70, s7
    s_addc_u32 s13, s71, 0
    s_mov_b32 s14, 0x80000
    s_mov_b32 s15, 0x20000
    s_mul_i32 s7, s6, 884736
    s_add_u32 s32, s82, 0x300000
    s_addc_u32 s33, s83, 0
    s_add_u32 s32, s32, s7
    s_addc_u32 s33, s33, 0
    s_mov_b32 s34, 0xd8000
    s_mov_b32 s35, 0x20000
    s_lshl_b32 s7, s6, 21
    s_lshl_b32 s3, s5, 14
    s_add_u32 s7, s7, s3
    s_add_u32 s36, s82, 0xa00000
    s_addc_u32 s37, s83, 0
    s_add_u32 s36, s36, s7
    s_addc_u32 s37, s37, 0
    s_mov_b32 s38, 0x184000
    s_mov_b32 s39, 0x20000
    s_mov_b32 s88, s98
    s_mov_b32 s89, s99
    s_mov_b32 s90, 0x100
    s_mov_b32 s91, 0x20000
    s_mov_b32 s48, 0
    s_mov_b32 s51, 0x3c853526
    s_mov_b32 s52, 0xc13504f3
    s_mov_b32 s58, 0xbfb8aa3b
    s_bfe_u32 s53, s2, 0x20001
    s_lshl_b32 s7, s6, 2
    s_add_u32 s53, s53, s7
    s_and_b32 s54, s2, 1
    s_lshl_b32 s54, s54, 2
    s_bfe_u32 s7, s2, 0x20003
    s_add_u32 s54, s54, s7
    v_mul_u32_u24 v247, 221184, v1
    v_add_u32 v247, v247, v3
    v_lshl_add_u32 v246, v1, 19, v3
    v_lshrrev_b32 v4, 4, v2
    v_bfe_u32 v5, v2, 2, 2
    v_and_b32 v6, 3, v2
    v_and_b32 v7, 15, v2
    v_lshl_add_u32 v8, v4, 3, v5
    v_lshlrev_b32 v8, 7, v8
    v_lshl_add_u32 v8, v6, 3, v8
    v_add_u32 v8, 98304, v8
    v_bfe_u32 v9, v2, 3, 2
    v_xor_b32 v10, 0, v9
    v_lshl_add_u32 v242, v10, 5, v8
    v_xor_b32 v10, 1, v9
    v_lshl_add_u32 v243, v10, 5, v8
    v_xor_b32 v10, 2, v9
    v_lshl_add_u32 v244, v10, 5, v8
    v_xor_b32 v10, 3, v9
    v_lshl_add_u32 v245, v10, 5, v8
    v_bfe_u32 v9, v2, 4, 1
    v_bfe_u32 v10, v2, 5, 1
    v_lshl_add_u32 v9, v9, 1, v10
    v_xor_b32 v9, v9, v7
    v_lshlrev_b32 v8, 8, v7
    v_xor_b32 v10, 0, v9
    v_lshl_add_u32 v224, v10, 4, v8
    v_xor_b32 v10, 4, v9
    v_lshl_add_u32 v225, v10, 4, v8
    v_xor_b32 v10, 8, v9
    v_lshl_add_u32 v226, v10, 4, v8
    v_xor_b32 v10, 12, v9
    v_lshl_add_u32 v227, v10, 4, v8
    v_lshrrev_b32 v9, 2, v2
    v_lshlrev_b32 v8, 8, v9
    v_lshl_add_u32 v8, v6, 3, v8
    v_add_u32 v8, 65536, v8
    v_and_b32 v9, 7, v9
    v_xor_b32 v10, 0, v9
    v_lshl_add_u32 v228, v10, 5, v8
    v_xor_b32 v10, 1, v9
    v_lshl_add_u32 v229, v10, 5, v8
    v_xor_b32 v10, 2, v9
    v_lshl_add_u32 v230, v10, 5, v8
    v_xor_b32 v10, 3, v9
    v_lshl_add_u32 v231, v10, 5, v8
    v_xor_b32 v10, 4, v9
    v_lshl_add_u32 v232, v10, 5, v8
    v_xor_b32 v10, 5, v9
    v_lshl_add_u32 v233, v10, 5, v8
    v_xor_b32 v10, 6, v9
    v_lshl_add_u32 v234, v10, 5, v8
    v_xor_b32 v10, 7, v9
    v_lshl_add_u32 v235, v10, 5, v8
    v_lshrrev_b32 v9, 4, v0
    v_lshlrev_b32 v8, 8, v9
    v_xor_b32 v10, v7, v9
    v_lshl_add_u32 v236, v10, 4, v8
    v_and_b32 v10, 7, v9
    v_lshlrev_b32 v10, 1, v10
    v_xor_b32 v10, v7, v10
    v_lshl_add_u32 v237, v10, 4, v8
    v_mov_b32 v238, v3
    v_and_b32 v9, 0x380, v3
    v_lshl_add_u32 v9, v9, 14, v3
    s_lshl_b32 s7, s6, 12
    s_add_u32 s7, s7, s40
    v_lshl_add_u32 v252, v9, 3, s7
    s_waitcnt lgkmcnt(0)
    s_add_u32 s92, s92, 0x9e3779b9
    s_add_u32 s93, s93, 0x7f4a7c15
    s_cmp_ge_u32 s4, 2
    s_cbranch_scc1 L_a_p1
    v_mov_b32 v120, s92
    v_mov_b32 v121, s93
    v_mov_b32 v122, s92
    v_mov_b32 v123, s93
    s_waitcnt vmcnt(0)
    buffer_store_dwordx4 v[120:123], v125, s[84:87], s56 offen sc1
    s_branch L_a_p1
.p2align 12
L_a_p1:
    s_lshl_b32 s7, s6, 2
    s_add_u32 s7, s7, s4
    s_lshl_b32 s7, s7, 11
    s_add_u32 s7, s7, 4096
    v_and_b32 v249, 0xf0, v238
    v_lshlrev_b32 v249, 3, v249
    s_cmp_lt_u32 s4, 2
    s_cbranch_scc1 L_vis_done
    s_mov_b64 exec, 0
    s_cmp_eq_u32 s4, 3
    s_cbranch_scc1 L_padB_0
    s_bitcmp0_b32 s2, 0
    s_cbranch_scc1 L_padA_0
    s_branch L_padC_0
L_vis_ret:
L_vis_done:
    s_mov_b64 exec, -1
    s_barrier
    s_add_u32 m0, s40, 114688
    s_add_u32 s41, s65, 128
    buffer_load_dwordx4 v240, s[16:19], s41 offen lds
    s_add_u32 m0, s40, 118784
    s_add_u32 s41, s65, 262272
    buffer_load_dwordx4 v240, s[16:19], s41 offen lds
    s_add_u32 m0, s40, 122880
    s_add_u32 s41, s65, 524416
    buffer_load_dwordx4 v240, s[16:19], s41 offen lds
    s_add_u32 m0, s40, 126976
    s_add_u32 s41, s65, 786560
    buffer_load_dwordx4 v240, s[16:19], s41 offen lds
    s_mov_b32 s59, 262144
L_s1:
    buffer_load_dwordx2 v[250:251], v249, s[84:87], s7 offen sc1
    s_waitcnt vmcnt(0)
    v_cmp_ne_u64 vcc, s[92:93], v[250:251]
    s_cbranch_vccz L_s1_ok
    s_sleep 1
    s_sub_u32 s59, s59, 1
    s_cmp_lg_u32 s59, 0
    s_cbranch_scc1 L_s1
L_s1_ok:
    s_lshl_b32 s59, s60, 11
    s_add_u32 s55, s59, 0
    buffer_load_dwordx4 a[64:67], v239, s[28:31], s55 offen offset:0 sc1
    buffer_load_dwordx4 a[68:71], v239, s[28:31], s55 offen offset:512 sc1
    buffer_load_dwordx4 a[72:75], v239, s[28:31], s55 offen offset:1024 sc1
    buffer_load_dwordx4 a[76:79], v239, s[28:31], s55 offen offset:1536 sc1
    s_add_u32 s55, s59, 20480
    buffer_load_dwordx4 a[80:83], v239, s[28:31], s55 offen offset:0 sc1
    buffer_load_dwordx4 a[84:87], v239, s[28:31], s55 offen offset:512 sc1
    buffer_load_dwordx4 a[88:91], v239, s[28:31], s55 offen offset:1024 sc1
    buffer_load_dwordx4 a[92:95], v239, s[28:31], s55 offen offset:1536 sc1
    s_add_u32 s55, s59, 40960
    buffer_load_dwordx4 a[96:99], v239, s[28:31], s55 offen offset:0 sc1
    buffer_load_dwordx4 a[100:103], v239, s[28:31], s55 offen offset:512 sc1
    buffer_load_dwordx4 a[104:107], v239, s[28:31], s55 offen offset:1024 sc1
    buffer_load_dwordx4 a[108:111], v239, s[28:31], s55 offen offset:1536 sc1
    s_add_u32 s55, s59, 61440
    buffer_load_dwordx4 a[112:115], v239, s[28:31], s55 offen offset:0 sc1
    buffer_load_dwordx4 a[116:119], v239, s[28:31], s55 offen offset:512 sc1
    buffer_load_dwordx4 a[120:123], v239, s[28:31], s55 offen offset:1024 sc1
    buffer_load_dwordx4 a[124:127], v239, s[28:31], s55 offen offset:1536 sc1
    s_barrier
    ds_read_b64_tr_b16 v[192:193], v242 offset:0
    ds_read_b64_tr_b16 v[194:195], v242 offset:512
    ds_read_b64_tr_b16 v[196:197], v242 offset:4096
    ds_read_b64_tr_b16 v[198:199], v242 offset:4608
    ds_read_b64_tr_b16 v[200:201], v242 offset:8192
    ds_read_b64_tr_b16 v[202:203], v242 offset:8704
    ds_read_b64_tr_b16 v[204:205], v242 offset:12288
    ds_read_b64_tr_b16 v[206:207], v242 offset:12800
    s_bitcmp1_b32 s2, 0
    s_cbranch_scc1 L_a_noffn
    s_lshl_b32 s49, s50, 13
    s_add_u32 s50, s49, 4096
    s_waitcnt vmcnt(12) lgkmcnt(0)
    v_mfma_f32_16x16x32_bf16 a[0:3], v[192:195], a[64:67], 0
    v_mfma_f32_16x16x32_bf16 a[0:3], v[196:199], a[68:71], a[0:3]
    ds_read_b64_tr_b16 v[208:209], v243 offset:0
    ds_read_b64_tr_b16 v[210:211], v243 offset:512
    v_mfma_f32_16x16x32_bf16 a[0:3], v[200:203], a[72:75], a[0:3]
    s_mul_i32 s65, s60, 442368
    v_mfma_f32_16x16x32_bf16 a[0:3], v[204:207], a[76:79], a[0:3]
    s_waitcnt vmcnt(8)
    ds_read_b64_tr_b16 v[212:213], v243 offset:4096
    ds_read_b64_tr_b16 v[214:215], v243 offset:4608
    v_mfma_f32_16x16x32_bf16 a[4:7], v[192:195], a[80:83], 0
    s_add_u32 m0, s40, 131072
    v_mfma_f32_16x16x32_bf16 a[4:7], v[196:199], a[84:87], a[4:7]
    s_add_u32 s41, s65, 0
    ds_read_b64_tr_b16 v[216:217], v243 offset:8192
    ds_read_b64_tr_b16 v[218:219], v243 offset:8704
    v_mfma_f32_16x16x32_bf16 a[4:7], v[200:203], a[88:91], a[4:7]
    buffer_load_dwordx4 v241, s[20:23], s41 offen lds
    v_mfma_f32_16x16x32_bf16 a[4:7], v[204:207], a[92:95], a[4:7]
    s_waitcnt vmcnt(5)
    ds_read_b64_tr_b16 v[220:221], v243 offset:12288
    ds_read_b64_tr_b16 v[222:223], v243 offset:12800
    v_mfma_f32_16x16x32_bf16 a[8:11], v[192:195], a[96:99], 0
    s_add_u32 m0, s40, 135168
    v_mfma_f32_16x16x32_bf16 a[8:11], v[196:199], a[100:103], a[8:11]
    s_add_u32 s41, s65, 110592
    v_mfma_f32_16x16x32_bf16 a[8:11], v[200:203], a[104:107], a[8:11]
    buffer_load_dwordx4 v241, s[20:23], s41 offen lds
    v_mfma_f32_16x16x32_bf16 a[8:11], v[204:207], a[108:111], a[8:11]
    s_waitcnt vmcnt(2)
    v_mfma_f32_16x16x32_bf16 a[12:15], v[192:195], a[112:115], 0
    v_mfma_f32_16x16x32_bf16 a[12:15], v[196:199], a[116:119], a[12:15]
    s_add_u32 m0, s40, 139264
    v_mfma_f32_16x16x32_bf16 a[12:15], v[200:203], a[120:123], a[12:15]
    s_add_u32 s41, s65, 221184
    v_mfma_f32_16x16x32_bf16 a[12:15], v[204:207], a[124:127], a[12:15]
    s_waitcnt lgkmcnt(0)
    v_mfma_f32_16x16x32_bf16 a[16:19], v[208:211], a[64:67], 0
    buffer_load_dwordx4 v241, s[20:23], s41 offen lds
    v_mfma_f32_16x16x32_bf16 a[16:19], v[212:215], a[68:71], a[16:19]
    ds_read_b64_tr_b16 v[192:193], v244 offset:0
    ds_read_b64_tr_b16 v[194:195], v244 offset:512
    v_mfma_f32_16x16x32_bf16 a[16:19], v[216:219], a[72:75], a[16:19]
    s_add_u32 m0, s40, 143360
    v_mfma_f32_16x16x32_bf16 a[16:19], v[220:223], a[76:79], a[16:19]
    s_add_u32 s41, s65, 331776
    ds_read_b64_tr_b16 v[196:197], v244 offset:4096
    ds_read_b64_tr_b16 v[198:199], v244 offset:4608
    v_mfma_f32_16x16x32_bf16 a[20:23], v[208:211], a[80:83], 0
    buffer_load_dwordx4 v241, s[20:23], s41 offen lds
    v_mfma_f32_16x16x32_bf16 a[20:23], v[212:215], a[84:87], a[20:23]
    ds_read_b64_tr_b16 v[200:201], v244 offset:8192
    ds_read_b64_tr_b16 v[202:203], v244 offset:8704
    v_mfma_f32_16x16x32_bf16 a[20:23], v[216:219], a[88:91], a[20:23]
    s_mul_i32 s65, s60, 442368
    v_mfma_f32_16x16x32_bf16 a[20:23], v[220:223], a[92:95], a[20:23]
    s_add_u32 m0, s40, 147456
    ds_read_b64_tr_b16 v[204:205], v244 offset:12288
    ds_read_b64_tr_b16 v[206:207], v244 offset:12800
    v_mfma_f32_16x16x32_bf16 a[24:27], v[208:211], a[96:99], 0
    s_add_u32 s41, s65, 0
    v_mfma_f32_16x16x32_bf16 a[24:27], v[212:215], a[100:103], a[24:27]
    buffer_load_dwordx4 v241, s[24:27], s41 offen lds
    v_mfma_f32_16x16x32_bf16 a[24:27], v[216:219], a[104:107], a[24:27]
    v_mfma_f32_16x16x32_bf16 a[24:27], v[220:223], a[108:111], a[24:27]
    v_mfma_f32_16x16x32_bf16 a[28:31], v[208:211], a[112:115], 0
    s_add_u32 m0, s40, 151552
    v_mfma_f32_16x16x32_bf16 a[28:31], v[212:215], a[116:119], a[28:31]
    s_add_u32 s41, s65, 110592
    v_mfma_f32_16x16x32_bf16 a[28:31], v[216:219], a[120:123], a[28:31]
    buffer_load_dwordx4 v241, s[24:27], s41 offen lds
    v_mfma_f32_16x16x32_bf16 a[28:31], v[220:223], a[124:127], a[28:31]
    s_waitcnt lgkmcnt(0)
    v_mfma_f32_16x16x32_bf16 a[32:35], v[192:195], a[64:67], 0
    v_mfma_f32_16x16x32_bf16 a[32:35], v[196:199], a[68:71], a[32:35]
    ds_read_b64_tr_b16 v[208:209], v245 offset:0
    ds_read_b64_tr_b16 v[210:211], v245 offset:512
    v_mfma_f32_16x16x32_bf16 a[32:35], v[200:203], a[72:75], a[32:35]
    s_add_u32 m0, s40, 155648
    v_mfma_f32_16x16x32_bf16 a[32:35], v[204:207], a[76:79], a[32:35]
    s_add_u32 s41, s65, 221184
    ds_read_b64_tr_b16 v[212:213], v245 offset:4096
    ds_read_b64_tr_b16 v[214:215], v245 offset:4608
    v_mfma_f32_16x16x32_bf16 a[36:39], v[192:195], a[80:83], 0
    buffer_load_dwordx4 v241, s[24:27], s41 offen lds
    v_mfma_f32_16x16x32_bf16 a[36:39], v[196:199], a[84:87], a[36:39]
    ds_read_b64_tr_b16 v[216:217], v245 offset:8192
    ds_read_b64_tr_b16 v[218:219], v245 offset:8704
    v_mfma_f32_16x16x32_bf16 a[36:39], v[200:203], a[88:91], a[36:39]
    s_add_u32 m0, s40, 159744
    v_mfma_f32_16x16x32_bf16 a[36:39], v[204:207], a[92:95], a[36:39]
    s_add_u32 s41, s65, 331776
    ds_read_b64_tr_b16 v[220:221], v245 offset:12288
    ds_read_b64_tr_b16 v[222:223], v245 offset:12800
    v_mfma_f32_16x16x32_bf16 a[40:43], v[192:195], a[96:99], 0
    buffer_load_dwordx4 v241, s[24:27], s41 offen lds
    v_mfma_f32_16x16x32_bf16 a[40:43], v[196:199], a[100:103], a[40:43]
    v_mfma_f32_16x16x32_bf16 a[40:43], v[200:203], a[104:107], a[40:43]
    v_mfma_f32_16x16x32_bf16 a[40:43], v[204:207], a[108:111], a[40:43]
    v_mfma_f32_16x16x32_bf16 a[44:47], v[192:195], a[112:115], 0
    v_mfma_f32_16x16x32_bf16 a[44:47], v[196:199], a[116:119], a[44:47]
    v_mfma_f32_16x16x32_bf16 a[44:47], v[200:203], a[120:123], a[44:47]
    v_mfma_f32_16x16x32_bf16 a[44:47], v[204:207], a[124:127], a[44:47]
    s_waitcnt lgkmcnt(0)
    v_mfma_f32_16x16x32_bf16 a[48:51], v[208:211], a[64:67], 0
    s_waitcnt vmcnt(25)
    s_barrier
    v_mfma_f32_16x16x32_bf16 a[48:51], v[212:215], a[68:71], a[48:51]
    s_mul_i32 s65, s61, 442368
    ds_read_b64_tr_b16 v[192:193], v242 offset:16384
    ds_read_b64_tr_b16 v[194:195], v242 offset:16896
    v_mfma_f32_16x16x32_bf16 a[48:51], v[216:219], a[72:75], a[48:51]
    s_add_u32 m0, s40, 98304
    v_mfma_f32_16x16x32_bf16 a[48:51], v[220:223], a[76:79], a[48:51]
    s_add_u32 s41, s65, 0
    ds_read_b64_tr_b16 v[196:197], v242 offset:20480
    ds_read_b64_tr_b16 v[198:199], v242 offset:20992
    v_mfma_f32_16x16x32_bf16 a[52:55], v[208:211], a[80:83], 0
    buffer_load_dwordx4 v241, s[20:23], s41 offen lds
    v_mfma_f32_16x16x32_bf16 a[52:55], v[212:215], a[84:87], a[52:55]
    ds_read_b64_tr_b16 v[200:201], v242 offset:24576
    ds_read_b64_tr_b16 v[202:203], v242 offset:25088
    v_mfma_f32_16x16x32_bf16 a[52:55], v[216:219], a[88:91], a[52:55]
    s_add_u32 m0, s40, 102400
    v_mfma_f32_16x16x32_bf16 a[52:55], v[220:223], a[92:95], a[52:55]
    s_add_u32 s41, s65, 110592
    ds_read_b64_tr_b16 v[204:205], v242 offset:28672
    ds_read_b64_tr_b16 v[206:207], v242 offset:29184
    v_mfma_f32_16x16x32_bf16 a[56:59], v[208:211], a[96:99], 0
    buffer_load_dwordx4 v241, s[20:23], s41 offen lds
    v_mfma_f32_16x16x32_bf16 a[56:59], v[212:215], a[100:103], a[56:59]
    v_mfma_f32_16x16x32_bf16 a[56:59], v[216:219], a[104:107], a[56:59]
    v_mfma_f32_16x16x32_bf16 a[56:59], v[220:223], a[108:111], a[56:59]
    s_add_u32 m0, s40, 106496
    v_mfma_f32_16x16x32_bf16 a[60:63], v[208:211], a[112:115], 0
    s_add_u32 s41, s65, 221184
    v_mfma_f32_16x16x32_bf16 a[60:63], v[212:215], a[116:119], a[60:63]
    buffer_load_dwordx4 v241, s[20:23], s41 offen lds
    v_mfma_f32_16x16x32_bf16 a[60:63], v[216:219], a[120:123], a[60:63]
    v_mfma_f32_16x16x32_bf16 a[60:63], v[220:223], a[124:127], a[60:63]
    s_waitcnt lgkmcnt(0)
    v_mfma_f32_16x16x32_bf16 v[128:131], v[192:195], a[64:67], 0
    s_add_u32 m0, s40, 110592
    v_mfma_f32_16x16x32_bf16 v[128:131], v[196:199], a[68:71], v[128:131]
    s_add_u32 s41, s65, 331776
    ds_read_b64_tr_b16 v[208:209], v243 offset:16384
    ds_read_b64_tr_b16 v[210:211], v243 offset:16896
    v_mfma_f32_16x16x32_bf16 v[128:131], v[200:203], a[72:75], v[128:131]
    buffer_load_dwordx4 v241, s[20:23], s41 offen lds
    v_mfma_f32_16x16x32_bf16 v[128:131], v[204:207], a[76:79], v[128:131]
    ds_read_b64_tr_b16 v[212:213], v243 offset:20480
    ds_read_b64_tr_b16 v[214:215], v243 offset:20992
    v_mfma_f32_16x16x32_bf16 v[132:135], v[192:195], a[80:83], 0
    v_mfma_f32_16x16x32_bf16 v[132:135], v[196:199], a[84:87], v[132:135]
    ds_read_b64_tr_b16 v[216:217], v243 offset:24576
    ds_read_b64_tr_b16 v[218:219], v243 offset:25088
    v_mfma_f32_16x16x32_bf16 v[132:135], v[200:203], a[88:91], v[132:135]
    s_lshl_b32 s59, s61, 11
    v_mfma_f32_16x16x32_bf16 v[132:135], v[204:207], a[92:95], v[132:135]
    s_add_u32 s55, s59, 0
    ds_read_b64_tr_b16 v[220:221], v243 offset:28672
    ds_read_b64_tr_b16 v[222:223], v243 offset:29184
    v_mfma_f32_16x16x32_bf16 v[136:139], v[192:195], a[96:99], 0
    buffer_load_dwordx4 a[128:131], v239, s[28:31], s55 offen offset:0 sc1
    v_mfma_f32_16x16x32_bf16 v[136:139], v[196:199], a[100:103], v[136:139]
    v_mfma_f32_16x16x32_bf16 v[136:139], v[200:203], a[104:107], v[136:139]
    v_mfma_f32_16x16x32_bf16 v[136:139], v[204:207], a[108:111], v[136:139]
    buffer_load_dwordx4 a[132:135], v239, s[28:31], s55 offen offset:512 sc1
    v_mfma_f32_16x16x32_bf16 v[140:143], v[192:195], a[112:115], 0
    v_mfma_f32_16x16x32_bf16 v[140:143], v[196:199], a[116:119], v[140:143]
    v_mfma_f32_16x16x32_bf16 v[140:143], v[200:203], a[120:123], v[140:143]
    v_mfma_f32_16x16x32_bf16 v[140:143], v[204:207], a[124:127], v[140:143]
    s_waitcnt lgkmcnt(0)
    v_mfma_f32_16x16x32_bf16 v[144:147], v[208:211], a[64:67], 0
    buffer_load_dwordx4 a[136:139], v239, s[28:31], s55 offen offset:1024 sc1
    v_mfma_f32_16x16x32_bf16 v[144:147], v[212:215], a[68:71], v[144:147]
    ds_read_b64_tr_b16 v[192:193], v244 offset:16384
    ds_read_b64_tr_b16 v[194:195], v244 offset:16896
    v_mfma_f32_16x16x32_bf16 v[144:147], v[216:219], a[72:75], v[144:147]
    v_mfma_f32_16x16x32_bf16 v[144:147], v[220:223], a[76:79], v[144:147]
    ds_read_b64_tr_b16 v[196:197], v244 offset:20480
    ds_read_b64_tr_b16 v[198:199], v244 offset:20992
    v_mfma_f32_16x16x32_bf16 v[148:151], v[208:211], a[80:83], 0
    v_mfma_f32_16x16x32_bf16 v[148:151], v[212:215], a[84:87], v[148:151]
    ds_read_b64_tr_b16 v[200:201], v244 offset:24576
    ds_read_b64_tr_b16 v[202:203], v244 offset:25088
    v_mfma_f32_16x16x32_bf16 v[148:151], v[216:219], a[88:91], v[148:151]
    buffer_load_dwordx4 a[140:143], v239, s[28:31], s55 offen offset:1536 sc1
    v_mfma_f32_16x16x32_bf16 v[148:151], v[220:223], a[92:95], v[148:151]
    ds_read_b64_tr_b16 v[204:205], v244 offset:28672
    ds_read_b64_tr_b16 v[206:207], v244 offset:29184
    v_mfma_f32_16x16x32_bf16 v[152:155], v[208:211], a[96:99], 0
    v_mfma_f32_16x16x32_bf16 v[152:155], v[212:215], a[100:103], v[152:155]
    s_add_u32 s55, s59, 20480
    v_mfma_f32_16x16x32_bf16 v[152:155], v[216:219], a[104:107], v[152:155]
    buffer_load_dwordx4 a[144:147], v239, s[28:31], s55 offen offset:0 sc1
    v_mfma_f32_16x16x32_bf16 v[152:155], v[220:223], a[108:111], v[152:155]
    v_mfma_f32_16x16x32_bf16 v[156:159], v[208:211], a[112:115], 0
    v_mfma_f32_16x16x32_bf16 v[156:159], v[212:215], a[116:119], v[156:159]
    v_mfma_f32_16x16x32_bf16 v[156:159], v[216:219], a[120:123], v[156:159]
    buffer_load_dwordx4 a[148:151], v239, s[28:31], s55 offen offset:512 sc1
    v_mfma_f32_16x16x32_bf16 v[156:159], v[220:223], a[124:127], v[156:159]
    s_waitcnt lgkmcnt(0)
    v_mfma_f32_16x16x32_bf16 v[160:163], v[192:195], a[64:67], 0
    v_mfma_f32_16x16x32_bf16 v[160:163], v[196:199], a[68:71], v[160:163]
    ds_read_b64_tr_b16 v[208:209], v245 offset:16384
    ds_read_b64_tr_b16 v[210:211], v245 offset:16896
    v_mfma_f32_16x16x32_bf16 v[160:163], v[200:203], a[72:75], v[160:163]
    v_mfma_f32_16x16x32_bf16 v[160:163], v[204:207], a[76:79], v[160:163]
    ds_read_b64_tr_b16 v[212:213], v245 offset:20480
    ds_read_b64_tr_b16 v[214:215], v245 offset:20992
    v_mfma_f32_16x16x32_bf16 v[164:167], v[192:195], a[80:83], 0
    buffer_load_dwordx4 a[152:155], v239, s[28:31], s55 offen offset:1024 sc1
    v_mfma_f32_16x16x32_bf16 v[164:167], v[196:199], a[84:87], v[164:167]
    ds_read_b64_tr_b16 v[216:217], v245 offset:24576
    ds_read_b64_tr_b16 v[218:219], v245 offset:25088
    v_mfma_f32_16x16x32_bf16 v[164:167], v[200:203], a[88:91], v[164:167]
    v_mfma_f32_16x16x32_bf16 v[164:167], v[204:207], a[92:95], v[164:167]
    ds_read_b64_tr_b16 v[220:221], v245 offset:28672
    ds_read_b64_tr_b16 v[222:223], v245 offset:29184
    v_mfma_f32_16x16x32_bf16 v[168:171], v[192:195], a[96:99], 0
    buffer_load_dwordx4 a[156:159], v239, s[28:31], s55 offen offset:1536 sc1
    v_mfma_f32_16x16x32_bf16 v[168:171], v[196:199], a[100:103], v[168:171]
    v_mfma_f32_16x16x32_bf16 v[168:171], v[200:203], a[104:107], v[168:171]
    v_mfma_f32_16x16x32_bf16 v[168:171], v[204:207], a[108:111], v[168:171]
    v_mfma_f32_16x16x32_bf16 v[172:175], v[192:195], a[112:115], 0
    v_mfma_f32_16x16x32_bf16 v[172:175], v[196:199], a[116:119], v[172:175]
    v_mfma_f32_16x16x32_bf16 v[172:175], v[200:203], a[120:123], v[172:175]
    v_mfma_f32_16x16x32_bf16 v[172:175], v[204:207], a[124:127], v[172:175]
    s_waitcnt lgkmcnt(0)
    v_mfma_f32_16x16x32_bf16 v[176:179], v[208:211], a[64:67], 0
    s_waitcnt vmcnt(16)
    s_barrier
    v_mfma_f32_16x16x32_bf16 v[176:179], v[212:215], a[68:71], v[176:179]
    s_mul_i32 s65, s61, 442368
    ds_read_b64_tr_b16 v[192:193], v242 offset:32768
    ds_read_b64_tr_b16 v[194:195], v242 offset:33280
    v_mfma_f32_16x16x32_bf16 v[176:179], v[216:219], a[72:75], v[176:179]
    s_add_u32 m0, s40, 114688
    v_mfma_f32_16x16x32_bf16 v[176:179], v[220:223], a[76:79], v[176:179]
    s_add_u32 s41, s65, 0
    ds_read_b64_tr_b16 v[196:197], v242 offset:36864
    ds_read_b64_tr_b16 v[198:199], v242 offset:37376
    v_mfma_f32_16x16x32_bf16 v[180:183], v[208:211], a[80:83], 0
    buffer_load_dwordx4 v241, s[24:27], s41 offen lds
    v_mfma_f32_16x16x32_bf16 v[180:183], v[212:215], a[84:87], v[180:183]
    ds_read_b64_tr_b16 v[200:201], v242 offset:40960
    ds_read_b64_tr_b16 v[202:203], v242 offset:41472
    v_mfma_f32_16x16x32_bf16 v[180:183], v[216:219], a[88:91], v[180:183]
    s_add_u32 m0, s40, 118784
    v_mfma_f32_16x16x32_bf16 v[180:183], v[220:223], a[92:95], v[180:183]
    s_add_u32 s41, s65, 110592
    ds_read_b64_tr_b16 v[204:205], v242 offset:45056
    ds_read_b64_tr_b16 v[206:207], v242 offset:45568
    v_mfma_f32_16x16x32_bf16 v[184:187], v[208:211], a[96:99], 0
    buffer_load_dwordx4 v241, s[24:27], s41 offen lds
    v_mfma_f32_16x16x32_bf16 v[184:187], v[212:215], a[100:103], v[184:187]
    v_mfma_f32_16x16x32_bf16 v[184:187], v[216:219], a[104:107], v[184:187]
    v_mfma_f32_16x16x32_bf16 v[184:187], v[220:223], a[108:111], v[184:187]
    s_add_u32 m0, s40, 122880
    v_mfma_f32_16x16x32_bf16 v[188:191], v[208:211], a[112:115], 0
    s_add_u32 s41, s65, 221184
    v_mfma_f32_16x16x32_bf16 v[188:191], v[212:215], a[116:119], v[188:191]
    buffer_load_dwordx4 v241, s[24:27], s41 offen lds
    v_mfma_f32_16x16x32_bf16 v[188:191], v[216:219], a[120:123], v[188:191]
    v_mfma_f32_16x16x32_bf16 v[188:191], v[220:223], a[124:127], v[188:191]
    s_waitcnt lgkmcnt(0)
    v_mfma_f32_16x16x32_bf16 v[0:3], v[192:195], a[64:67], 0
    s_add_u32 m0, s40, 126976
    v_mfma_f32_16x16x32_bf16 v[0:3], v[196:199], a[68:71], v[0:3]
    s_add_u32 s41, s65, 331776
    ds_read_b64_tr_b16 v[208:209], v243 offset:32768
    ds_read_b64_tr_b16 v[210:211], v243 offset:33280
    v_mfma_f32_16x16x32_bf16 v[0:3], v[200:203], a[72:75], v[0:3]
    buffer_load_dwordx4 v241, s[24:27], s41 offen lds
    v_mfma_f32_16x16x32_bf16 v[0:3], v[204:207], a[76:79], v[0:3]
    ds_read_b64_tr_b16 v[212:213], v243 offset:36864
    ds_read_b64_tr_b16 v[214:215], v243 offset:37376
    v_mfma_f32_16x16x32_bf16 v[4:7], v[192:195], a[80:83], 0
    v_mfma_f32_16x16x32_bf16 v[4:7], v[196:199], a[84:87], v[4:7]
    ds_read_b64_tr_b16 v[216:217], v243 offset:40960
    ds_read_b64_tr_b16 v[218:219], v243 offset:41472
    v_mfma_f32_16x16x32_bf16 v[4:7], v[200:203], a[88:91], v[4:7]
    v_mfma_f32_16x16x32_bf16 v[4:7], v[204:207], a[92:95], v[4:7]
    s_add_u32 s55, s59, 40960
    ds_read_b64_tr_b16 v[220:221], v243 offset:45056
    ds_read_b64_tr_b16 v[222:223], v243 offset:45568
    v_mfma_f32_16x16x32_bf16 v[8:11], v[192:195], a[96:99], 0
    buffer_load_dwordx4 a[160:163], v239, s[28:31], s55 offen offset:0 sc1
    v_mfma_f32_16x16x32_bf16 v[8:11], v[196:199], a[100:103], v[8:11]
    v_mfma_f32_16x16x32_bf16 v[8:11], v[200:203], a[104:107], v[8:11]
    v_mfma_f32_16x16x32_bf16 v[8:11], v[204:207], a[108:111], v[8:11]
    buffer_load_dwordx4 a[164:167], v239, s[28:31], s55 offen offset:512 sc1
    v_mfma_f32_16x16x32_bf16 v[12:15], v[192:195], a[112:115], 0
    v_mfma_f32_16x16x32_bf16 v[12:15], v[196:199], a[116:119], v[12:15]
    v_mfma_f32_16x16x32_bf16 v[12:15], v[200:203], a[120:123], v[12:15]
    v_mfma_f32_16x16x32_bf16 v[12:15], v[204:207], a[124:127], v[12:15]
    s_waitcnt lgkmcnt(0)
    v_mfma_f32_16x16x32_bf16 v[16:19], v[208:211], a[64:67], 0
    buffer_load_dwordx4 a[168:171], v239, s[28:31], s55 offen offset:1024 sc1
    v_mfma_f32_16x16x32_bf16 v[16:19], v[212:215], a[68:71], v[16:19]
    ds_read_b64_tr_b16 v[192:193], v244 offset:32768
    ds_read_b64_tr_b16 v[194:195], v244 offset:33280
    v_mfma_f32_16x16x32_bf16 v[16:19], v[216:219], a[72:75], v[16:19]
    v_mfma_f32_16x16x32_bf16 v[16:19], v[220:223], a[76:79], v[16:19]
    ds_read_b64_tr_b16 v[196:197], v244 offset:36864
    ds_read_b64_tr_b16 v[198:199], v244 offset:37376
    v_mfma_f32_16x16x32_bf16 v[20:23], v[208:211], a[80:83], 0
    v_mfma_f32_16x16x32_bf16 v[20:23], v[212:215], a[84:87], v[20:23]
    ds_read_b64_tr_b16 v[200:201], v244 offset:40960
    ds_read_b64_tr_b16 v[202:203], v244 offset:41472
    v_mfma_f32_16x16x32_bf16 v[20:23], v[216:219], a[88:91], v[20:23]
    buffer_load_dwordx4 a[172:175], v239, s[28:31], s55 offen offset:1536 sc1
    v_mfma_f32_16x16x32_bf16 v[20:23], v[220:223], a[92:95], v[20:23]
    ds_read_b64_tr_b16 v[204:205], v244 offset:45056
    ds_read_b64_tr_b16 v[206:207], v244 offset:45568
    v_mfma_f32_16x16x32_bf16 v[24:27], v[208:211], a[96:99], 0
    v_mfma_f32_16x16x32_bf16 v[24:27], v[212:215], a[100:103], v[24:27]
    s_add_u32 s55, s59, 61440
    v_mfma_f32_16x16x32_bf16 v[24:27], v[216:219], a[104:107], v[24:27]
    buffer_load_dwordx4 a[176:179], v239, s[28:31], s55 offen offset:0 sc1
    v_mfma_f32_16x16x32_bf16 v[24:27], v[220:223], a[108:111], v[24:27]
    v_mfma_f32_16x16x32_bf16 v[28:31], v[208:211], a[112:115], 0
    v_mfma_f32_16x16x32_bf16 v[28:31], v[212:215], a[116:119], v[28:31]
    v_mfma_f32_16x16x32_bf16 v[28:31], v[216:219], a[120:123], v[28:31]
    buffer_load_dwordx4 a[180:183], v239, s[28:31], s55 offen offset:512 sc1
    v_mfma_f32_16x16x32_bf16 v[28:31], v[220:223], a[124:127], v[28:31]
    s_waitcnt lgkmcnt(0)
    v_mfma_f32_16x16x32_bf16 v[32:35], v[192:195], a[64:67], 0
    v_mfma_f32_16x16x32_bf16 v[32:35], v[196:199], a[68:71], v[32:35]
    ds_read_b64_tr_b16 v[208:209], v245 offset:32768
    ds_read_b64_tr_b16 v[210:211], v245 offset:33280
    v_mfma_f32_16x16x32_bf16 v[32:35], v[200:203], a[72:75], v[32:35]
    v_mfma_f32_16x16x32_bf16 v[32:35], v[204:207], a[76:79], v[32:35]
    ds_read_b64_tr_b16 v[212:213], v245 offset:36864
    ds_read_b64_tr_b16 v[214:215], v245 offset:37376
    v_mfma_f32_16x16x32_bf16 v[36:39], v[192:195], a[80:83], 0
    buffer_load_dwordx4 a[184:187], v239, s[28:31], s55 offen offset:1024 sc1
    v_mfma_f32_16x16x32_bf16 v[36:39], v[196:199], a[84:87], v[36:39]
    ds_read_b64_tr_b16 v[216:217], v245 offset:40960
    ds_read_b64_tr_b16 v[218:219], v245 offset:41472
    v_mfma_f32_16x16x32_bf16 v[36:39], v[200:203], a[88:91], v[36:39]
    v_mfma_f32_16x16x32_bf16 v[36:39], v[204:207], a[92:95], v[36:39]
    ds_read_b64_tr_b16 v[220:221], v245 offset:45056
    ds_read_b64_tr_b16 v[222:223], v245 offset:45568
    v_mfma_f32_16x16x32_bf16 v[40:43], v[192:195], a[96:99], 0
    buffer_load_dwordx4 a[188:191], v239, s[28:31], s55 offen offset:1536 sc1
    v_mfma_f32_16x16x32_bf16 v[40:43], v[196:199], a[100:103], v[40:43]
    v_mfma_f32_16x16x32_bf16 v[40:43], v[200:203], a[104:107], v[40:43]
    v_mfma_f32_16x16x32_bf16 v[40:43], v[204:207], a[108:111], v[40:43]
    v_mfma_f32_16x16x32_bf16 v[44:47], v[192:195], a[112:115], 0
    v_mfma_f32_16x16x32_bf16 v[44:47], v[196:199], a[116:119], v[44:47]
    v_mfma_f32_16x16x32_bf16 v[44:47], v[200:203], a[120:123], v[44:47]
    v_mfma_f32_16x16x32_bf16 v[44:47], v[204:207], a[124:127], v[44:47]
    s_waitcnt lgkmcnt(0)
    v_mfma_f32_16x16x32_bf16 v[48:51], v[208:211], a[64:67], 0
    s_waitcnt vmcnt(24)
    s_barrier
    v_mfma_f32_16x16x32_bf16 v[48:51], v[212:215], a[68:71], v[48:51]
    s_mul_i32 s65, s61, 1048576
    ds_read_b64_tr_b16 v[192:193], v242 offset:49152
    ds_read_b64_tr_b16 v[194:195], v242 offset:49664
    v_mfma_f32_16x16x32_bf16 v[48:51], v[216:219], a[72:75], v[48:51]
    s_add_u32 m0, s40, 131072
    v_mfma_f32_16x16x32_bf16 v[48:51], v[220:223], a[76:79], v[48:51]
    s_add_u32 s41, s65, 0
    ds_read_b64_tr_b16 v[196:197], v242 offset:53248
    ds_read_b64_tr_b16 v[198:199], v242 offset:53760
    v_mfma_f32_16x16x32_bf16 v[52:55], v[208:211], a[80:83], 0
    buffer_load_dwordx4 v240, s[16:19], s41 offen lds
    v_mfma_f32_16x16x32_bf16 v[52:55], v[212:215], a[84:87], v[52:55]
    ds_read_b64_tr_b16 v[200:201], v242 offset:57344
    ds_read_b64_tr_b16 v[202:203], v242 offset:57856
    v_mfma_f32_16x16x32_bf16 v[52:55], v[216:219], a[88:91], v[52:55]
    v_mfma_f32_16x16x32_bf16 v[52:55], v[220:223], a[92:95], v[52:55]
    s_add_u32 m0, s40, 135168
    ds_read_b64_tr_b16 v[204:205], v242 offset:61440
    ds_read_b64_tr_b16 v[206:207], v242 offset:61952
    v_mfma_f32_16x16x32_bf16 v[56:59], v[208:211], a[96:99], 0
    s_add_u32 s41, s65, 262144
    v_mfma_f32_16x16x32_bf16 v[56:59], v[212:215], a[100:103], v[56:59]
    buffer_load_dwordx4 v240, s[16:19], s41 offen lds
    v_mfma_f32_16x16x32_bf16 v[56:59], v[216:219], a[104:107], v[56:59]
    v_mfma_f32_16x16x32_bf16 v[56:59], v[220:223], a[108:111], v[56:59]
    v_mfma_f32_16x16x32_bf16 v[60:63], v[208:211], a[112:115], 0
    v_mfma_f32_16x16x32_bf16 v[60:63], v[212:215], a[116:119], v[60:63]
    s_add_u32 m0, s40, 139264
    v_mfma_f32_16x16x32_bf16 v[60:63], v[216:219], a[120:123], v[60:63]
    s_add_u32 s41, s65, 524288
    v_mfma_f32_16x16x32_bf16 v[60:63], v[220:223], a[124:127], v[60:63]
    s_waitcnt lgkmcnt(0)
    v_mfma_f32_16x16x32_bf16 v[64:67], v[192:195], a[64:67], 0
    buffer_load_dwordx4 v240, s[16:19], s41 offen lds
    v_mfma_f32_16x16x32_bf16 v[64:67], v[196:199], a[68:71], v[64:67]
    ds_read_b64_tr_b16 v[208:209], v243 offset:49152
    ds_read_b64_tr_b16 v[210:211], v243 offset:49664
    v_mfma_f32_16x16x32_bf16 v[64:67], v[200:203], a[72:75], v[64:67]
    v_mfma_f32_16x16x32_bf16 v[64:67], v[204:207], a[76:79], v[64:67]
    ds_read_b64_tr_b16 v[212:213], v243 offset:53248
    ds_read_b64_tr_b16 v[214:215], v243 offset:53760
    v_mfma_f32_16x16x32_bf16 v[68:71], v[192:195], a[80:83], 0
    s_add_u32 m0, s40, 143360
    v_mfma_f32_16x16x32_bf16 v[68:71], v[196:199], a[84:87], v[68:71]
    s_add_u32 s41, s65, 786432
    ds_read_b64_tr_b16 v[216:217], v243 offset:57344
    ds_read_b64_tr_b16 v[218:219], v243 offset:57856
    v_mfma_f32_16x16x32_bf16 v[68:71], v[200:203], a[88:91], v[68:71]
    buffer_load_dwordx4 v240, s[16:19], s41 offen lds
    v_mfma_f32_16x16x32_bf16 v[68:71], v[204:207], a[92:95], v[68:71]
    ds_read_b64_tr_b16 v[220:221], v243 offset:61440
    ds_read_b64_tr_b16 v[222:223], v243 offset:61952
    v_mfma_f32_16x16x32_bf16 v[72:75], v[192:195], a[96:99], 0
    s_lshl_b32 s59, s62, 11
    v_mfma_f32_16x16x32_bf16 v[72:75], v[196:199], a[100:103], v[72:75]
    s_add_u32 s55, s59, 0
    v_mfma_f32_16x16x32_bf16 v[72:75], v[200:203], a[104:107], v[72:75]
    buffer_load_dwordx4 a[192:195], v239, s[28:31], s55 offen offset:0 sc1
    v_mfma_f32_16x16x32_bf16 v[72:75], v[204:207], a[108:111], v[72:75]
    v_mfma_f32_16x16x32_bf16 v[76:79], v[192:195], a[112:115], 0
    v_mfma_f32_16x16x32_bf16 v[76:79], v[196:199], a[116:119], v[76:79]
    v_mfma_f32_16x16x32_bf16 v[76:79], v[200:203], a[120:123], v[76:79]
    v_mfma_f32_16x16x32_bf16 v[76:79], v[204:207], a[124:127], v[76:79]
    s_waitcnt lgkmcnt(0)
    v_mfma_f32_16x16x32_bf16 v[80:83], v[208:211], a[64:67], 0
    buffer_load_dwordx4 a[196:199], v239, s[28:31], s55 offen offset:512 sc1
    v_mfma_f32_16x16x32_bf16 v[80:83], v[212:215], a[68:71], v[80:83]
    ds_read_b64_tr_b16 v[192:193], v244 offset:49152
    ds_read_b64_tr_b16 v[194:195], v244 offset:49664
    v_mfma_f32_16x16x32_bf16 v[80:83], v[216:219], a[72:75], v[80:83]
    v_mfma_f32_16x16x32_bf16 v[80:83], v[220:223], a[76:79], v[80:83]
    ds_read_b64_tr_b16 v[196:197], v244 offset:53248
    ds_read_b64_tr_b16 v[198:199], v244 offset:53760
    v_mfma_f32_16x16x32_bf16 v[84:87], v[208:211], a[80:83], 0
    v_mfma_f32_16x16x32_bf16 v[84:87], v[212:215], a[84:87], v[84:87]
    ds_read_b64_tr_b16 v[200:201], v244 offset:57344
    ds_read_b64_tr_b16 v[202:203], v244 offset:57856
    v_mfma_f32_16x16x32_bf16 v[84:87], v[216:219], a[88:91], v[84:87]
    buffer_load_dwordx4 a[200:203], v239, s[28:31], s55 offen offset:1024 sc1
    v_mfma_f32_16x16x32_bf16 v[84:87], v[220:223], a[92:95], v[84:87]
    ds_read_b64_tr_b16 v[204:205], v244 offset:61440
    ds_read_b64_tr_b16 v[206:207], v244 offset:61952
    v_mfma_f32_16x16x32_bf16 v[88:91], v[208:211], a[96:99], 0
    v_mfma_f32_16x16x32_bf16 v[88:91], v[212:215], a[100:103], v[88:91]
    v_mfma_f32_16x16x32_bf16 v[88:91], v[216:219], a[104:107], v[88:91]
    v_mfma_f32_16x16x32_bf16 v[88:91], v[220:223], a[108:111], v[88:91]
    buffer_load_dwordx4 a[204:207], v239, s[28:31], s55 offen offset:1536 sc1
    v_mfma_f32_16x16x32_bf16 v[92:95], v[208:211], a[112:115], 0
    v_mfma_f32_16x16x32_bf16 v[92:95], v[212:215], a[116:119], v[92:95]
    v_mfma_f32_16x16x32_bf16 v[92:95], v[216:219], a[120:123], v[92:95]
    v_mfma_f32_16x16x32_bf16 v[92:95], v[220:223], a[124:127], v[92:95]
    s_waitcnt lgkmcnt(0)
    v_mfma_f32_16x16x32_bf16 v[96:99], v[192:195], a[64:67], 0
    v_mfma_f32_16x16x32_bf16 v[96:99], v[196:199], a[68:71], v[96:99]
    s_add_u32 s55, s59, 20480
    ds_read_b64_tr_b16 v[208:209], v245 offset:49152
    ds_read_b64_tr_b16 v[210:211], v245 offset:49664
    v_mfma_f32_16x16x32_bf16 v[96:99], v[200:203], a[72:75], v[96:99]
    buffer_load_dwordx4 a[208:211], v239, s[28:31], s55 offen offset:0 sc1
    v_mfma_f32_16x16x32_bf16 v[96:99], v[204:207], a[76:79], v[96:99]
    ds_read_b64_tr_b16 v[212:213], v245 offset:53248
    ds_read_b64_tr_b16 v[214:215], v245 offset:53760
    v_mfma_f32_16x16x32_bf16 v[100:103], v[192:195], a[80:83], 0
    v_mfma_f32_16x16x32_bf16 v[100:103], v[196:199], a[84:87], v[100:103]
    ds_read_b64_tr_b16 v[216:217], v245 offset:57344
    ds_read_b64_tr_b16 v[218:219], v245 offset:57856
    v_mfma_f32_16x16x32_bf16 v[100:103], v[200:203], a[88:91], v[100:103]
    v_mfma_f32_16x16x32_bf16 v[100:103], v[204:207], a[92:95], v[100:103]
    ds_read_b64_tr_b16 v[220:221], v245 offset:61440
    ds_read_b64_tr_b16 v[222:223], v245 offset:61952
    v_mfma_f32_16x16x32_bf16 v[104:107], v[192:195], a[96:99], 0
    buffer_load_dwordx4 a[212:215], v239, s[28:31], s55 offen offset:512 sc1
    v_mfma_f32_16x16x32_bf16 v[104:107], v[196:199], a[100:103], v[104:107]
L_padA_0:
    s_cbranch_execz L_padA_1
    v_mfma_f32_16x16x32_bf16 v[104:107], v[200:203], a[104:107], v[104:107]
    v_mfma_f32_16x16x32_bf16 v[104:107], v[204:207], a[108:111], v[104:107]
    v_mfma_f32_16x16x32_bf16 v[108:111], v[192:195], a[112:115], 0
    v_mfma_f32_16x16x32_bf16 v[108:111], v[196:199], a[116:119], v[108:111]
    v_mfma_f32_16x16x32_bf16 v[108:111], v[200:203], a[120:123], v[108:111]
    v_mfma_f32_16x16x32_bf16 v[108:111], v[204:207], a[124:127], v[108:111]
    s_waitcnt lgkmcnt(0)
    v_mfma_f32_16x16x32_bf16 v[112:115], v[208:211], a[64:67], 0
    s_waitcnt vmcnt(30)
    s_barrier
    v_mfma_f32_16x16x32_bf16 v[112:115], v[212:215], a[68:71], v[112:115]
    s_mul_i32 s65, s61, 1048576
    ds_read_b64_tr_b16 v[192:193], v242 offset:0
    ds_read_b64_tr_b16 v[194:195], v242 offset:512
    v_mfma_f32_16x16x32_bf16 v[112:115], v[216:219], a[72:75], v[112:115]
    s_add_u32 m0, s40, 147456
    v_mfma_f32_16x16x32_bf16 v[112:115], v[220:223], a[76:79], v[112:115]
    s_add_u32 s41, s65, 128
    ds_read_b64_tr_b16 v[196:197], v242 offset:4096
    ds_read_b64_tr_b16 v[198:199], v242 offset:4608
    v_mfma_f32_16x16x32_bf16 v[116:119], v[208:211], a[80:83], 0
    buffer_load_dwordx4 v240, s[16:19], s41 offen lds
    v_mfma_f32_16x16x32_bf16 v[116:119], v[212:215], a[84:87], v[116:119]
    ds_read_b64_tr_b16 v[200:201], v242 offset:8192
    ds_read_b64_tr_b16 v[202:203], v242 offset:8704
    v_mfma_f32_16x16x32_bf16 v[116:119], v[216:219], a[88:91], v[116:119]
    v_mfma_f32_16x16x32_bf16 v[116:119], v[220:223], a[92:95], v[116:119]
    s_add_u32 m0, s40, 151552
    ds_read_b64_tr_b16 v[204:205], v242 offset:12288
    ds_read_b64_tr_b16 v[206:207], v242 offset:12800
    v_mfma_f32_16x16x32_bf16 v[120:123], v[208:211], a[96:99], 0
    s_add_u32 s41, s65, 262272
    v_mfma_f32_16x16x32_bf16 v[120:123], v[212:215], a[100:103], v[120:123]
    buffer_load_dwordx4 v240, s[16:19], s41 offen lds
    v_mfma_f32_16x16x32_bf16 v[120:123], v[216:219], a[104:107], v[120:123]
    v_mfma_f32_16x16x32_bf16 v[120:123], v[220:223], a[108:111], v[120:123]
    v_mfma_f32_16x16x32_bf16 v[124:127], v[208:211], a[112:115], 0
    s_add_u32 m0, s40, 155648
    v_mfma_f32_16x16x32_bf16 v[124:127], v[212:215], a[116:119], v[124:127]
    s_add_u32 s41, s65, 524416
    v_mfma_f32_16x16x32_bf16 v[124:127], v[216:219], a[120:123], v[124:127]
    buffer_load_dwordx4 v240, s[16:19], s41 offen lds
    v_mfma_f32_16x16x32_bf16 v[124:127], v[220:223], a[124:127], v[124:127]
    s_waitcnt lgkmcnt(0) vmcnt(13)
    v_mfma_f32_16x16x32_bf16 v[0:3], v[192:195], a[128:131], v[0:3]
    v_mfma_f32_16x16x32_bf16 v[0:3], v[196:199], a[132:135], v[0:3]
    ds_read_b64_tr_b16 v[208:209], v243 offset:0
    ds_read_b64_tr_b16 v[210:211], v243 offset:512
    v_mfma_f32_16x16x32_bf16 v[0:3], v[200:203], a[136:139], v[0:3]
    s_add_u32 m0, s40, 159744
    v_mfma_f32_16x16x32_bf16 v[0:3], v[204:207], a[140:143], v[0:3]
    s_add_u32 s41, s65, 786560
    ds_read_b64_tr_b16 v[212:213], v243 offset:4096
    ds_read_b64_tr_b16 v[214:215], v243 offset:4608
    v_mfma_f32_16x16x32_bf16 v[4:7], v[192:195], a[144:147], v[4:7]
    buffer_load_dwordx4 v240, s[16:19], s41 offen lds
    v_mfma_f32_16x16x32_bf16 v[4:7], v[196:199], a[148:151], v[4:7]
    ds_read_b64_tr_b16 v[216:217], v243 offset:8192
    ds_read_b64_tr_b16 v[218:219], v243 offset:8704
    v_mfma_f32_16x16x32_bf16 v[4:7], v[200:203], a[152:155], v[4:7]
    v_mfma_f32_16x16x32_bf16 v[4:7], v[204:207], a[156:159], v[4:7]
    ds_read_b64_tr_b16 v[220:221], v243 offset:12288
    ds_read_b64_tr_b16 v[222:223], v243 offset:12800
    v_mfma_f32_16x16x32_bf16 v[8:11], v[192:195], a[160:163], v[8:11]
    buffer_load_dwordx4 a[216:219], v239, s[28:31], s55 offen offset:1024 sc1
    v_mfma_f32_16x16x32_bf16 v[8:11], v[196:199], a[164:167], v[8:11]
    v_mfma_f32_16x16x32_bf16 v[8:11], v[200:203], a[168:171], v[8:11]
    v_mfma_f32_16x16x32_bf16 v[8:11], v[204:207], a[172:175], v[8:11]
    v_mfma_f32_16x16x32_bf16 v[12:15], v[192:195], a[176:179], v[12:15]
    v_mfma_f32_16x16x32_bf16 v[12:15], v[196:199], a[180:183], v[12:15]
    buffer_load_dwordx4 a[220:223], v239, s[28:31], s55 offen offset:1536 sc1
    v_mfma_f32_16x16x32_bf16 v[12:15], v[200:203], a[184:187], v[12:15]
    v_mfma_f32_16x16x32_bf16 v[12:15], v[204:207], a[188:191], v[12:15]
    s_waitcnt lgkmcnt(0)
    v_mfma_f32_16x16x32_bf16 v[16:19], v[208:211], a[128:131], v[16:19]
    v_mfma_f32_16x16x32_bf16 v[16:19], v[212:215], a[132:135], v[16:19]
    ds_read_b64_tr_b16 v[192:193], v244 offset:0
    ds_read_b64_tr_b16 v[194:195], v244 offset:512
    v_mfma_f32_16x16x32_bf16 v[16:19], v[216:219], a[136:139], v[16:19]
    v_mfma_f32_16x16x32_bf16 v[16:19], v[220:223], a[140:143], v[16:19]
    s_add_u32 s55, s59, 40960
    ds_read_b64_tr_b16 v[196:197], v244 offset:4096
    ds_read_b64_tr_b16 v[198:199], v244 offset:4608
    v_mfma_f32_16x16x32_bf16 v[20:23], v[208:211], a[144:147], v[20:23]
    buffer_load_dwordx4 a[224:227], v239, s[28:31], s55 offen offset:0 sc1
    v_mfma_f32_16x16x32_bf16 v[20:23], v[212:215], a[148:151], v[20:23]
    ds_read_b64_tr_b16 v[200:201], v244 offset:8192
    ds_read_b64_tr_b16 v[202:203], v244 offset:8704
    v_mfma_f32_16x16x32_bf16 v[20:23], v[216:219], a[152:155], v[20:23]
    v_mfma_f32_16x16x32_bf16 v[20:23], v[220:223], a[156:159], v[20:23]
    ds_read_b64_tr_b16 v[204:205], v244 offset:12288
    ds_read_b64_tr_b16 v[206:207], v244 offset:12800
    v_mfma_f32_16x16x32_bf16 v[24:27], v[208:211], a[160:163], v[24:27]
    buffer_load_dwordx4 a[228:231], v239, s[28:31], s55 offen offset:512 sc1
    v_mfma_f32_16x16x32_bf16 v[24:27], v[212:215], a[164:167], v[24:27]
    v_mfma_f32_16x16x32_bf16 v[24:27], v[216:219], a[168:171], v[24:27]
    v_mfma_f32_16x16x32_bf16 v[24:27], v[220:223], a[172:175], v[24:27]
    v_mfma_f32_16x16x32_bf16 v[28:31], v[208:211], a[176:179], v[28:31]
    v_mfma_f32_16x16x32_bf16 v[28:31], v[212:215], a[180:183], v[28:31]
    buffer_load_dwordx4 a[232:235], v239, s[28:31], s55 offen offset:1024 sc1
    v_mfma_f32_16x16x32_bf16 v[28:31], v[216:219], a[184:187], v[28:31]
    v_mfma_f32_16x16x32_bf16 v[28:31], v[220:223], a[188:191], v[28:31]
    s_waitcnt lgkmcnt(0)
    v_mfma_f32_16x16x32_bf16 v[32:35], v[192:195], a[128:131], v[32:35]
    v_mfma_f32_16x16x32_bf16 v[32:35], v[196:199], a[132:135], v[32:35]
    ds_read_b64_tr_b16 v[208:209], v245 offset:0
    ds_read_b64_tr_b16 v[210:211], v245 offset:512
    v_mfma_f32_16x16x32_bf16 v[32:35], v[200:203], a[136:139], v[32:35]
    buffer_load_dwordx4 a[236:239], v239, s[28:31], s55 offen offset:1536 sc1
    v_mfma_f32_16x16x32_bf16 v[32:35], v[204:207], a[140:143], v[32:35]
    ds_read_b64_tr_b16 v[212:213], v245 offset:4096
    ds_read_b64_tr_b16 v[214:215], v245 offset:4608
    v_mfma_f32_16x16x32_bf16 v[36:39], v[192:195], a[144:147], v[36:39]
    v_mfma_f32_16x16x32_bf16 v[36:39], v[196:199], a[148:151], v[36:39]
    ds_read_b64_tr_b16 v[216:217], v245 offset:8192
    ds_read_b64_tr_b16 v[218:219], v245 offset:8704
    v_mfma_f32_16x16x32_bf16 v[36:39], v[200:203], a[152:155], v[36:39]
    v_mfma_f32_16x16x32_bf16 v[36:39], v[204:207], a[156:159], v[36:39]
    s_add_u32 s55, s59, 61440
    ds_read_b64_tr_b16 v[220:221], v245 offset:12288
    ds_read_b64_tr_b16 v[222:223], v245 offset:12800
    v_mfma_f32_16x16x32_bf16 v[40:43], v[192:195], a[160:163], v[40:43]
    buffer_load_dwordx4 a[240:243], v239, s[28:31], s55 offen offset:0 sc1
    v_mfma_f32_16x16x32_bf16 v[40:43], v[196:199], a[164:167], v[40:43]
    v_mfma_f32_16x16x32_bf16 v[40:43], v[200:203], a[168:171], v[40:43]
    v_mfma_f32_16x16x32_bf16 v[40:43], v[204:207], a[172:175], v[40:43]
    v_mfma_f32_16x16x32_bf16 v[44:47], v[192:195], a[176:179], v[44:47]
    v_mfma_f32_16x16x32_bf16 v[44:47], v[196:199], a[180:183], v[44:47]
    v_mfma_f32_16x16x32_bf16 v[44:47], v[200:203], a[184:187], v[44:47]
    v_mfma_f32_16x16x32_bf16 v[44:47], v[204:207], a[188:191], v[44:47]
    s_waitcnt lgkmcnt(0)
    v_mfma_f32_16x16x32_bf16 v[48:51], v[208:211], a[128:131], v[48:51]
    s_waitcnt vmcnt(29)
    s_barrier
    v_mfma_f32_16x16x32_bf16 v[48:51], v[212:215], a[132:135], v[48:51]
    s_mul_i32 s65, s62, 442368
    ds_read_b64_tr_b16 v[192:193], v242 offset:16384
    ds_read_b64_tr_b16 v[194:195], v242 offset:16896
    v_mfma_f32_16x16x32_bf16 v[48:51], v[216:219], a[136:139], v[48:51]
    s_add_u32 m0, s40, 98304
    v_mfma_f32_16x16x32_bf16 v[48:51], v[220:223], a[140:143], v[48:51]
    s_add_u32 s41, s65, 0
    ds_read_b64_tr_b16 v[196:197], v242 offset:20480
    ds_read_b64_tr_b16 v[198:199], v242 offset:20992
    v_mfma_f32_16x16x32_bf16 v[52:55], v[208:211], a[144:147], v[52:55]
    buffer_load_dwordx4 v241, s[20:23], s41 offen lds
    v_mfma_f32_16x16x32_bf16 v[52:55], v[212:215], a[148:151], v[52:55]
    ds_read_b64_tr_b16 v[200:201], v242 offset:24576
    ds_read_b64_tr_b16 v[202:203], v242 offset:25088
    v_mfma_f32_16x16x32_bf16 v[52:55], v[216:219], a[152:155], v[52:55]
    v_mfma_f32_16x16x32_bf16 v[52:55], v[220:223], a[156:159], v[52:55]
    s_add_u32 m0, s40, 102400
    ds_read_b64_tr_b16 v[204:205], v242 offset:28672
    ds_read_b64_tr_b16 v[206:207], v242 offset:29184
    v_mfma_f32_16x16x32_bf16 v[56:59], v[208:211], a[160:163], v[56:59]
    s_add_u32 s41, s65, 110592
    v_mfma_f32_16x16x32_bf16 v[56:59], v[212:215], a[164:167], v[56:59]
    buffer_load_dwordx4 v241, s[20:23], s41 offen lds
    v_mfma_f32_16x16x32_bf16 v[56:59], v[216:219], a[168:171], v[56:59]
    v_mfma_f32_16x16x32_bf16 v[56:59], v[220:223], a[172:175], v[56:59]
    v_mfma_f32_16x16x32_bf16 v[60:63], v[208:211], a[176:179], v[60:63]
    s_add_u32 m0, s40, 106496
    v_mfma_f32_16x16x32_bf16 v[60:63], v[212:215], a[180:183], v[60:63]
    s_add_u32 s41, s65, 221184
    v_mfma_f32_16x16x32_bf16 v[60:63], v[216:219], a[184:187], v[60:63]
    buffer_load_dwordx4 v241, s[20:23], s41 offen lds
    v_mfma_f32_16x16x32_bf16 v[60:63], v[220:223], a[188:191], v[60:63]
    s_waitcnt lgkmcnt(0)
    v_mfma_f32_16x16x32_bf16 v[64:67], v[192:195], a[128:131], v[64:67]
    v_mfma_f32_16x16x32_bf16 v[64:67], v[196:199], a[132:135], v[64:67]
    ds_read_b64_tr_b16 v[208:209], v243 offset:16384
    ds_read_b64_tr_b16 v[210:211], v243 offset:16896
    v_mfma_f32_16x16x32_bf16 v[64:67], v[200:203], a[136:139], v[64:67]
    s_add_u32 m0, s40, 110592
    v_mfma_f32_16x16x32_bf16 v[64:67], v[204:207], a[140:143], v[64:67]
    s_add_u32 s41, s65, 331776
    ds_read_b64_tr_b16 v[212:213], v243 offset:20480
    ds_read_b64_tr_b16 v[214:215], v243 offset:20992
    v_mfma_f32_16x16x32_bf16 v[68:71], v[192:195], a[144:147], v[68:71]
    buffer_load_dwordx4 v241, s[20:23], s41 offen lds
    v_mfma_f32_16x16x32_bf16 v[68:71], v[196:199], a[148:151], v[68:71]
    ds_read_b64_tr_b16 v[216:217], v243 offset:24576
    ds_read_b64_tr_b16 v[218:219], v243 offset:25088
    v_mfma_f32_16x16x32_bf16 v[68:71], v[200:203], a[152:155], v[68:71]
    v_mfma_f32_16x16x32_bf16 v[68:71], v[204:207], a[156:159], v[68:71]
    ds_read_b64_tr_b16 v[220:221], v243 offset:28672
    ds_read_b64_tr_b16 v[222:223], v243 offset:29184
    v_mfma_f32_16x16x32_bf16 v[72:75], v[192:195], a[160:163], v[72:75]
    buffer_load_dwordx4 a[244:247], v239, s[28:31], s55 offen offset:512 sc1
    v_mfma_f32_16x16x32_bf16 v[72:75], v[196:199], a[164:167], v[72:75]
    v_mfma_f32_16x16x32_bf16 v[72:75], v[200:203], a[168:171], v[72:75]
    v_mfma_f32_16x16x32_bf16 v[72:75], v[204:207], a[172:175], v[72:75]
    v_mfma_f32_16x16x32_bf16 v[76:79], v[192:195], a[176:179], v[76:79]
    v_mfma_f32_16x16x32_bf16 v[76:79], v[196:199], a[180:183], v[76:79]
    buffer_load_dwordx4 a[248:251], v239, s[28:31], s55 offen offset:1024 sc1
    v_mfma_f32_16x16x32_bf16 v[76:79], v[200:203], a[184:187], v[76:79]
    v_mfma_f32_16x16x32_bf16 v[76:79], v[204:207], a[188:191], v[76:79]
    s_waitcnt lgkmcnt(0)
    v_mfma_f32_16x16x32_bf16 v[80:83], v[208:211], a[128:131], v[80:83]
    v_mfma_f32_16x16x32_bf16 v[80:83], v[212:215], a[132:135], v[80:83]
    ds_read_b64_tr_b16 v[192:193], v244 offset:16384
    ds_read_b64_tr_b16 v[194:195], v244 offset:16896
    v_mfma_f32_16x16x32_bf16 v[80:83], v[216:219], a[136:139], v[80:83]
    v_mfma_f32_16x16x32_bf16 v[80:83], v[220:223], a[140:143], v[80:83]
    ds_read_b64_tr_b16 v[196:197], v244 offset:20480
    ds_read_b64_tr_b16 v[198:199], v244 offset:20992
    v_mfma_f32_16x16x32_bf16 v[84:87], v[208:211], a[144:147], v[84:87]
    buffer_load_dwordx4 a[252:255], v239, s[28:31], s55 offen offset:1536 sc1
    v_mfma_f32_16x16x32_bf16 v[84:87], v[212:215], a[148:151], v[84:87]
    ds_read_b64_tr_b16 v[200:201], v244 offset:24576
    ds_read_b64_tr_b16 v[202:203], v244 offset:25088
    v_mfma_f32_16x16x32_bf16 v[84:87], v[216:219], a[152:155], v[84:87]
    s_lshl_b32 s59, s63, 11
    v_mfma_f32_16x16x32_bf16 v[84:87], v[220:223], a[156:159], v[84:87]
    s_add_u32 s55, s59, 0
    ds_read_b64_tr_b16 v[204:205], v244 offset:28672
    ds_read_b64_tr_b16 v[206:207], v244 offset:29184
    v_mfma_f32_16x16x32_bf16 v[88:91], v[208:211], a[160:163], v[88:91]
    buffer_load_dwordx4 a[64:67], v239, s[28:31], s55 offen offset:0 sc1
    v_mfma_f32_16x16x32_bf16 v[88:91], v[212:215], a[164:167], v[88:91]
    v_mfma_f32_16x16x32_bf16 v[88:91], v[216:219], a[168:171], v[88:91]
    v_mfma_f32_16x16x32_bf16 v[88:91], v[220:223], a[172:175], v[88:91]
    v_mfma_f32_16x16x32_bf16 v[92:95], v[208:211], a[176:179], v[92:95]
    v_mfma_f32_16x16x32_bf16 v[92:95], v[212:215], a[180:183], v[92:95]
    buffer_load_dwordx4 a[68:71], v239, s[28:31], s55 offen offset:512 sc1
    v_mfma_f32_16x16x32_bf16 v[92:95], v[216:219], a[184:187], v[92:95]
    v_mfma_f32_16x16x32_bf16 v[92:95], v[220:223], a[188:191], v[92:95]
    s_waitcnt lgkmcnt(0)
    v_mfma_f32_16x16x32_bf16 v[96:99], v[192:195], a[128:131], v[96:99]
    v_mfma_f32_16x16x32_bf16 v[96:99], v[196:199], a[132:135], v[96:99]
    ds_read_b64_tr_b16 v[208:209], v245 offset:16384
    ds_read_b64_tr_b16 v[210:211], v245 offset:16896
    v_mfma_f32_16x16x32_bf16 v[96:99], v[200:203], a[136:139], v[96:99]
    buffer_load_dwordx4 a[72:75], v239, s[28:31], s55 offen offset:1024 sc1
    v_mfma_f32_16x16x32_bf16 v[96:99], v[204:207], a[140:143], v[96:99]
    ds_read_b64_tr_b16 v[212:213], v245 offset:20480
    ds_read_b64_tr_b16 v[214:215], v245 offset:20992
    v_mfma_f32_16x16x32_bf16 v[100:103], v[192:195], a[144:147], v[100:103]
    v_mfma_f32_16x16x32_bf16 v[100:103], v[196:199], a[148:151], v[100:103]
    ds_read_b64_tr_b16 v[216:217], v245 offset:24576
    ds_read_b64_tr_b16 v[218:219], v245 offset:25088
    v_mfma_f32_16x16x32_bf16 v[100:103], v[200:203], a[152:155], v[100:103]
    v_mfma_f32_16x16x32_bf16 v[100:103], v[204:207], a[156:159], v[100:103]
    ds_read_b64_tr_b16 v[220:221], v245 offset:28672
    ds_read_b64_tr_b16 v[222:223], v245 offset:29184
    v_mfma_f32_16x16x32_bf16 v[104:107], v[192:195], a[160:163], v[104:107]
    buffer_load_dwordx4 a[76:79], v239, s[28:31], s55 offen offset:1536 sc1
    v_mfma_f32_16x16x32_bf16 v[104:107], v[196:199], a[164:167], v[104:107]
    v_mfma_f32_16x16x32_bf16 v[104:107], v[200:203], a[168:171], v[104:107]
    v_mfma_f32_16x16x32_bf16 v[104:107], v[204:207], a[172:175], v[104:107]
    v_mfma_f32_16x16x32_bf16 v[108:111], v[192:195], a[176:179], v[108:111]
    v_mfma_f32_16x16x32_bf16 v[108:111], v[196:199], a[180:183], v[108:111]
    v_mfma_f32_16x16x32_bf16 v[108:111], v[200:203], a[184:187], v[108:111]
    v_mfma_f32_16x16x32_bf16 v[108:111], v[204:207], a[188:191], v[108:111]
    s_waitcnt lgkmcnt(0)
    v_mfma_f32_16x16x32_bf16 v[112:115], v[208:211], a[128:131], v[112:115]
    s_waitcnt vmcnt(28)
    s_barrier
    v_mfma_f32_16x16x32_bf16 v[112:115], v[212:215], a[132:135], v[112:115]
    s_mul_i32 s65, s63, 442368
    ds_read_b64_tr_b16 v[192:193], v242 offset:32768
    ds_read_b64_tr_b16 v[194:195], v242 offset:33280
    v_mfma_f32_16x16x32_bf16 v[112:115], v[216:219], a[136:139], v[112:115]
    s_add_u32 m0, s40, 114688
    v_mfma_f32_16x16x32_bf16 v[112:115], v[220:223], a[140:143], v[112:115]
    s_add_u32 s41, s65, 0
    ds_read_b64_tr_b16 v[196:197], v242 offset:36864
    ds_read_b64_tr_b16 v[198:199], v242 offset:37376
    v_mfma_f32_16x16x32_bf16 v[116:119], v[208:211], a[144:147], v[116:119]
    buffer_load_dwordx4 v241, s[20:23], s41 offen lds
    v_mfma_f32_16x16x32_bf16 v[116:119], v[212:215], a[148:151], v[116:119]
    ds_read_b64_tr_b16 v[200:201], v242 offset:40960
    ds_read_b64_tr_b16 v[202:203], v242 offset:41472
    v_mfma_f32_16x16x32_bf16 v[116:119], v[216:219], a[152:155], v[116:119]
    v_mfma_f32_16x16x32_bf16 v[116:119], v[220:223], a[156:159], v[116:119]
    s_add_u32 m0, s40, 118784
    ds_read_b64_tr_b16 v[204:205], v242 offset:45056
    ds_read_b64_tr_b16 v[206:207], v242 offset:45568
    v_mfma_f32_16x16x32_bf16 v[120:123], v[208:211], a[160:163], v[120:123]
    s_add_u32 s41, s65, 110592
    v_mfma_f32_16x16x32_bf16 v[120:123], v[212:215], a[164:167], v[120:123]
    buffer_load_dwordx4 v241, s[20:23], s41 offen lds
    v_mfma_f32_16x16x32_bf16 v[120:123], v[216:219], a[168:171], v[120:123]
    v_mfma_f32_16x16x32_bf16 v[120:123], v[220:223], a[172:175], v[120:123]
    v_mfma_f32_16x16x32_bf16 v[124:127], v[208:211], a[176:179], v[124:127]
    v_mfma_f32_16x16x32_bf16 v[124:127], v[212:215], a[180:183], v[124:127]
    s_add_u32 m0, s40, 122880
    v_mfma_f32_16x16x32_bf16 v[124:127], v[216:219], a[184:187], v[124:127]
    s_add_u32 s41, s65, 221184
    v_mfma_f32_16x16x32_bf16 v[124:127], v[220:223], a[188:191], v[124:127]
    s_waitcnt lgkmcnt(0)
    v_mfma_f32_16x16x32_bf16 a[0:3], v[192:195], a[128:131], a[0:3]
    buffer_load_dwordx4 v241, s[20:23], s41 offen lds
    v_mfma_f32_16x16x32_bf16 a[0:3], v[196:199], a[132:135], a[0:3]
    ds_read_b64_tr_b16 v[208:209], v243 offset:32768
    ds_read_b64_tr_b16 v[210:211], v243 offset:33280
    v_mfma_f32_16x16x32_bf16 a[0:3], v[200:203], a[136:139], a[0:3]
    v_mfma_f32_16x16x32_bf16 a[0:3], v[204:207], a[140:143], a[0:3]
    ds_read_b64_tr_b16 v[212:213], v243 offset:36864
    ds_read_b64_tr_b16 v[214:215], v243 offset:37376
    v_mfma_f32_16x16x32_bf16 a[4:7], v[192:195], a[144:147], a[4:7]
    s_add_u32 m0, s40, 126976
    v_mfma_f32_16x16x32_bf16 a[4:7], v[196:199], a[148:151], a[4:7]
    s_add_u32 s41, s65, 331776
    ds_read_b64_tr_b16 v[216:217], v243 offset:40960
    ds_read_b64_tr_b16 v[218:219], v243 offset:41472
    v_mfma_f32_16x16x32_bf16 a[4:7], v[200:203], a[152:155], a[4:7]
    buffer_load_dwordx4 v241, s[20:23], s41 offen lds
    v_mfma_f32_16x16x32_bf16 a[4:7], v[204:207], a[156:159], a[4:7]
    ds_read_b64_tr_b16 v[220:221], v243 offset:45056
    ds_read_b64_tr_b16 v[222:223], v243 offset:45568
    v_mfma_f32_16x16x32_bf16 a[8:11], v[192:195], a[160:163], a[8:11]
    v_mfma_f32_16x16x32_bf16 a[8:11], v[196:199], a[164:167], a[8:11]
    s_add_u32 s55, s59, 20480
    v_mfma_f32_16x16x32_bf16 a[8:11], v[200:203], a[168:171], a[8:11]
    buffer_load_dwordx4 a[80:83], v239, s[28:31], s55 offen offset:0 sc1
    v_mfma_f32_16x16x32_bf16 a[8:11], v[204:207], a[172:175], a[8:11]
    v_mfma_f32_16x16x32_bf16 a[12:15], v[192:195], a[176:179], a[12:15]
    v_mfma_f32_16x16x32_bf16 a[12:15], v[196:199], a[180:183], a[12:15]
    v_mfma_f32_16x16x32_bf16 a[12:15], v[200:203], a[184:187], a[12:15]
    v_mfma_f32_16x16x32_bf16 a[12:15], v[204:207], a[188:191], a[12:15]
    s_waitcnt lgkmcnt(0)
    v_mfma_f32_16x16x32_bf16 a[16:19], v[208:211], a[128:131], a[16:19]
    buffer_load_dwordx4 a[84:87], v239, s[28:31], s55 offen offset:512 sc1
    v_mfma_f32_16x16x32_bf16 a[16:19], v[212:215], a[132:135], a[16:19]
    ds_read_b64_tr_b16 v[192:193], v244 offset:32768
    ds_read_b64_tr_b16 v[194:195], v244 offset:33280
    v_mfma_f32_16x16x32_bf16 a[16:19], v[216:219], a[136:139], a[16:19]
    v_mfma_f32_16x16x32_bf16 a[16:19], v[220:223], a[140:143], a[16:19]
    ds_read_b64_tr_b16 v[196:197], v244 offset:36864
    ds_read_b64_tr_b16 v[198:199], v244 offset:37376
    v_mfma_f32_16x16x32_bf16 a[20:23], v[208:211], a[144:147], a[20:23]
    v_mfma_f32_16x16x32_bf16 a[20:23], v[212:215], a[148:151], a[20:23]
    ds_read_b64_tr_b16 v[200:201], v244 offset:40960
    ds_read_b64_tr_b16 v[202:203], v244 offset:41472
    v_mfma_f32_16x16x32_bf16 a[20:23], v[216:219], a[152:155], a[20:23]
    buffer_load_dwordx4 a[88:91], v239, s[28:31], s55 offen offset:1024 sc1
    v_mfma_f32_16x16x32_bf16 a[20:23], v[220:223], a[156:159], a[20:23]
    ds_read_b64_tr_b16 v[204:205], v244 offset:45056
    ds_read_b64_tr_b16 v[206:207], v244 offset:45568
    v_mfma_f32_16x16x32_bf16 a[24:27], v[208:211], a[160:163], a[24:27]
    v_mfma_f32_16x16x32_bf16 a[24:27], v[212:215], a[164:167], a[24:27]
    v_mfma_f32_16x16x32_bf16 a[24:27], v[216:219], a[168:171], a[24:27]
    v_mfma_f32_16x16x32_bf16 a[24:27], v[220:223], a[172:175], a[24:27]
    buffer_load_dwordx4 a[92:95], v239, s[28:31], s55 offen offset:1536 sc1
    v_mfma_f32_16x16x32_bf16 a[28:31], v[208:211], a[176:179], a[28:31]
    v_mfma_f32_16x16x32_bf16 a[28:31], v[212:215], a[180:183], a[28:31]
    v_mfma_f32_16x16x32_bf16 a[28:31], v[216:219], a[184:187], a[28:31]
    v_mfma_f32_16x16x32_bf16 a[28:31], v[220:223], a[188:191], a[28:31]
    s_waitcnt lgkmcnt(0)
    v_mfma_f32_16x16x32_bf16 a[32:35], v[192:195], a[128:131], a[32:35]
    v_mfma_f32_16x16x32_bf16 a[32:35], v[196:199], a[132:135], a[32:35]
    s_add_u32 s55, s59, 40960
    ds_read_b64_tr_b16 v[208:209], v245 offset:32768
    ds_read_b64_tr_b16 v[210:211], v245 offset:33280
    v_mfma_f32_16x16x32_bf16 a[32:35], v[200:203], a[136:139], a[32:35]
    buffer_load_dwordx4 a[96:99], v239, s[28:31], s55 offen offset:0 sc1
    v_mfma_f32_16x16x32_bf16 a[32:35], v[204:207], a[140:143], a[32:35]
    ds_read_b64_tr_b16 v[212:213], v245 offset:36864
    ds_read_b64_tr_b16 v[214:215], v245 offset:37376
    v_mfma_f32_16x16x32_bf16 a[36:39], v[192:195], a[144:147], a[36:39]
    v_mfma_f32_16x16x32_bf16 a[36:39], v[196:199], a[148:151], a[36:39]
    ds_read_b64_tr_b16 v[216:217], v245 offset:40960
    ds_read_b64_tr_b16 v[218:219], v245 offset:41472
    v_mfma_f32_16x16x32_bf16 a[36:39], v[200:203], a[152:155], a[36:39]
    v_mfma_f32_16x16x32_bf16 a[36:39], v[204:207], a[156:159], a[36:39]
    ds_read_b64_tr_b16 v[220:221], v245 offset:45056
    ds_read_b64_tr_b16 v[222:223], v245 offset:45568
    v_mfma_f32_16x16x32_bf16 a[40:43], v[192:195], a[160:163], a[40:43]
    buffer_load_dwordx4 a[100:103], v239, s[28:31], s55 offen offset:512 sc1
    v_mfma_f32_16x16x32_bf16 a[40:43], v[196:199], a[164:167], a[40:43]
    v_mfma_f32_16x16x32_bf16 a[40:43], v[200:203], a[168:171], a[40:43]
    v_mfma_f32_16x16x32_bf16 a[40:43], v[204:207], a[172:175], a[40:43]
    v_mfma_f32_16x16x32_bf16 a[44:47], v[192:195], a[176:179], a[44:47]
    v_mfma_f32_16x16x32_bf16 a[44:47], v[196:199], a[180:183], a[44:47]
    v_mfma_f32_16x16x32_bf16 a[44:47], v[200:203], a[184:187], a[44:47]
    v_mfma_f32_16x16x32_bf16 a[44:47], v[204:207], a[188:191], a[44:47]
    s_waitcnt lgkmcnt(0)
    v_mfma_f32_16x16x32_bf16 a[48:51], v[208:211], a[128:131], a[48:51]
    s_waitcnt vmcnt(28)
    s_barrier
    v_mfma_f32_16x16x32_bf16 a[48:51], v[212:215], a[132:135], a[48:51]
    s_mul_i32 s65, s62, 442368
    ds_read_b64_tr_b16 v[192:193], v242 offset:49152
    ds_read_b64_tr_b16 v[194:195], v242 offset:49664
    v_mfma_f32_16x16x32_bf16 a[48:51], v[216:219], a[136:139], a[48:51]
    s_add_u32 m0, s40, 131072
    v_mfma_f32_16x16x32_bf16 a[48:51], v[220:223], a[140:143], a[48:51]
    s_add_u32 s41, s65, 0
    ds_read_b64_tr_b16 v[196:197], v242 offset:53248
    ds_read_b64_tr_b16 v[198:199], v242 offset:53760
    v_mfma_f32_16x16x32_bf16 a[52:55], v[208:211], a[144:147], a[52:55]
    buffer_load_dwordx4 v241, s[24:27], s41 offen lds
    v_mfma_f32_16x16x32_bf16 a[52:55], v[212:215], a[148:151], a[52:55]
    ds_read_b64_tr_b16 v[200:201], v242 offset:57344
    ds_read_b64_tr_b16 v[202:203], v242 offset:57856
    v_mfma_f32_16x16x32_bf16 a[52:55], v[216:219], a[152:155], a[52:55]
    v_mfma_f32_16x16x32_bf16 a[52:55], v[220:223], a[156:159], a[52:55]
    s_add_u32 m0, s40, 135168
    ds_read_b64_tr_b16 v[204:205], v242 offset:61440
    ds_read_b64_tr_b16 v[206:207], v242 offset:61952
    v_mfma_f32_16x16x32_bf16 a[56:59], v[208:211], a[160:163], a[56:59]
    s_add_u32 s41, s65, 110592
    v_mfma_f32_16x16x32_bf16 a[56:59], v[212:215], a[164:167], a[56:59]
    buffer_load_dwordx4 v241, s[24:27], s41 offen lds
    v_mfma_f32_16x16x32_bf16 a[56:59], v[216:219], a[168:171], a[56:59]
    v_mfma_f32_16x16x32_bf16 a[56:59], v[220:223], a[172:175], a[56:59]
    v_mfma_f32_16x16x32_bf16 a[60:63], v[208:211], a[176:179], a[60:63]
    v_mfma_f32_16x16x32_bf16 a[60:63], v[212:215], a[180:183], a[60:63]
    s_add_u32 m0, s40, 139264
    v_mfma_f32_16x16x32_bf16 a[60:63], v[216:219], a[184:187], a[60:63]
    s_add_u32 s41, s65, 221184
    v_mfma_f32_16x16x32_bf16 a[60:63], v[220:223], a[188:191], a[60:63]
    s_waitcnt lgkmcnt(0)
    v_mfma_f32_16x16x32_bf16 v[128:131], v[192:195], a[128:131], v[128:131]
    buffer_load_dwordx4 v241, s[24:27], s41 offen lds
    v_mfma_f32_16x16x32_bf16 v[128:131], v[196:199], a[132:135], v[128:131]
    ds_read_b64_tr_b16 v[208:209], v243 offset:49152
    ds_read_b64_tr_b16 v[210:211], v243 offset:49664
    v_mfma_f32_16x16x32_bf16 v[128:131], v[200:203], a[136:139], v[128:131]
    v_mfma_f32_16x16x32_bf16 v[128:131], v[204:207], a[140:143], v[128:131]
    ds_read_b64_tr_b16 v[212:213], v243 offset:53248
    ds_read_b64_tr_b16 v[214:215], v243 offset:53760
    v_mfma_f32_16x16x32_bf16 v[132:135], v[192:195], a[144:147], v[132:135]
    s_add_u32 m0, s40, 143360
    v_mfma_f32_16x16x32_bf16 v[132:135], v[196:199], a[148:151], v[132:135]
    s_add_u32 s41, s65, 331776
    ds_read_b64_tr_b16 v[216:217], v243 offset:57344
    ds_read_b64_tr_b16 v[218:219], v243 offset:57856
    v_mfma_f32_16x16x32_bf16 v[132:135], v[200:203], a[152:155], v[132:135]
    buffer_load_dwordx4 v241, s[24:27], s41 offen lds
    v_mfma_f32_16x16x32_bf16 v[132:135], v[204:207], a[156:159], v[132:135]
    ds_read_b64_tr_b16 v[220:221], v243 offset:61440
    ds_read_b64_tr_b16 v[222:223], v243 offset:61952
    v_mfma_f32_16x16x32_bf16 v[136:139], v[192:195], a[160:163], v[136:139]
    v_mfma_f32_16x16x32_bf16 v[136:139], v[196:199], a[164:167], v[136:139]
    v_mfma_f32_16x16x32_bf16 v[136:139], v[200:203], a[168:171], v[136:139]
    buffer_load_dwordx4 a[104:107], v239, s[28:31], s55 offen offset:1024 sc1
    v_mfma_f32_16x16x32_bf16 v[136:139], v[204:207], a[172:175], v[136:139]
    v_mfma_f32_16x16x32_bf16 v[140:143], v[192:195], a[176:179], v[140:143]
    v_mfma_f32_16x16x32_bf16 v[140:143], v[196:199], a[180:183], v[140:143]
    v_mfma_f32_16x16x32_bf16 v[140:143], v[200:203], a[184:187], v[140:143]
    v_mfma_f32_16x16x32_bf16 v[140:143], v[204:207], a[188:191], v[140:143]
    s_waitcnt lgkmcnt(0)
    v_mfma_f32_16x16x32_bf16 v[144:147], v[208:211], a[128:131], v[144:147]
    buffer_load_dwordx4 a[108:111], v239, s[28:31], s55 offen offset:1536 sc1
    v_mfma_f32_16x16x32_bf16 v[144:147], v[212:215], a[132:135], v[144:147]
    ds_read_b64_tr_b16 v[192:193], v244 offset:49152
    ds_read_b64_tr_b16 v[194:195], v244 offset:49664
    v_mfma_f32_16x16x32_bf16 v[144:147], v[216:219], a[136:139], v[144:147]
    v_mfma_f32_16x16x32_bf16 v[144:147], v[220:223], a[140:143], v[144:147]
    ds_read_b64_tr_b16 v[196:197], v244 offset:53248
    ds_read_b64_tr_b16 v[198:199], v244 offset:53760
    v_mfma_f32_16x16x32_bf16 v[148:151], v[208:211], a[144:147], v[148:151]
    v_mfma_f32_16x16x32_bf16 v[148:151], v[212:215], a[148:151], v[148:151]
    s_add_u32 s55, s59, 61440
    ds_read_b64_tr_b16 v[200:201], v244 offset:57344
    ds_read_b64_tr_b16 v[202:203], v244 offset:57856
    v_mfma_f32_16x16x32_bf16 v[148:151], v[216:219], a[152:155], v[148:151]
    buffer_load_dwordx4 a[112:115], v239, s[28:31], s55 offen offset:0 sc1
    v_mfma_f32_16x16x32_bf16 v[148:151], v[220:223], a[156:159], v[148:151]
    ds_read_b64_tr_b16 v[204:205], v244 offset:61440
    ds_read_b64_tr_b16 v[206:207], v244 offset:61952
    v_mfma_f32_16x16x32_bf16 v[152:155], v[208:211], a[160:163], v[152:155]
    v_mfma_f32_16x16x32_bf16 v[152:155], v[212:215], a[164:167], v[152:155]
    v_mfma_f32_16x16x32_bf16 v[152:155], v[216:219], a[168:171], v[152:155]
    v_mfma_f32_16x16x32_bf16 v[152:155], v[220:223], a[172:175], v[152:155]
    buffer_load_dwordx4 a[116:119], v239, s[28:31], s55 offen offset:512 sc1
    v_mfma_f32_16x16x32_bf16 v[156:159], v[208:211], a[176:179], v[156:159]
    v_mfma_f32_16x16x32_bf16 v[156:159], v[212:215], a[180:183], v[156:159]
    v_mfma_f32_16x16x32_bf16 v[156:159], v[216:219], a[184:187], v[156:159]
    v_mfma_f32_16x16x32_bf16 v[156:159], v[220:223], a[188:191], v[156:159]
    s_waitcnt lgkmcnt(0)
    v_mfma_f32_16x16x32_bf16 v[160:163], v[192:195], a[128:131], v[160:163]
    v_mfma_f32_16x16x32_bf16 v[160:163], v[196:199], a[132:135], v[160:163]
    ds_read_b64_tr_b16 v[208:209], v245 offset:49152
    ds_read_b64_tr_b16 v[210:211], v245 offset:49664
    v_mfma_f32_16x16x32_bf16 v[160:163], v[200:203], a[136:139], v[160:163]
    buffer_load_dwordx4 a[120:123], v239, s[28:31], s55 offen offset:1024 sc1
    v_mfma_f32_16x16x32_bf16 v[160:163], v[204:207], a[140:143], v[160:163]
    ds_read_b64_tr_b16 v[212:213], v245 offset:53248
    ds_read_b64_tr_b16 v[214:215], v245 offset:53760
    v_mfma_f32_16x16x32_bf16 v[164:167], v[192:195], a[144:147], v[164:167]
    v_mfma_f32_16x16x32_bf16 v[164:167], v[196:199], a[148:151], v[164:167]
    ds_read_b64_tr_b16 v[216:217], v245 offset:57344
    ds_read_b64_tr_b16 v[218:219], v245 offset:57856
    v_mfma_f32_16x16x32_bf16 v[164:167], v[200:203], a[152:155], v[164:167]
    v_mfma_f32_16x16x32_bf16 v[164:167], v[204:207], a[156:159], v[164:167]
    ds_read_b64_tr_b16 v[220:221], v245 offset:61440
    ds_read_b64_tr_b16 v[222:223], v245 offset:61952
    v_mfma_f32_16x16x32_bf16 v[168:171], v[192:195], a[160:163], v[168:171]
    buffer_load_dwordx4 a[124:127], v239, s[28:31], s55 offen offset:1536 sc1
    v_mfma_f32_16x16x32_bf16 v[168:171], v[196:199], a[164:167], v[168:171]
    v_mfma_f32_16x16x32_bf16 v[168:171], v[200:203], a[168:171], v[168:171]
    v_mfma_f32_16x16x32_bf16 v[168:171], v[204:207], a[172:175], v[168:171]
    v_mfma_f32_16x16x32_bf16 v[172:175], v[192:195], a[176:179], v[172:175]
    v_mfma_f32_16x16x32_bf16 v[172:175], v[196:199], a[180:183], v[172:175]
    v_mfma_f32_16x16x32_bf16 v[172:175], v[200:203], a[184:187], v[172:175]
    v_mfma_f32_16x16x32_bf16 v[172:175], v[204:207], a[188:191], v[172:175]
    s_waitcnt lgkmcnt(0)
    v_mfma_f32_16x16x32_bf16 v[176:179], v[208:211], a[128:131], v[176:179]
    s_waitcnt vmcnt(27)
    s_barrier
    v_mfma_f32_16x16x32_bf16 v[176:179], v[212:215], a[132:135], v[176:179]
    s_mul_i32 s65, s64, 442368
    ds_read_b64_tr_b16 v[192:193], v242 offset:0
    ds_read_b64_tr_b16 v[194:195], v242 offset:512
    v_mfma_f32_16x16x32_bf16 v[176:179], v[216:219], a[136:139], v[176:179]
    s_add_u32 m0, s40, 147456
    v_mfma_f32_16x16x32_bf16 v[176:179], v[220:223], a[140:143], v[176:179]
    s_add_u32 s41, s65, 0
    ds_read_b64_tr_b16 v[196:197], v242 offset:4096
    ds_read_b64_tr_b16 v[198:199], v242 offset:4608
    v_mfma_f32_16x16x32_bf16 v[180:183], v[208:211], a[144:147], v[180:183]
    buffer_load_dwordx4 v241, s[20:23], s41 offen lds
    v_mfma_f32_16x16x32_bf16 v[180:183], v[212:215], a[148:151], v[180:183]
    ds_read_b64_tr_b16 v[200:201], v242 offset:8192
    ds_read_b64_tr_b16 v[202:203], v242 offset:8704
    v_mfma_f32_16x16x32_bf16 v[180:183], v[216:219], a[152:155], v[180:183]
    s_add_u32 m0, s40, 151552
    v_mfma_f32_16x16x32_bf16 v[180:183], v[220:223], a[156:159], v[180:183]
    s_add_u32 s41, s65, 110592
    ds_read_b64_tr_b16 v[204:205], v242 offset:12288
    ds_read_b64_tr_b16 v[206:207], v242 offset:12800
    v_mfma_f32_16x16x32_bf16 v[184:187], v[208:211], a[160:163], v[184:187]
    buffer_load_dwordx4 v241, s[20:23], s41 offen lds
    v_mfma_f32_16x16x32_bf16 v[184:187], v[212:215], a[164:167], v[184:187]
L_padA_1:
    s_cbranch_execz L_padA_2
    v_mfma_f32_16x16x32_bf16 v[184:187], v[216:219], a[168:171], v[184:187]
    v_mfma_f32_16x16x32_bf16 v[184:187], v[220:223], a[172:175], v[184:187]
    s_add_u32 m0, s40, 155648
    v_mfma_f32_16x16x32_bf16 v[188:191], v[208:211], a[176:179], v[188:191]
    s_add_u32 s41, s65, 221184
    v_mfma_f32_16x16x32_bf16 v[188:191], v[212:215], a[180:183], v[188:191]
    buffer_load_dwordx4 v241, s[20:23], s41 offen lds
    v_mfma_f32_16x16x32_bf16 v[188:191], v[216:219], a[184:187], v[188:191]
    v_mfma_f32_16x16x32_bf16 v[188:191], v[220:223], a[188:191], v[188:191]
    s_waitcnt lgkmcnt(0) vmcnt(27)
    v_mfma_f32_16x16x32_bf16 v[0:3], v[192:195], a[192:195], v[0:3]
    s_add_u32 m0, s40, 159744
    v_mfma_f32_16x16x32_bf16 v[0:3], v[196:199], a[196:199], v[0:3]
    s_add_u32 s41, s65, 331776
    ds_read_b64_tr_b16 v[208:209], v243 offset:0
    ds_read_b64_tr_b16 v[210:211], v243 offset:512
    v_mfma_f32_16x16x32_bf16 v[0:3], v[200:203], a[200:203], v[0:3]
    buffer_load_dwordx4 v241, s[20:23], s41 offen lds
    v_mfma_f32_16x16x32_bf16 v[0:3], v[204:207], a[204:207], v[0:3]
    ds_read_b64_tr_b16 v[212:213], v243 offset:4096
    ds_read_b64_tr_b16 v[214:215], v243 offset:4608
    v_mfma_f32_16x16x32_bf16 v[4:7], v[192:195], a[208:211], v[4:7]
    v_mfma_f32_16x16x32_bf16 v[4:7], v[196:199], a[212:215], v[4:7]
    ds_read_b64_tr_b16 v[216:217], v243 offset:8192
    ds_read_b64_tr_b16 v[218:219], v243 offset:8704
    v_mfma_f32_16x16x32_bf16 v[4:7], v[200:203], a[216:219], v[4:7]
    s_lshl_b32 s59, s64, 11
    v_mfma_f32_16x16x32_bf16 v[4:7], v[204:207], a[220:223], v[4:7]
    s_add_u32 s55, s59, 0
    ds_read_b64_tr_b16 v[220:221], v243 offset:12288
    ds_read_b64_tr_b16 v[222:223], v243 offset:12800
    v_mfma_f32_16x16x32_bf16 v[8:11], v[192:195], a[224:227], v[8:11]
    buffer_load_dwordx4 a[128:131], v239, s[28:31], s55 offen offset:0 sc1
    v_mfma_f32_16x16x32_bf16 v[8:11], v[196:199], a[228:231], v[8:11]
    v_mfma_f32_16x16x32_bf16 v[8:11], v[200:203], a[232:235], v[8:11]
    v_mfma_f32_16x16x32_bf16 v[8:11], v[204:207], a[236:239], v[8:11]
    buffer_load_dwordx4 a[132:135], v239, s[28:31], s55 offen offset:512 sc1
    v_mfma_f32_16x16x32_bf16 v[12:15], v[192:195], a[240:243], v[12:15]
    v_mfma_f32_16x16x32_bf16 v[12:15], v[196:199], a[244:247], v[12:15]
    v_mfma_f32_16x16x32_bf16 v[12:15], v[200:203], a[248:251], v[12:15]
    v_mfma_f32_16x16x32_bf16 v[12:15], v[204:207], a[252:255], v[12:15]
    s_waitcnt lgkmcnt(0)
    v_mfma_f32_16x16x32_bf16 v[16:19], v[208:211], a[192:195], v[16:19]
    buffer_load_dwordx4 a[136:139], v239, s[28:31], s55 offen offset:1024 sc1
    v_mfma_f32_16x16x32_bf16 v[16:19], v[212:215], a[196:199], v[16:19]
    ds_read_b64_tr_b16 v[192:193], v244 offset:0
    ds_read_b64_tr_b16 v[194:195], v244 offset:512
    v_mfma_f32_16x16x32_bf16 v[16:19], v[216:219], a[200:203], v[16:19]
    v_mfma_f32_16x16x32_bf16 v[16:19], v[220:223], a[204:207], v[16:19]
    ds_read_b64_tr_b16 v[196:197], v244 offset:4096
    ds_read_b64_tr_b16 v[198:199], v244 offset:4608
    v_mfma_f32_16x16x32_bf16 v[20:23], v[208:211], a[208:211], v[20:23]
    v_mfma_f32_16x16x32_bf16 v[20:23], v[212:215], a[212:215], v[20:23]
    ds_read_b64_tr_b16 v[200:201], v244 offset:8192
    ds_read_b64_tr_b16 v[202:203], v244 offset:8704
    v_mfma_f32_16x16x32_bf16 v[20:23], v[216:219], a[216:219], v[20:23]
    buffer_load_dwordx4 a[140:143], v239, s[28:31], s55 offen offset:1536 sc1
    v_mfma_f32_16x16x32_bf16 v[20:23], v[220:223], a[220:223], v[20:23]
    ds_read_b64_tr_b16 v[204:205], v244 offset:12288
    ds_read_b64_tr_b16 v[206:207], v244 offset:12800
    v_mfma_f32_16x16x32_bf16 v[24:27], v[208:211], a[224:227], v[24:27]
    v_mfma_f32_16x16x32_bf16 v[24:27], v[212:215], a[228:231], v[24:27]
    s_add_u32 s55, s59, 20480
    v_mfma_f32_16x16x32_bf16 v[24:27], v[216:219], a[232:235], v[24:27]
    buffer_load_dwordx4 a[144:147], v239, s[28:31], s55 offen offset:0 sc1
    v_mfma_f32_16x16x32_bf16 v[24:27], v[220:223], a[236:239], v[24:27]
    v_mfma_f32_16x16x32_bf16 v[28:31], v[208:211], a[240:243], v[28:31]
    v_mfma_f32_16x16x32_bf16 v[28:31], v[212:215], a[244:247], v[28:31]
    v_mfma_f32_16x16x32_bf16 v[28:31], v[216:219], a[248:251], v[28:31]
    buffer_load_dwordx4 a[148:151], v239, s[28:31], s55 offen offset:512 sc1
    v_mfma_f32_16x16x32_bf16 v[28:31], v[220:223], a[252:255], v[28:31]
    s_waitcnt lgkmcnt(0)
    v_mfma_f32_16x16x32_bf16 v[32:35], v[192:195], a[192:195], v[32:35]
    v_mfma_f32_16x16x32_bf16 v[32:35], v[196:199], a[196:199], v[32:35]
    ds_read_b64_tr_b16 v[208:209], v245 offset:0
    ds_read_b64_tr_b16 v[210:211], v245 offset:512
    v_mfma_f32_16x16x32_bf16 v[32:35], v[200:203], a[200:203], v[32:35]
    v_mfma_f32_16x16x32_bf16 v[32:35], v[204:207], a[204:207], v[32:35]
    ds_read_b64_tr_b16 v[212:213], v245 offset:4096
    ds_read_b64_tr_b16 v[214:215], v245 offset:4608
    v_mfma_f32_16x16x32_bf16 v[36:39], v[192:195], a[208:211], v[36:39]
    buffer_load_dwordx4 a[152:155], v239, s[28:31], s55 offen offset:1024 sc1
    v_mfma_f32_16x16x32_bf16 v[36:39], v[196:199], a[212:215], v[36:39]
    ds_read_b64_tr_b16 v[216:217], v245 offset:8192
    ds_read_b64_tr_b16 v[218:219], v245 offset:8704
    v_mfma_f32_16x16x32_bf16 v[36:39], v[200:203], a[216:219], v[36:39]
    v_mfma_f32_16x16x32_bf16 v[36:39], v[204:207], a[220:223], v[36:39]
    ds_read_b64_tr_b16 v[220:221], v245 offset:12288
    ds_read_b64_tr_b16 v[222:223], v245 offset:12800
    v_mfma_f32_16x16x32_bf16 v[40:43], v[192:195], a[224:227], v[40:43]
    buffer_load_dwordx4 a[156:159], v239, s[28:31], s55 offen offset:1536 sc1
    v_mfma_f32_16x16x32_bf16 v[40:43], v[196:199], a[228:231], v[40:43]
    v_mfma_f32_16x16x32_bf16 v[40:43], v[200:203], a[232:235], v[40:43]
    v_mfma_f32_16x16x32_bf16 v[40:43], v[204:207], a[236:239], v[40:43]
    v_mfma_f32_16x16x32_bf16 v[44:47], v[192:195], a[240:243], v[44:47]
    v_mfma_f32_16x16x32_bf16 v[44:47], v[196:199], a[244:247], v[44:47]
    v_mfma_f32_16x16x32_bf16 v[44:47], v[200:203], a[248:251], v[44:47]
    v_mfma_f32_16x16x32_bf16 v[44:47], v[204:207], a[252:255], v[44:47]
    s_waitcnt lgkmcnt(0)
    v_mfma_f32_16x16x32_bf16 v[48:51], v[208:211], a[192:195], v[48:51]
    s_waitcnt vmcnt(28)
    s_barrier
    v_mfma_f32_16x16x32_bf16 v[48:51], v[212:215], a[196:199], v[48:51]
    s_mul_i32 s65, s63, 442368
    ds_read_b64_tr_b16 v[192:193], v242 offset:16384
    ds_read_b64_tr_b16 v[194:195], v242 offset:16896
    v_mfma_f32_16x16x32_bf16 v[48:51], v[216:219], a[200:203], v[48:51]
    s_add_u32 m0, s40, 98304
    v_mfma_f32_16x16x32_bf16 v[48:51], v[220:223], a[204:207], v[48:51]
    s_add_u32 s41, s65, 0
    ds_read_b64_tr_b16 v[196:197], v242 offset:20480
    ds_read_b64_tr_b16 v[198:199], v242 offset:20992
    v_mfma_f32_16x16x32_bf16 v[52:55], v[208:211], a[208:211], v[52:55]
    buffer_load_dwordx4 v241, s[24:27], s41 offen lds
    v_mfma_f32_16x16x32_bf16 v[52:55], v[212:215], a[212:215], v[52:55]
    ds_read_b64_tr_b16 v[200:201], v242 offset:24576
    ds_read_b64_tr_b16 v[202:203], v242 offset:25088
    v_mfma_f32_16x16x32_bf16 v[52:55], v[216:219], a[216:219], v[52:55]
    s_add_u32 m0, s40, 102400
    v_mfma_f32_16x16x32_bf16 v[52:55], v[220:223], a[220:223], v[52:55]
    s_add_u32 s41, s65, 110592
    ds_read_b64_tr_b16 v[204:205], v242 offset:28672
    ds_read_b64_tr_b16 v[206:207], v242 offset:29184
    v_mfma_f32_16x16x32_bf16 v[56:59], v[208:211], a[224:227], v[56:59]
    buffer_load_dwordx4 v241, s[24:27], s41 offen lds
    v_mfma_f32_16x16x32_bf16 v[56:59], v[212:215], a[228:231], v[56:59]
    v_mfma_f32_16x16x32_bf16 v[56:59], v[216:219], a[232:235], v[56:59]
    v_mfma_f32_16x16x32_bf16 v[56:59], v[220:223], a[236:239], v[56:59]
    s_add_u32 m0, s40, 106496
    v_mfma_f32_16x16x32_bf16 v[60:63], v[208:211], a[240:243], v[60:63]
    s_add_u32 s41, s65, 221184
    v_mfma_f32_16x16x32_bf16 v[60:63], v[212:215], a[244:247], v[60:63]
    buffer_load_dwordx4 v241, s[24:27], s41 offen lds
    v_mfma_f32_16x16x32_bf16 v[60:63], v[216:219], a[248:251], v[60:63]
    v_mfma_f32_16x16x32_bf16 v[60:63], v[220:223], a[252:255], v[60:63]
    s_waitcnt lgkmcnt(0) vmcnt(15)
    v_mfma_f32_16x16x32_bf16 v[0:3], v[192:195], a[64:67], v[0:3]
    s_add_u32 m0, s40, 110592
    v_mfma_f32_16x16x32_bf16 v[0:3], v[196:199], a[68:71], v[0:3]
    s_add_u32 s41, s65, 331776
    ds_read_b64_tr_b16 v[208:209], v243 offset:16384
    ds_read_b64_tr_b16 v[210:211], v243 offset:16896
    v_mfma_f32_16x16x32_bf16 v[0:3], v[200:203], a[72:75], v[0:3]
    buffer_load_dwordx4 v241, s[24:27], s41 offen lds
    v_mfma_f32_16x16x32_bf16 v[0:3], v[204:207], a[76:79], v[0:3]
    ds_read_b64_tr_b16 v[212:213], v243 offset:20480
    ds_read_b64_tr_b16 v[214:215], v243 offset:20992
    v_mfma_f32_16x16x32_bf16 v[4:7], v[192:195], a[80:83], v[4:7]
    v_mfma_f32_16x16x32_bf16 v[4:7], v[196:199], a[84:87], v[4:7]
    ds_read_b64_tr_b16 v[216:217], v243 offset:24576
    ds_read_b64_tr_b16 v[218:219], v243 offset:25088
    v_mfma_f32_16x16x32_bf16 v[4:7], v[200:203], a[88:91], v[4:7]
    v_mfma_f32_16x16x32_bf16 v[4:7], v[204:207], a[92:95], v[4:7]
    s_add_u32 s55, s59, 40960
    ds_read_b64_tr_b16 v[220:221], v243 offset:28672
    ds_read_b64_tr_b16 v[222:223], v243 offset:29184
    v_mfma_f32_16x16x32_bf16 v[8:11], v[192:195], a[96:99], v[8:11]
    buffer_load_dwordx4 a[160:163], v239, s[28:31], s55 offen offset:0 sc1
    v_mfma_f32_16x16x32_bf16 v[8:11], v[196:199], a[100:103], v[8:11]
    v_mfma_f32_16x16x32_bf16 v[8:11], v[200:203], a[104:107], v[8:11]
    v_mfma_f32_16x16x32_bf16 v[8:11], v[204:207], a[108:111], v[8:11]
    buffer_load_dwordx4 a[164:167], v239, s[28:31], s55 offen offset:512 sc1
    v_mfma_f32_16x16x32_bf16 v[12:15], v[192:195], a[112:115], v[12:15]
    v_mfma_f32_16x16x32_bf16 v[12:15], v[196:199], a[116:119], v[12:15]
    v_mfma_f32_16x16x32_bf16 v[12:15], v[200:203], a[120:123], v[12:15]
    v_mfma_f32_16x16x32_bf16 v[12:15], v[204:207], a[124:127], v[12:15]
    s_waitcnt lgkmcnt(0)
    v_mfma_f32_16x16x32_bf16 v[16:19], v[208:211], a[64:67], v[16:19]
    buffer_load_dwordx4 a[168:171], v239, s[28:31], s55 offen offset:1024 sc1
    v_mfma_f32_16x16x32_bf16 v[16:19], v[212:215], a[68:71], v[16:19]
    ds_read_b64_tr_b16 v[192:193], v244 offset:16384
    ds_read_b64_tr_b16 v[194:195], v244 offset:16896
    v_mfma_f32_16x16x32_bf16 v[16:19], v[216:219], a[72:75], v[16:19]
    v_mfma_f32_16x16x32_bf16 v[16:19], v[220:223], a[76:79], v[16:19]
    ds_read_b64_tr_b16 v[196:197], v244 offset:20480
    ds_read_b64_tr_b16 v[198:199], v244 offset:20992
    v_mfma_f32_16x16x32_bf16 v[20:23], v[208:211], a[80:83], v[20:23]
    v_mfma_f32_16x16x32_bf16 v[20:23], v[212:215], a[84:87], v[20:23]
    ds_read_b64_tr_b16 v[200:201], v244 offset:24576
    ds_read_b64_tr_b16 v[202:203], v244 offset:25088
    v_mfma_f32_16x16x32_bf16 v[20:23], v[216:219], a[88:91], v[20:23]
    buffer_load_dwordx4 a[172:175], v239, s[28:31], s55 offen offset:1536 sc1
    v_mfma_f32_16x16x32_bf16 v[20:23], v[220:223], a[92:95], v[20:23]
    ds_read_b64_tr_b16 v[204:205], v244 offset:28672
    ds_read_b64_tr_b16 v[206:207], v244 offset:29184
    v_mfma_f32_16x16x32_bf16 v[24:27], v[208:211], a[96:99], v[24:27]
    v_mfma_f32_16x16x32_bf16 v[24:27], v[212:215], a[100:103], v[24:27]
    s_add_u32 s55, s59, 61440
    v_mfma_f32_16x16x32_bf16 v[24:27], v[216:219], a[104:107], v[24:27]
    buffer_load_dwordx4 a[176:179], v239, s[28:31], s55 offen offset:0 sc1
    v_mfma_f32_16x16x32_bf16 v[24:27], v[220:223], a[108:111], v[24:27]
    v_mfma_f32_16x16x32_bf16 v[28:31], v[208:211], a[112:115], v[28:31]
    v_mfma_f32_16x16x32_bf16 v[28:31], v[212:215], a[116:119], v[28:31]
    v_mfma_f32_16x16x32_bf16 v[28:31], v[216:219], a[120:123], v[28:31]
    buffer_load_dwordx4 a[180:183], v239, s[28:31], s55 offen offset:512 sc1
    v_mfma_f32_16x16x32_bf16 v[28:31], v[220:223], a[124:127], v[28:31]
    s_waitcnt lgkmcnt(0)
    v_mfma_f32_16x16x32_bf16 v[32:35], v[192:195], a[64:67], v[32:35]
    v_mfma_f32_16x16x32_bf16 v[32:35], v[196:199], a[68:71], v[32:35]
    ds_read_b64_tr_b16 v[208:209], v245 offset:16384
    ds_read_b64_tr_b16 v[210:211], v245 offset:16896
    v_mfma_f32_16x16x32_bf16 v[32:35], v[200:203], a[72:75], v[32:35]
    v_mfma_f32_16x16x32_bf16 v[32:35], v[204:207], a[76:79], v[32:35]
    ds_read_b64_tr_b16 v[212:213], v245 offset:20480
    ds_read_b64_tr_b16 v[214:215], v245 offset:20992
    v_mfma_f32_16x16x32_bf16 v[36:39], v[192:195], a[80:83], v[36:39]
    buffer_load_dwordx4 a[184:187], v239, s[28:31], s55 offen offset:1024 sc1
    v_mfma_f32_16x16x32_bf16 v[36:39], v[196:199], a[84:87], v[36:39]
    ds_read_b64_tr_b16 v[216:217], v245 offset:24576
    ds_read_b64_tr_b16 v[218:219], v245 offset:25088
    v_mfma_f32_16x16x32_bf16 v[36:39], v[200:203], a[88:91], v[36:39]
    v_mfma_f32_16x16x32_bf16 v[36:39], v[204:207], a[92:95], v[36:39]
    ds_read_b64_tr_b16 v[220:221], v245 offset:28672
    ds_read_b64_tr_b16 v[222:223], v245 offset:29184
    v_mfma_f32_16x16x32_bf16 v[40:43], v[192:195], a[96:99], v[40:43]
    buffer_load_dwordx4 a[188:191], v239, s[28:31], s55 offen offset:1536 sc1
    v_mfma_f32_16x16x32_bf16 v[40:43], v[196:199], a[100:103], v[40:43]
    v_mfma_f32_16x16x32_bf16 v[40:43], v[200:203], a[104:107], v[40:43]
    v_mfma_f32_16x16x32_bf16 v[40:43], v[204:207], a[108:111], v[40:43]
    v_mfma_f32_16x16x32_bf16 v[44:47], v[192:195], a[112:115], v[44:47]
    v_mfma_f32_16x16x32_bf16 v[44:47], v[196:199], a[116:119], v[44:47]
    v_mfma_f32_16x16x32_bf16 v[44:47], v[200:203], a[120:123], v[44:47]
    v_mfma_f32_16x16x32_bf16 v[44:47], v[204:207], a[124:127], v[44:47]
    s_waitcnt lgkmcnt(0)
    v_mfma_f32_16x16x32_bf16 v[48:51], v[208:211], a[64:67], v[48:51]
    s_waitcnt vmcnt(30)
    s_barrier
    v_mfma_f32_16x16x32_bf16 v[48:51], v[212:215], a[68:71], v[48:51]
    s_mul_i32 s65, s64, 442368
    ds_read_b64_tr_b16 v[192:193], v242 offset:32768
    ds_read_b64_tr_b16 v[194:195], v242 offset:33280
    v_mfma_f32_16x16x32_bf16 v[48:51], v[216:219], a[72:75], v[48:51]
    s_add_u32 m0, s40, 114688
    v_mfma_f32_16x16x32_bf16 v[48:51], v[220:223], a[76:79], v[48:51]
    s_add_u32 s41, s65, 0
    ds_read_b64_tr_b16 v[196:197], v242 offset:36864
    ds_read_b64_tr_b16 v[198:199], v242 offset:37376
    v_mfma_f32_16x16x32_bf16 v[52:55], v[208:211], a[80:83], v[52:55]
    buffer_load_dwordx4 v241, s[24:27], s41 offen lds
    v_mfma_f32_16x16x32_bf16 v[52:55], v[212:215], a[84:87], v[52:55]
    ds_read_b64_tr_b16 v[200:201], v242 offset:40960
    ds_read_b64_tr_b16 v[202:203], v242 offset:41472
    v_mfma_f32_16x16x32_bf16 v[52:55], v[216:219], a[88:91], v[52:55]
    v_mfma_f32_16x16x32_bf16 v[52:55], v[220:223], a[92:95], v[52:55]
    ds_read_b64_tr_b16 v[204:205], v242 offset:45056
    ds_read_b64_tr_b16 v[206:207], v242 offset:45568
    v_mfma_f32_16x16x32_bf16 v[56:59], v[208:211], a[96:99], v[56:59]
    s_add_u32 m0, s40, 118784
    v_mfma_f32_16x16x32_bf16 v[56:59], v[212:215], a[100:103], v[56:59]
    s_add_u32 s41, s65, 110592
    v_mfma_f32_16x16x32_bf16 v[56:59], v[216:219], a[104:107], v[56:59]
    buffer_load_dwordx4 v241, s[24:27], s41 offen lds
    v_mfma_f32_16x16x32_bf16 v[56:59], v[220:223], a[108:111], v[56:59]
    v_mfma_f32_16x16x32_bf16 v[60:63], v[208:211], a[112:115], v[60:63]
    v_mfma_f32_16x16x32_bf16 v[60:63], v[212:215], a[116:119], v[60:63]
    s_add_u32 m0, s40, 122880
    v_mfma_f32_16x16x32_bf16 v[60:63], v[216:219], a[120:123], v[60:63]
    s_add_u32 s41, s65, 221184
    v_mfma_f32_16x16x32_bf16 v[60:63], v[220:223], a[124:127], v[60:63]
    s_waitcnt lgkmcnt(0)
    v_mfma_f32_16x16x32_bf16 v[64:67], v[192:195], a[192:195], v[64:67]
    buffer_load_dwordx4 v241, s[24:27], s41 offen lds
    v_mfma_f32_16x16x32_bf16 v[64:67], v[196:199], a[196:199], v[64:67]
    ds_read_b64_tr_b16 v[208:209], v243 offset:32768
    ds_read_b64_tr_b16 v[210:211], v243 offset:33280
    v_mfma_f32_16x16x32_bf16 v[64:67], v[200:203], a[200:203], v[64:67]
    v_mfma_f32_16x16x32_bf16 v[64:67], v[204:207], a[204:207], v[64:67]
    ds_read_b64_tr_b16 v[212:213], v243 offset:36864
    ds_read_b64_tr_b16 v[214:215], v243 offset:37376
    v_mfma_f32_16x16x32_bf16 v[68:71], v[192:195], a[208:211], v[68:71]
    s_add_u32 m0, s40, 126976
    v_mfma_f32_16x16x32_bf16 v[68:71], v[196:199], a[212:215], v[68:71]
    s_add_u32 s41, s65, 331776
    ds_read_b64_tr_b16 v[216:217], v243 offset:40960
    ds_read_b64_tr_b16 v[218:219], v243 offset:41472
    v_mfma_f32_16x16x32_bf16 v[68:71], v[200:203], a[216:219], v[68:71]
    buffer_load_dwordx4 v241, s[24:27], s41 offen lds
    v_mfma_f32_16x16x32_bf16 v[68:71], v[204:207], a[220:223], v[68:71]
    ds_read_b64_tr_b16 v[220:221], v243 offset:45056
    ds_read_b64_tr_b16 v[222:223], v243 offset:45568
    v_mfma_f32_16x16x32_bf16 v[72:75], v[192:195], a[224:227], v[72:75]
    v_mfma_f32_16x16x32_bf16 v[72:75], v[196:199], a[228:231], v[72:75]
    v_mfma_f32_16x16x32_bf16 v[72:75], v[200:203], a[232:235], v[72:75]
    v_mfma_f32_16x16x32_bf16 v[72:75], v[204:207], a[236:239], v[72:75]
    s_mov_b32 s41, 0
    v_mfma_f32_16x16x32_bf16 v[76:79], v[192:195], a[240:243], v[76:79]
    buffer_load_dword v254, v252, s[8:11], s41 offen
    v_mfma_f32_16x16x32_bf16 v[76:79], v[196:199], a[244:247], v[76:79]
    v_mfma_f32_16x16x32_bf16 v[76:79], v[200:203], a[248:251], v[76:79]
    v_mfma_f32_16x16x32_bf16 v[76:79], v[204:207], a[252:255], v[76:79]
    s_waitcnt lgkmcnt(0)
    v_mfma_f32_16x16x32_bf16 v[80:83], v[208:211], a[192:195], v[80:83]
    v_mfma_f32_16x16x32_bf16 v[80:83], v[212:215], a[196:199], v[80:83]
    s_mov_b32 s41, 32768
    ds_read_b64_tr_b16 v[192:193], v244 offset:32768
    ds_read_b64_tr_b16 v[194:195], v244 offset:33280
    v_mfma_f32_16x16x32_bf16 v[80:83], v[216:219], a[200:203], v[80:83]
    buffer_load_dword v254, v252, s[8:11], s41 offen
    v_mfma_f32_16x16x32_bf16 v[80:83], v[220:223], a[204:207], v[80:83]
    ds_read_b64_tr_b16 v[196:197], v244 offset:36864
    ds_read_b64_tr_b16 v[198:199], v244 offset:37376
    v_mfma_f32_16x16x32_bf16 v[84:87], v[208:211], a[208:211], v[84:87]
    v_mfma_f32_16x16x32_bf16 v[84:87], v[212:215], a[212:215], v[84:87]
    ds_read_b64_tr_b16 v[200:201], v244 offset:40960
    ds_read_b64_tr_b16 v[202:203], v244 offset:41472
    v_mfma_f32_16x16x32_bf16 v[84:87], v[216:219], a[216:219], v[84:87]
    v_mfma_f32_16x16x32_bf16 v[84:87], v[220:223], a[220:223], v[84:87]
    s_mov_b32 s41, 0
    ds_read_b64_tr_b16 v[204:205], v244 offset:45056
    ds_read_b64_tr_b16 v[206:207], v244 offset:45568
    v_mfma_f32_16x16x32_bf16 v[88:91], v[208:211], a[224:227], v[88:91]
    buffer_load_dword v254, v252, s[12:15], s41 offen
    v_mfma_f32_16x16x32_bf16 v[88:91], v[212:215], a[228:231], v[88:91]
    v_mfma_f32_16x16x32_bf16 v[88:91], v[216:219], a[232:235], v[88:91]
    v_mfma_f32_16x16x32_bf16 v[88:91], v[220:223], a[236:239], v[88:91]
    v_mfma_f32_16x16x32_bf16 v[92:95], v[208:211], a[240:243], v[92:95]
    v_mfma_f32_16x16x32_bf16 v[92:95], v[212:215], a[244:247], v[92:95]
    s_mov_b32 s41, 65536
    v_mfma_f32_16x16x32_bf16 v[92:95], v[216:219], a[248:251], v[92:95]
    buffer_load_dword v254, v252, s[8:11], s41 offen
    v_mfma_f32_16x16x32_bf16 v[92:95], v[220:223], a[252:255], v[92:95]
    s_waitcnt lgkmcnt(0)
    v_mfma_f32_16x16x32_bf16 v[96:99], v[192:195], a[192:195], v[96:99]
    v_mfma_f32_16x16x32_bf16 v[96:99], v[196:199], a[196:199], v[96:99]
    ds_read_b64_tr_b16 v[208:209], v245 offset:32768
    ds_read_b64_tr_b16 v[210:211], v245 offset:33280
    v_mfma_f32_16x16x32_bf16 v[96:99], v[200:203], a[200:203], v[96:99]
    v_mfma_f32_16x16x32_bf16 v[96:99], v[204:207], a[204:207], v[96:99]
    s_mov_b32 s41, 32768
    ds_read_b64_tr_b16 v[212:213], v245 offset:36864
    ds_read_b64_tr_b16 v[214:215], v245 offset:37376
    v_mfma_f32_16x16x32_bf16 v[100:103], v[192:195], a[208:211], v[100:103]
    buffer_load_dword v254, v252, s[12:15], s41 offen
    v_mfma_f32_16x16x32_bf16 v[100:103], v[196:199], a[212:215], v[100:103]
    ds_read_b64_tr_b16 v[216:217], v245 offset:40960
    ds_read_b64_tr_b16 v[218:219], v245 offset:41472
    v_mfma_f32_16x16x32_bf16 v[100:103], v[200:203], a[216:219], v[100:103]
    v_mfma_f32_16x16x32_bf16 v[100:103], v[204:207], a[220:223], v[100:103]
    ds_read_b64_tr_b16 v[220:221], v245 offset:45056
    ds_read_b64_tr_b16 v[222:223], v245 offset:45568
    v_mfma_f32_16x16x32_bf16 v[104:107], v[192:195], a[224:227], v[104:107]
    v_mfma_f32_16x16x32_bf16 v[104:107], v[196:199], a[228:231], v[104:107]
    v_mfma_f32_16x16x32_bf16 v[104:107], v[200:203], a[232:235], v[104:107]
    v_mfma_f32_16x16x32_bf16 v[104:107], v[204:207], a[236:239], v[104:107]
    v_mfma_f32_16x16x32_bf16 v[108:111], v[192:195], a[240:243], v[108:111]
    v_mfma_f32_16x16x32_bf16 v[108:111], v[196:199], a[244:247], v[108:111]
    v_mfma_f32_16x16x32_bf16 v[108:111], v[200:203], a[248:251], v[108:111]
    v_mfma_f32_16x16x32_bf16 v[108:111], v[204:207], a[252:255], v[108:111]
    s_waitcnt lgkmcnt(0)
    v_mfma_f32_16x16x32_bf16 v[112:115], v[208:211], a[192:195], v[112:115]
    s_waitcnt vmcnt(29)
    s_barrier
    v_lshrrev_b32 v248, 4, v238
    v_mfma_f32_16x16x32_bf16 v[112:115], v[212:215], a[196:199], v[112:115]
    ds_read_b64_tr_b16 v[192:193], v242 offset:49152
    ds_read_b64_tr_b16 v[194:195], v242 offset:49664
    v_mfma_f32_16x16x32_bf16 v[112:115], v[216:219], a[200:203], v[112:115]
    v_mul_u32_u24 v249, 6554, v248
    v_lshrrev_b32 v249, 16, v249
    v_mfma_f32_16x16x32_bf16 v[112:115], v[220:223], a[204:207], v[112:115]
    ds_read_b64_tr_b16 v[196:197], v242 offset:53248
    ds_read_b64_tr_b16 v[198:199], v242 offset:53760
    v_mfma_f32_16x16x32_bf16 v[116:119], v[208:211], a[208:211], v[116:119]
    v_mul_u32_u24 v249, 1120, v249
    v_lshl_add_u32 v239, v248, 4, v249
    v_mfma_f32_16x16x32_bf16 v[116:119], v[212:215], a[212:215], v[116:119]
    ds_read_b64_tr_b16 v[200:201], v242 offset:57344
    ds_read_b64_tr_b16 v[202:203], v242 offset:57856
    v_mfma_f32_16x16x32_bf16 v[116:119], v[216:219], a[216:219], v[116:119]
    v_add_u32 v248, 64, v248
    v_mul_u32_u24 v249, 6554, v248
    v_mfma_f32_16x16x32_bf16 v[116:119], v[220:223], a[220:223], v[116:119]
    ds_read_b64_tr_b16 v[204:205], v242 offset:61440
    ds_read_b64_tr_b16 v[206:207], v242 offset:61952
    v_mfma_f32_16x16x32_bf16 v[120:123], v[208:211], a[224:227], v[120:123]
    v_lshrrev_b32 v249, 16, v249
    v_mul_u32_u24 v249, 1120, v249
    v_mfma_f32_16x16x32_bf16 v[120:123], v[212:215], a[228:231], v[120:123]
    v_lshl_add_u32 v241, v248, 4, v249
    v_add_u32 v248, 64, v248
    v_mfma_f32_16x16x32_bf16 v[120:123], v[216:219], a[232:235], v[120:123]
    v_mul_u32_u24 v249, 6554, v248
    v_lshrrev_b32 v249, 16, v249
    v_mfma_f32_16x16x32_bf16 v[120:123], v[220:223], a[236:239], v[120:123]
    v_mul_u32_u24 v249, 1120, v249
    v_lshl_add_u32 v253, v248, 4, v249
    v_mfma_f32_16x16x32_bf16 v[124:127], v[208:211], a[240:243], v[124:127]
    v_and_b32 v248, 0x200, v238
    v_lshl_add_u32 v253, v248, 20, v253
    v_mfma_f32_16x16x32_bf16 v[124:127], v[212:215], a[244:247], v[124:127]
    v_mfma_f32_16x16x32_bf16 v[124:127], v[216:219], a[248:251], v[124:127]
    v_mfma_f32_16x16x32_bf16 v[124:127], v[220:223], a[252:255], v[124:127]
    s_waitcnt lgkmcnt(0) vmcnt(9)
    v_mfma_f32_16x16x32_bf16 v[0:3], v[192:195], a[128:131], v[0:3]
    s_mov_b32 s20, s80
    v_mfma_f32_16x16x32_bf16 v[0:3], v[196:199], a[132:135], v[0:3]
    s_mov_b32 s21, s81
    ds_read_b64_tr_b16 v[208:209], v243 offset:49152
    ds_read_b64_tr_b16 v[210:211], v243 offset:49664
    v_mfma_f32_16x16x32_bf16 v[0:3], v[200:203], a[136:139], v[0:3]
    s_mov_b32 s22, 0x21c000
    v_mfma_f32_16x16x32_bf16 v[0:3], v[204:207], a[140:143], v[0:3]
    s_mov_b32 s23, 0x20000
    ds_read_b64_tr_b16 v[212:213], v243 offset:53248
    ds_read_b64_tr_b16 v[214:215], v243 offset:53760
    v_mfma_f32_16x16x32_bf16 v[4:7], v[192:195], a[144:147], v[4:7]
    s_bfe_u32 s3, s2, 0x10001
    v_mfma_f32_16x16x32_bf16 v[4:7], v[196:199], a[148:151], v[4:7]
    s_lshl_b32 s3, s3, 2
    ds_read_b64_tr_b16 v[216:217], v243 offset:57344
    ds_read_b64_tr_b16 v[218:219], v243 offset:57856
    v_mfma_f32_16x16x32_bf16 v[4:7], v[200:203], a[152:155], v[4:7]
    s_add_u32 s3, s3, s4
    v_mfma_f32_16x16x32_bf16 v[4:7], v[204:207], a[156:159], v[4:7]
    s_mul_i32 s56, s3, 160
    ds_read_b64_tr_b16 v[220:221], v243 offset:61440
    ds_read_b64_tr_b16 v[222:223], v243 offset:61952
    v_mfma_f32_16x16x32_bf16 v[8:11], v[192:195], a[160:163], v[8:11]
    s_mul_i32 s3, s3, 931840
    v_mfma_f32_16x16x32_bf16 v[8:11], v[196:199], a[164:167], v[8:11]
    s_lshr_b32 s7, s2, 2
    v_mfma_f32_16x16x32_bf16 v[8:11], v[200:203], a[168:171], v[8:11]
    s_mul_i32 s57, s7, 40960
    v_mfma_f32_16x16x32_bf16 v[8:11], v[204:207], a[172:175], v[8:11]
    s_add_u32 s56, s56, s57
    v_mfma_f32_16x16x32_bf16 v[12:15], v[192:195], a[176:179], v[12:15]
    s_add_u32 s57, s56, 20480
    v_mfma_f32_16x16x32_bf16 v[12:15], v[196:199], a[180:183], v[12:15]
    s_mul_i32 s7, s7, 5120
    v_mfma_f32_16x16x32_bf16 v[12:15], v[200:203], a[184:187], v[12:15]
    s_add_u32 s7, s7, s3
    v_mfma_f32_16x16x32_bf16 v[12:15], v[204:207], a[188:191], v[12:15]
    s_waitcnt lgkmcnt(0)
    v_mfma_f32_16x16x32_bf16 v[16:19], v[208:211], a[128:131], v[16:19]
    s_add_u32 s24, s82, 0x1a00000
    s_addc_u32 s25, s83, 0
    v_mfma_f32_16x16x32_bf16 v[16:19], v[212:215], a[132:135], v[16:19]
    s_add_u32 s24, s24, s7
    s_addc_u32 s25, s25, 0
    ds_read_b64_tr_b16 v[192:193], v244 offset:49152
    ds_read_b64_tr_b16 v[194:195], v244 offset:49664
    v_mfma_f32_16x16x32_bf16 v[16:19], v[216:219], a[136:139], v[16:19]
    s_mov_b32 s26, 0x0
    v_mfma_f32_16x16x32_bf16 v[16:19], v[220:223], a[140:143], v[16:19]
    s_mov_b32 s27, 0x20000
    ds_read_b64_tr_b16 v[196:197], v244 offset:53248
    ds_read_b64_tr_b16 v[198:199], v244 offset:53760
    v_mfma_f32_16x16x32_bf16 v[20:23], v[208:211], a[144:147], v[20:23]
    s_cmp_lt_u32 s2, 216
    s_cselect_b32 s26, 5120, 0
    v_mfma_f32_16x16x32_bf16 v[20:23], v[212:215], a[148:151], v[20:23]
    s_lshl_b32 s66, s4, 13
    ds_read_b64_tr_b16 v[200:201], v244 offset:57344
    ds_read_b64_tr_b16 v[202:203], v244 offset:57856
    v_mfma_f32_16x16x32_bf16 v[20:23], v[216:219], a[152:155], v[20:23]
    s_add_u32 s66, s66, 98304
    v_mfma_f32_16x16x32_bf16 v[20:23], v[220:223], a[156:159], v[20:23]
    ds_read_b64_tr_b16 v[204:205], v244 offset:61440
    ds_read_b64_tr_b16 v[206:207], v244 offset:61952
    v_mfma_f32_16x16x32_bf16 v[24:27], v[208:211], a[160:163], v[24:27]
    v_mfma_f32_16x16x32_bf16 v[24:27], v[212:215], a[164:167], v[24:27]
    v_mfma_f32_16x16x32_bf16 v[24:27], v[216:219], a[168:171], v[24:27]
    v_mfma_f32_16x16x32_bf16 v[24:27], v[220:223], a[172:175], v[24:27]
    v_mfma_f32_16x16x32_bf16 v[28:31], v[208:211], a[176:179], v[28:31]
    v_mfma_f32_16x16x32_bf16 v[28:31], v[212:215], a[180:183], v[28:31]
    v_mfma_f32_16x16x32_bf16 v[28:31], v[216:219], a[184:187], v[28:31]
    v_mfma_f32_16x16x32_bf16 v[28:31], v[220:223], a[188:191], v[28:31]
    s_waitcnt lgkmcnt(0)
    v_mfma_f32_16x16x32_bf16 v[32:35], v[192:195], a[128:131], v[32:35]
    v_mfma_f32_16x16x32_bf16 v[32:35], v[196:199], a[132:135], v[32:35]
    ds_read_b64_tr_b16 v[208:209], v245 offset:49152
    ds_read_b64_tr_b16 v[210:211], v245 offset:49664
    v_mfma_f32_16x16x32_bf16 v[32:35], v[200:203], a[136:139], v[32:35]
    v_mfma_f32_16x16x32_bf16 v[32:35], v[204:207], a[140:143], v[32:35]
    ds_read_b64_tr_b16 v[212:213], v245 offset:53248
    ds_read_b64_tr_b16 v[214:215], v245 offset:53760
    v_mfma_f32_16x16x32_bf16 v[36:39], v[192:195], a[144:147], v[36:39]
    v_mul_f32 v248, s52, v0
    v_mul_f32 v249, s52, v1
    v_mfma_f32_16x16x32_bf16 v[36:39], v[196:199], a[148:151], v[36:39]
    ds_read_b64_tr_b16 v[216:217], v245 offset:57344
    ds_read_b64_tr_b16 v[218:219], v245 offset:57856
    v_mfma_f32_16x16x32_bf16 v[36:39], v[200:203], a[152:155], v[36:39]
    v_mul_f32 v250, s52, v2
    v_mul_f32 v251, s52, v3
    v_mfma_f32_16x16x32_bf16 v[36:39], v[204:207], a[156:159], v[36:39]
    ds_read_b64_tr_b16 v[220:221], v245 offset:61440
    ds_read_b64_tr_b16 v[222:223], v245 offset:61952
    v_mfma_f32_16x16x32_bf16 v[40:43], v[192:195], a[160:163], v[40:43]
    v_exp_f32 v248, v248
    v_mfma_f32_16x16x32_bf16 v[40:43], v[196:199], a[164:167], v[40:43]
    v_exp_f32 v249, v249
    v_mfma_f32_16x16x32_bf16 v[40:43], v[200:203], a[168:171], v[40:43]
    v_exp_f32 v250, v250
    v_mfma_f32_16x16x32_bf16 v[40:43], v[204:207], a[172:175], v[40:43]
    v_exp_f32 v251, v251
    v_mfma_f32_16x16x32_bf16 v[44:47], v[192:195], a[176:179], v[44:47]
    v_fma_f32 v248, v248, s51, s51
    v_fma_f32 v249, v249, s51, s51
    v_mfma_f32_16x16x32_bf16 v[44:47], v[196:199], a[180:183], v[44:47]
    v_fma_f32 v250, v250, s51, s51
    v_fma_f32 v251, v251, s51, s51
    v_mfma_f32_16x16x32_bf16 v[44:47], v[200:203], a[184:187], v[44:47]
    v_rcp_f32 v248, v248
    v_mfma_f32_16x16x32_bf16 v[44:47], v[204:207], a[188:191], v[44:47]
    s_waitcnt lgkmcnt(0)
    v_rcp_f32 v249, v249
    v_mfma_f32_16x16x32_bf16 v[48:51], v[208:211], a[128:131], v[48:51]
    s_waitcnt vmcnt(17)
    s_barrier
    v_mfma_f32_16x16x32_bf16 v[48:51], v[212:215], a[132:135], v[48:51]
    s_mul_i32 s65, s62, 1048576
    ds_read_b64_tr_b16 v[192:193], v242 offset:0
    ds_read_b64_tr_b16 v[194:195], v242 offset:512
    v_mfma_f32_16x16x32_bf16 v[48:51], v[216:219], a[136:139], v[48:51]
    s_add_u32 m0, s40, 131072
    v_rcp_f32 v250, v250
    v_mfma_f32_16x16x32_bf16 v[48:51], v[220:223], a[140:143], v[48:51]
    s_add_u32 s41, s65, 0
    ds_read_b64_tr_b16 v[196:197], v242 offset:4096
    ds_read_b64_tr_b16 v[198:199], v242 offset:4608
    v_mfma_f32_16x16x32_bf16 v[52:55], v[208:211], a[144:147], v[52:55]
    buffer_load_dwordx4 v240, s[16:19], s41 offen lds
    v_mfma_f32_16x16x32_bf16 v[52:55], v[212:215], a[148:151], v[52:55]
    ds_read_b64_tr_b16 v[200:201], v242 offset:8192
    ds_read_b64_tr_b16 v[202:203], v242 offset:8704
    v_mfma_f32_16x16x32_bf16 v[52:55], v[216:219], a[152:155], v[52:55]
    v_rcp_f32 v251, v251
    v_mfma_f32_16x16x32_bf16 v[52:55], v[220:223], a[156:159], v[52:55]
    ds_read_b64_tr_b16 v[204:205], v242 offset:12288
    ds_read_b64_tr_b16 v[206:207], v242 offset:12800
    v_mfma_f32_16x16x32_bf16 v[56:59], v[208:211], a[160:163], v[56:59]
    s_add_u32 m0, s40, 135168
    v_mul_f32 v0, v0, v248
    v_mul_f32 v1, v1, v249
    v_mfma_f32_16x16x32_bf16 v[56:59], v[212:215], a[164:167], v[56:59]
    s_add_u32 s41, s65, 262144
    v_mul_f32 v2, v2, v250
    v_mul_f32 v3, v3, v251
    v_mfma_f32_16x16x32_bf16 v[56:59], v[216:219], a[168:171], v[56:59]
    buffer_load_dwordx4 v240, s[16:19], s41 offen lds
    v_mfma_f32_16x16x32_bf16 v[56:59], v[220:223], a[172:175], v[56:59]
    v_mul_f32 v248, s52, v16
    v_mul_f32 v249, s52, v17
    v_mfma_f32_16x16x32_bf16 v[60:63], v[208:211], a[176:179], v[60:63]
L_padA_2:
    s_cbranch_execz L_padA_3
    v_mul_f32 v250, s52, v18
    v_mul_f32 v251, s52, v19
    v_mfma_f32_16x16x32_bf16 v[60:63], v[212:215], a[180:183], v[60:63]
    s_add_u32 m0, s40, 139264
    v_exp_f32 v248, v248
    v_mfma_f32_16x16x32_bf16 v[60:63], v[216:219], a[184:187], v[60:63]
    s_add_u32 s41, s65, 524288
    v_exp_f32 v249, v249
    v_mfma_f32_16x16x32_bf16 v[60:63], v[220:223], a[188:191], v[60:63]
    s_waitcnt lgkmcnt(0)
    v_exp_f32 v250, v250
    v_mfma_f32_16x16x32_bf16 v[64:67], v[192:195], a[64:67], v[64:67]
    buffer_load_dwordx4 v240, s[16:19], s41 offen lds
    v_mfma_f32_16x16x32_bf16 v[64:67], v[196:199], a[68:71], v[64:67]
    ds_read_b64_tr_b16 v[208:209], v243 offset:0
    ds_read_b64_tr_b16 v[210:211], v243 offset:512
    v_mfma_f32_16x16x32_bf16 v[64:67], v[200:203], a[72:75], v[64:67]
    v_exp_f32 v251, v251
    v_mfma_f32_16x16x32_bf16 v[64:67], v[204:207], a[76:79], v[64:67]
    ds_read_b64_tr_b16 v[212:213], v243 offset:4096
    ds_read_b64_tr_b16 v[214:215], v243 offset:4608
    v_mfma_f32_16x16x32_bf16 v[68:71], v[192:195], a[80:83], v[68:71]
    s_add_u32 m0, s40, 143360
    v_fma_f32 v248, v248, s51, s51
    v_fma_f32 v249, v249, s51, s51
    v_mfma_f32_16x16x32_bf16 v[68:71], v[196:199], a[84:87], v[68:71]
    s_add_u32 s41, s65, 786432
    ds_read_b64_tr_b16 v[216:217], v243 offset:8192
    ds_read_b64_tr_b16 v[218:219], v243 offset:8704
    v_mfma_f32_16x16x32_bf16 v[68:71], v[200:203], a[88:91], v[68:71]
    buffer_load_dwordx4 v240, s[16:19], s41 offen lds
    v_mfma_f32_16x16x32_bf16 v[68:71], v[204:207], a[92:95], v[68:71]
    ds_read_b64_tr_b16 v[220:221], v243 offset:12288
    ds_read_b64_tr_b16 v[222:223], v243 offset:12800
    v_mfma_f32_16x16x32_bf16 v[72:75], v[192:195], a[96:99], v[72:75]
    v_fma_f32 v250, v250, s51, s51
    v_fma_f32 v251, v251, s51, s51
    v_mfma_f32_16x16x32_bf16 v[72:75], v[196:199], a[100:103], v[72:75]
    s_mul_i32 s65, s63, 1048576
    v_rcp_f32 v248, v248
    v_mfma_f32_16x16x32_bf16 v[72:75], v[200:203], a[104:107], v[72:75]
    s_add_u32 m0, s40, 147456
    v_rcp_f32 v249, v249
    v_mfma_f32_16x16x32_bf16 v[72:75], v[204:207], a[108:111], v[72:75]
    s_add_u32 s41, s65, 0
    v_rcp_f32 v250, v250
    v_mfma_f32_16x16x32_bf16 v[76:79], v[192:195], a[112:115], v[76:79]
    buffer_load_dwordx4 v240, s[16:19], s41 offen lds
    v_mfma_f32_16x16x32_bf16 v[76:79], v[196:199], a[116:119], v[76:79]
    v_rcp_f32 v251, v251
    v_mfma_f32_16x16x32_bf16 v[76:79], v[200:203], a[120:123], v[76:79]
    v_mul_f32 v16, v16, v248
    v_mul_f32 v17, v17, v249
    v_mfma_f32_16x16x32_bf16 v[76:79], v[204:207], a[124:127], v[76:79]
    s_waitcnt lgkmcnt(0)
    v_mul_f32 v18, v18, v250
    v_mul_f32 v19, v19, v251
    v_mfma_f32_16x16x32_bf16 v[80:83], v[208:211], a[64:67], v[80:83]
    s_add_u32 m0, s40, 151552
    v_mul_f32 v248, s52, v4
    v_mul_f32 v249, s52, v5
    v_mfma_f32_16x16x32_bf16 v[80:83], v[212:215], a[68:71], v[80:83]
    s_add_u32 s41, s65, 262144
    ds_read_b64_tr_b16 v[192:193], v244 offset:0
    ds_read_b64_tr_b16 v[194:195], v244 offset:512
    v_mfma_f32_16x16x32_bf16 v[80:83], v[216:219], a[72:75], v[80:83]
    buffer_load_dwordx4 v240, s[16:19], s41 offen lds
    v_mfma_f32_16x16x32_bf16 v[80:83], v[220:223], a[76:79], v[80:83]
    ds_read_b64_tr_b16 v[196:197], v244 offset:4096
    ds_read_b64_tr_b16 v[198:199], v244 offset:4608
    v_mfma_f32_16x16x32_bf16 v[84:87], v[208:211], a[80:83], v[84:87]
    v_mul_f32 v250, s52, v6
    v_mul_f32 v251, s52, v7
    v_mfma_f32_16x16x32_bf16 v[84:87], v[212:215], a[84:87], v[84:87]
    ds_read_b64_tr_b16 v[200:201], v244 offset:8192
    ds_read_b64_tr_b16 v[202:203], v244 offset:8704
    v_mfma_f32_16x16x32_bf16 v[84:87], v[216:219], a[88:91], v[84:87]
    s_add_u32 m0, s40, 155648
    v_exp_f32 v248, v248
    v_mfma_f32_16x16x32_bf16 v[84:87], v[220:223], a[92:95], v[84:87]
    s_add_u32 s41, s65, 524288
    ds_read_b64_tr_b16 v[204:205], v244 offset:12288
    ds_read_b64_tr_b16 v[206:207], v244 offset:12800
    v_mfma_f32_16x16x32_bf16 v[88:91], v[208:211], a[96:99], v[88:91]
    buffer_load_dwordx4 v240, s[16:19], s41 offen lds
    v_mfma_f32_16x16x32_bf16 v[88:91], v[212:215], a[100:103], v[88:91]
    v_exp_f32 v249, v249
    v_mfma_f32_16x16x32_bf16 v[88:91], v[216:219], a[104:107], v[88:91]
    v_exp_f32 v250, v250
    v_mfma_f32_16x16x32_bf16 v[88:91], v[220:223], a[108:111], v[88:91]
    v_exp_f32 v251, v251
    v_mfma_f32_16x16x32_bf16 v[92:95], v[208:211], a[112:115], v[92:95]
    s_add_u32 m0, s40, 159744
    v_fma_f32 v248, v248, s51, s51
    v_fma_f32 v249, v249, s51, s51
    v_mfma_f32_16x16x32_bf16 v[92:95], v[212:215], a[116:119], v[92:95]
    s_add_u32 s41, s65, 786432
    v_fma_f32 v250, v250, s51, s51
    v_fma_f32 v251, v251, s51, s51
    v_mfma_f32_16x16x32_bf16 v[92:95], v[216:219], a[120:123], v[92:95]
    buffer_load_dwordx4 v240, s[16:19], s41 offen lds
    v_mfma_f32_16x16x32_bf16 v[92:95], v[220:223], a[124:127], v[92:95]
    s_waitcnt lgkmcnt(0)
    v_rcp_f32 v248, v248
    v_mfma_f32_16x16x32_bf16 v[96:99], v[192:195], a[64:67], v[96:99]
    v_rcp_f32 v249, v249
    v_mfma_f32_16x16x32_bf16 v[96:99], v[196:199], a[68:71], v[96:99]
    ds_read_b64_tr_b16 v[208:209], v245 offset:0
    ds_read_b64_tr_b16 v[210:211], v245 offset:512
    v_mfma_f32_16x16x32_bf16 v[96:99], v[200:203], a[72:75], v[96:99]
    v_rcp_f32 v250, v250
    v_mfma_f32_16x16x32_bf16 v[96:99], v[204:207], a[76:79], v[96:99]
    ds_read_b64_tr_b16 v[212:213], v245 offset:4096
    ds_read_b64_tr_b16 v[214:215], v245 offset:4608
    v_mfma_f32_16x16x32_bf16 v[100:103], v[192:195], a[80:83], v[100:103]
    v_rcp_f32 v251, v251
    v_mfma_f32_16x16x32_bf16 v[100:103], v[196:199], a[84:87], v[100:103]
    ds_read_b64_tr_b16 v[216:217], v245 offset:8192
    ds_read_b64_tr_b16 v[218:219], v245 offset:8704
    v_mfma_f32_16x16x32_bf16 v[100:103], v[200:203], a[88:91], v[100:103]
    v_mul_f32 v4, v4, v248
    v_mul_f32 v5, v5, v249
    v_mfma_f32_16x16x32_bf16 v[100:103], v[204:207], a[92:95], v[100:103]
    ds_read_b64_tr_b16 v[220:221], v245 offset:12288
    ds_read_b64_tr_b16 v[222:223], v245 offset:12800
    v_mfma_f32_16x16x32_bf16 v[104:107], v[192:195], a[96:99], v[104:107]
    v_mul_f32 v6, v6, v250
    v_mul_f32 v7, v7, v251
    v_mfma_f32_16x16x32_bf16 v[104:107], v[196:199], a[100:103], v[104:107]
    v_mul_f32 v248, s52, v20
    v_mul_f32 v249, s52, v21
    v_mfma_f32_16x16x32_bf16 v[104:107], v[200:203], a[104:107], v[104:107]
    v_mul_f32 v250, s52, v22
    v_mul_f32 v251, s52, v23
    v_mfma_f32_16x16x32_bf16 v[104:107], v[204:207], a[108:111], v[104:107]
    v_exp_f32 v248, v248
    v_mfma_f32_16x16x32_bf16 v[108:111], v[192:195], a[112:115], v[108:111]
    v_exp_f32 v249, v249
    v_mfma_f32_16x16x32_bf16 v[108:111], v[196:199], a[116:119], v[108:111]
    v_exp_f32 v250, v250
    v_mfma_f32_16x16x32_bf16 v[108:111], v[200:203], a[120:123], v[108:111]
    v_exp_f32 v251, v251
    v_mfma_f32_16x16x32_bf16 v[108:111], v[204:207], a[124:127], v[108:111]
    s_waitcnt lgkmcnt(0)
    v_fma_f32 v248, v248, s51, s51
    v_fma_f32 v249, v249, s51, s51
    v_mfma_f32_16x16x32_bf16 v[112:115], v[208:211], a[64:67], v[112:115]
    s_waitcnt vmcnt(13)
    s_barrier
    v_fma_f32 v250, v250, s51, s51
    v_mfma_f32_16x16x32_bf16 v[112:115], v[212:215], a[68:71], v[112:115]
    s_mul_i32 s65, s64, 1048576
    ds_read_b64_tr_b16 v[192:193], v242 offset:16384
    ds_read_b64_tr_b16 v[194:195], v242 offset:16896
    v_mfma_f32_16x16x32_bf16 v[112:115], v[216:219], a[72:75], v[112:115]
    s_add_u32 m0, s40, 98304
    v_fma_f32 v251, v251, s51, s51
    v_mfma_f32_16x16x32_bf16 v[112:115], v[220:223], a[76:79], v[112:115]
    s_add_u32 s41, s65, 0
    ds_read_b64_tr_b16 v[196:197], v242 offset:20480
    ds_read_b64_tr_b16 v[198:199], v242 offset:20992
    v_mfma_f32_16x16x32_bf16 v[116:119], v[208:211], a[80:83], v[116:119]
    buffer_load_dwordx4 v240, s[16:19], s41 offen lds
    v_mfma_f32_16x16x32_bf16 v[116:119], v[212:215], a[84:87], v[116:119]
    ds_read_b64_tr_b16 v[200:201], v242 offset:24576
    ds_read_b64_tr_b16 v[202:203], v242 offset:25088
    v_mfma_f32_16x16x32_bf16 v[116:119], v[216:219], a[88:91], v[116:119]
    v_rcp_f32 v248, v248
    v_mfma_f32_16x16x32_bf16 v[116:119], v[220:223], a[92:95], v[116:119]
    ds_read_b64_tr_b16 v[204:205], v242 offset:28672
    ds_read_b64_tr_b16 v[206:207], v242 offset:29184
    v_mfma_f32_16x16x32_bf16 v[120:123], v[208:211], a[96:99], v[120:123]
    s_add_u32 m0, s40, 102400
    v_rcp_f32 v249, v249
    v_mfma_f32_16x16x32_bf16 v[120:123], v[212:215], a[100:103], v[120:123]
    s_add_u32 s41, s65, 262144
    v_rcp_f32 v250, v250
    v_mfma_f32_16x16x32_bf16 v[120:123], v[216:219], a[104:107], v[120:123]
    buffer_load_dwordx4 v240, s[16:19], s41 offen lds
    v_mfma_f32_16x16x32_bf16 v[120:123], v[220:223], a[108:111], v[120:123]
    v_rcp_f32 v251, v251
    v_mfma_f32_16x16x32_bf16 v[124:127], v[208:211], a[112:115], v[124:127]
    v_mul_f32 v20, v20, v248
    v_mul_f32 v21, v21, v249
    v_mfma_f32_16x16x32_bf16 v[124:127], v[212:215], a[116:119], v[124:127]
    s_add_u32 m0, s40, 106496
    v_mul_f32 v22, v22, v250
    v_mul_f32 v23, v23, v251
    v_mfma_f32_16x16x32_bf16 v[124:127], v[216:219], a[120:123], v[124:127]
    s_add_u32 s41, s65, 524288
    v_mul_f32 v248, s52, v8
    v_mul_f32 v249, s52, v9
    v_mfma_f32_16x16x32_bf16 v[124:127], v[220:223], a[124:127], v[124:127]
    s_waitcnt lgkmcnt(0)
    v_mul_f32 v250, s52, v10
    v_mul_f32 v251, s52, v11
    v_mfma_f32_16x16x32_bf16 v[64:67], v[192:195], a[128:131], v[64:67]
    buffer_load_dwordx4 v240, s[16:19], s41 offen lds
    v_mfma_f32_16x16x32_bf16 v[64:67], v[196:199], a[132:135], v[64:67]
    ds_read_b64_tr_b16 v[208:209], v243 offset:16384
    ds_read_b64_tr_b16 v[210:211], v243 offset:16896
    v_mfma_f32_16x16x32_bf16 v[64:67], v[200:203], a[136:139], v[64:67]
    v_exp_f32 v248, v248
    v_mfma_f32_16x16x32_bf16 v[64:67], v[204:207], a[140:143], v[64:67]
    ds_read_b64_tr_b16 v[212:213], v243 offset:20480
    ds_read_b64_tr_b16 v[214:215], v243 offset:20992
    v_mfma_f32_16x16x32_bf16 v[68:71], v[192:195], a[144:147], v[68:71]
    s_add_u32 m0, s40, 110592
    v_exp_f32 v249, v249
    v_mfma_f32_16x16x32_bf16 v[68:71], v[196:199], a[148:151], v[68:71]
    s_add_u32 s41, s65, 786432
    ds_read_b64_tr_b16 v[216:217], v243 offset:24576
    ds_read_b64_tr_b16 v[218:219], v243 offset:25088
    v_mfma_f32_16x16x32_bf16 v[68:71], v[200:203], a[152:155], v[68:71]
    buffer_load_dwordx4 v240, s[16:19], s41 offen lds
    v_mfma_f32_16x16x32_bf16 v[68:71], v[204:207], a[156:159], v[68:71]
    ds_read_b64_tr_b16 v[220:221], v243 offset:28672
    ds_read_b64_tr_b16 v[222:223], v243 offset:29184
    v_mfma_f32_16x16x32_bf16 v[72:75], v[192:195], a[160:163], v[72:75]
    v_exp_f32 v250, v250
    v_mfma_f32_16x16x32_bf16 v[72:75], v[196:199], a[164:167], v[72:75]
    v_exp_f32 v251, v251
    v_mfma_f32_16x16x32_bf16 v[72:75], v[200:203], a[168:171], v[72:75]
    s_add_u32 m0, s40, 0
    v_fma_f32 v248, v248, s51, s51
    v_fma_f32 v249, v249, s51, s51
    v_mfma_f32_16x16x32_bf16 v[72:75], v[204:207], a[172:175], v[72:75]
    s_mov_b32 s41, 0
    v_fma_f32 v250, v250, s51, s51
    v_fma_f32 v251, v251, s51, s51
    v_mfma_f32_16x16x32_bf16 v[76:79], v[192:195], a[176:179], v[76:79]
    buffer_load_dwordx4 v236, s[8:11], s41 offen lds
    v_mfma_f32_16x16x32_bf16 v[76:79], v[196:199], a[180:183], v[76:79]
    v_rcp_f32 v248, v248
    v_mfma_f32_16x16x32_bf16 v[76:79], v[200:203], a[184:187], v[76:79]
    v_rcp_f32 v249, v249
    v_mfma_f32_16x16x32_bf16 v[76:79], v[204:207], a[188:191], v[76:79]
    s_waitcnt lgkmcnt(0)
    v_rcp_f32 v250, v250
    v_mfma_f32_16x16x32_bf16 v[80:83], v[208:211], a[128:131], v[80:83]
    s_add_u32 m0, s40, 4096
    v_rcp_f32 v251, v251
    v_mfma_f32_16x16x32_bf16 v[80:83], v[212:215], a[132:135], v[80:83]
    s_mov_b32 s41, 4096
    ds_read_b64_tr_b16 v[192:193], v244 offset:16384
    ds_read_b64_tr_b16 v[194:195], v244 offset:16896
    v_mfma_f32_16x16x32_bf16 v[80:83], v[216:219], a[136:139], v[80:83]
    buffer_load_dwordx4 v236, s[8:11], s41 offen lds
    v_mfma_f32_16x16x32_bf16 v[80:83], v[220:223], a[140:143], v[80:83]
    ds_read_b64_tr_b16 v[196:197], v244 offset:20480
    ds_read_b64_tr_b16 v[198:199], v244 offset:20992
    v_mfma_f32_16x16x32_bf16 v[84:87], v[208:211], a[144:147], v[84:87]
    v_mul_f32 v8, v8, v248
    v_mul_f32 v9, v9, v249
    v_mfma_f32_16x16x32_bf16 v[84:87], v[212:215], a[148:151], v[84:87]
    ds_read_b64_tr_b16 v[200:201], v244 offset:24576
    ds_read_b64_tr_b16 v[202:203], v244 offset:25088
    v_mfma_f32_16x16x32_bf16 v[84:87], v[216:219], a[152:155], v[84:87]
    s_add_u32 m0, s40, 8192
    v_mul_f32 v10, v10, v250
    v_mul_f32 v11, v11, v251
    v_mfma_f32_16x16x32_bf16 v[84:87], v[220:223], a[156:159], v[84:87]
    s_mov_b32 s41, 8192
    ds_read_b64_tr_b16 v[204:205], v244 offset:28672
    ds_read_b64_tr_b16 v[206:207], v244 offset:29184
    v_mfma_f32_16x16x32_bf16 v[88:91], v[208:211], a[160:163], v[88:91]
    buffer_load_dwordx4 v236, s[8:11], s41 offen lds
    v_mfma_f32_16x16x32_bf16 v[88:91], v[212:215], a[164:167], v[88:91]
    v_mul_f32 v248, s52, v24
    v_mul_f32 v249, s52, v25
    v_mfma_f32_16x16x32_bf16 v[88:91], v[216:219], a[168:171], v[88:91]
    v_mul_f32 v250, s52, v26
    v_mul_f32 v251, s52, v27
    v_mfma_f32_16x16x32_bf16 v[88:91], v[220:223], a[172:175], v[88:91]
    v_exp_f32 v248, v248
    v_mfma_f32_16x16x32_bf16 v[92:95], v[208:211], a[176:179], v[92:95]
    s_add_u32 m0, s40, 12288
    v_exp_f32 v249, v249
    v_mfma_f32_16x16x32_bf16 v[92:95], v[212:215], a[180:183], v[92:95]
    s_mov_b32 s41, 12288
    v_exp_f32 v250, v250
    v_mfma_f32_16x16x32_bf16 v[92:95], v[216:219], a[184:187], v[92:95]
    buffer_load_dwordx4 v236, s[8:11], s41 offen lds
    v_mfma_f32_16x16x32_bf16 v[92:95], v[220:223], a[188:191], v[92:95]
    s_waitcnt lgkmcnt(0)
    v_exp_f32 v251, v251
    v_mfma_f32_16x16x32_bf16 v[96:99], v[192:195], a[128:131], v[96:99]
    v_fma_f32 v248, v248, s51, s51
    v_fma_f32 v249, v249, s51, s51
    v_mfma_f32_16x16x32_bf16 v[96:99], v[196:199], a[132:135], v[96:99]
    ds_read_b64_tr_b16 v[208:209], v245 offset:16384
    ds_read_b64_tr_b16 v[210:211], v245 offset:16896
    v_mfma_f32_16x16x32_bf16 v[96:99], v[200:203], a[136:139], v[96:99]
    v_fma_f32 v250, v250, s51, s51
    v_fma_f32 v251, v251, s51, s51
    v_mfma_f32_16x16x32_bf16 v[96:99], v[204:207], a[140:143], v[96:99]
    ds_read_b64_tr_b16 v[212:213], v245 offset:20480
    ds_read_b64_tr_b16 v[214:215], v245 offset:20992
    v_mfma_f32_16x16x32_bf16 v[100:103], v[192:195], a[144:147], v[100:103]
    v_rcp_f32 v248, v248
    v_mfma_f32_16x16x32_bf16 v[100:103], v[196:199], a[148:151], v[100:103]
    ds_read_b64_tr_b16 v[216:217], v245 offset:24576
    ds_read_b64_tr_b16 v[218:219], v245 offset:25088
    v_mfma_f32_16x16x32_bf16 v[100:103], v[200:203], a[152:155], v[100:103]
    v_rcp_f32 v249, v249
    v_mfma_f32_16x16x32_bf16 v[100:103], v[204:207], a[156:159], v[100:103]
    ds_read_b64_tr_b16 v[220:221], v245 offset:28672
    ds_read_b64_tr_b16 v[222:223], v245 offset:29184
    v_mfma_f32_16x16x32_bf16 v[104:107], v[192:195], a[160:163], v[104:107]
    v_rcp_f32 v250, v250
    v_mfma_f32_16x16x32_bf16 v[104:107], v[196:199], a[164:167], v[104:107]
    v_rcp_f32 v251, v251
    v_mfma_f32_16x16x32_bf16 v[104:107], v[200:203], a[168:171], v[104:107]
    v_mul_f32 v24, v24, v248
    v_mul_f32 v25, v25, v249
    v_mfma_f32_16x16x32_bf16 v[104:107], v[204:207], a[172:175], v[104:107]
    v_mul_f32 v26, v26, v250
    v_mul_f32 v27, v27, v251
    v_mfma_f32_16x16x32_bf16 v[108:111], v[192:195], a[176:179], v[108:111]
    v_mul_f32 v248, s52, v12
    v_mul_f32 v249, s52, v13
    v_mfma_f32_16x16x32_bf16 v[108:111], v[196:199], a[180:183], v[108:111]
    v_mul_f32 v250, s52, v14
    v_mul_f32 v251, s52, v15
    v_mfma_f32_16x16x32_bf16 v[108:111], v[200:203], a[184:187], v[108:111]
    v_exp_f32 v248, v248
    v_mfma_f32_16x16x32_bf16 v[108:111], v[204:207], a[188:191], v[108:111]
    s_waitcnt lgkmcnt(0)
    v_exp_f32 v249, v249
    v_mfma_f32_16x16x32_bf16 v[112:115], v[208:211], a[128:131], v[112:115]
    s_waitcnt vmcnt(12)
    s_barrier
    v_mfma_f32_16x16x32_bf16 v[112:115], v[212:215], a[132:135], v[112:115]
    s_mul_i32 s65, s62, 1048576
    ds_read_b64_tr_b16 v[192:193], v242 offset:32768
    ds_read_b64_tr_b16 v[194:195], v242 offset:33280
    v_mfma_f32_16x16x32_bf16 v[112:115], v[216:219], a[136:139], v[112:115]
    s_add_u32 m0, s40, 114688
    v_exp_f32 v250, v250
    v_mfma_f32_16x16x32_bf16 v[112:115], v[220:223], a[140:143], v[112:115]
    s_add_u32 s41, s65, 128
    ds_read_b64_tr_b16 v[196:197], v242 offset:36864
    ds_read_b64_tr_b16 v[198:199], v242 offset:37376
    v_mfma_f32_16x16x32_bf16 v[116:119], v[208:211], a[144:147], v[116:119]
    buffer_load_dwordx4 v240, s[16:19], s41 offen lds
    v_mfma_f32_16x16x32_bf16 v[116:119], v[212:215], a[148:151], v[116:119]
    ds_read_b64_tr_b16 v[200:201], v242 offset:40960
    ds_read_b64_tr_b16 v[202:203], v242 offset:41472
    v_mfma_f32_16x16x32_bf16 v[116:119], v[216:219], a[152:155], v[116:119]
    v_exp_f32 v251, v251
    v_mfma_f32_16x16x32_bf16 v[116:119], v[220:223], a[156:159], v[116:119]
    ds_read_b64_tr_b16 v[204:205], v242 offset:45056
    ds_read_b64_tr_b16 v[206:207], v242 offset:45568
    v_mfma_f32_16x16x32_bf16 v[120:123], v[208:211], a[160:163], v[120:123]
    s_add_u32 m0, s40, 118784
    v_fma_f32 v248, v248, s51, s51
    v_fma_f32 v249, v249, s51, s51
    v_mfma_f32_16x16x32_bf16 v[120:123], v[212:215], a[164:167], v[120:123]
    s_add_u32 s41, s65, 262272
    v_fma_f32 v250, v250, s51, s51
    v_fma_f32 v251, v251, s51, s51
    v_mfma_f32_16x16x32_bf16 v[120:123], v[216:219], a[168:171], v[120:123]
    buffer_load_dwordx4 v240, s[16:19], s41 offen lds
    v_mfma_f32_16x16x32_bf16 v[120:123], v[220:223], a[172:175], v[120:123]
    v_rcp_f32 v248, v248
    v_mfma_f32_16x16x32_bf16 v[124:127], v[208:211], a[176:179], v[124:127]
    v_rcp_f32 v249, v249
    v_mfma_f32_16x16x32_bf16 v[124:127], v[212:215], a[180:183], v[124:127]
    s_add_u32 m0, s40, 122880
    v_rcp_f32 v250, v250
    v_mfma_f32_16x16x32_bf16 v[124:127], v[216:219], a[184:187], v[124:127]
    s_add_u32 s41, s65, 524416
    v_rcp_f32 v251, v251
    v_mfma_f32_16x16x32_bf16 v[124:127], v[220:223], a[188:191], v[124:127]
    s_waitcnt lgkmcnt(0)
    v_mul_f32 v12, v12, v248
    v_mul_f32 v13, v13, v249
    v_mfma_f32_16x16x32_bf16 a[0:3], v[192:195], a[192:195], a[0:3]
    buffer_load_dwordx4 v240, s[16:19], s41 offen lds
    v_mfma_f32_16x16x32_bf16 a[0:3], v[196:199], a[196:199], a[0:3]
    ds_read_b64_tr_b16 v[208:209], v243 offset:32768
    ds_read_b64_tr_b16 v[210:211], v243 offset:33280
    v_mfma_f32_16x16x32_bf16 a[0:3], v[200:203], a[200:203], a[0:3]
    v_mul_f32 v14, v14, v250
    v_mul_f32 v15, v15, v251
    v_mfma_f32_16x16x32_bf16 a[0:3], v[204:207], a[204:207], a[0:3]
    ds_read_b64_tr_b16 v[212:213], v243 offset:36864
    ds_read_b64_tr_b16 v[214:215], v243 offset:37376
    v_mfma_f32_16x16x32_bf16 a[4:7], v[192:195], a[208:211], a[4:7]
    s_add_u32 m0, s40, 126976
    v_mul_f32 v248, s52, v28
    v_mul_f32 v249, s52, v29
    v_mfma_f32_16x16x32_bf16 a[4:7], v[196:199], a[212:215], a[4:7]
    s_add_u32 s41, s65, 786560
    ds_read_b64_tr_b16 v[216:217], v243 offset:40960
    ds_read_b64_tr_b16 v[218:219], v243 offset:41472
    v_mfma_f32_16x16x32_bf16 a[4:7], v[200:203], a[216:219], a[4:7]
    buffer_load_dwordx4 v240, s[16:19], s41 offen lds
    v_mfma_f32_16x16x32_bf16 a[4:7], v[204:207], a[220:223], a[4:7]
    ds_read_b64_tr_b16 v[220:221], v243 offset:45056
    ds_read_b64_tr_b16 v[222:223], v243 offset:45568
    v_mfma_f32_16x16x32_bf16 a[8:11], v[192:195], a[224:227], a[8:11]
    v_mul_f32 v250, s52, v30
    v_mul_f32 v251, s52, v31
    v_mfma_f32_16x16x32_bf16 a[8:11], v[196:199], a[228:231], a[8:11]
    v_exp_f32 v248, v248
    v_mfma_f32_16x16x32_bf16 a[8:11], v[200:203], a[232:235], a[8:11]
    s_add_u32 m0, s40, 16384
    v_exp_f32 v249, v249
    v_mfma_f32_16x16x32_bf16 a[8:11], v[204:207], a[236:239], a[8:11]
    s_mov_b32 s41, 16384
    v_exp_f32 v250, v250
    v_mfma_f32_16x16x32_bf16 a[12:15], v[192:195], a[240:243], a[12:15]
    buffer_load_dwordx4 v236, s[8:11], s41 offen lds
    v_mfma_f32_16x16x32_bf16 a[12:15], v[196:199], a[244:247], a[12:15]
    v_exp_f32 v251, v251
    v_mfma_f32_16x16x32_bf16 a[12:15], v[200:203], a[248:251], a[12:15]
    v_fma_f32 v248, v248, s51, s51
    v_fma_f32 v249, v249, s51, s51
    v_mfma_f32_16x16x32_bf16 a[12:15], v[204:207], a[252:255], a[12:15]
    s_waitcnt lgkmcnt(0)
    v_fma_f32 v250, v250, s51, s51
    v_fma_f32 v251, v251, s51, s51
    v_mfma_f32_16x16x32_bf16 a[16:19], v[208:211], a[192:195], a[16:19]
    s_add_u32 m0, s40, 20480
    v_rcp_f32 v248, v248
    v_mfma_f32_16x16x32_bf16 a[16:19], v[212:215], a[196:199], a[16:19]
    s_mov_b32 s41, 20480
    ds_read_b64_tr_b16 v[192:193], v244 offset:32768
    ds_read_b64_tr_b16 v[194:195], v244 offset:33280
    v_mfma_f32_16x16x32_bf16 a[16:19], v[216:219], a[200:203], a[16:19]
    buffer_load_dwordx4 v236, s[8:11], s41 offen lds
    v_mfma_f32_16x16x32_bf16 a[16:19], v[220:223], a[204:207], a[16:19]
    ds_read_b64_tr_b16 v[196:197], v244 offset:36864
    ds_read_b64_tr_b16 v[198:199], v244 offset:37376
    v_mfma_f32_16x16x32_bf16 a[20:23], v[208:211], a[208:211], a[20:23]
    v_rcp_f32 v249, v249
    v_mfma_f32_16x16x32_bf16 a[20:23], v[212:215], a[212:215], a[20:23]
    ds_read_b64_tr_b16 v[200:201], v244 offset:40960
    ds_read_b64_tr_b16 v[202:203], v244 offset:41472
    v_mfma_f32_16x16x32_bf16 a[20:23], v[216:219], a[216:219], a[20:23]
    s_add_u32 m0, s40, 24576
    v_rcp_f32 v250, v250
    v_mfma_f32_16x16x32_bf16 a[20:23], v[220:223], a[220:223], a[20:23]
    s_mov_b32 s41, 24576
    ds_read_b64_tr_b16 v[204:205], v244 offset:45056
    ds_read_b64_tr_b16 v[206:207], v244 offset:45568
    v_mfma_f32_16x16x32_bf16 a[24:27], v[208:211], a[224:227], a[24:27]
    buffer_load_dwordx4 v236, s[8:11], s41 offen lds
    v_mfma_f32_16x16x32_bf16 a[24:27], v[212:215], a[228:231], a[24:27]
    v_rcp_f32 v251, v251
    v_mfma_f32_16x16x32_bf16 a[24:27], v[216:219], a[232:235], a[24:27]
    v_mul_f32 v28, v28, v248
    v_mul_f32 v29, v29, v249
    v_mfma_f32_16x16x32_bf16 a[24:27], v[220:223], a[236:239], a[24:27]
    v_mul_f32 v30, v30, v250
    v_mul_f32 v31, v31, v251
    v_mfma_f32_16x16x32_bf16 a[28:31], v[208:211], a[240:243], a[28:31]
    s_add_u32 m0, s40, 28672
    v_mul_f32 v0, v0, v64
    v_mul_f32 v1, v1, v65
    v_mfma_f32_16x16x32_bf16 a[28:31], v[212:215], a[244:247], a[28:31]
    s_mov_b32 s41, 28672
    v_mul_f32 v2, v2, v66
    v_mul_f32 v3, v3, v67
    v_mfma_f32_16x16x32_bf16 a[28:31], v[216:219], a[248:251], a[28:31]
    buffer_load_dwordx4 v236, s[8:11], s41 offen lds
    v_mfma_f32_16x16x32_bf16 a[28:31], v[220:223], a[252:255], a[28:31]
    s_waitcnt lgkmcnt(0)
    v_mul_f32 v16, v16, v80
    v_mul_f32 v17, v17, v81
    v_mfma_f32_16x16x32_bf16 a[32:35], v[192:195], a[192:195], a[32:35]
    v_mul_f32 v18, v18, v82
    v_mul_f32 v19, v19, v83
    v_mfma_f32_16x16x32_bf16 a[32:35], v[196:199], a[196:199], a[32:35]
    ds_read_b64_tr_b16 v[208:209], v245 offset:32768
    ds_read_b64_tr_b16 v[210:211], v245 offset:33280
    v_mfma_f32_16x16x32_bf16 a[32:35], v[200:203], a[200:203], a[32:35]
    v_cvt_pk_bf16_f32 v64, v0, v1
    v_cvt_pk_bf16_f32 v65, v2, v3
    v_mfma_f32_16x16x32_bf16 a[32:35], v[204:207], a[204:207], a[32:35]
    ds_read_b64_tr_b16 v[212:213], v245 offset:36864
    ds_read_b64_tr_b16 v[214:215], v245 offset:37376
    v_mfma_f32_16x16x32_bf16 a[36:39], v[192:195], a[208:211], a[36:39]
    v_cvt_pk_bf16_f32 v66, v16, v17
    v_cvt_pk_bf16_f32 v67, v18, v19
    v_mfma_f32_16x16x32_bf16 a[36:39], v[196:199], a[212:215], a[36:39]
    ds_read_b64_tr_b16 v[216:217], v245 offset:40960
    ds_read_b64_tr_b16 v[218:219], v245 offset:41472
    v_mfma_f32_16x16x32_bf16 a[36:39], v[200:203], a[216:219], a[36:39]
    v_mul_f32 v4, v4, v68
    v_mul_f32 v5, v5, v69
    v_mfma_f32_16x16x32_bf16 a[36:39], v[204:207], a[220:223], a[36:39]
    ds_read_b64_tr_b16 v[220:221], v245 offset:45056
    ds_read_b64_tr_b16 v[222:223], v245 offset:45568
    v_mfma_f32_16x16x32_bf16 a[40:43], v[192:195], a[224:227], a[40:43]
    v_mul_f32 v6, v6, v70
    v_mul_f32 v7, v7, v71
    v_mfma_f32_16x16x32_bf16 a[40:43], v[196:199], a[228:231], a[40:43]
    v_mul_f32 v20, v20, v84
    v_mul_f32 v21, v21, v85
    v_mfma_f32_16x16x32_bf16 a[40:43], v[200:203], a[232:235], a[40:43]
    v_mul_f32 v22, v22, v86
    v_mul_f32 v23, v23, v87
    v_mfma_f32_16x16x32_bf16 a[40:43], v[204:207], a[236:239], a[40:43]
    v_cvt_pk_bf16_f32 v68, v4, v5
    v_cvt_pk_bf16_f32 v69, v6, v7
    v_mfma_f32_16x16x32_bf16 a[44:47], v[192:195], a[240:243], a[44:47]
    v_cvt_pk_bf16_f32 v70, v20, v21
    v_cvt_pk_bf16_f32 v71, v22, v23
    v_mfma_f32_16x16x32_bf16 a[44:47], v[196:199], a[244:247], a[44:47]
    v_mul_f32 v8, v8, v72
    v_mul_f32 v9, v9, v73
    v_mfma_f32_16x16x32_bf16 a[44:47], v[200:203], a[248:251], a[44:47]
    v_mul_f32 v10, v10, v74
    v_mul_f32 v11, v11, v75
    v_mfma_f32_16x16x32_bf16 a[44:47], v[204:207], a[252:255], a[44:47]
    s_waitcnt lgkmcnt(0)
    v_mul_f32 v24, v24, v88
    v_mul_f32 v25, v25, v89
    v_mfma_f32_16x16x32_bf16 a[48:51], v[208:211], a[192:195], a[48:51]
    s_waitcnt vmcnt(16)
    s_barrier
    v_mul_f32 v26, v26, v90
    v_mfma_f32_16x16x32_bf16 a[48:51], v[212:215], a[196:199], a[48:51]
    s_mul_i32 s65, s63, 1048576
    ds_read_b64_tr_b16 v[192:193], v242 offset:49152
    ds_read_b64_tr_b16 v[194:195], v242 offset:49664
    v_mfma_f32_16x16x32_bf16 a[48:51], v[216:219], a[200:203], a[48:51]
    s_add_u32 m0, s40, 131072
    v_mul_f32 v27, v27, v91
    v_cvt_pk_bf16_f32 v72, v8, v9
    v_mfma_f32_16x16x32_bf16 a[48:51], v[220:223], a[204:207], a[48:51]
    s_add_u32 s41, s65, 128
    ds_read_b64_tr_b16 v[196:197], v242 offset:53248
    ds_read_b64_tr_b16 v[198:199], v242 offset:53760
    v_mfma_f32_16x16x32_bf16 a[52:55], v[208:211], a[208:211], a[52:55]
    buffer_load_dwordx4 v240, s[16:19], s41 offen lds
    v_mfma_f32_16x16x32_bf16 a[52:55], v[212:215], a[212:215], a[52:55]
    ds_read_b64_tr_b16 v[200:201], v242 offset:57344
    ds_read_b64_tr_b16 v[202:203], v242 offset:57856
    v_mfma_f32_16x16x32_bf16 a[52:55], v[216:219], a[216:219], a[52:55]
    v_cvt_pk_bf16_f32 v73, v10, v11
    v_cvt_pk_bf16_f32 v74, v24, v25
    v_mfma_f32_16x16x32_bf16 a[52:55], v[220:223], a[220:223], a[52:55]
    ds_read_b64_tr_b16 v[204:205], v242 offset:61440
    ds_read_b64_tr_b16 v[206:207], v242 offset:61952
    v_mfma_f32_16x16x32_bf16 a[56:59], v[208:211], a[224:227], a[56:59]
    s_add_u32 m0, s40, 135168
    v_cvt_pk_bf16_f32 v75, v26, v27
    v_mul_f32 v12, v12, v76
    v_mfma_f32_16x16x32_bf16 a[56:59], v[212:215], a[228:231], a[56:59]
    s_add_u32 s41, s65, 262272
    v_mul_f32 v13, v13, v77
    v_mul_f32 v14, v14, v78
    v_mfma_f32_16x16x32_bf16 a[56:59], v[216:219], a[232:235], a[56:59]
    buffer_load_dwordx4 v240, s[16:19], s41 offen lds
    v_mfma_f32_16x16x32_bf16 a[56:59], v[220:223], a[236:239], a[56:59]
    v_mul_f32 v15, v15, v79
    v_mul_f32 v28, v28, v92
    v_mfma_f32_16x16x32_bf16 a[60:63], v[208:211], a[240:243], a[60:63]
    v_mul_f32 v29, v29, v93
    v_mul_f32 v30, v30, v94
    v_mfma_f32_16x16x32_bf16 a[60:63], v[212:215], a[244:247], a[60:63]
    s_add_u32 m0, s40, 139264
    v_mul_f32 v31, v31, v95
    v_cvt_pk_bf16_f32 v76, v12, v13
    v_mfma_f32_16x16x32_bf16 a[60:63], v[216:219], a[248:251], a[60:63]
    s_add_u32 s41, s65, 524416
    v_cvt_pk_bf16_f32 v77, v14, v15
    v_cvt_pk_bf16_f32 v78, v28, v29
    v_mfma_f32_16x16x32_bf16 a[60:63], v[220:223], a[252:255], a[60:63]
    s_waitcnt lgkmcnt(0)
    v_cvt_pk_bf16_f32 v79, v30, v31
    v_mfma_f32_16x16x32_bf16 a[0:3], v[192:195], a[64:67], a[0:3]
    buffer_load_dwordx4 v240, s[16:19], s41 offen lds
    v_mfma_f32_16x16x32_bf16 a[0:3], v[196:199], a[68:71], a[0:3]
    ds_read_b64_tr_b16 v[208:209], v243 offset:49152
    ds_read_b64_tr_b16 v[210:211], v243 offset:49664
    v_mfma_f32_16x16x32_bf16 a[0:3], v[200:203], a[72:75], a[0:3]
    buffer_store_dwordx4 v[64:67], v247, s[32:35], s49 offen offset:0 sc1
    v_mfma_f32_16x16x32_bf16 a[0:3], v[204:207], a[76:79], a[0:3]
    ds_read_b64_tr_b16 v[212:213], v243 offset:53248
    ds_read_b64_tr_b16 v[214:215], v243 offset:53760
    v_mfma_f32_16x16x32_bf16 a[4:7], v[192:195], a[80:83], a[4:7]
    s_add_u32 m0, s40, 143360
    v_mfma_f32_16x16x32_bf16 a[4:7], v[196:199], a[84:87], a[4:7]
    s_add_u32 s41, s65, 786560
    ds_read_b64_tr_b16 v[216:217], v243 offset:57344
    ds_read_b64_tr_b16 v[218:219], v243 offset:57856
    v_mfma_f32_16x16x32_bf16 a[4:7], v[200:203], a[88:91], a[4:7]
    buffer_load_dwordx4 v240, s[16:19], s41 offen lds
    v_mfma_f32_16x16x32_bf16 a[4:7], v[204:207], a[92:95], a[4:7]
L_padA_3:
    s_cbranch_execz L_padA_4
    ds_read_b64_tr_b16 v[220:221], v243 offset:61440
    ds_read_b64_tr_b16 v[222:223], v243 offset:61952
    v_mfma_f32_16x16x32_bf16 a[8:11], v[192:195], a[96:99], a[8:11]
    buffer_store_dwordx4 v[68:71], v247, s[32:35], s49 offen offset:1024 sc1
    v_mfma_f32_16x16x32_bf16 a[8:11], v[196:199], a[100:103], a[8:11]
    buffer_store_dwordx4 v[72:75], v247, s[32:35], s49 offen offset:2048 sc1
    v_mfma_f32_16x16x32_bf16 a[8:11], v[200:203], a[104:107], a[8:11]
    s_add_u32 m0, s40, 32768
    v_mfma_f32_16x16x32_bf16 a[8:11], v[204:207], a[108:111], a[8:11]
    s_mov_b32 s41, 32768
    v_mfma_f32_16x16x32_bf16 a[12:15], v[192:195], a[112:115], a[12:15]
    buffer_load_dwordx4 v236, s[8:11], s41 offen lds
    v_mfma_f32_16x16x32_bf16 a[12:15], v[196:199], a[116:119], a[12:15]
    buffer_store_dwordx4 v[76:79], v247, s[32:35], s49 offen offset:3072 sc1
    v_mfma_f32_16x16x32_bf16 a[12:15], v[200:203], a[120:123], a[12:15]
    v_mul_f32 v248, s52, v32
    v_mul_f32 v249, s52, v33
    v_mfma_f32_16x16x32_bf16 a[12:15], v[204:207], a[124:127], a[12:15]
    s_waitcnt lgkmcnt(0)
    v_mul_f32 v250, s52, v34
    v_mul_f32 v251, s52, v35
    v_mfma_f32_16x16x32_bf16 a[16:19], v[208:211], a[64:67], a[16:19]
    s_add_u32 m0, s40, 36864
    v_exp_f32 v248, v248
    v_mfma_f32_16x16x32_bf16 a[16:19], v[212:215], a[68:71], a[16:19]
    s_mov_b32 s41, 36864
    ds_read_b64_tr_b16 v[192:193], v244 offset:49152
    ds_read_b64_tr_b16 v[194:195], v244 offset:49664
    v_mfma_f32_16x16x32_bf16 a[16:19], v[216:219], a[72:75], a[16:19]
    buffer_load_dwordx4 v236, s[8:11], s41 offen lds
    v_mfma_f32_16x16x32_bf16 a[16:19], v[220:223], a[76:79], a[16:19]
    ds_read_b64_tr_b16 v[196:197], v244 offset:53248
    ds_read_b64_tr_b16 v[198:199], v244 offset:53760
    v_mfma_f32_16x16x32_bf16 a[20:23], v[208:211], a[80:83], a[20:23]
    v_exp_f32 v249, v249
    v_mfma_f32_16x16x32_bf16 a[20:23], v[212:215], a[84:87], a[20:23]
    ds_read_b64_tr_b16 v[200:201], v244 offset:57344
    ds_read_b64_tr_b16 v[202:203], v244 offset:57856
    v_mfma_f32_16x16x32_bf16 a[20:23], v[216:219], a[88:91], a[20:23]
    s_add_u32 m0, s40, 40960
    v_exp_f32 v250, v250
    v_mfma_f32_16x16x32_bf16 a[20:23], v[220:223], a[92:95], a[20:23]
    s_mov_b32 s41, 40960
    ds_read_b64_tr_b16 v[204:205], v244 offset:61440
    ds_read_b64_tr_b16 v[206:207], v244 offset:61952
    v_mfma_f32_16x16x32_bf16 a[24:27], v[208:211], a[96:99], a[24:27]
    buffer_load_dwordx4 v236, s[8:11], s41 offen lds
    v_mfma_f32_16x16x32_bf16 a[24:27], v[212:215], a[100:103], a[24:27]
    v_exp_f32 v251, v251
    v_mfma_f32_16x16x32_bf16 a[24:27], v[216:219], a[104:107], a[24:27]
    v_fma_f32 v248, v248, s51, s51
    v_fma_f32 v249, v249, s51, s51
    v_mfma_f32_16x16x32_bf16 a[24:27], v[220:223], a[108:111], a[24:27]
    v_fma_f32 v250, v250, s51, s51
    v_fma_f32 v251, v251, s51, s51
    v_mfma_f32_16x16x32_bf16 a[28:31], v[208:211], a[112:115], a[28:31]
    s_add_u32 m0, s40, 45056
    v_rcp_f32 v248, v248
    v_mfma_f32_16x16x32_bf16 a[28:31], v[212:215], a[116:119], a[28:31]
    s_mov_b32 s41, 45056
    v_rcp_f32 v249, v249
    v_mfma_f32_16x16x32_bf16 a[28:31], v[216:219], a[120:123], a[28:31]
    buffer_load_dwordx4 v236, s[8:11], s41 offen lds
    v_mfma_f32_16x16x32_bf16 a[28:31], v[220:223], a[124:127], a[28:31]
    s_waitcnt lgkmcnt(0)
    v_rcp_f32 v250, v250
    v_mfma_f32_16x16x32_bf16 a[32:35], v[192:195], a[64:67], a[32:35]
    v_rcp_f32 v251, v251
    v_mfma_f32_16x16x32_bf16 a[32:35], v[196:199], a[68:71], a[32:35]
    ds_read_b64_tr_b16 v[208:209], v245 offset:49152
    ds_read_b64_tr_b16 v[210:211], v245 offset:49664
    v_mfma_f32_16x16x32_bf16 a[32:35], v[200:203], a[72:75], a[32:35]
    v_mul_f32 v32, v32, v248
    v_mul_f32 v33, v33, v249
    v_mfma_f32_16x16x32_bf16 a[32:35], v[204:207], a[76:79], a[32:35]
    ds_read_b64_tr_b16 v[212:213], v245 offset:53248
    ds_read_b64_tr_b16 v[214:215], v245 offset:53760
    v_mfma_f32_16x16x32_bf16 a[36:39], v[192:195], a[80:83], a[36:39]
    v_mul_f32 v34, v34, v250
    v_mul_f32 v35, v35, v251
    v_mfma_f32_16x16x32_bf16 a[36:39], v[196:199], a[84:87], a[36:39]
    ds_read_b64_tr_b16 v[216:217], v245 offset:57344
    ds_read_b64_tr_b16 v[218:219], v245 offset:57856
    v_mfma_f32_16x16x32_bf16 a[36:39], v[200:203], a[88:91], a[36:39]
    v_mul_f32 v248, s52, v48
    v_mul_f32 v249, s52, v49
    v_mfma_f32_16x16x32_bf16 a[36:39], v[204:207], a[92:95], a[36:39]
    ds_read_b64_tr_b16 v[220:221], v245 offset:61440
    ds_read_b64_tr_b16 v[222:223], v245 offset:61952
    v_mfma_f32_16x16x32_bf16 a[40:43], v[192:195], a[96:99], a[40:43]
    v_mul_f32 v250, s52, v50
    v_mul_f32 v251, s52, v51
    v_mfma_f32_16x16x32_bf16 a[40:43], v[196:199], a[100:103], a[40:43]
    v_exp_f32 v248, v248
    v_mfma_f32_16x16x32_bf16 a[40:43], v[200:203], a[104:107], a[40:43]
    v_exp_f32 v249, v249
    v_mfma_f32_16x16x32_bf16 a[40:43], v[204:207], a[108:111], a[40:43]
    v_exp_f32 v250, v250
    v_mfma_f32_16x16x32_bf16 a[44:47], v[192:195], a[112:115], a[44:47]
    v_exp_f32 v251, v251
    v_mfma_f32_16x16x32_bf16 a[44:47], v[196:199], a[116:119], a[44:47]
    v_fma_f32 v248, v248, s51, s51
    v_fma_f32 v249, v249, s51, s51
    v_mfma_f32_16x16x32_bf16 a[44:47], v[200:203], a[120:123], a[44:47]
    v_fma_f32 v250, v250, s51, s51
    v_fma_f32 v251, v251, s51, s51
    v_mfma_f32_16x16x32_bf16 a[44:47], v[204:207], a[124:127], a[44:47]
    s_waitcnt lgkmcnt(0)
    v_rcp_f32 v248, v248
    v_mfma_f32_16x16x32_bf16 a[48:51], v[208:211], a[64:67], a[48:51]
    s_waitcnt vmcnt(24)
    s_barrier
    v_mfma_f32_16x16x32_bf16 a[48:51], v[212:215], a[68:71], a[48:51]
    s_mul_i32 s65, s64, 1048576
    ds_read_b64_tr_b16 v[192:193], v242 offset:0
    ds_read_b64_tr_b16 v[194:195], v242 offset:512
    v_mfma_f32_16x16x32_bf16 a[48:51], v[216:219], a[72:75], a[48:51]
    s_add_u32 m0, s40, 147456
    v_rcp_f32 v249, v249
    v_mfma_f32_16x16x32_bf16 a[48:51], v[220:223], a[76:79], a[48:51]
    s_add_u32 s41, s65, 128
    ds_read_b64_tr_b16 v[196:197], v242 offset:4096
    ds_read_b64_tr_b16 v[198:199], v242 offset:4608
    v_mfma_f32_16x16x32_bf16 a[52:55], v[208:211], a[80:83], a[52:55]
    buffer_load_dwordx4 v240, s[16:19], s41 offen lds
    v_mfma_f32_16x16x32_bf16 a[52:55], v[212:215], a[84:87], a[52:55]
    ds_read_b64_tr_b16 v[200:201], v242 offset:8192
    ds_read_b64_tr_b16 v[202:203], v242 offset:8704
    v_mfma_f32_16x16x32_bf16 a[52:55], v[216:219], a[88:91], a[52:55]
    v_rcp_f32 v250, v250
    v_mfma_f32_16x16x32_bf16 a[52:55], v[220:223], a[92:95], a[52:55]
    ds_read_b64_tr_b16 v[204:205], v242 offset:12288
    ds_read_b64_tr_b16 v[206:207], v242 offset:12800
    v_mfma_f32_16x16x32_bf16 a[56:59], v[208:211], a[96:99], a[56:59]
    s_add_u32 m0, s40, 151552
    v_rcp_f32 v251, v251
    v_mfma_f32_16x16x32_bf16 a[56:59], v[212:215], a[100:103], a[56:59]
    s_add_u32 s41, s65, 262272
    v_mul_f32 v48, v48, v248
    v_mul_f32 v49, v49, v249
    v_mfma_f32_16x16x32_bf16 a[56:59], v[216:219], a[104:107], a[56:59]
    buffer_load_dwordx4 v240, s[16:19], s41 offen lds
    v_mfma_f32_16x16x32_bf16 a[56:59], v[220:223], a[108:111], a[56:59]
    v_mul_f32 v50, v50, v250
    v_mul_f32 v51, v51, v251
    v_mfma_f32_16x16x32_bf16 a[60:63], v[208:211], a[112:115], a[60:63]
    v_mul_f32 v248, s52, v36
    v_mul_f32 v249, s52, v37
    v_mfma_f32_16x16x32_bf16 a[60:63], v[212:215], a[116:119], a[60:63]
    s_add_u32 m0, s40, 155648
    v_mul_f32 v250, s52, v38
    v_mul_f32 v251, s52, v39
    v_mfma_f32_16x16x32_bf16 a[60:63], v[216:219], a[120:123], a[60:63]
    s_add_u32 s41, s65, 524416
    v_exp_f32 v248, v248
    v_mfma_f32_16x16x32_bf16 a[60:63], v[220:223], a[124:127], a[60:63]
    s_waitcnt lgkmcnt(0)
    v_exp_f32 v249, v249
    v_mfma_f32_16x16x32_bf16 a[0:3], v[192:195], a[128:131], a[0:3]
    buffer_load_dwordx4 v240, s[16:19], s41 offen lds
    v_mfma_f32_16x16x32_bf16 a[0:3], v[196:199], a[132:135], a[0:3]
    ds_read_b64_tr_b16 v[208:209], v243 offset:0
    ds_read_b64_tr_b16 v[210:211], v243 offset:512
    v_mfma_f32_16x16x32_bf16 a[0:3], v[200:203], a[136:139], a[0:3]
    v_exp_f32 v250, v250
    v_mfma_f32_16x16x32_bf16 a[0:3], v[204:207], a[140:143], a[0:3]
    ds_read_b64_tr_b16 v[212:213], v243 offset:4096
    ds_read_b64_tr_b16 v[214:215], v243 offset:4608
    v_mfma_f32_16x16x32_bf16 a[4:7], v[192:195], a[144:147], a[4:7]
    s_add_u32 m0, s40, 159744
    v_exp_f32 v251, v251
    v_mfma_f32_16x16x32_bf16 a[4:7], v[196:199], a[148:151], a[4:7]
    s_add_u32 s41, s65, 786560
    ds_read_b64_tr_b16 v[216:217], v243 offset:8192
    ds_read_b64_tr_b16 v[218:219], v243 offset:8704
    v_mfma_f32_16x16x32_bf16 a[4:7], v[200:203], a[152:155], a[4:7]
    buffer_load_dwordx4 v240, s[16:19], s41 offen lds
    v_mfma_f32_16x16x32_bf16 a[4:7], v[204:207], a[156:159], a[4:7]
    ds_read_b64_tr_b16 v[220:221], v243 offset:12288
    ds_read_b64_tr_b16 v[222:223], v243 offset:12800
    v_mfma_f32_16x16x32_bf16 a[8:11], v[192:195], a[160:163], a[8:11]
    v_fma_f32 v248, v248, s51, s51
    v_fma_f32 v249, v249, s51, s51
    v_mfma_f32_16x16x32_bf16 a[8:11], v[196:199], a[164:167], a[8:11]
    v_fma_f32 v250, v250, s51, s51
    v_fma_f32 v251, v251, s51, s51
    v_mfma_f32_16x16x32_bf16 a[8:11], v[200:203], a[168:171], a[8:11]
    s_add_u32 m0, s40, 49152
    v_rcp_f32 v248, v248
    v_mfma_f32_16x16x32_bf16 a[8:11], v[204:207], a[172:175], a[8:11]
    s_mov_b32 s41, 49152
    v_rcp_f32 v249, v249
    v_mfma_f32_16x16x32_bf16 a[12:15], v[192:195], a[176:179], a[12:15]
    buffer_load_dwordx4 v236, s[8:11], s41 offen lds
    v_mfma_f32_16x16x32_bf16 a[12:15], v[196:199], a[180:183], a[12:15]
    v_rcp_f32 v250, v250
    v_mfma_f32_16x16x32_bf16 a[12:15], v[200:203], a[184:187], a[12:15]
    v_rcp_f32 v251, v251
    v_mfma_f32_16x16x32_bf16 a[12:15], v[204:207], a[188:191], a[12:15]
    s_waitcnt lgkmcnt(0)
    v_mul_f32 v36, v36, v248
    v_mul_f32 v37, v37, v249
    v_mfma_f32_16x16x32_bf16 a[16:19], v[208:211], a[128:131], a[16:19]
    s_add_u32 m0, s40, 53248
    v_mul_f32 v38, v38, v250
    v_mul_f32 v39, v39, v251
    v_mfma_f32_16x16x32_bf16 a[16:19], v[212:215], a[132:135], a[16:19]
    s_mov_b32 s41, 53248
    ds_read_b64_tr_b16 v[192:193], v244 offset:0
    ds_read_b64_tr_b16 v[194:195], v244 offset:512
    v_mfma_f32_16x16x32_bf16 a[16:19], v[216:219], a[136:139], a[16:19]
    buffer_load_dwordx4 v236, s[8:11], s41 offen lds
    v_mfma_f32_16x16x32_bf16 a[16:19], v[220:223], a[140:143], a[16:19]
    ds_read_b64_tr_b16 v[196:197], v244 offset:4096
    ds_read_b64_tr_b16 v[198:199], v244 offset:4608
    v_mfma_f32_16x16x32_bf16 a[20:23], v[208:211], a[144:147], a[20:23]
    v_mul_f32 v248, s52, v52
    v_mul_f32 v249, s52, v53
    v_mfma_f32_16x16x32_bf16 a[20:23], v[212:215], a[148:151], a[20:23]
    ds_read_b64_tr_b16 v[200:201], v244 offset:8192
    ds_read_b64_tr_b16 v[202:203], v244 offset:8704
    v_mfma_f32_16x16x32_bf16 a[20:23], v[216:219], a[152:155], a[20:23]
    s_add_u32 m0, s40, 57344
    v_mul_f32 v250, s52, v54
    v_mul_f32 v251, s52, v55
    v_mfma_f32_16x16x32_bf16 a[20:23], v[220:223], a[156:159], a[20:23]
    s_mov_b32 s41, 57344
    ds_read_b64_tr_b16 v[204:205], v244 offset:12288
    ds_read_b64_tr_b16 v[206:207], v244 offset:12800
    v_mfma_f32_16x16x32_bf16 a[24:27], v[208:211], a[160:163], a[24:27]
    buffer_load_dwordx4 v236, s[8:11], s41 offen lds
    v_mfma_f32_16x16x32_bf16 a[24:27], v[212:215], a[164:167], a[24:27]
    v_exp_f32 v248, v248
    v_mfma_f32_16x16x32_bf16 a[24:27], v[216:219], a[168:171], a[24:27]
    v_exp_f32 v249, v249
    v_mfma_f32_16x16x32_bf16 a[24:27], v[220:223], a[172:175], a[24:27]
    v_exp_f32 v250, v250
    v_mfma_f32_16x16x32_bf16 a[28:31], v[208:211], a[176:179], a[28:31]
    s_add_u32 m0, s40, 61440
    v_exp_f32 v251, v251
    v_mfma_f32_16x16x32_bf16 a[28:31], v[212:215], a[180:183], a[28:31]
    s_mov_b32 s41, 61440
    v_fma_f32 v248, v248, s51, s51
    v_fma_f32 v249, v249, s51, s51
    v_mfma_f32_16x16x32_bf16 a[28:31], v[216:219], a[184:187], a[28:31]
    buffer_load_dwordx4 v236, s[8:11], s41 offen lds
    v_mfma_f32_16x16x32_bf16 a[28:31], v[220:223], a[188:191], a[28:31]
    s_waitcnt lgkmcnt(0)
    v_fma_f32 v250, v250, s51, s51
    v_fma_f32 v251, v251, s51, s51
    v_mfma_f32_16x16x32_bf16 a[32:35], v[192:195], a[128:131], a[32:35]
    v_rcp_f32 v248, v248
    v_mfma_f32_16x16x32_bf16 a[32:35], v[196:199], a[132:135], a[32:35]
    ds_read_b64_tr_b16 v[208:209], v245 offset:0
    ds_read_b64_tr_b16 v[210:211], v245 offset:512
    v_mfma_f32_16x16x32_bf16 a[32:35], v[200:203], a[136:139], a[32:35]
    v_rcp_f32 v249, v249
    v_mfma_f32_16x16x32_bf16 a[32:35], v[204:207], a[140:143], a[32:35]
    ds_read_b64_tr_b16 v[212:213], v245 offset:4096
    ds_read_b64_tr_b16 v[214:215], v245 offset:4608
    v_mfma_f32_16x16x32_bf16 a[36:39], v[192:195], a[144:147], a[36:39]
    v_rcp_f32 v250, v250
    v_mfma_f32_16x16x32_bf16 a[36:39], v[196:199], a[148:151], a[36:39]
    ds_read_b64_tr_b16 v[216:217], v245 offset:8192
    ds_read_b64_tr_b16 v[218:219], v245 offset:8704
    v_mfma_f32_16x16x32_bf16 a[36:39], v[200:203], a[152:155], a[36:39]
    v_rcp_f32 v251, v251
    v_mfma_f32_16x16x32_bf16 a[36:39], v[204:207], a[156:159], a[36:39]
    ds_read_b64_tr_b16 v[220:221], v245 offset:12288
    ds_read_b64_tr_b16 v[222:223], v245 offset:12800
    v_mfma_f32_16x16x32_bf16 a[40:43], v[192:195], a[160:163], a[40:43]
    v_mul_f32 v52, v52, v248
    v_mul_f32 v53, v53, v249
    v_mfma_f32_16x16x32_bf16 a[40:43], v[196:199], a[164:167], a[40:43]
    v_mul_f32 v54, v54, v250
    v_mul_f32 v55, v55, v251
    v_mfma_f32_16x16x32_bf16 a[40:43], v[200:203], a[168:171], a[40:43]
    v_mul_f32 v248, s52, v40
    v_mul_f32 v249, s52, v41
    v_mfma_f32_16x16x32_bf16 a[40:43], v[204:207], a[172:175], a[40:43]
    v_mul_f32 v250, s52, v42
    v_mul_f32 v251, s52, v43
    v_mfma_f32_16x16x32_bf16 a[44:47], v[192:195], a[176:179], a[44:47]
    v_exp_f32 v248, v248
    v_mfma_f32_16x16x32_bf16 a[44:47], v[196:199], a[180:183], a[44:47]
    v_exp_f32 v249, v249
    v_mfma_f32_16x16x32_bf16 a[44:47], v[200:203], a[184:187], a[44:47]
    v_exp_f32 v250, v250
    v_mfma_f32_16x16x32_bf16 a[44:47], v[204:207], a[188:191], a[44:47]
    s_waitcnt lgkmcnt(0)
    v_exp_f32 v251, v251
    v_mfma_f32_16x16x32_bf16 a[48:51], v[208:211], a[128:131], a[48:51]
    s_waitcnt vmcnt(24)
    s_barrier
    v_fma_f32 v248, v248, s51, s51
    v_mfma_f32_16x16x32_bf16 a[48:51], v[212:215], a[132:135], a[48:51]
    ds_read_b64_tr_b16 v[192:193], v242 offset:16384
    ds_read_b64_tr_b16 v[194:195], v242 offset:16896
    v_mfma_f32_16x16x32_bf16 a[48:51], v[216:219], a[136:139], a[48:51]
    s_add_u32 m0, s40, 65536
    v_fma_f32 v249, v249, s51, s51
    v_fma_f32 v250, v250, s51, s51
    v_mfma_f32_16x16x32_bf16 a[48:51], v[220:223], a[140:143], a[48:51]
    s_mov_b32 s41, 0
    ds_read_b64_tr_b16 v[196:197], v242 offset:20480
    ds_read_b64_tr_b16 v[198:199], v242 offset:20992
    v_mfma_f32_16x16x32_bf16 a[52:55], v[208:211], a[144:147], a[52:55]
    buffer_load_dwordx4 v237, s[12:15], s41 offen lds
    v_mfma_f32_16x16x32_bf16 a[52:55], v[212:215], a[148:151], a[52:55]
    ds_read_b64_tr_b16 v[200:201], v242 offset:24576
    ds_read_b64_tr_b16 v[202:203], v242 offset:25088
    v_mfma_f32_16x16x32_bf16 a[52:55], v[216:219], a[152:155], a[52:55]
    v_fma_f32 v251, v251, s51, s51
    v_mfma_f32_16x16x32_bf16 a[52:55], v[220:223], a[156:159], a[52:55]
    ds_read_b64_tr_b16 v[204:205], v242 offset:28672
    ds_read_b64_tr_b16 v[206:207], v242 offset:29184
    v_mfma_f32_16x16x32_bf16 a[56:59], v[208:211], a[160:163], a[56:59]
    s_add_u32 m0, s40, 69632
    v_rcp_f32 v248, v248
    v_mfma_f32_16x16x32_bf16 a[56:59], v[212:215], a[164:167], a[56:59]
    s_mov_b32 s41, 4096
    v_rcp_f32 v249, v249
    v_mfma_f32_16x16x32_bf16 a[56:59], v[216:219], a[168:171], a[56:59]
    buffer_load_dwordx4 v237, s[12:15], s41 offen lds
    v_mfma_f32_16x16x32_bf16 a[56:59], v[220:223], a[172:175], a[56:59]
    v_rcp_f32 v250, v250
    v_mfma_f32_16x16x32_bf16 a[60:63], v[208:211], a[176:179], a[60:63]
    v_rcp_f32 v251, v251
    v_mfma_f32_16x16x32_bf16 a[60:63], v[212:215], a[180:183], a[60:63]
    s_add_u32 m0, s40, 73728
    v_mul_f32 v40, v40, v248
    v_mul_f32 v41, v41, v249
    v_mfma_f32_16x16x32_bf16 a[60:63], v[216:219], a[184:187], a[60:63]
    s_mov_b32 s41, 8192
    v_mul_f32 v42, v42, v250
    v_mul_f32 v43, v43, v251
    v_mfma_f32_16x16x32_bf16 a[60:63], v[220:223], a[188:191], a[60:63]
    s_waitcnt lgkmcnt(0)
    v_mul_f32 v248, s52, v56
    v_mul_f32 v249, s52, v57
    v_mfma_f32_16x16x32_bf16 v[128:131], v[192:195], a[192:195], v[128:131]
    buffer_load_dwordx4 v237, s[12:15], s41 offen lds
    v_mfma_f32_16x16x32_bf16 v[128:131], v[196:199], a[196:199], v[128:131]
    ds_read_b64_tr_b16 v[208:209], v243 offset:16384
    ds_read_b64_tr_b16 v[210:211], v243 offset:16896
    v_mfma_f32_16x16x32_bf16 v[128:131], v[200:203], a[200:203], v[128:131]
    v_mul_f32 v250, s52, v58
    v_mul_f32 v251, s52, v59
    v_mfma_f32_16x16x32_bf16 v[128:131], v[204:207], a[204:207], v[128:131]
    ds_read_b64_tr_b16 v[212:213], v243 offset:20480
    ds_read_b64_tr_b16 v[214:215], v243 offset:20992
    v_mfma_f32_16x16x32_bf16 v[132:135], v[192:195], a[208:211], v[132:135]
    s_add_u32 m0, s40, 77824
    v_exp_f32 v248, v248
    v_mfma_f32_16x16x32_bf16 v[132:135], v[196:199], a[212:215], v[132:135]
    s_mov_b32 s41, 12288
    ds_read_b64_tr_b16 v[216:217], v243 offset:24576
    ds_read_b64_tr_b16 v[218:219], v243 offset:25088
    v_mfma_f32_16x16x32_bf16 v[132:135], v[200:203], a[216:219], v[132:135]
    buffer_load_dwordx4 v237, s[12:15], s41 offen lds
    v_mfma_f32_16x16x32_bf16 v[132:135], v[204:207], a[220:223], v[132:135]
    ds_read_b64_tr_b16 v[220:221], v243 offset:28672
    ds_read_b64_tr_b16 v[222:223], v243 offset:29184
    v_mfma_f32_16x16x32_bf16 v[136:139], v[192:195], a[224:227], v[136:139]
    v_exp_f32 v249, v249
    v_mfma_f32_16x16x32_bf16 v[136:139], v[196:199], a[228:231], v[136:139]
    v_exp_f32 v250, v250
    v_mfma_f32_16x16x32_bf16 v[136:139], v[200:203], a[232:235], v[136:139]
    s_add_u32 m0, s40, 81920
    v_exp_f32 v251, v251
    v_mfma_f32_16x16x32_bf16 v[136:139], v[204:207], a[236:239], v[136:139]
    s_mov_b32 s41, 16384
    v_fma_f32 v248, v248, s51, s51
    v_fma_f32 v249, v249, s51, s51
    v_mfma_f32_16x16x32_bf16 v[140:143], v[192:195], a[240:243], v[140:143]
    buffer_load_dwordx4 v237, s[12:15], s41 offen lds
    v_mfma_f32_16x16x32_bf16 v[140:143], v[196:199], a[244:247], v[140:143]
    v_fma_f32 v250, v250, s51, s51
    v_fma_f32 v251, v251, s51, s51
    v_mfma_f32_16x16x32_bf16 v[140:143], v[200:203], a[248:251], v[140:143]
    v_rcp_f32 v248, v248
    v_mfma_f32_16x16x32_bf16 v[140:143], v[204:207], a[252:255], v[140:143]
    s_waitcnt lgkmcnt(0)
    v_rcp_f32 v249, v249
    v_mfma_f32_16x16x32_bf16 v[144:147], v[208:211], a[192:195], v[144:147]
    s_add_u32 m0, s40, 86016
    v_rcp_f32 v250, v250
    v_mfma_f32_16x16x32_bf16 v[144:147], v[212:215], a[196:199], v[144:147]
    s_mov_b32 s41, 20480
    ds_read_b64_tr_b16 v[192:193], v244 offset:16384
    ds_read_b64_tr_b16 v[194:195], v244 offset:16896
    v_mfma_f32_16x16x32_bf16 v[144:147], v[216:219], a[200:203], v[144:147]
    buffer_load_dwordx4 v237, s[12:15], s41 offen lds
    v_mfma_f32_16x16x32_bf16 v[144:147], v[220:223], a[204:207], v[144:147]
    ds_read_b64_tr_b16 v[196:197], v244 offset:20480
    ds_read_b64_tr_b16 v[198:199], v244 offset:20992
    v_mfma_f32_16x16x32_bf16 v[148:151], v[208:211], a[208:211], v[148:151]
    v_rcp_f32 v251, v251
    v_mfma_f32_16x16x32_bf16 v[148:151], v[212:215], a[212:215], v[148:151]
    ds_read_b64_tr_b16 v[200:201], v244 offset:24576
    ds_read_b64_tr_b16 v[202:203], v244 offset:25088
    v_mfma_f32_16x16x32_bf16 v[148:151], v[216:219], a[216:219], v[148:151]
    s_add_u32 m0, s40, 90112
    v_mul_f32 v56, v56, v248
    v_mul_f32 v57, v57, v249
    v_mfma_f32_16x16x32_bf16 v[148:151], v[220:223], a[220:223], v[148:151]
    s_mov_b32 s41, 24576
    ds_read_b64_tr_b16 v[204:205], v244 offset:28672
    ds_read_b64_tr_b16 v[206:207], v244 offset:29184
    v_mfma_f32_16x16x32_bf16 v[152:155], v[208:211], a[224:227], v[152:155]
    buffer_load_dwordx4 v237, s[12:15], s41 offen lds
    v_mfma_f32_16x16x32_bf16 v[152:155], v[212:215], a[228:231], v[152:155]
    v_mul_f32 v58, v58, v250
    v_mul_f32 v59, v59, v251
    v_mfma_f32_16x16x32_bf16 v[152:155], v[216:219], a[232:235], v[152:155]
    v_mul_f32 v248, s52, v44
    v_mul_f32 v249, s52, v45
    v_mfma_f32_16x16x32_bf16 v[152:155], v[220:223], a[236:239], v[152:155]
    v_mul_f32 v250, s52, v46
    v_mul_f32 v251, s52, v47
    v_mfma_f32_16x16x32_bf16 v[156:159], v[208:211], a[240:243], v[156:159]
    s_add_u32 m0, s40, 94208
    v_exp_f32 v248, v248
    v_mfma_f32_16x16x32_bf16 v[156:159], v[212:215], a[244:247], v[156:159]
    s_mov_b32 s41, 28672
    v_exp_f32 v249, v249
    v_mfma_f32_16x16x32_bf16 v[156:159], v[216:219], a[248:251], v[156:159]
    buffer_load_dwordx4 v237, s[12:15], s41 offen lds
    v_mfma_f32_16x16x32_bf16 v[156:159], v[220:223], a[252:255], v[156:159]
    s_waitcnt lgkmcnt(0)
    v_exp_f32 v250, v250
    v_mfma_f32_16x16x32_bf16 v[160:163], v[192:195], a[192:195], v[160:163]
    v_exp_f32 v251, v251
    v_mfma_f32_16x16x32_bf16 v[160:163], v[196:199], a[196:199], v[160:163]
    ds_read_b64_tr_b16 v[208:209], v245 offset:16384
    ds_read_b64_tr_b16 v[210:211], v245 offset:16896
    v_mfma_f32_16x16x32_bf16 v[160:163], v[200:203], a[200:203], v[160:163]
    v_fma_f32 v248, v248, s51, s51
    v_fma_f32 v249, v249, s51, s51
    v_mfma_f32_16x16x32_bf16 v[160:163], v[204:207], a[204:207], v[160:163]
    ds_read_b64_tr_b16 v[212:213], v245 offset:20480
    ds_read_b64_tr_b16 v[214:215], v245 offset:20992
    v_mfma_f32_16x16x32_bf16 v[164:167], v[192:195], a[208:211], v[164:167]
    v_fma_f32 v250, v250, s51, s51
    v_fma_f32 v251, v251, s51, s51
    v_mfma_f32_16x16x32_bf16 v[164:167], v[196:199], a[212:215], v[164:167]
    ds_read_b64_tr_b16 v[216:217], v245 offset:24576
    ds_read_b64_tr_b16 v[218:219], v245 offset:25088
    v_mfma_f32_16x16x32_bf16 v[164:167], v[200:203], a[216:219], v[164:167]
    v_rcp_f32 v248, v248
    v_mfma_f32_16x16x32_bf16 v[164:167], v[204:207], a[220:223], v[164:167]
    ds_read_b64_tr_b16 v[220:221], v245 offset:28672
    ds_read_b64_tr_b16 v[222:223], v245 offset:29184
    v_mfma_f32_16x16x32_bf16 v[168:171], v[192:195], a[224:227], v[168:171]
    v_rcp_f32 v249, v249
    v_mfma_f32_16x16x32_bf16 v[168:171], v[196:199], a[228:231], v[168:171]
    v_rcp_f32 v250, v250
    v_mfma_f32_16x16x32_bf16 v[168:171], v[200:203], a[232:235], v[168:171]
    v_rcp_f32 v251, v251
    v_mfma_f32_16x16x32_bf16 v[168:171], v[204:207], a[236:239], v[168:171]
    v_mul_f32 v44, v44, v248
    v_mul_f32 v45, v45, v249
    v_mfma_f32_16x16x32_bf16 v[172:175], v[192:195], a[240:243], v[172:175]
    v_mul_f32 v46, v46, v250
    v_mul_f32 v47, v47, v251
    v_mfma_f32_16x16x32_bf16 v[172:175], v[196:199], a[244:247], v[172:175]
    v_mul_f32 v248, s52, v60
    v_mul_f32 v249, s52, v61
    v_mfma_f32_16x16x32_bf16 v[172:175], v[200:203], a[248:251], v[172:175]
    v_mul_f32 v250, s52, v62
    v_mul_f32 v251, s52, v63
    v_mfma_f32_16x16x32_bf16 v[172:175], v[204:207], a[252:255], v[172:175]
    s_waitcnt lgkmcnt(0)
    v_exp_f32 v248, v248
    v_mfma_f32_16x16x32_bf16 v[176:179], v[208:211], a[192:195], v[176:179]
    s_waitcnt vmcnt(23)
    s_barrier
    v_mfma_f32_16x16x32_bf16 v[176:179], v[212:215], a[196:199], v[176:179]
    ds_read_b64_tr_b16 v[192:193], v242 offset:32768
    ds_read_b64_tr_b16 v[194:195], v242 offset:33280
    v_mfma_f32_16x16x32_bf16 v[176:179], v[216:219], a[200:203], v[176:179]
    v_exp_f32 v249, v249
    v_mfma_f32_16x16x32_bf16 v[176:179], v[220:223], a[204:207], v[176:179]
    s_add_u32 m0, s66, 0
    ds_read_b64_tr_b16 v[196:197], v242 offset:36864
    ds_read_b64_tr_b16 v[198:199], v242 offset:37376
    v_mfma_f32_16x16x32_bf16 v[180:183], v[208:211], a[208:211], v[180:183]
    buffer_load_dwordx4 v239, s[20:23], s56 offen lds
    v_mfma_f32_16x16x32_bf16 v[180:183], v[212:215], a[212:215], v[180:183]
    ds_read_b64_tr_b16 v[200:201], v242 offset:40960
    ds_read_b64_tr_b16 v[202:203], v242 offset:41472
    v_mfma_f32_16x16x32_bf16 v[180:183], v[216:219], a[216:219], v[180:183]
    v_exp_f32 v250, v250
    v_mfma_f32_16x16x32_bf16 v[180:183], v[220:223], a[220:223], v[180:183]
    ds_read_b64_tr_b16 v[204:205], v242 offset:45056
    ds_read_b64_tr_b16 v[206:207], v242 offset:45568
    v_mfma_f32_16x16x32_bf16 v[184:187], v[208:211], a[224:227], v[184:187]
    v_exp_f32 v251, v251
    v_mfma_f32_16x16x32_bf16 v[184:187], v[212:215], a[228:231], v[184:187]
    s_add_u32 m0, s66, 1024
    v_fma_f32 v248, v248, s51, s51
    v_fma_f32 v249, v249, s51, s51
    v_mfma_f32_16x16x32_bf16 v[184:187], v[216:219], a[232:235], v[184:187]
    buffer_load_dwordx4 v241, s[20:23], s56 offen lds
    v_mfma_f32_16x16x32_bf16 v[184:187], v[220:223], a[236:239], v[184:187]
    v_fma_f32 v250, v250, s51, s51
    v_fma_f32 v251, v251, s51, s51
    v_mfma_f32_16x16x32_bf16 v[188:191], v[208:211], a[240:243], v[188:191]
    v_rcp_f32 v248, v248
    v_mfma_f32_16x16x32_bf16 v[188:191], v[212:215], a[244:247], v[188:191]
    v_rcp_f32 v249, v249
    v_mfma_f32_16x16x32_bf16 v[188:191], v[216:219], a[248:251], v[188:191]
    s_add_u32 m0, s66, 2048
    v_rcp_f32 v250, v250
    v_mfma_f32_16x16x32_bf16 v[188:191], v[220:223], a[252:255], v[188:191]
    s_waitcnt lgkmcnt(0)
    v_rcp_f32 v251, v251
    v_mfma_f32_16x16x32_bf16 v[128:131], v[192:195], a[64:67], v[128:131]
    s_mov_b32 exec_hi, 0
    buffer_load_dwordx4 v253, s[20:23], s56 offen lds
    s_mov_b32 exec_hi, -1
    v_mfma_f32_16x16x32_bf16 v[128:131], v[196:199], a[68:71], v[128:131]
    ds_read_b64_tr_b16 v[208:209], v243 offset:32768
    ds_read_b64_tr_b16 v[210:211], v243 offset:33280
    v_mfma_f32_16x16x32_bf16 v[128:131], v[200:203], a[72:75], v[128:131]
    v_mul_f32 v60, v60, v248
    v_mul_f32 v61, v61, v249
    v_mfma_f32_16x16x32_bf16 v[128:131], v[204:207], a[76:79], v[128:131]
    ds_read_b64_tr_b16 v[212:213], v243 offset:36864
    ds_read_b64_tr_b16 v[214:215], v243 offset:37376
    v_mfma_f32_16x16x32_bf16 v[132:135], v[192:195], a[80:83], v[132:135]
    v_mul_f32 v62, v62, v250
    v_mul_f32 v63, v63, v251
    v_mfma_f32_16x16x32_bf16 v[132:135], v[196:199], a[84:87], v[132:135]
    s_add_u32 m0, s66, 2560
    ds_read_b64_tr_b16 v[216:217], v243 offset:40960
    ds_read_b64_tr_b16 v[218:219], v243 offset:41472
    v_mfma_f32_16x16x32_bf16 v[132:135], v[200:203], a[88:91], v[132:135]
    buffer_load_dwordx4 v239, s[20:23], s57 offen lds
    v_mfma_f32_16x16x32_bf16 v[132:135], v[204:207], a[92:95], v[132:135]
    ds_read_b64_tr_b16 v[220:221], v243 offset:45056
    ds_read_b64_tr_b16 v[222:223], v243 offset:45568
    v_mfma_f32_16x16x32_bf16 v[136:139], v[192:195], a[96:99], v[136:139]
    v_mul_f32 v32, v32, v96
    v_mul_f32 v33, v33, v97
    v_mfma_f32_16x16x32_bf16 v[136:139], v[196:199], a[100:103], v[136:139]
    v_mul_f32 v34, v34, v98
    v_mul_f32 v35, v35, v99
    v_mfma_f32_16x16x32_bf16 v[136:139], v[200:203], a[104:107], v[136:139]
    v_mul_f32 v48, v48, v112
    v_mul_f32 v49, v49, v113
    v_mfma_f32_16x16x32_bf16 v[136:139], v[204:207], a[108:111], v[136:139]
    s_add_u32 m0, s66, 3584
    v_mul_f32 v50, v50, v114
    v_mul_f32 v51, v51, v115
    v_mfma_f32_16x16x32_bf16 v[140:143], v[192:195], a[112:115], v[140:143]
    buffer_load_dwordx4 v241, s[20:23], s57 offen lds
    v_mfma_f32_16x16x32_bf16 v[140:143], v[196:199], a[116:119], v[140:143]
    v_cvt_pk_bf16_f32 v96, v32, v33
    v_cvt_pk_bf16_f32 v97, v34, v35
    v_mfma_f32_16x16x32_bf16 v[140:143], v[200:203], a[120:123], v[140:143]
    v_cvt_pk_bf16_f32 v98, v48, v49
    v_cvt_pk_bf16_f32 v99, v50, v51
    v_mfma_f32_16x16x32_bf16 v[140:143], v[204:207], a[124:127], v[140:143]
    s_waitcnt lgkmcnt(0)
    v_mul_f32 v36, v36, v100
    v_mul_f32 v37, v37, v101
    v_mfma_f32_16x16x32_bf16 v[144:147], v[208:211], a[64:67], v[144:147]
    v_mul_f32 v38, v38, v102
    v_mul_f32 v39, v39, v103
    v_mfma_f32_16x16x32_bf16 v[144:147], v[212:215], a[68:71], v[144:147]
    s_add_u32 m0, s66, 4608
    ds_read_b64_tr_b16 v[192:193], v244 offset:32768
    ds_read_b64_tr_b16 v[194:195], v244 offset:33280
    v_mfma_f32_16x16x32_bf16 v[144:147], v[216:219], a[72:75], v[144:147]
    s_mov_b32 exec_hi, 0
    buffer_load_dwordx4 v253, s[20:23], s57 offen lds
    s_mov_b32 exec_hi, -1
    v_mfma_f32_16x16x32_bf16 v[144:147], v[220:223], a[76:79], v[144:147]
    ds_read_b64_tr_b16 v[196:197], v244 offset:36864
    ds_read_b64_tr_b16 v[198:199], v244 offset:37376
    v_mfma_f32_16x16x32_bf16 v[148:151], v[208:211], a[80:83], v[148:151]
    v_mul_f32 v52, v52, v116
    v_mul_f32 v53, v53, v117
    v_mfma_f32_16x16x32_bf16 v[148:151], v[212:215], a[84:87], v[148:151]
    ds_read_b64_tr_b16 v[200:201], v244 offset:40960
    ds_read_b64_tr_b16 v[202:203], v244 offset:41472
    v_mfma_f32_16x16x32_bf16 v[148:151], v[216:219], a[88:91], v[148:151]
    v_mul_f32 v54, v54, v118
    v_mul_f32 v55, v55, v119
    v_mfma_f32_16x16x32_bf16 v[148:151], v[220:223], a[92:95], v[148:151]
    ds_read_b64_tr_b16 v[204:205], v244 offset:45056
    ds_read_b64_tr_b16 v[206:207], v244 offset:45568
    v_mfma_f32_16x16x32_bf16 v[152:155], v[208:211], a[96:99], v[152:155]
    v_cvt_pk_bf16_f32 v100, v36, v37
    v_cvt_pk_bf16_f32 v101, v38, v39
    v_mfma_f32_16x16x32_bf16 v[152:155], v[212:215], a[100:103], v[152:155]
L_padA_4:
    s_cbranch_execz L_padD_0
    v_cvt_pk_bf16_f32 v102, v52, v53
    v_cvt_pk_bf16_f32 v103, v54, v55
    v_mfma_f32_16x16x32_bf16 v[152:155], v[216:219], a[104:107], v[152:155]
    v_mul_f32 v40, v40, v104
    v_mul_f32 v41, v41, v105
    v_mfma_f32_16x16x32_bf16 v[152:155], v[220:223], a[108:111], v[152:155]
    v_mul_f32 v42, v42, v106
    v_mul_f32 v43, v43, v107
    v_mfma_f32_16x16x32_bf16 v[156:159], v[208:211], a[112:115], v[156:159]
    v_mul_f32 v56, v56, v120
    v_mul_f32 v57, v57, v121
    v_mfma_f32_16x16x32_bf16 v[156:159], v[212:215], a[116:119], v[156:159]
    v_mul_f32 v58, v58, v122
    v_mul_f32 v59, v59, v123
    v_mfma_f32_16x16x32_bf16 v[156:159], v[216:219], a[120:123], v[156:159]
    v_cvt_pk_bf16_f32 v104, v40, v41
    v_cvt_pk_bf16_f32 v105, v42, v43
    v_mfma_f32_16x16x32_bf16 v[156:159], v[220:223], a[124:127], v[156:159]
    s_waitcnt lgkmcnt(0)
    v_cvt_pk_bf16_f32 v106, v56, v57
    v_cvt_pk_bf16_f32 v107, v58, v59
    v_mfma_f32_16x16x32_bf16 v[160:163], v[192:195], a[64:67], v[160:163]
    v_mul_f32 v44, v44, v108
    v_mul_f32 v45, v45, v109
    v_mfma_f32_16x16x32_bf16 v[160:163], v[196:199], a[68:71], v[160:163]
    ds_read_b64_tr_b16 v[208:209], v245 offset:32768
    ds_read_b64_tr_b16 v[210:211], v245 offset:33280
    v_mfma_f32_16x16x32_bf16 v[160:163], v[200:203], a[72:75], v[160:163]
    v_mul_f32 v46, v46, v110
    v_mul_f32 v47, v47, v111
    v_mfma_f32_16x16x32_bf16 v[160:163], v[204:207], a[76:79], v[160:163]
    ds_read_b64_tr_b16 v[212:213], v245 offset:36864
    ds_read_b64_tr_b16 v[214:215], v245 offset:37376
    v_mfma_f32_16x16x32_bf16 v[164:167], v[192:195], a[80:83], v[164:167]
    v_mul_f32 v60, v60, v124
    v_mul_f32 v61, v61, v125
    v_mfma_f32_16x16x32_bf16 v[164:167], v[196:199], a[84:87], v[164:167]
    ds_read_b64_tr_b16 v[216:217], v245 offset:40960
    ds_read_b64_tr_b16 v[218:219], v245 offset:41472
    v_mfma_f32_16x16x32_bf16 v[164:167], v[200:203], a[88:91], v[164:167]
    v_mul_f32 v62, v62, v126
    v_mul_f32 v63, v63, v127
    v_mfma_f32_16x16x32_bf16 v[164:167], v[204:207], a[92:95], v[164:167]
    ds_read_b64_tr_b16 v[220:221], v245 offset:45056
    ds_read_b64_tr_b16 v[222:223], v245 offset:45568
    v_mfma_f32_16x16x32_bf16 v[168:171], v[192:195], a[96:99], v[168:171]
    v_cvt_pk_bf16_f32 v108, v44, v45
    v_cvt_pk_bf16_f32 v109, v46, v47
    v_mfma_f32_16x16x32_bf16 v[168:171], v[196:199], a[100:103], v[168:171]
    v_cvt_pk_bf16_f32 v110, v60, v61
    v_cvt_pk_bf16_f32 v111, v62, v63
    v_mfma_f32_16x16x32_bf16 v[168:171], v[200:203], a[104:107], v[168:171]
    buffer_store_dwordx4 v[96:99], v247, s[32:35], s50 offen offset:0 sc1
    v_mfma_f32_16x16x32_bf16 v[168:171], v[204:207], a[108:111], v[168:171]
    buffer_store_dwordx4 v[100:103], v247, s[32:35], s50 offen offset:1024 sc1
    v_mfma_f32_16x16x32_bf16 v[172:175], v[192:195], a[112:115], v[172:175]
    buffer_store_dwordx4 v[104:107], v247, s[32:35], s50 offen offset:2048 sc1
    v_mfma_f32_16x16x32_bf16 v[172:175], v[196:199], a[116:119], v[172:175]
    buffer_store_dwordx4 v[108:111], v247, s[32:35], s50 offen offset:3072 sc1
    v_mfma_f32_16x16x32_bf16 v[172:175], v[200:203], a[120:123], v[172:175]
    v_mov_b32 v120, 0xff800000
    v_mov_b32 v121, 0xff800000
    v_mfma_f32_16x16x32_bf16 v[172:175], v[204:207], a[124:127], v[172:175]
    s_waitcnt lgkmcnt(0)
    v_mov_b32 v122, 0xff800000
    v_mov_b32 v123, 0xff800000
    v_mfma_f32_16x16x32_bf16 v[176:179], v[208:211], a[64:67], v[176:179]
    s_waitcnt vmcnt(22)
    s_barrier
    v_lshrrev_b32 v124, 6, v238
    v_bfe_u32 v125, v238, 4, 2
    v_mfma_f32_16x16x32_bf16 v[176:179], v[212:215], a[68:71], v[176:179]
    ds_read_b64_tr_b16 v[192:193], v242 offset:49152
    ds_read_b64_tr_b16 v[194:195], v242 offset:49664
    v_mfma_f32_16x16x32_bf16 v[176:179], v[216:219], a[72:75], v[176:179]
    v_mul_u32_u24 v124, 160, v124
    v_lshl_add_u32 v124, v125, 3, v124
    v_mfma_f32_16x16x32_bf16 v[176:179], v[220:223], a[76:79], v[176:179]
    ds_read_b64_tr_b16 v[196:197], v242 offset:53248
    ds_read_b64_tr_b16 v[198:199], v242 offset:53760
    v_mfma_f32_16x16x32_bf16 v[180:183], v[208:211], a[80:83], v[180:183]
    v_add_u32 v124, s66, v124
    v_accvgpr_read_b32 v248, a0
    v_accvgpr_read_b32 v249, a1
    v_mfma_f32_16x16x32_bf16 v[180:183], v[212:215], a[84:87], v[180:183]
    ds_read_b64_tr_b16 v[200:201], v242 offset:57344
    ds_read_b64_tr_b16 v[202:203], v242 offset:57856
    v_mfma_f32_16x16x32_bf16 v[180:183], v[216:219], a[88:91], v[180:183]
    v_accvgpr_read_b32 v250, a2
    v_accvgpr_read_b32 v251, a3
    v_mfma_f32_16x16x32_bf16 v[180:183], v[220:223], a[92:95], v[180:183]
    ds_read_b64_tr_b16 v[204:205], v242 offset:61440
    ds_read_b64_tr_b16 v[206:207], v242 offset:61952
    v_cvt_pk_bf16_f32 v0, v248, v249
    v_mfma_f32_16x16x32_bf16 v[184:187], v[208:211], a[96:99], v[184:187]
    v_cvt_pk_bf16_f32 v1, v250, v251
    v_accvgpr_read_b32 v248, a16
    v_mfma_f32_16x16x32_bf16 v[184:187], v[212:215], a[100:103], v[184:187]
    v_accvgpr_read_b32 v249, a17
    v_accvgpr_read_b32 v250, a18
    v_mfma_f32_16x16x32_bf16 v[184:187], v[216:219], a[104:107], v[184:187]
    v_accvgpr_read_b32 v251, a19
    v_cvt_pk_bf16_f32 v2, v248, v249
    v_mfma_f32_16x16x32_bf16 v[184:187], v[220:223], a[108:111], v[184:187]
    v_cvt_pk_bf16_f32 v3, v250, v251
    v_accvgpr_read_b32 v248, a4
    v_accvgpr_read_b32 v249, a5
    v_mfma_f32_16x16x32_bf16 v[188:191], v[208:211], a[112:115], v[188:191]
    v_accvgpr_read_b32 v250, a6
    v_accvgpr_read_b32 v251, a7
    v_mfma_f32_16x16x32_bf16 v[188:191], v[212:215], a[116:119], v[188:191]
    v_cvt_pk_bf16_f32 v16, v248, v249
    v_cvt_pk_bf16_f32 v17, v250, v251
    v_mfma_f32_16x16x32_bf16 v[188:191], v[216:219], a[120:123], v[188:191]
    v_accvgpr_read_b32 v248, a20
    v_accvgpr_read_b32 v249, a21
    v_mfma_f32_16x16x32_bf16 v[188:191], v[220:223], a[124:127], v[188:191]
    s_waitcnt lgkmcnt(0)
    v_accvgpr_read_b32 v250, a22
    v_accvgpr_read_b32 v251, a23
    v_cvt_pk_bf16_f32 v18, v248, v249
    v_mfma_f32_16x16x32_bf16 v[128:131], v[192:195], a[128:131], v[128:131]
    v_cvt_pk_bf16_f32 v19, v250, v251
    v_accvgpr_read_b32 v248, a8
    v_mfma_f32_16x16x32_bf16 v[128:131], v[196:199], a[132:135], v[128:131]
    ds_read_b64_tr_b16 v[208:209], v243 offset:49152
    ds_read_b64_tr_b16 v[210:211], v243 offset:49664
    v_mfma_f32_16x16x32_bf16 v[128:131], v[200:203], a[136:139], v[128:131]
    v_accvgpr_read_b32 v249, a9
    v_accvgpr_read_b32 v250, a10
    v_accvgpr_read_b32 v251, a11
    v_mfma_f32_16x16x32_bf16 v[128:131], v[204:207], a[140:143], v[128:131]
    ds_read_b64_tr_b16 v[212:213], v243 offset:53248
    ds_read_b64_tr_b16 v[214:215], v243 offset:53760
    v_mfma_f32_16x16x32_bf16 v[132:135], v[192:195], a[144:147], v[132:135]
    v_cvt_pk_bf16_f32 v32, v248, v249
    v_cvt_pk_bf16_f32 v33, v250, v251
    v_mfma_f32_16x16x32_bf16 v[132:135], v[196:199], a[148:151], v[132:135]
    ds_read_b64_tr_b16 v[216:217], v243 offset:57344
    ds_read_b64_tr_b16 v[218:219], v243 offset:57856
    v_mfma_f32_16x16x32_bf16 v[132:135], v[200:203], a[152:155], v[132:135]
    v_accvgpr_read_b32 v248, a24
    v_accvgpr_read_b32 v249, a25
    v_accvgpr_read_b32 v250, a26
    v_mfma_f32_16x16x32_bf16 v[132:135], v[204:207], a[156:159], v[132:135]
    ds_read_b64_tr_b16 v[220:221], v243 offset:61440
    ds_read_b64_tr_b16 v[222:223], v243 offset:61952
    v_mfma_f32_16x16x32_bf16 v[136:139], v[192:195], a[160:163], v[136:139]
    v_accvgpr_read_b32 v251, a27
    v_cvt_pk_bf16_f32 v34, v248, v249
    v_mfma_f32_16x16x32_bf16 v[136:139], v[196:199], a[164:167], v[136:139]
    v_cvt_pk_bf16_f32 v35, v250, v251
    v_accvgpr_read_b32 v248, a12
    v_mfma_f32_16x16x32_bf16 v[136:139], v[200:203], a[168:171], v[136:139]
    v_accvgpr_read_b32 v249, a13
    v_accvgpr_read_b32 v250, a14
    v_accvgpr_read_b32 v251, a15
    v_mfma_f32_16x16x32_bf16 v[136:139], v[204:207], a[172:175], v[136:139]
    v_cvt_pk_bf16_f32 v48, v248, v249
    v_cvt_pk_bf16_f32 v49, v250, v251
    v_mfma_f32_16x16x32_bf16 v[140:143], v[192:195], a[176:179], v[140:143]
    v_accvgpr_read_b32 v248, a28
    v_accvgpr_read_b32 v249, a29
    v_mfma_f32_16x16x32_bf16 v[140:143], v[196:199], a[180:183], v[140:143]
    v_accvgpr_read_b32 v250, a30
    v_accvgpr_read_b32 v251, a31
    v_cvt_pk_bf16_f32 v50, v248, v249
    v_mfma_f32_16x16x32_bf16 v[140:143], v[200:203], a[184:187], v[140:143]
    v_cvt_pk_bf16_f32 v51, v250, v251
    v_permlane16_swap_b32 v0, v2
    v_mfma_f32_16x16x32_bf16 v[140:143], v[204:207], a[188:191], v[140:143]
    s_waitcnt lgkmcnt(0)
    v_permlane16_swap_b32 v1, v3
    v_permlane16_swap_b32 v16, v18
    v_mfma_f32_16x16x32_bf16 v[144:147], v[208:211], a[128:131], v[144:147]
    v_permlane16_swap_b32 v17, v19
    v_permlane16_swap_b32 v32, v34
    v_mfma_f32_16x16x32_bf16 v[144:147], v[212:215], a[132:135], v[144:147]
    ds_read_b64_tr_b16 v[192:193], v244 offset:49152
    ds_read_b64_tr_b16 v[194:195], v244 offset:49664
    v_permlane16_swap_b32 v33, v35
    v_mfma_f32_16x16x32_bf16 v[144:147], v[216:219], a[136:139], v[144:147]
    v_permlane16_swap_b32 v48, v50
    v_permlane16_swap_b32 v49, v51
    v_mfma_f32_16x16x32_bf16 v[144:147], v[220:223], a[140:143], v[144:147]
    ds_read_b64_tr_b16 v[196:197], v244 offset:53248
    ds_read_b64_tr_b16 v[198:199], v244 offset:53760
    v_mfma_f32_16x16x32_bf16 v[148:151], v[208:211], a[144:147], v[148:151]
    v_accvgpr_read_b32 v248, a32
    v_accvgpr_read_b32 v249, a33
    v_accvgpr_read_b32 v250, a34
    v_mfma_f32_16x16x32_bf16 v[148:151], v[212:215], a[148:151], v[148:151]
    ds_read_b64_tr_b16 v[200:201], v244 offset:57344
    ds_read_b64_tr_b16 v[202:203], v244 offset:57856
    v_mfma_f32_16x16x32_bf16 v[148:151], v[216:219], a[152:155], v[148:151]
    v_accvgpr_read_b32 v251, a35
    v_cvt_pk_bf16_f32 v4, v248, v249
    v_mfma_f32_16x16x32_bf16 v[148:151], v[220:223], a[156:159], v[148:151]
    ds_read_b64_tr_b16 v[204:205], v244 offset:61440
    ds_read_b64_tr_b16 v[206:207], v244 offset:61952
    v_mfma_f32_16x16x32_bf16 v[152:155], v[208:211], a[160:163], v[152:155]
    v_cvt_pk_bf16_f32 v5, v250, v251
    v_accvgpr_read_b32 v248, a48
    v_accvgpr_read_b32 v249, a49
    v_mfma_f32_16x16x32_bf16 v[152:155], v[212:215], a[164:167], v[152:155]
    v_accvgpr_read_b32 v250, a50
    v_accvgpr_read_b32 v251, a51
    v_mfma_f32_16x16x32_bf16 v[152:155], v[216:219], a[168:171], v[152:155]
    v_cvt_pk_bf16_f32 v6, v248, v249
    v_cvt_pk_bf16_f32 v7, v250, v251
    v_mfma_f32_16x16x32_bf16 v[152:155], v[220:223], a[172:175], v[152:155]
    v_accvgpr_read_b32 v248, a36
    v_accvgpr_read_b32 v249, a37
    v_mfma_f32_16x16x32_bf16 v[156:159], v[208:211], a[176:179], v[156:159]
    v_accvgpr_read_b32 v250, a38
    v_accvgpr_read_b32 v251, a39
    v_cvt_pk_bf16_f32 v20, v248, v249
    v_mfma_f32_16x16x32_bf16 v[156:159], v[212:215], a[180:183], v[156:159]
    v_cvt_pk_bf16_f32 v21, v250, v251
    v_accvgpr_read_b32 v248, a52
    v_mfma_f32_16x16x32_bf16 v[156:159], v[216:219], a[184:187], v[156:159]
    v_accvgpr_read_b32 v249, a53
    v_accvgpr_read_b32 v250, a54
    v_mfma_f32_16x16x32_bf16 v[156:159], v[220:223], a[188:191], v[156:159]
    s_waitcnt lgkmcnt(0)
    v_accvgpr_read_b32 v251, a55
    v_cvt_pk_bf16_f32 v22, v248, v249
    v_cvt_pk_bf16_f32 v23, v250, v251
    v_mfma_f32_16x16x32_bf16 v[160:163], v[192:195], a[128:131], v[160:163]
    v_accvgpr_read_b32 v248, a40
    v_accvgpr_read_b32 v249, a41
    v_mfma_f32_16x16x32_bf16 v[160:163], v[196:199], a[132:135], v[160:163]
    ds_read_b64_tr_b16 v[208:209], v245 offset:49152
    ds_read_b64_tr_b16 v[210:211], v245 offset:49664
    v_mfma_f32_16x16x32_bf16 v[160:163], v[200:203], a[136:139], v[160:163]
    v_accvgpr_read_b32 v250, a42
    v_accvgpr_read_b32 v251, a43
    v_mfma_f32_16x16x32_bf16 v[160:163], v[204:207], a[140:143], v[160:163]
    ds_read_b64_tr_b16 v[212:213], v245 offset:53248
    ds_read_b64_tr_b16 v[214:215], v245 offset:53760
    v_cvt_pk_bf16_f32 v36, v248, v249
    v_mfma_f32_16x16x32_bf16 v[164:167], v[192:195], a[144:147], v[164:167]
    v_cvt_pk_bf16_f32 v37, v250, v251
    v_accvgpr_read_b32 v248, a56
    v_mfma_f32_16x16x32_bf16 v[164:167], v[196:199], a[148:151], v[164:167]
    ds_read_b64_tr_b16 v[216:217], v245 offset:57344
    ds_read_b64_tr_b16 v[218:219], v245 offset:57856
    v_mfma_f32_16x16x32_bf16 v[164:167], v[200:203], a[152:155], v[164:167]
    v_accvgpr_read_b32 v249, a57
    v_accvgpr_read_b32 v250, a58
    v_mfma_f32_16x16x32_bf16 v[164:167], v[204:207], a[156:159], v[164:167]
    ds_read_b64_tr_b16 v[220:221], v245 offset:61440
    ds_read_b64_tr_b16 v[222:223], v245 offset:61952
    v_accvgpr_read_b32 v251, a59
    v_mfma_f32_16x16x32_bf16 v[168:171], v[192:195], a[160:163], v[168:171]
    v_cvt_pk_bf16_f32 v38, v248, v249
    v_cvt_pk_bf16_f32 v39, v250, v251
    v_mfma_f32_16x16x32_bf16 v[168:171], v[196:199], a[164:167], v[168:171]
    v_accvgpr_read_b32 v248, a44
    v_accvgpr_read_b32 v249, a45
    v_mfma_f32_16x16x32_bf16 v[168:171], v[200:203], a[168:171], v[168:171]
    v_accvgpr_read_b32 v250, a46
    v_accvgpr_read_b32 v251, a47
    v_cvt_pk_bf16_f32 v52, v248, v249
    v_mfma_f32_16x16x32_bf16 v[168:171], v[204:207], a[172:175], v[168:171]
    v_cvt_pk_bf16_f32 v53, v250, v251
    v_accvgpr_read_b32 v248, a60
    v_mfma_f32_16x16x32_bf16 v[172:175], v[192:195], a[176:179], v[172:175]
    v_accvgpr_read_b32 v249, a61
    v_accvgpr_read_b32 v250, a62
    v_mfma_f32_16x16x32_bf16 v[172:175], v[196:199], a[180:183], v[172:175]
    v_accvgpr_read_b32 v251, a63
    v_cvt_pk_bf16_f32 v54, v248, v249
    v_mfma_f32_16x16x32_bf16 v[172:175], v[200:203], a[184:187], v[172:175]
    v_cvt_pk_bf16_f32 v55, v250, v251
    v_permlane16_swap_b32 v4, v6
    v_permlane16_swap_b32 v5, v7
    v_mfma_f32_16x16x32_bf16 v[172:175], v[204:207], a[188:191], v[172:175]
    s_waitcnt lgkmcnt(0)
    v_permlane16_swap_b32 v20, v22
    v_permlane16_swap_b32 v21, v23
    v_mfma_f32_16x16x32_bf16 v[176:179], v[208:211], a[128:131], v[176:179]
    s_waitcnt vmcnt(38)
    s_barrier
    v_permlane16_swap_b32 v36, v38
    v_mfma_f32_16x16x32_bf16 v[176:179], v[212:215], a[132:135], v[176:179]
    v_permlane16_swap_b32 v37, v39
    v_permlane16_swap_b32 v52, v54
    v_permlane16_swap_b32 v53, v55
    v_mfma_f32_16x16x32_bf16 v[176:179], v[216:219], a[136:139], v[176:179]
    v_cvt_pk_bf16_f32 v8, v128, v129
    v_cvt_pk_bf16_f32 v9, v130, v131
    v_mfma_f32_16x16x32_bf16 v[176:179], v[220:223], a[140:143], v[176:179]
    v_cvt_pk_bf16_f32 v10, v144, v145
    v_cvt_pk_bf16_f32 v11, v146, v147
    v_mfma_f32_16x16x32_bf16 v[180:183], v[208:211], a[144:147], v[180:183]
    v_cvt_pk_bf16_f32 v24, v132, v133
    v_cvt_pk_bf16_f32 v25, v134, v135
    v_mfma_f32_16x16x32_bf16 v[180:183], v[212:215], a[148:151], v[180:183]
    v_cvt_pk_bf16_f32 v26, v148, v149
    v_cvt_pk_bf16_f32 v27, v150, v151
    v_mfma_f32_16x16x32_bf16 v[180:183], v[216:219], a[152:155], v[180:183]
    v_cvt_pk_bf16_f32 v40, v136, v137
    v_cvt_pk_bf16_f32 v41, v138, v139
    v_mfma_f32_16x16x32_bf16 v[180:183], v[220:223], a[156:159], v[180:183]
    v_cvt_pk_bf16_f32 v42, v152, v153
    v_cvt_pk_bf16_f32 v43, v154, v155
    v_mfma_f32_16x16x32_bf16 v[184:187], v[208:211], a[160:163], v[184:187]
    v_cvt_pk_bf16_f32 v56, v140, v141
    v_cvt_pk_bf16_f32 v57, v142, v143
    v_mfma_f32_16x16x32_bf16 v[184:187], v[212:215], a[164:167], v[184:187]
    v_cvt_pk_bf16_f32 v58, v156, v157
    v_cvt_pk_bf16_f32 v59, v158, v159
    v_mfma_f32_16x16x32_bf16 v[184:187], v[216:219], a[168:171], v[184:187]
    v_permlane16_swap_b32 v8, v10
    v_permlane16_swap_b32 v9, v11
    v_mfma_f32_16x16x32_bf16 v[184:187], v[220:223], a[172:175], v[184:187]
    v_permlane16_swap_b32 v24, v26
    v_permlane16_swap_b32 v25, v27
    v_mfma_f32_16x16x32_bf16 v[188:191], v[208:211], a[176:179], v[188:191]
    v_permlane16_swap_b32 v40, v42
    v_permlane16_swap_b32 v41, v43
    v_mfma_f32_16x16x32_bf16 v[188:191], v[212:215], a[180:183], v[188:191]
    v_permlane16_swap_b32 v56, v58
    v_permlane16_swap_b32 v57, v59
    v_mfma_f32_16x16x32_bf16 v[188:191], v[216:219], a[184:187], v[188:191]
    v_mfma_f32_16x16x32_bf16 v[188:191], v[220:223], a[188:191], v[188:191]
    s_waitcnt vmcnt(4)
    ds_read_b64_tr_b16 a[200:201], v124 offset:0
    ds_read_b64_tr_b16 a[202:203], v124 offset:2560
    ds_read_b64_tr_b16 a[204:205], v124 offset:32
    ds_read_b64_tr_b16 a[206:207], v124 offset:2592
    ds_read_b64_tr_b16 a[208:209], v124 offset:64
    ds_read_b64_tr_b16 a[210:211], v124 offset:2624
    ds_read_b64_tr_b16 a[212:213], v124 offset:96
    ds_read_b64_tr_b16 a[214:215], v124 offset:2656
    ds_read_b64_tr_b16 a[216:217], v124 offset:128
    ds_read_b64_tr_b16 a[218:219], v124 offset:2688
    ds_read_b128 a[144:147], v224 offset:0
    ds_read_b128 a[148:151], v225 offset:0
    ds_read_b128 a[152:155], v226 offset:0
    ds_read_b128 a[156:159], v227 offset:0
    s_nop 1
    v_cvt_pk_bf16_f32 v12, v160, v161
    v_cvt_pk_bf16_f32 v13, v162, v163
    v_cvt_pk_bf16_f32 v14, v176, v177
    v_cvt_pk_bf16_f32 v15, v178, v179
    v_cvt_pk_bf16_f32 v28, v164, v165
    v_cvt_pk_bf16_f32 v29, v166, v167
    v_cvt_pk_bf16_f32 v30, v180, v181
    v_cvt_pk_bf16_f32 v31, v182, v183
    v_cvt_pk_bf16_f32 v44, v168, v169
    v_cvt_pk_bf16_f32 v45, v170, v171
    v_cvt_pk_bf16_f32 v46, v184, v185
    v_cvt_pk_bf16_f32 v47, v186, v187
    v_cvt_pk_bf16_f32 v60, v172, v173
    v_cvt_pk_bf16_f32 v61, v174, v175
    v_cvt_pk_bf16_f32 v62, v188, v189
    v_cvt_pk_bf16_f32 v63, v190, v191
    v_permlane16_swap_b32 v12, v14
    v_permlane16_swap_b32 v13, v15
    v_permlane16_swap_b32 v28, v30
    v_permlane16_swap_b32 v29, v31
    v_permlane16_swap_b32 v44, v46
    v_permlane16_swap_b32 v45, v47
    v_permlane16_swap_b32 v60, v62
    v_permlane16_swap_b32 v61, v63
    s_waitcnt lgkmcnt(4)
    buffer_store_dwordx4 a[200:203], v238, s[24:27], 0 offen offset:0 sc1
    buffer_store_dwordx4 a[204:207], v238, s[24:27], 0 offen offset:1024 sc1
    buffer_store_dwordx4 a[208:211], v238, s[24:27], 0 offen offset:2048 sc1
    buffer_store_dwordx4 a[212:215], v238, s[24:27], 0 offen offset:3072 sc1
    buffer_store_dwordx4 a[216:219], v238, s[24:27], s45 offen offset:0 sc1
L_a_attn:
    s_mov_b32 s28, s74
L_padB_0:
    s_cbranch_execz L_padB_1
    s_mov_b32 s29, s75
    s_mov_b32 s30, 0x500000
    s_mov_b32 s31, 0x20000
    s_lshr_b32 s3, s2, 1
    s_mul_i32 s56, s3, 40960
    s_and_b32 s3, s2, 1
    s_lshl_b32 s3, s3, 2
    s_add_u32 s3, s3, s4
    s_mul_i32 s3, s3, 160
    s_add_u32 s56, s56, s3
    s_lshl_b32 s66, s4, 13
    s_add_u32 s66, s66, 131072
    s_waitcnt lgkmcnt(0)
    v_mfma_f32_16x16x32_bf16 v[192:195], a[144:147], v[0:3], 0
    s_add_u32 s57, s56, 20480
    v_mfma_f32_16x16x32_bf16 v[192:195], a[148:151], v[4:7], v[192:195]
    s_add_u32 m0, s66, 2560
    v_mfma_f32_16x16x32_bf16 v[192:195], a[152:155], v[8:11], v[192:195]
    buffer_load_dwordx4 v239, s[28:31], s56 offen lds
    v_mfma_f32_16x16x32_bf16 v[192:195], a[156:159], v[12:15], v[192:195]
    v_mfma_f32_16x16x32_bf16 v[196:199], a[144:147], v[16:19], 0
    v_mfma_f32_16x16x32_bf16 v[196:199], a[148:151], v[20:23], v[196:199]
    s_add_u32 m0, s66, 3584
    v_mfma_f32_16x16x32_bf16 v[196:199], a[152:155], v[24:27], v[196:199]
    buffer_load_dwordx4 v241, s[28:31], s56 offen lds
    v_mfma_f32_16x16x32_bf16 v[196:199], a[156:159], v[28:31], v[196:199]
    v_mfma_f32_16x16x32_bf16 v[200:203], a[144:147], v[32:35], 0
    v_mfma_f32_16x16x32_bf16 v[200:203], a[148:151], v[36:39], v[200:203]
    s_add_u32 m0, s66, 4608
    v_mfma_f32_16x16x32_bf16 v[200:203], a[152:155], v[40:43], v[200:203]
    s_mov_b32 exec_hi, 0
    buffer_load_dwordx4 v253, s[28:31], s56 offen lds
    s_mov_b32 exec_hi, -1
    v_mfma_f32_16x16x32_bf16 v[200:203], a[156:159], v[44:47], v[200:203]
    v_mfma_f32_16x16x32_bf16 v[204:207], a[144:147], v[48:51], 0
    v_max3_f32 v120, v120, v192, v193
    v_max3_f32 v120, v120, v194, v195
    v_mfma_f32_16x16x32_bf16 v[204:207], a[148:151], v[52:55], v[204:207]
    v_mfma_f32_16x16x32_bf16 v[204:207], a[152:155], v[56:59], v[204:207]
    v_max3_f32 v121, v121, v196, v197
    v_max3_f32 v121, v121, v198, v199
    v_mfma_f32_16x16x32_bf16 v[204:207], a[156:159], v[60:63], v[204:207]
    s_nop 1
    v_max3_f32 v122, v122, v200, v201
    v_max3_f32 v122, v122, v202, v203
    s_nop 3
    v_max3_f32 v123, v123, v204, v205
    v_max3_f32 v123, v123, v206, v207
    v_mov_b32 v248, v120
    v_mov_b32 v249, v121
    v_mov_b32 v250, v122
    v_mov_b32 v251, v123
    s_nop 0
    v_permlane16_swap_b32 v120, v248
    v_permlane16_swap_b32 v121, v249
    v_permlane16_swap_b32 v122, v250
    v_permlane16_swap_b32 v123, v251
    v_max_f32 v120, v120, v248
    v_max_f32 v121, v121, v249
    v_max_f32 v122, v122, v250
    v_max_f32 v123, v123, v251
    v_mov_b32 v248, v120
    v_mov_b32 v249, v121
    v_mov_b32 v250, v122
    v_mov_b32 v251, v123
    s_nop 0
    v_permlane32_swap_b32 v120, v248
    v_permlane32_swap_b32 v121, v249
    v_permlane32_swap_b32 v122, v250
    v_permlane32_swap_b32 v123, v251
    v_max_f32 v120, v120, v248
    v_max_f32 v121, v121, v249
    v_max_f32 v122, v122, v250
    v_max_f32 v123, v123, v251
    v_sub_f32 v208, 0, v120
    v_sub_f32 v209, 0, v120
    v_sub_f32 v210, 0, v120
    v_sub_f32 v211, 0, v120
    v_sub_f32 v212, 0, v121
    v_sub_f32 v213, 0, v121
    v_sub_f32 v214, 0, v121
    v_sub_f32 v215, 0, v121
    v_sub_f32 v216, 0, v122
    v_sub_f32 v217, 0, v122
    v_sub_f32 v218, 0, v122
    v_sub_f32 v219, 0, v122
    v_sub_f32 v220, 0, v123
    v_sub_f32 v221, 0, v123
    v_sub_f32 v222, 0, v123
    v_sub_f32 v223, 0, v123
L_a_pre:
    s_mov_b32 s42, 32768
    s_mov_b32 s43, 7
    v_mfma_f32_16x16x32_bf16 v[192:195], a[144:147], v[0:3], v[208:211]
    s_add_u32 m0, s66, 5120
    v_lshrrev_b32 v250, 6, v238
    v_bfe_u32 v251, v238, 4, 2
    v_mfma_f32_16x16x32_bf16 v[192:195], a[148:151], v[4:7], v[192:195]
    buffer_load_dwordx4 v239, s[28:31], s57 offen lds
    v_mfma_f32_16x16x32_bf16 v[192:195], a[152:155], v[8:11], v[192:195]
    v_mul_u32_u24 v250, 160, v250
    v_lshl_add_u32 v250, v251, 3, v250
    v_mfma_f32_16x16x32_bf16 v[192:195], a[156:159], v[12:15], v[192:195]
    ds_read_b128 a[160:163], v224 offset:4096
    ds_read_b128 a[164:167], v225 offset:4096
    v_mfma_f32_16x16x32_bf16 v[196:199], a[144:147], v[16:19], v[212:215]
    s_add_u32 m0, s66, 6144
    v_add_u32 v250, s66, v250
    v_add_u32 v250, 2560, v250
    v_mfma_f32_16x16x32_bf16 v[196:199], a[148:151], v[20:23], v[196:199]
    buffer_load_dwordx4 v241, s[28:31], s57 offen lds
    v_mfma_f32_16x16x32_bf16 v[196:199], a[152:155], v[24:27], v[196:199]
    v_mfma_f32_16x16x32_bf16 v[196:199], a[156:159], v[28:31], v[196:199]
    ds_read_b128 a[168:171], v226 offset:4096
    ds_read_b128 a[172:175], v227 offset:4096
    v_mfma_f32_16x16x32_bf16 v[200:203], a[144:147], v[32:35], v[216:219]
    v_exp_f32 v192, v192
    v_mfma_f32_16x16x32_bf16 v[200:203], a[148:151], v[36:39], v[200:203]
    v_exp_f32 v193, v193
    v_mfma_f32_16x16x32_bf16 v[200:203], a[152:155], v[40:43], v[200:203]
    s_add_u32 m0, s66, 7168
    v_exp_f32 v194, v194
    v_mfma_f32_16x16x32_bf16 v[200:203], a[156:159], v[44:47], v[200:203]
    s_mov_b32 exec_hi, 0
    buffer_load_dwordx4 v253, s[28:31], s57 offen lds
    s_mov_b32 exec_hi, -1
    v_exp_f32 v195, v195
    v_cvt_pk_bf16_f32 v64, v192, v193
    v_cvt_pk_bf16_f32 v65, v194, v195
    v_mfma_f32_16x16x32_bf16 v[204:207], a[144:147], v[48:51], v[220:223]
    s_mul_i32 s7, s53, 81920
    v_exp_f32 v196, v196
    v_mfma_f32_16x16x32_bf16 v[204:207], a[148:151], v[52:55], v[204:207]
    s_mul_i32 s41, s54, 160
    v_exp_f32 v197, v197
    v_mfma_f32_16x16x32_bf16 v[204:207], a[152:155], v[56:59], v[204:207]
    s_add_u32 s7, s7, s41
    v_exp_f32 v198, v198
    v_mfma_f32_16x16x32_bf16 v[204:207], a[156:159], v[60:63], v[204:207]
    s_waitcnt lgkmcnt(0)
    v_exp_f32 v199, v199
    v_cvt_pk_bf16_f32 v80, v196, v197
    v_cvt_pk_bf16_f32 v81, v198, v199
    v_mfma_f32_16x16x32_bf16 v[192:195], a[160:163], v[0:3], v[208:211]
    s_add_u32 s32, s94, s7
    v_exp_f32 v200, v200
    v_mfma_f32_16x16x32_bf16 v[192:195], a[164:167], v[4:7], v[192:195]
    s_addc_u32 s33, s95, 0
    v_exp_f32 v201, v201
    v_mfma_f32_16x16x32_bf16 v[192:195], a[168:171], v[8:11], v[192:195]
    s_sub_u32 s34, 2621440, s7
    v_exp_f32 v202, v202
    v_mfma_f32_16x16x32_bf16 v[192:195], a[172:175], v[12:15], v[192:195]
    s_mov_b32 s35, 0x20000
    ds_read_b128 a[144:147], v224 offset:8192
    ds_read_b128 a[148:151], v225 offset:8192
    v_exp_f32 v203, v203
    v_cvt_pk_bf16_f32 v96, v200, v201
    v_cvt_pk_bf16_f32 v97, v202, v203
    v_mfma_f32_16x16x32_bf16 v[196:199], a[160:163], v[16:19], v[212:215]
    s_mul_i32 s3, s4, 20480
    v_exp_f32 v204, v204
    v_mfma_f32_16x16x32_bf16 v[196:199], a[164:167], v[20:23], v[196:199]
    v_exp_f32 v205, v205
    v_mfma_f32_16x16x32_bf16 v[196:199], a[168:171], v[24:27], v[196:199]
    v_exp_f32 v206, v206
    v_mfma_f32_16x16x32_bf16 v[196:199], a[172:175], v[28:31], v[196:199]
    ds_read_b128 a[152:155], v226 offset:8192
    ds_read_b128 a[156:159], v227 offset:8192
    v_exp_f32 v207, v207
    v_cvt_pk_bf16_f32 v112, v204, v205
    v_cvt_pk_bf16_f32 v113, v206, v207
    v_mfma_f32_16x16x32_bf16 v[200:203], a[160:163], v[32:35], v[216:219]
    v_exp_f32 v192, v192
    v_mfma_f32_16x16x32_bf16 v[200:203], a[164:167], v[36:39], v[200:203]
    v_exp_f32 v193, v193
    v_mfma_f32_16x16x32_bf16 v[200:203], a[168:171], v[40:43], v[200:203]
    s_add_u32 m0, s66, 0
    v_exp_f32 v194, v194
    v_mfma_f32_16x16x32_bf16 v[200:203], a[172:175], v[44:47], v[200:203]
    buffer_load_dwordx4 v239, s[32:35], s3 offen lds
    v_exp_f32 v195, v195
    v_cvt_pk_bf16_f32 v66, v192, v193
    v_cvt_pk_bf16_f32 v67, v194, v195
    v_mfma_f32_16x16x32_bf16 v[204:207], a[160:163], v[48:51], v[220:223]
    v_exp_f32 v196, v196
    v_mfma_f32_16x16x32_bf16 v[204:207], a[164:167], v[52:55], v[204:207]
    v_exp_f32 v197, v197
    v_mfma_f32_16x16x32_bf16 v[204:207], a[168:171], v[56:59], v[204:207]
    v_exp_f32 v198, v198
    v_mfma_f32_16x16x32_bf16 v[204:207], a[172:175], v[60:63], v[204:207]
    s_waitcnt lgkmcnt(0)
    v_exp_f32 v199, v199
    v_cvt_pk_bf16_f32 v82, v196, v197
    v_cvt_pk_bf16_f32 v83, v198, v199
    v_mfma_f32_16x16x32_bf16 v[192:195], a[144:147], v[0:3], v[208:211]
    v_exp_f32 v200, v200
    v_mfma_f32_16x16x32_bf16 v[192:195], a[148:151], v[4:7], v[192:195]
    v_exp_f32 v201, v201
    v_mfma_f32_16x16x32_bf16 v[192:195], a[152:155], v[8:11], v[192:195]
    s_add_u32 m0, s66, 1024
    v_exp_f32 v202, v202
    v_mfma_f32_16x16x32_bf16 v[192:195], a[156:159], v[12:15], v[192:195]
    ds_read_b128 a[160:163], v224 offset:12288
    ds_read_b128 a[164:167], v225 offset:12288
    buffer_load_dwordx4 v241, s[32:35], s3 offen lds
    v_exp_f32 v203, v203
    v_cvt_pk_bf16_f32 v98, v200, v201
    v_cvt_pk_bf16_f32 v99, v202, v203
    v_mfma_f32_16x16x32_bf16 v[196:199], a[144:147], v[16:19], v[212:215]
    v_exp_f32 v204, v204
    v_mfma_f32_16x16x32_bf16 v[196:199], a[148:151], v[20:23], v[196:199]
    v_exp_f32 v205, v205
    v_mfma_f32_16x16x32_bf16 v[196:199], a[152:155], v[24:27], v[196:199]
    v_exp_f32 v206, v206
    v_mfma_f32_16x16x32_bf16 v[196:199], a[156:159], v[28:31], v[196:199]
    ds_read_b128 a[168:171], v226 offset:12288
    ds_read_b128 a[172:175], v227 offset:12288
    v_exp_f32 v207, v207
    v_cvt_pk_bf16_f32 v114, v204, v205
    v_cvt_pk_bf16_f32 v115, v206, v207
    v_mfma_f32_16x16x32_bf16 v[200:203], a[144:147], v[32:35], v[216:219]
L_padB_1:
    s_cbranch_execz L_padB_2
    v_exp_f32 v192, v192
    v_mfma_f32_16x16x32_bf16 v[200:203], a[148:151], v[36:39], v[200:203]
    v_exp_f32 v193, v193
    v_mfma_f32_16x16x32_bf16 v[200:203], a[152:155], v[40:43], v[200:203]
    s_add_u32 m0, s66, 2048
    v_exp_f32 v194, v194
    v_mfma_f32_16x16x32_bf16 v[200:203], a[156:159], v[44:47], v[200:203]
    s_mov_b32 exec_hi, 0
    buffer_load_dwordx4 v253, s[32:35], s3 offen lds
    s_mov_b32 exec_hi, -1
    v_exp_f32 v195, v195
    v_cvt_pk_bf16_f32 v68, v192, v193
    v_cvt_pk_bf16_f32 v69, v194, v195
    v_mfma_f32_16x16x32_bf16 v[204:207], a[144:147], v[48:51], v[220:223]
    v_exp_f32 v196, v196
    v_mfma_f32_16x16x32_bf16 v[204:207], a[148:151], v[52:55], v[204:207]
    s_mul_i32 s7, s53, 221184
    v_exp_f32 v197, v197
    v_mfma_f32_16x16x32_bf16 v[204:207], a[152:155], v[56:59], v[204:207]
    v_exp_f32 v198, v198
    v_mfma_f32_16x16x32_bf16 v[204:207], a[156:159], v[60:63], v[204:207]
    s_waitcnt lgkmcnt(0)
    v_exp_f32 v199, v199
    v_cvt_pk_bf16_f32 v84, v196, v197
    v_cvt_pk_bf16_f32 v85, v198, v199
    v_mfma_f32_16x16x32_bf16 v[192:195], a[160:163], v[0:3], v[208:211]
    s_add_u32 s16, s82, 0x300000
    v_exp_f32 v200, v200
    v_mfma_f32_16x16x32_bf16 v[192:195], a[164:167], v[4:7], v[192:195]
    s_addc_u32 s17, s83, 0
    v_exp_f32 v201, v201
    v_mfma_f32_16x16x32_bf16 v[192:195], a[168:171], v[8:11], v[192:195]
    s_add_u32 s16, s16, s7
    v_exp_f32 v202, v202
    v_mfma_f32_16x16x32_bf16 v[192:195], a[172:175], v[12:15], v[192:195]
    s_addc_u32 s17, s17, 0
    ds_read_b128 a[144:147], v224 offset:16384
    ds_read_b128 a[148:151], v225 offset:16384
    v_exp_f32 v203, v203
    v_cvt_pk_bf16_f32 v100, v200, v201
    v_cvt_pk_bf16_f32 v101, v202, v203
    v_mfma_f32_16x16x32_bf16 v[196:199], a[160:163], v[16:19], v[212:215]
    s_mov_b32 s18, 0x36000
    v_exp_f32 v204, v204
    v_mfma_f32_16x16x32_bf16 v[196:199], a[164:167], v[20:23], v[196:199]
    s_mov_b32 s19, 0x20000
    v_exp_f32 v205, v205
    v_mfma_f32_16x16x32_bf16 v[196:199], a[168:171], v[24:27], v[196:199]
    s_mul_i32 s7, s54, 931840
    v_exp_f32 v206, v206
    v_mfma_f32_16x16x32_bf16 v[196:199], a[172:175], v[28:31], v[196:199]
    s_add_u32 s20, s82, 0x1a00000
    ds_read_b128 a[152:155], v226 offset:16384
    ds_read_b128 a[156:159], v227 offset:16384
    v_exp_f32 v207, v207
    v_cvt_pk_bf16_f32 v116, v204, v205
    v_cvt_pk_bf16_f32 v117, v206, v207
    v_mfma_f32_16x16x32_bf16 v[200:203], a[160:163], v[32:35], v[216:219]
    s_addc_u32 s21, s83, 0
    v_exp_f32 v192, v192
    v_mfma_f32_16x16x32_bf16 v[200:203], a[164:167], v[36:39], v[200:203]
    s_add_u32 s20, s20, s7
    v_exp_f32 v193, v193
    v_mfma_f32_16x16x32_bf16 v[200:203], a[168:171], v[40:43], v[200:203]
    s_addc_u32 s21, s21, 0
    v_exp_f32 v194, v194
    v_mfma_f32_16x16x32_bf16 v[200:203], a[172:175], v[44:47], v[200:203]
    s_mov_b32 s22, 0x43800
    v_exp_f32 v195, v195
    v_cvt_pk_bf16_f32 v70, v192, v193
    v_cvt_pk_bf16_f32 v71, v194, v195
    v_mfma_f32_16x16x32_bf16 v[204:207], a[160:163], v[48:51], v[220:223]
    s_mov_b32 s23, 0x20000
    v_exp_f32 v196, v196
    v_mfma_f32_16x16x32_bf16 v[204:207], a[164:167], v[52:55], v[204:207]
    s_and_b32 s41, s53, 1
    v_exp_f32 v197, v197
    v_mfma_f32_16x16x32_bf16 v[204:207], a[168:171], v[56:59], v[204:207]
    s_mul_i32 s41, s41, 327680
    v_exp_f32 v198, v198
    v_mfma_f32_16x16x32_bf16 v[204:207], a[172:175], v[60:63], v[204:207]
    s_waitcnt lgkmcnt(0)
    v_exp_f32 v199, v199
    v_cvt_pk_bf16_f32 v86, v196, v197
    v_cvt_pk_bf16_f32 v87, v198, v199
    v_mfma_f32_16x16x32_bf16 v[192:195], a[144:147], v[0:3], v[208:211]
    s_add_u32 s7, s7, s41
    v_exp_f32 v200, v200
    v_mfma_f32_16x16x32_bf16 v[192:195], a[148:151], v[4:7], v[192:195]
    s_add_u32 s24, s82, 0x1a43800
    v_exp_f32 v201, v201
    v_mfma_f32_16x16x32_bf16 v[192:195], a[152:155], v[8:11], v[192:195]
    s_addc_u32 s25, s83, 0
    v_exp_f32 v202, v202
    v_mfma_f32_16x16x32_bf16 v[192:195], a[156:159], v[12:15], v[192:195]
    s_add_u32 s24, s24, s7
    ds_read_b128 a[160:163], v224 offset:20480
    ds_read_b128 a[164:167], v225 offset:20480
    v_exp_f32 v203, v203
    v_cvt_pk_bf16_f32 v102, v200, v201
    v_cvt_pk_bf16_f32 v103, v202, v203
    v_mfma_f32_16x16x32_bf16 v[196:199], a[144:147], v[16:19], v[212:215]
    s_addc_u32 s25, s25, 0
    v_exp_f32 v204, v204
    v_mfma_f32_16x16x32_bf16 v[196:199], a[148:151], v[20:23], v[196:199]
    s_mov_b32 s26, 0x50000
    v_exp_f32 v205, v205
    v_mfma_f32_16x16x32_bf16 v[196:199], a[152:155], v[24:27], v[196:199]
    s_mov_b32 s27, 0x20000
    v_exp_f32 v206, v206
    v_mfma_f32_16x16x32_bf16 v[196:199], a[156:159], v[28:31], v[196:199]
    s_bfe_u32 s7, s2, 0x20003
    ds_read_b128 a[168:171], v226 offset:20480
    ds_read_b128 a[172:175], v227 offset:20480
    v_exp_f32 v207, v207
    v_cvt_pk_bf16_f32 v118, v204, v205
    v_cvt_pk_bf16_f32 v119, v206, v207
    v_mfma_f32_16x16x32_bf16 v[200:203], a[144:147], v[32:35], v[216:219]
    s_add_u32 s50, s7, s6
    v_exp_f32 v192, v192
    v_mfma_f32_16x16x32_bf16 v[200:203], a[148:151], v[36:39], v[200:203]
    s_and_b32 s50, s50, 3
    v_exp_f32 v193, v193
    v_mfma_f32_16x16x32_bf16 v[200:203], a[152:155], v[40:43], v[200:203]
    s_lshl_b32 s7, s6, 2
    v_exp_f32 v194, v194
    v_mfma_f32_16x16x32_bf16 v[200:203], a[156:159], v[44:47], v[200:203]
    s_add_u32 s7, s7, s4
    v_exp_f32 v195, v195
    v_cvt_pk_bf16_f32 v72, v192, v193
    v_cvt_pk_bf16_f32 v73, v194, v195
    v_mfma_f32_16x16x32_bf16 v[204:207], a[144:147], v[48:51], v[220:223]
    s_lshl_b32 s7, s7, 5
    v_exp_f32 v196, v196
    v_mfma_f32_16x16x32_bf16 v[204:207], a[148:151], v[52:55], v[204:207]
    s_add_u32 s7, s7, s5
    v_exp_f32 v197, v197
    v_mfma_f32_16x16x32_bf16 v[204:207], a[152:155], v[56:59], v[204:207]
    s_lshl_b32 s7, s7, 7
    v_exp_f32 v198, v198
    v_mfma_f32_16x16x32_bf16 v[204:207], a[156:159], v[60:63], v[204:207]
    s_waitcnt lgkmcnt(0)
    v_exp_f32 v199, v199
    v_cvt_pk_bf16_f32 v88, v196, v197
    v_cvt_pk_bf16_f32 v89, v198, v199
    v_mfma_f32_16x16x32_bf16 v[192:195], a[160:163], v[0:3], v[208:211]
    s_add_u32 s51, s7, 131072
    v_exp_f32 v200, v200
    v_mfma_f32_16x16x32_bf16 v[192:195], a[164:167], v[4:7], v[192:195]
    s_and_b32 s7, s2, 1
    v_exp_f32 v201, v201
    v_mfma_f32_16x16x32_bf16 v[192:195], a[168:171], v[8:11], v[192:195]
    s_lshl_b32 s7, s7, 2
    v_exp_f32 v202, v202
    v_mfma_f32_16x16x32_bf16 v[192:195], a[172:175], v[12:15], v[192:195]
    s_add_u32 s7, s7, s4
    ds_read_b128 a[144:147], v224 offset:24576
    ds_read_b128 a[148:151], v225 offset:24576
    v_exp_f32 v203, v203
    v_cvt_pk_bf16_f32 v104, v200, v201
    v_cvt_pk_bf16_f32 v105, v202, v203
    v_mfma_f32_16x16x32_bf16 v[196:199], a[160:163], v[16:19], v[212:215]
    s_mul_i32 s7, s7, 931840
    v_exp_f32 v204, v204
    v_mfma_f32_16x16x32_bf16 v[196:199], a[164:167], v[20:23], v[196:199]
    s_lshr_b32 s41, s2, 1
    v_exp_f32 v205, v205
    v_mfma_f32_16x16x32_bf16 v[196:199], a[168:171], v[24:27], v[196:199]
    s_mul_i32 s41, s41, 5120
    v_exp_f32 v206, v206
    v_mfma_f32_16x16x32_bf16 v[196:199], a[172:175], v[28:31], v[196:199]
    s_add_u32 s7, s7, s41
    ds_read_b128 a[152:155], v226 offset:24576
    ds_read_b128 a[156:159], v227 offset:24576
    v_exp_f32 v207, v207
    v_cvt_pk_bf16_f32 v120, v204, v205
    v_cvt_pk_bf16_f32 v121, v206, v207
    v_mfma_f32_16x16x32_bf16 v[200:203], a[160:163], v[32:35], v[216:219]
    s_add_u32 s60, s82, 0x1a43800
    v_exp_f32 v192, v192
    v_mfma_f32_16x16x32_bf16 v[200:203], a[164:167], v[36:39], v[200:203]
    s_addc_u32 s61, s83, 0
    v_exp_f32 v193, v193
    v_mfma_f32_16x16x32_bf16 v[200:203], a[168:171], v[40:43], v[200:203]
    s_add_u32 s60, s60, s7
    v_exp_f32 v194, v194
    v_mfma_f32_16x16x32_bf16 v[200:203], a[172:175], v[44:47], v[200:203]
    s_addc_u32 s61, s61, 0
    v_exp_f32 v195, v195
    v_cvt_pk_bf16_f32 v74, v192, v193
    v_cvt_pk_bf16_f32 v75, v194, v195
    v_mfma_f32_16x16x32_bf16 v[204:207], a[160:163], v[48:51], v[220:223]
    s_mov_b32 s62, 0x1400
    v_exp_f32 v196, v196
    v_mfma_f32_16x16x32_bf16 v[204:207], a[164:167], v[52:55], v[204:207]
    s_mov_b32 s63, 0x20000
    v_exp_f32 v197, v197
    v_mfma_f32_16x16x32_bf16 v[204:207], a[168:171], v[56:59], v[204:207]
    s_mul_i32 s7, s2, 6
    v_exp_f32 v198, v198
    v_mfma_f32_16x16x32_bf16 v[204:207], a[172:175], v[60:63], v[204:207]
    s_waitcnt lgkmcnt(0)
    v_exp_f32 v199, v199
    v_cvt_pk_bf16_f32 v90, v196, v197
    v_cvt_pk_bf16_f32 v91, v198, v199
    v_mfma_f32_16x16x32_bf16 v[192:195], a[144:147], v[0:3], v[208:211]
    s_lshr_b32 s7, s7, 8
    v_exp_f32 v200, v200
    v_mfma_f32_16x16x32_bf16 v[192:195], a[148:151], v[4:7], v[192:195]
    s_sub_u32 s67, 7, s7
    v_exp_f32 v201, v201
    v_mfma_f32_16x16x32_bf16 v[192:195], a[152:155], v[8:11], v[192:195]
    s_or_b32 s7, s4, s48
    v_exp_f32 v202, v202
    v_mfma_f32_16x16x32_bf16 v[192:195], a[156:159], v[12:15], v[192:195]
    s_lshl_b32 s7, s7, 4
    ds_read_b128 a[160:163], v224 offset:28672
    ds_read_b128 a[164:167], v225 offset:28672
    v_exp_f32 v203, v203
    v_cvt_pk_bf16_f32 v106, v200, v201
    v_cvt_pk_bf16_f32 v107, v202, v203
    v_mfma_f32_16x16x32_bf16 v[196:199], a[144:147], v[16:19], v[212:215]
    s_add_u32 s67, s67, s7
    v_exp_f32 v204, v204
    v_mfma_f32_16x16x32_bf16 v[196:199], a[148:151], v[20:23], v[196:199]
    v_exp_f32 v205, v205
    v_mfma_f32_16x16x32_bf16 v[196:199], a[152:155], v[24:27], v[196:199]
    v_exp_f32 v206, v206
    v_mfma_f32_16x16x32_bf16 v[196:199], a[156:159], v[28:31], v[196:199]
    ds_read_b128 a[168:171], v226 offset:28672
    ds_read_b128 a[172:175], v227 offset:28672
    v_exp_f32 v207, v207
    v_cvt_pk_bf16_f32 v122, v204, v205
    v_cvt_pk_bf16_f32 v123, v206, v207
    v_mfma_f32_16x16x32_bf16 v[200:203], a[144:147], v[32:35], v[216:219]
    v_exp_f32 v192, v192
    v_mfma_f32_16x16x32_bf16 v[200:203], a[148:151], v[36:39], v[200:203]
    v_exp_f32 v193, v193
    v_mfma_f32_16x16x32_bf16 v[200:203], a[152:155], v[40:43], v[200:203]
    v_exp_f32 v194, v194
    v_mfma_f32_16x16x32_bf16 v[200:203], a[156:159], v[44:47], v[200:203]
    v_exp_f32 v195, v195
    v_cvt_pk_bf16_f32 v76, v192, v193
    v_cvt_pk_bf16_f32 v77, v194, v195
    v_mfma_f32_16x16x32_bf16 v[204:207], a[144:147], v[48:51], v[220:223]
    v_exp_f32 v196, v196
    v_mfma_f32_16x16x32_bf16 v[204:207], a[148:151], v[52:55], v[204:207]
    v_exp_f32 v197, v197
    v_mfma_f32_16x16x32_bf16 v[204:207], a[152:155], v[56:59], v[204:207]
    v_exp_f32 v198, v198
    v_mfma_f32_16x16x32_bf16 v[204:207], a[156:159], v[60:63], v[204:207]
    s_waitcnt lgkmcnt(0)
    v_exp_f32 v199, v199
    v_cvt_pk_bf16_f32 v92, v196, v197
    v_cvt_pk_bf16_f32 v93, v198, v199
    v_mfma_f32_16x16x32_bf16 v[192:195], a[160:163], v[0:3], v[208:211]
    s_waitcnt vmcnt(9)
    s_barrier
    v_exp_f32 v200, v200
    v_mfma_f32_16x16x32_bf16 v[192:195], a[164:167], v[4:7], v[192:195]
    v_exp_f32 v201, v201
    v_mfma_f32_16x16x32_bf16 v[192:195], a[168:171], v[8:11], v[192:195]
    v_exp_f32 v202, v202
    v_mfma_f32_16x16x32_bf16 v[192:195], a[172:175], v[12:15], v[192:195]
    ds_read_b128 a[144:147], v224 offset:32768
    ds_read_b128 a[148:151], v225 offset:32768
    v_exp_f32 v203, v203
    v_cvt_pk_bf16_f32 v108, v200, v201
    v_cvt_pk_bf16_f32 v109, v202, v203
    v_mfma_f32_16x16x32_bf16 v[196:199], a[160:163], v[16:19], v[212:215]
    v_exp_f32 v204, v204
    v_mfma_f32_16x16x32_bf16 v[196:199], a[164:167], v[20:23], v[196:199]
    v_exp_f32 v205, v205
    v_mfma_f32_16x16x32_bf16 v[196:199], a[168:171], v[24:27], v[196:199]
    v_exp_f32 v206, v206
    v_mfma_f32_16x16x32_bf16 v[196:199], a[172:175], v[28:31], v[196:199]
    ds_read_b128 a[152:155], v226 offset:32768
    ds_read_b128 a[156:159], v227 offset:32768
    v_exp_f32 v207, v207
    v_cvt_pk_bf16_f32 v124, v204, v205
    v_cvt_pk_bf16_f32 v125, v206, v207
    v_mfma_f32_16x16x32_bf16 v[200:203], a[160:163], v[32:35], v[216:219]
    v_exp_f32 v192, v192
    v_mfma_f32_16x16x32_bf16 v[200:203], a[164:167], v[36:39], v[200:203]
    v_exp_f32 v193, v193
    v_mfma_f32_16x16x32_bf16 v[200:203], a[168:171], v[40:43], v[200:203]
    v_exp_f32 v194, v194
    v_mfma_f32_16x16x32_bf16 v[200:203], a[172:175], v[44:47], v[200:203]
    v_exp_f32 v195, v195
    v_cvt_pk_bf16_f32 v78, v192, v193
    v_cvt_pk_bf16_f32 v79, v194, v195
    v_mfma_f32_16x16x32_bf16 v[204:207], a[160:163], v[48:51], v[220:223]
    v_exp_f32 v196, v196
    v_mfma_f32_16x16x32_bf16 v[204:207], a[164:167], v[52:55], v[204:207]
    v_exp_f32 v197, v197
    v_mfma_f32_16x16x32_bf16 v[204:207], a[168:171], v[56:59], v[204:207]
    v_exp_f32 v198, v198
    v_mfma_f32_16x16x32_bf16 v[204:207], a[172:175], v[60:63], v[204:207]
    v_exp_f32 v199, v199
    v_cvt_pk_bf16_f32 v94, v196, v197
    v_cvt_pk_bf16_f32 v95, v198, v199
    v_exp_f32 v200, v200
    v_exp_f32 v201, v201
    v_exp_f32 v202, v202
    v_exp_f32 v203, v203
    v_cvt_pk_bf16_f32 v110, v200, v201
    v_cvt_pk_bf16_f32 v111, v202, v203
    s_waitcnt lgkmcnt(0)
    v_mfma_f32_16x16x32_bf16 v[192:195], a[144:147], v[0:3], v[208:211]
    v_exp_f32 v204, v204
    v_mfma_f32_16x16x32_bf16 v[192:195], a[148:151], v[4:7], v[192:195]
    ds_read_b64_tr_b16 a[160:161], v228 offset:0
    ds_read_b64_tr_b16 a[162:163], v228 offset:4096
    v_mfma_f32_16x16x32_bf16 v[192:195], a[152:155], v[8:11], v[192:195]
    v_exp_f32 v205, v205
    v_mfma_f32_16x16x32_bf16 v[192:195], a[156:159], v[12:15], v[192:195]
    s_add_u32 m0, s40, 98304
    ds_read_b64_tr_b16 a[164:165], v228 offset:8192
    v_cvt_pk_bf16_f32 v126, v204, v205
    v_mfma_f32_16x16x32_bf16 v[196:199], a[144:147], v[16:19], v[212:215]
    s_add_u32 s41, s42, 0
    v_exp_f32 v206, v206
    v_mfma_f32_16x16x32_bf16 v[196:199], a[148:151], v[20:23], v[196:199]
    buffer_load_dwordx4 v237, s[12:15], s41 offen lds
    v_mfma_f32_16x16x32_bf16 v[196:199], a[152:155], v[24:27], v[196:199]
    v_exp_f32 v207, v207
    v_mfma_f32_16x16x32_bf16 v[196:199], a[156:159], v[28:31], v[196:199]
    ds_read_b64_tr_b16 a[166:167], v228 offset:12288
    v_cvt_pk_bf16_f32 v127, v206, v207
    v_mfma_f32_16x16x32_bf16 v[200:203], a[144:147], v[32:35], v[216:219]
    v_exp_f32 v192, v192
    v_mfma_f32_16x16x32_bf16 v[200:203], a[148:151], v[36:39], v[200:203]
    ds_read_b64_tr_b16 a[168:169], v228 offset:16384
    ds_read_b64_tr_b16 a[170:171], v228 offset:20480
    v_mfma_f32_16x16x32_bf16 v[200:203], a[152:155], v[40:43], v[200:203]
    v_exp_f32 v193, v193
    v_mfma_f32_16x16x32_bf16 v[200:203], a[156:159], v[44:47], v[200:203]
    s_add_u32 m0, s40, 0
    ds_read_b64_tr_b16 a[172:173], v228 offset:24576
    ds_read_b64_tr_b16 a[174:175], v228 offset:28672
    v_mfma_f32_16x16x32_bf16 v[204:207], a[144:147], v[48:51], v[220:223]
    s_add_u32 s41, s42, 32768
    v_exp_f32 v194, v194
    v_mfma_f32_16x16x32_bf16 v[204:207], a[148:151], v[52:55], v[204:207]
    buffer_load_dwordx4 v236, s[8:11], s41 offen lds
    v_mfma_f32_16x16x32_bf16 v[204:207], a[152:155], v[56:59], v[204:207]
    v_exp_f32 v195, v195
    v_mfma_f32_16x16x32_bf16 v[204:207], a[156:159], v[60:63], v[204:207]
    s_waitcnt lgkmcnt(4)
    v_cvt_pk_bf16_f32 v128, v192, v193
    v_cvt_pk_bf16_f32 v129, v194, v195
    v_mfma_f32_16x16x32_bf16 a[0:3], a[160:163], v[64:67], 0
    v_exp_f32 v196, v196
    v_mfma_f32_16x16x32_bf16 a[0:3], a[164:167], v[68:71], a[0:3]
    s_waitcnt lgkmcnt(2)
    ds_read_b128 a[144:147], v224 offset:36864
    ds_read_b128 a[148:151], v225 offset:36864
    v_mfma_f32_16x16x32_bf16 a[0:3], a[168:171], v[72:75], a[0:3]
    s_waitcnt lgkmcnt(2)
    v_exp_f32 v197, v197
    v_mfma_f32_16x16x32_bf16 a[0:3], a[172:175], v[76:79], a[0:3]
    s_add_u32 m0, s40, 102400
    ds_read_b128 a[152:155], v226 offset:36864
    v_cvt_pk_bf16_f32 v144, v196, v197
    v_mfma_f32_16x16x32_bf16 a[4:7], a[160:163], v[80:83], 0
    s_add_u32 s41, s42, 4096
    v_exp_f32 v198, v198
    v_mfma_f32_16x16x32_bf16 a[4:7], a[164:167], v[84:87], a[4:7]
    buffer_load_dwordx4 v237, s[12:15], s41 offen lds
    v_mfma_f32_16x16x32_bf16 a[4:7], a[168:171], v[88:91], a[4:7]
    v_exp_f32 v199, v199
    v_mfma_f32_16x16x32_bf16 a[4:7], a[172:175], v[92:95], a[4:7]
    s_add_u32 m0, s40, 4096
    ds_read_b128 a[156:159], v227 offset:36864
    v_cvt_pk_bf16_f32 v145, v198, v199
    v_mfma_f32_16x16x32_bf16 a[8:11], a[160:163], v[96:99], 0
    s_add_u32 s41, s42, 36864
    v_exp_f32 v200, v200
    v_mfma_f32_16x16x32_bf16 a[8:11], a[164:167], v[100:103], a[8:11]
    buffer_load_dwordx4 v236, s[8:11], s41 offen lds
    v_mfma_f32_16x16x32_bf16 a[8:11], a[168:171], v[104:107], a[8:11]
    v_exp_f32 v201, v201
    v_mfma_f32_16x16x32_bf16 a[8:11], a[172:175], v[108:111], a[8:11]
    s_add_u32 m0, s40, 106496
    v_cvt_pk_bf16_f32 v160, v200, v201
    v_mfma_f32_16x16x32_bf16 a[12:15], a[160:163], v[112:115], 0
    s_add_u32 s41, s42, 8192
    v_exp_f32 v202, v202
    v_mfma_f32_16x16x32_bf16 a[12:15], a[164:167], v[116:119], a[12:15]
    buffer_load_dwordx4 v237, s[12:15], s41 offen lds
    v_mfma_f32_16x16x32_bf16 a[12:15], a[168:171], v[120:123], a[12:15]
    v_exp_f32 v203, v203
    v_mfma_f32_16x16x32_bf16 a[12:15], a[172:175], v[124:127], a[12:15]
    s_waitcnt lgkmcnt(0)
    v_cvt_pk_bf16_f32 v161, v202, v203
    v_mfma_f32_16x16x32_bf16 v[192:195], a[144:147], v[0:3], v[208:211]
    v_exp_f32 v204, v204
    v_mfma_f32_16x16x32_bf16 v[192:195], a[148:151], v[4:7], v[192:195]
    ds_read_b64_tr_b16 a[160:161], v229 offset:0
    ds_read_b64_tr_b16 a[162:163], v229 offset:4096
    v_mfma_f32_16x16x32_bf16 v[192:195], a[152:155], v[8:11], v[192:195]
    v_exp_f32 v205, v205
    v_mfma_f32_16x16x32_bf16 v[192:195], a[156:159], v[12:15], v[192:195]
    s_add_u32 m0, s40, 8192
    ds_read_b64_tr_b16 a[164:165], v229 offset:8192
    v_cvt_pk_bf16_f32 v176, v204, v205
    v_mfma_f32_16x16x32_bf16 v[196:199], a[144:147], v[16:19], v[212:215]
    s_add_u32 s41, s42, 40960
    v_exp_f32 v206, v206
    v_mfma_f32_16x16x32_bf16 v[196:199], a[148:151], v[20:23], v[196:199]
    buffer_load_dwordx4 v236, s[8:11], s41 offen lds
    v_mfma_f32_16x16x32_bf16 v[196:199], a[152:155], v[24:27], v[196:199]
    v_exp_f32 v207, v207
    v_mfma_f32_16x16x32_bf16 v[196:199], a[156:159], v[28:31], v[196:199]
    ds_read_b64_tr_b16 a[166:167], v229 offset:12288
    v_cvt_pk_bf16_f32 v177, v206, v207
    v_mfma_f32_16x16x32_bf16 v[200:203], a[144:147], v[32:35], v[216:219]
    v_exp_f32 v192, v192
    v_mfma_f32_16x16x32_bf16 v[200:203], a[148:151], v[36:39], v[200:203]
    ds_read_b64_tr_b16 a[168:169], v229 offset:16384
    ds_read_b64_tr_b16 a[170:171], v229 offset:20480
    v_mfma_f32_16x16x32_bf16 v[200:203], a[152:155], v[40:43], v[200:203]
    v_exp_f32 v193, v193
    v_mfma_f32_16x16x32_bf16 v[200:203], a[156:159], v[44:47], v[200:203]
    s_add_u32 m0, s40, 110592
    ds_read_b64_tr_b16 a[172:173], v229 offset:24576
    ds_read_b64_tr_b16 a[174:175], v229 offset:28672
    v_mfma_f32_16x16x32_bf16 v[204:207], a[144:147], v[48:51], v[220:223]
    s_add_u32 s41, s42, 12288
    v_exp_f32 v194, v194
    v_mfma_f32_16x16x32_bf16 v[204:207], a[148:151], v[52:55], v[204:207]
    buffer_load_dwordx4 v237, s[12:15], s41 offen lds
    v_mfma_f32_16x16x32_bf16 v[204:207], a[152:155], v[56:59], v[204:207]
    v_exp_f32 v195, v195
    v_mfma_f32_16x16x32_bf16 v[204:207], a[156:159], v[60:63], v[204:207]
    s_waitcnt lgkmcnt(4)
    v_cvt_pk_bf16_f32 v130, v192, v193
    v_cvt_pk_bf16_f32 v131, v194, v195
    v_mfma_f32_16x16x32_bf16 a[16:19], a[160:163], v[64:67], 0
    v_exp_f32 v196, v196
    v_mfma_f32_16x16x32_bf16 a[16:19], a[164:167], v[68:71], a[16:19]
    s_waitcnt lgkmcnt(2)
    ds_read_b128 a[144:147], v224 offset:40960
    ds_read_b128 a[148:151], v225 offset:40960
    v_mfma_f32_16x16x32_bf16 a[16:19], a[168:171], v[72:75], a[16:19]
    s_waitcnt lgkmcnt(2)
    v_exp_f32 v197, v197
    v_mfma_f32_16x16x32_bf16 a[16:19], a[172:175], v[76:79], a[16:19]
    ds_read_b128 a[152:155], v226 offset:40960
    v_cvt_pk_bf16_f32 v146, v196, v197
    v_mfma_f32_16x16x32_bf16 a[20:23], a[160:163], v[80:83], 0
    s_waitcnt vmcnt(7)
    v_exp_f32 v198, v198
    v_mfma_f32_16x16x32_bf16 a[20:23], a[164:167], v[84:87], a[20:23]
    ds_read_b64_tr_b16 a[180:181], v250 offset:0
    ds_read_b64_tr_b16 a[182:183], v250 offset:2560
    v_mfma_f32_16x16x32_bf16 a[20:23], a[168:171], v[88:91], a[20:23]
    v_exp_f32 v199, v199
    v_mfma_f32_16x16x32_bf16 a[20:23], a[172:175], v[92:95], a[20:23]
    ds_read_b128 a[156:159], v227 offset:40960
    v_cvt_pk_bf16_f32 v147, v198, v199
    v_mfma_f32_16x16x32_bf16 a[24:27], a[160:163], v[96:99], 0
    v_exp_f32 v200, v200
    v_mfma_f32_16x16x32_bf16 a[24:27], a[164:167], v[100:103], a[24:27]
    ds_read_b64_tr_b16 a[184:185], v250 offset:32
    ds_read_b64_tr_b16 a[186:187], v250 offset:2592
    v_mfma_f32_16x16x32_bf16 a[24:27], a[168:171], v[104:107], a[24:27]
    v_exp_f32 v201, v201
    v_mfma_f32_16x16x32_bf16 a[24:27], a[172:175], v[108:111], a[24:27]
    s_add_u32 m0, s40, 12288
    ds_read_b64_tr_b16 a[188:189], v250 offset:64
    v_cvt_pk_bf16_f32 v162, v200, v201
    v_mfma_f32_16x16x32_bf16 a[28:31], a[160:163], v[112:115], 0
    s_add_u32 s41, s42, 45056
    v_exp_f32 v202, v202
    v_mfma_f32_16x16x32_bf16 a[28:31], a[164:167], v[116:119], a[28:31]
    buffer_load_dwordx4 v236, s[8:11], s41 offen lds
    v_mfma_f32_16x16x32_bf16 a[28:31], a[168:171], v[120:123], a[28:31]
    v_exp_f32 v203, v203
    v_mfma_f32_16x16x32_bf16 a[28:31], a[172:175], v[124:127], a[28:31]
    s_waitcnt lgkmcnt(0)
    v_cvt_pk_bf16_f32 v163, v202, v203
    v_mfma_f32_16x16x32_bf16 v[192:195], a[144:147], v[0:3], v[208:211]
    v_exp_f32 v204, v204
    v_mfma_f32_16x16x32_bf16 v[192:195], a[148:151], v[4:7], v[192:195]
    ds_read_b64_tr_b16 a[160:161], v230 offset:0
    ds_read_b64_tr_b16 a[162:163], v230 offset:4096
    v_mfma_f32_16x16x32_bf16 v[192:195], a[152:155], v[8:11], v[192:195]
    v_exp_f32 v205, v205
    v_mfma_f32_16x16x32_bf16 v[192:195], a[156:159], v[12:15], v[192:195]
    s_add_u32 m0, s40, 114688
    ds_read_b64_tr_b16 a[164:165], v230 offset:8192
    v_cvt_pk_bf16_f32 v178, v204, v205
    v_mfma_f32_16x16x32_bf16 v[196:199], a[144:147], v[16:19], v[212:215]
    s_add_u32 s41, s42, 16384
    v_exp_f32 v206, v206
    v_mfma_f32_16x16x32_bf16 v[196:199], a[148:151], v[20:23], v[196:199]
    buffer_load_dwordx4 v237, s[12:15], s41 offen lds
    v_mfma_f32_16x16x32_bf16 v[196:199], a[152:155], v[24:27], v[196:199]
    v_exp_f32 v207, v207
    v_mfma_f32_16x16x32_bf16 v[196:199], a[156:159], v[28:31], v[196:199]
    ds_read_b64_tr_b16 a[166:167], v230 offset:12288
    v_cvt_pk_bf16_f32 v179, v206, v207
    v_mfma_f32_16x16x32_bf16 v[200:203], a[144:147], v[32:35], v[216:219]
    v_exp_f32 v192, v192
    v_mfma_f32_16x16x32_bf16 v[200:203], a[148:151], v[36:39], v[200:203]
    ds_read_b64_tr_b16 a[168:169], v230 offset:16384
    ds_read_b64_tr_b16 a[170:171], v230 offset:20480
    v_mfma_f32_16x16x32_bf16 v[200:203], a[152:155], v[40:43], v[200:203]
    v_exp_f32 v193, v193
    v_mfma_f32_16x16x32_bf16 v[200:203], a[156:159], v[44:47], v[200:203]
    s_add_u32 m0, s40, 16384
    ds_read_b64_tr_b16 a[172:173], v230 offset:24576
    ds_read_b64_tr_b16 a[174:175], v230 offset:28672
    v_mfma_f32_16x16x32_bf16 v[204:207], a[144:147], v[48:51], v[220:223]
    s_add_u32 s41, s42, 49152
    v_exp_f32 v194, v194
    v_mfma_f32_16x16x32_bf16 v[204:207], a[148:151], v[52:55], v[204:207]
    buffer_load_dwordx4 v236, s[8:11], s41 offen lds
    v_mfma_f32_16x16x32_bf16 v[204:207], a[152:155], v[56:59], v[204:207]
    v_exp_f32 v195, v195
    v_mfma_f32_16x16x32_bf16 v[204:207], a[156:159], v[60:63], v[204:207]
    s_waitcnt lgkmcnt(4)
    v_cvt_pk_bf16_f32 v132, v192, v193
    v_cvt_pk_bf16_f32 v133, v194, v195
    v_mfma_f32_16x16x32_bf16 a[32:35], a[160:163], v[64:67], 0
    v_exp_f32 v196, v196
    v_mfma_f32_16x16x32_bf16 a[32:35], a[164:167], v[68:71], a[32:35]
    s_waitcnt lgkmcnt(2)
    ds_read_b128 a[144:147], v224 offset:45056
    ds_read_b128 a[148:151], v225 offset:45056
    v_mfma_f32_16x16x32_bf16 a[32:35], a[168:171], v[72:75], a[32:35]
    s_waitcnt lgkmcnt(2)
    v_exp_f32 v197, v197
    v_mfma_f32_16x16x32_bf16 a[32:35], a[172:175], v[76:79], a[32:35]
    ds_read_b128 a[152:155], v226 offset:45056
    v_cvt_pk_bf16_f32 v148, v196, v197
    v_mfma_f32_16x16x32_bf16 a[36:39], a[160:163], v[80:83], 0
    v_exp_f32 v198, v198
    v_mfma_f32_16x16x32_bf16 a[36:39], a[164:167], v[84:87], a[36:39]
    ds_read_b64_tr_b16 a[190:191], v250 offset:2624
    ds_read_b64_tr_b16 a[192:193], v250 offset:96
    v_mfma_f32_16x16x32_bf16 a[36:39], a[168:171], v[88:91], a[36:39]
    v_exp_f32 v199, v199
    v_mfma_f32_16x16x32_bf16 a[36:39], a[172:175], v[92:95], a[36:39]
    ds_read_b128 a[156:159], v227 offset:45056
    v_cvt_pk_bf16_f32 v149, v198, v199
    v_mfma_f32_16x16x32_bf16 a[40:43], a[160:163], v[96:99], 0
    v_exp_f32 v200, v200
    v_mfma_f32_16x16x32_bf16 a[40:43], a[164:167], v[100:103], a[40:43]
    ds_read_b64_tr_b16 a[194:195], v250 offset:2656
    ds_read_b64_tr_b16 a[196:197], v250 offset:128
    v_mfma_f32_16x16x32_bf16 a[40:43], a[168:171], v[104:107], a[40:43]
    v_exp_f32 v201, v201
    v_mfma_f32_16x16x32_bf16 a[40:43], a[172:175], v[108:111], a[40:43]
    s_add_u32 m0, s40, 118784
    ds_read_b64_tr_b16 a[198:199], v250 offset:2688
    v_cvt_pk_bf16_f32 v164, v200, v201
    v_mfma_f32_16x16x32_bf16 a[44:47], a[160:163], v[112:115], 0
    s_add_u32 s41, s42, 20480
    v_exp_f32 v202, v202
    v_mfma_f32_16x16x32_bf16 a[44:47], a[164:167], v[116:119], a[44:47]
    buffer_load_dwordx4 v237, s[12:15], s41 offen lds
    v_mfma_f32_16x16x32_bf16 a[44:47], a[168:171], v[120:123], a[44:47]
    v_exp_f32 v203, v203
    v_mfma_f32_16x16x32_bf16 a[44:47], a[172:175], v[124:127], a[44:47]
    s_waitcnt lgkmcnt(0)
    v_cvt_pk_bf16_f32 v165, v202, v203
    v_mfma_f32_16x16x32_bf16 v[192:195], a[144:147], v[0:3], v[208:211]
    v_exp_f32 v204, v204
    v_mfma_f32_16x16x32_bf16 v[192:195], a[148:151], v[4:7], v[192:195]
    ds_read_b64_tr_b16 a[160:161], v231 offset:0
    ds_read_b64_tr_b16 a[162:163], v231 offset:4096
    v_mfma_f32_16x16x32_bf16 v[192:195], a[152:155], v[8:11], v[192:195]
    v_exp_f32 v205, v205
    v_mfma_f32_16x16x32_bf16 v[192:195], a[156:159], v[12:15], v[192:195]
    s_add_u32 m0, s40, 20480
    ds_read_b64_tr_b16 a[164:165], v231 offset:8192
    v_cvt_pk_bf16_f32 v180, v204, v205
    v_mfma_f32_16x16x32_bf16 v[196:199], a[144:147], v[16:19], v[212:215]
    s_add_u32 s41, s42, 53248
    v_exp_f32 v206, v206
    v_mfma_f32_16x16x32_bf16 v[196:199], a[148:151], v[20:23], v[196:199]
    buffer_load_dwordx4 v236, s[8:11], s41 offen lds
    v_mfma_f32_16x16x32_bf16 v[196:199], a[152:155], v[24:27], v[196:199]
    v_exp_f32 v207, v207
    v_mfma_f32_16x16x32_bf16 v[196:199], a[156:159], v[28:31], v[196:199]
    ds_read_b64_tr_b16 a[166:167], v231 offset:12288
    v_cvt_pk_bf16_f32 v181, v206, v207
    v_mfma_f32_16x16x32_bf16 v[200:203], a[144:147], v[32:35], v[216:219]
    v_exp_f32 v192, v192
    v_mfma_f32_16x16x32_bf16 v[200:203], a[148:151], v[36:39], v[200:203]
    ds_read_b64_tr_b16 a[168:169], v231 offset:16384
    ds_read_b64_tr_b16 a[170:171], v231 offset:20480
    v_mfma_f32_16x16x32_bf16 v[200:203], a[152:155], v[40:43], v[200:203]
    v_exp_f32 v193, v193
    v_mfma_f32_16x16x32_bf16 v[200:203], a[156:159], v[44:47], v[200:203]
    s_add_u32 m0, s40, 122880
    ds_read_b64_tr_b16 a[172:173], v231 offset:24576
    ds_read_b64_tr_b16 a[174:175], v231 offset:28672
    v_mfma_f32_16x16x32_bf16 v[204:207], a[144:147], v[48:51], v[220:223]
    s_add_u32 s41, s42, 24576
    v_exp_f32 v194, v194
    v_mfma_f32_16x16x32_bf16 v[204:207], a[148:151], v[52:55], v[204:207]
    buffer_load_dwordx4 v237, s[12:15], s41 offen lds
    v_mfma_f32_16x16x32_bf16 v[204:207], a[152:155], v[56:59], v[204:207]
    v_exp_f32 v195, v195
    v_mfma_f32_16x16x32_bf16 v[204:207], a[156:159], v[60:63], v[204:207]
    s_waitcnt lgkmcnt(4)
    v_cvt_pk_bf16_f32 v134, v192, v193
    v_cvt_pk_bf16_f32 v135, v194, v195
    v_mfma_f32_16x16x32_bf16 a[48:51], a[160:163], v[64:67], 0
L_padB_2:
    s_cbranch_execz L_padB_3
    v_exp_f32 v196, v196
    v_mfma_f32_16x16x32_bf16 a[48:51], a[164:167], v[68:71], a[48:51]
    s_waitcnt lgkmcnt(2)
    ds_read_b128 a[144:147], v224 offset:49152
    ds_read_b128 a[148:151], v225 offset:49152
    v_mfma_f32_16x16x32_bf16 a[48:51], a[168:171], v[72:75], a[48:51]
    s_waitcnt lgkmcnt(2)
    v_exp_f32 v197, v197
    v_mfma_f32_16x16x32_bf16 a[48:51], a[172:175], v[76:79], a[48:51]
    s_add_u32 m0, s40, 24576
    ds_read_b128 a[152:155], v226 offset:49152
    v_cvt_pk_bf16_f32 v150, v196, v197
    v_mfma_f32_16x16x32_bf16 a[52:55], a[160:163], v[80:83], 0
    s_add_u32 s41, s42, 57344
    v_exp_f32 v198, v198
    v_mfma_f32_16x16x32_bf16 a[52:55], a[164:167], v[84:87], a[52:55]
    buffer_load_dwordx4 v236, s[8:11], s41 offen lds
    v_mfma_f32_16x16x32_bf16 a[52:55], a[168:171], v[88:91], a[52:55]
    v_exp_f32 v199, v199
    v_mfma_f32_16x16x32_bf16 a[52:55], a[172:175], v[92:95], a[52:55]
    s_add_u32 m0, s40, 126976
    ds_read_b128 a[156:159], v227 offset:49152
    v_cvt_pk_bf16_f32 v151, v198, v199
    v_mfma_f32_16x16x32_bf16 a[56:59], a[160:163], v[96:99], 0
    s_add_u32 s41, s42, 28672
    v_exp_f32 v200, v200
    v_mfma_f32_16x16x32_bf16 a[56:59], a[164:167], v[100:103], a[56:59]
    buffer_load_dwordx4 v237, s[12:15], s41 offen lds
    v_mfma_f32_16x16x32_bf16 a[56:59], a[168:171], v[104:107], a[56:59]
    v_exp_f32 v201, v201
    v_mfma_f32_16x16x32_bf16 a[56:59], a[172:175], v[108:111], a[56:59]
    s_add_u32 m0, s40, 28672
    v_cvt_pk_bf16_f32 v166, v200, v201
    v_bfe_i32 v251, v238, 5, 1
    v_mfma_f32_16x16x32_bf16 a[60:63], a[160:163], v[112:115], 0
    s_add_u32 s41, s42, 61440
    v_exp_f32 v202, v202
    v_mfma_f32_16x16x32_bf16 a[60:63], a[164:167], v[116:119], a[60:63]
    buffer_load_dwordx4 v236, s[8:11], s41 offen lds
    v_mfma_f32_16x16x32_bf16 a[60:63], a[168:171], v[120:123], a[60:63]
    v_exp_f32 v203, v203
    v_mfma_f32_16x16x32_bf16 a[60:63], a[172:175], v[124:127], a[60:63]
    s_waitcnt lgkmcnt(0)
    v_cvt_pk_bf16_f32 v167, v202, v203
    v_bfe_i32 v253, v238, 4, 1
    v_mfma_f32_16x16x32_bf16 v[192:195], a[144:147], v[0:3], v[208:211]
    v_exp_f32 v204, v204
    v_mfma_f32_16x16x32_bf16 v[192:195], a[148:151], v[4:7], v[192:195]
    ds_read_b64_tr_b16 a[160:161], v232 offset:0
    ds_read_b64_tr_b16 a[162:163], v232 offset:4096
    v_mfma_f32_16x16x32_bf16 v[192:195], a[152:155], v[8:11], v[192:195]
    v_exp_f32 v205, v205
    v_mfma_f32_16x16x32_bf16 v[192:195], a[156:159], v[12:15], v[192:195]
    ds_read_b64_tr_b16 a[164:165], v232 offset:8192
    v_cvt_pk_bf16_f32 v182, v204, v205
    v_mfma_f32_16x16x32_bf16 v[196:199], a[144:147], v[16:19], v[212:215]
    v_exp_f32 v206, v206
    v_mfma_f32_16x16x32_bf16 v[196:199], a[148:151], v[20:23], v[196:199]
    buffer_store_dwordx4 a[180:183], v238, s[60:63], 0 offen offset:0 sc1
    v_mfma_f32_16x16x32_bf16 v[196:199], a[152:155], v[24:27], v[196:199]
    v_exp_f32 v207, v207
    v_mfma_f32_16x16x32_bf16 v[196:199], a[156:159], v[28:31], v[196:199]
    ds_read_b64_tr_b16 a[166:167], v232 offset:12288
    v_cvt_pk_bf16_f32 v183, v206, v207
    v_mfma_f32_16x16x32_bf16 v[200:203], a[144:147], v[32:35], v[216:219]
    v_exp_f32 v192, v192
    v_mfma_f32_16x16x32_bf16 v[200:203], a[148:151], v[36:39], v[200:203]
    ds_read_b64_tr_b16 a[168:169], v232 offset:16384
    ds_read_b64_tr_b16 a[170:171], v232 offset:20480
    v_mfma_f32_16x16x32_bf16 v[200:203], a[152:155], v[40:43], v[200:203]
    v_exp_f32 v193, v193
    v_mfma_f32_16x16x32_bf16 v[200:203], a[156:159], v[44:47], v[200:203]
    ds_read_b64_tr_b16 a[172:173], v232 offset:24576
    ds_read_b64_tr_b16 a[174:175], v232 offset:28672
    v_mfma_f32_16x16x32_bf16 v[204:207], a[144:147], v[48:51], v[220:223]
    v_exp_f32 v194, v194
    v_mfma_f32_16x16x32_bf16 v[204:207], a[148:151], v[52:55], v[204:207]
    buffer_store_dwordx4 a[184:187], v238, s[60:63], 0 offen offset:1024 sc1
    v_mfma_f32_16x16x32_bf16 v[204:207], a[152:155], v[56:59], v[204:207]
    v_exp_f32 v195, v195
    v_mfma_f32_16x16x32_bf16 v[204:207], a[156:159], v[60:63], v[204:207]
    s_waitcnt lgkmcnt(4)
    v_cvt_pk_bf16_f32 v136, v192, v193
    v_cvt_pk_bf16_f32 v137, v194, v195
    v_mfma_f32_16x16x32_bf16 a[64:67], a[160:163], v[64:67], 0
    v_exp_f32 v196, v196
    v_mfma_f32_16x16x32_bf16 a[64:67], a[164:167], v[68:71], a[64:67]
    s_waitcnt lgkmcnt(2)
    ds_read_b128 a[144:147], v224 offset:53248
    ds_read_b128 a[148:151], v225 offset:53248
    v_mfma_f32_16x16x32_bf16 a[64:67], a[168:171], v[72:75], a[64:67]
    s_waitcnt lgkmcnt(2)
    v_exp_f32 v197, v197
    v_mfma_f32_16x16x32_bf16 a[64:67], a[172:175], v[76:79], a[64:67]
    ds_read_b128 a[152:155], v226 offset:53248
    v_cvt_pk_bf16_f32 v152, v196, v197
    v_mfma_f32_16x16x32_bf16 a[68:71], a[160:163], v[80:83], 0
    v_exp_f32 v198, v198
    v_mfma_f32_16x16x32_bf16 a[68:71], a[164:167], v[84:87], a[68:71]
    buffer_store_dwordx4 a[188:191], v238, s[60:63], 0 offen offset:2048 sc1
    v_mfma_f32_16x16x32_bf16 a[68:71], a[168:171], v[88:91], a[68:71]
    v_exp_f32 v199, v199
    v_mfma_f32_16x16x32_bf16 a[68:71], a[172:175], v[92:95], a[68:71]
    s_add_u32 s3, s4, 0
    ds_read_b128 a[156:159], v227 offset:53248
    v_cvt_pk_bf16_f32 v153, v198, v199
    v_mfma_f32_16x16x32_bf16 a[72:75], a[160:163], v[96:99], 0
    s_and_b32 s3, s3, 3
    v_exp_f32 v200, v200
    v_mfma_f32_16x16x32_bf16 a[72:75], a[164:167], v[100:103], a[72:75]
    buffer_store_dwordx4 a[192:195], v238, s[60:63], 0 offen offset:3072 sc1
    v_mfma_f32_16x16x32_bf16 a[72:75], a[168:171], v[104:107], a[72:75]
    s_lshl_b32 s3, s3, 10
    v_exp_f32 v201, v201
    v_mfma_f32_16x16x32_bf16 a[72:75], a[172:175], v[108:111], a[72:75]
    s_lshl_b32 s7, s4, 12
    v_cvt_pk_bf16_f32 v168, v200, v201
    v_not_b32 v251, v251
    v_mfma_f32_16x16x32_bf16 a[76:79], a[160:163], v[112:115], 0
    s_add_u32 s3, s3, s7
    v_exp_f32 v202, v202
    v_mfma_f32_16x16x32_bf16 a[76:79], a[164:167], v[116:119], a[76:79]
    buffer_store_dwordx4 a[196:199], v238, s[60:63], s45 offen offset:0 sc1
    v_mfma_f32_16x16x32_bf16 a[76:79], a[168:171], v[120:123], a[76:79]
    v_exp_f32 v203, v203
    v_mfma_f32_16x16x32_bf16 a[76:79], a[172:175], v[124:127], a[76:79]
    s_waitcnt lgkmcnt(0)
    v_cvt_pk_bf16_f32 v169, v202, v203
    v_and_b32 v253, 0xaaaaaaaa, v253
    v_mfma_f32_16x16x32_bf16 v[192:195], a[144:147], v[0:3], v[208:211]
    v_exp_f32 v204, v204
    v_mfma_f32_16x16x32_bf16 v[192:195], a[148:151], v[4:7], v[192:195]
    ds_read_b64_tr_b16 a[160:161], v233 offset:0
    ds_read_b64_tr_b16 a[162:163], v233 offset:4096
    v_mfma_f32_16x16x32_bf16 v[192:195], a[152:155], v[8:11], v[192:195]
    v_exp_f32 v205, v205
    v_mfma_f32_16x16x32_bf16 v[192:195], a[156:159], v[12:15], v[192:195]
    ds_read_b64_tr_b16 a[164:165], v233 offset:8192
    v_cvt_pk_bf16_f32 v184, v204, v205
    v_mfma_f32_16x16x32_bf16 v[196:199], a[144:147], v[16:19], v[212:215]
    s_add_u32 s41, s42, 32768
    v_exp_f32 v206, v206
    v_mfma_f32_16x16x32_bf16 v[196:199], a[148:151], v[20:23], v[196:199]
    buffer_load_dword v254, v252, s[12:15], s41 offen
    v_mfma_f32_16x16x32_bf16 v[196:199], a[152:155], v[24:27], v[196:199]
    v_exp_f32 v207, v207
    v_mfma_f32_16x16x32_bf16 v[196:199], a[156:159], v[28:31], v[196:199]
    ds_read_b64_tr_b16 a[166:167], v233 offset:12288
    v_cvt_pk_bf16_f32 v185, v206, v207
    v_mfma_f32_16x16x32_bf16 v[200:203], a[144:147], v[32:35], v[216:219]
    v_exp_f32 v192, v192
    v_mfma_f32_16x16x32_bf16 v[200:203], a[148:151], v[36:39], v[200:203]
    ds_read_b64_tr_b16 a[168:169], v233 offset:16384
    ds_read_b64_tr_b16 a[170:171], v233 offset:20480
    v_mfma_f32_16x16x32_bf16 v[200:203], a[152:155], v[40:43], v[200:203]
    v_exp_f32 v193, v193
    v_mfma_f32_16x16x32_bf16 v[200:203], a[156:159], v[44:47], v[200:203]
    ds_read_b64_tr_b16 a[172:173], v233 offset:24576
    ds_read_b64_tr_b16 a[174:175], v233 offset:28672
    v_mfma_f32_16x16x32_bf16 v[204:207], a[144:147], v[48:51], v[220:223]
    s_add_u32 s41, s42, 65536
    v_exp_f32 v194, v194
    v_mfma_f32_16x16x32_bf16 v[204:207], a[148:151], v[52:55], v[204:207]
    buffer_load_dword v254, v252, s[8:11], s41 offen
    v_mfma_f32_16x16x32_bf16 v[204:207], a[152:155], v[56:59], v[204:207]
    v_exp_f32 v195, v195
    v_mfma_f32_16x16x32_bf16 v[204:207], a[156:159], v[60:63], v[204:207]
    s_waitcnt lgkmcnt(4)
    v_cvt_pk_bf16_f32 v138, v192, v193
    v_cvt_pk_bf16_f32 v139, v194, v195
    v_mfma_f32_16x16x32_bf16 a[80:83], a[160:163], v[64:67], 0
    v_exp_f32 v196, v196
    v_mfma_f32_16x16x32_bf16 a[80:83], a[164:167], v[68:71], a[80:83]
    s_waitcnt lgkmcnt(2)
    ds_read_b128 a[144:147], v224 offset:57344
    ds_read_b128 a[148:151], v225 offset:57344
    v_mfma_f32_16x16x32_bf16 a[80:83], a[168:171], v[72:75], a[80:83]
    s_waitcnt lgkmcnt(2)
    v_exp_f32 v197, v197
    v_mfma_f32_16x16x32_bf16 a[80:83], a[172:175], v[76:79], a[80:83]
    ds_read_b128 a[152:155], v226 offset:57344
    v_cvt_pk_bf16_f32 v154, v196, v197
    v_mfma_f32_16x16x32_bf16 a[84:87], a[160:163], v[80:83], 0
    v_exp_f32 v198, v198
    v_mfma_f32_16x16x32_bf16 a[84:87], a[164:167], v[84:87], a[84:87]
    v_and_b32 v251, 0x3f803f80, v251
    v_or_b32 v253, 0x44444444, v253
    v_mfma_f32_16x16x32_bf16 a[84:87], a[168:171], v[88:91], a[84:87]
    v_exp_f32 v199, v199
    v_mfma_f32_16x16x32_bf16 a[84:87], a[172:175], v[92:95], a[84:87]
    ds_read_b128 a[156:159], v227 offset:57344
    v_cvt_pk_bf16_f32 v155, v198, v199
    v_mfma_f32_16x16x32_bf16 a[88:91], a[160:163], v[96:99], 0
    v_exp_f32 v200, v200
    v_mfma_f32_16x16x32_bf16 a[88:91], a[164:167], v[100:103], a[88:91]
    v_accvgpr_write_b32 a176, v251
    v_accvgpr_write_b32 a177, v251
    v_mfma_f32_16x16x32_bf16 a[88:91], a[168:171], v[104:107], a[88:91]
    v_exp_f32 v201, v201
    v_mfma_f32_16x16x32_bf16 a[88:91], a[172:175], v[108:111], a[88:91]
    v_cvt_pk_bf16_f32 v170, v200, v201
    v_accvgpr_write_b32 a178, v251
    v_mfma_f32_16x16x32_bf16 a[92:95], a[160:163], v[112:115], 0
    v_exp_f32 v202, v202
    v_mfma_f32_16x16x32_bf16 a[92:95], a[164:167], v[116:119], a[92:95]
    v_accvgpr_write_b32 a179, v251
    v_accvgpr_write_b32 a128, 0
    v_mfma_f32_16x16x32_bf16 a[92:95], a[168:171], v[120:123], a[92:95]
    v_exp_f32 v203, v203
    v_mfma_f32_16x16x32_bf16 a[92:95], a[172:175], v[124:127], a[92:95]
    s_waitcnt lgkmcnt(0)
    v_cvt_pk_bf16_f32 v171, v202, v203
    v_accvgpr_write_b32 a129, 0
    v_mfma_f32_16x16x32_bf16 v[192:195], a[144:147], v[0:3], v[208:211]
    v_exp_f32 v204, v204
    v_mfma_f32_16x16x32_bf16 v[192:195], a[148:151], v[4:7], v[192:195]
    ds_read_b64_tr_b16 a[160:161], v234 offset:0
    ds_read_b64_tr_b16 a[162:163], v234 offset:4096
    v_mfma_f32_16x16x32_bf16 v[192:195], a[152:155], v[8:11], v[192:195]
    v_exp_f32 v205, v205
    v_mfma_f32_16x16x32_bf16 v[192:195], a[156:159], v[12:15], v[192:195]
    ds_read_b64_tr_b16 a[164:165], v234 offset:8192
    v_cvt_pk_bf16_f32 v186, v204, v205
    v_mfma_f32_16x16x32_bf16 v[196:199], a[144:147], v[16:19], v[212:215]
    v_exp_f32 v206, v206
    v_mfma_f32_16x16x32_bf16 v[196:199], a[148:151], v[20:23], v[196:199]
    v_accvgpr_write_b32 a132, 0
    v_accvgpr_write_b32 a133, 0
    v_mfma_f32_16x16x32_bf16 v[196:199], a[152:155], v[24:27], v[196:199]
    v_exp_f32 v207, v207
    v_mfma_f32_16x16x32_bf16 v[196:199], a[156:159], v[28:31], v[196:199]
    ds_read_b64_tr_b16 a[166:167], v234 offset:12288
    v_cvt_pk_bf16_f32 v187, v206, v207
    v_mfma_f32_16x16x32_bf16 v[200:203], a[144:147], v[32:35], v[216:219]
    v_exp_f32 v192, v192
    v_mfma_f32_16x16x32_bf16 v[200:203], a[148:151], v[36:39], v[200:203]
    ds_read_b64_tr_b16 a[168:169], v234 offset:16384
    ds_read_b64_tr_b16 a[170:171], v234 offset:20480
    v_mfma_f32_16x16x32_bf16 v[200:203], a[152:155], v[40:43], v[200:203]
    v_exp_f32 v193, v193
    v_mfma_f32_16x16x32_bf16 v[200:203], a[156:159], v[44:47], v[200:203]
    ds_read_b64_tr_b16 a[172:173], v234 offset:24576
    ds_read_b64_tr_b16 a[174:175], v234 offset:28672
    v_mfma_f32_16x16x32_bf16 v[204:207], a[144:147], v[48:51], v[220:223]
    v_exp_f32 v194, v194
    v_mfma_f32_16x16x32_bf16 v[204:207], a[148:151], v[52:55], v[204:207]
    v_accvgpr_write_b32 a136, 0
    v_accvgpr_write_b32 a137, 0
    v_mfma_f32_16x16x32_bf16 v[204:207], a[152:155], v[56:59], v[204:207]
    v_exp_f32 v195, v195
    v_mfma_f32_16x16x32_bf16 v[204:207], a[156:159], v[60:63], v[204:207]
    s_waitcnt lgkmcnt(4)
    v_cvt_pk_bf16_f32 v140, v192, v193
    v_cvt_pk_bf16_f32 v141, v194, v195
    v_mfma_f32_16x16x32_bf16 a[96:99], a[160:163], v[64:67], 0
    v_exp_f32 v196, v196
    v_mfma_f32_16x16x32_bf16 a[96:99], a[164:167], v[68:71], a[96:99]
    s_waitcnt lgkmcnt(2)
    ds_read_b128 a[144:147], v224 offset:61440
    ds_read_b128 a[148:151], v225 offset:61440
    v_mfma_f32_16x16x32_bf16 a[96:99], a[168:171], v[72:75], a[96:99]
    s_waitcnt lgkmcnt(2)
    v_exp_f32 v197, v197
    v_mfma_f32_16x16x32_bf16 a[96:99], a[172:175], v[76:79], a[96:99]
    ds_read_b128 a[152:155], v226 offset:61440
    v_cvt_pk_bf16_f32 v156, v196, v197
    v_mfma_f32_16x16x32_bf16 a[100:103], a[160:163], v[80:83], 0
    v_exp_f32 v198, v198
    v_mfma_f32_16x16x32_bf16 a[100:103], a[164:167], v[84:87], a[100:103]
    v_accvgpr_write_b32 a140, 0
    v_accvgpr_write_b32 a141, 0
    v_mfma_f32_16x16x32_bf16 a[100:103], a[168:171], v[88:91], a[100:103]
    v_exp_f32 v199, v199
    v_mfma_f32_16x16x32_bf16 a[100:103], a[172:175], v[92:95], a[100:103]
    ds_read_b128 a[156:159], v227 offset:61440
    v_cvt_pk_bf16_f32 v157, v198, v199
    v_mfma_f32_16x16x32_bf16 a[104:107], a[160:163], v[96:99], 0
    v_exp_f32 v200, v200
    v_mfma_f32_16x16x32_bf16 a[104:107], a[164:167], v[100:103], a[104:107]
    v_lshlrev_b32 v248, 20, v238
    v_mov_b32 v249, 1
    v_mfma_f32_16x16x32_bf16 a[104:107], a[168:171], v[104:107], a[104:107]
    v_exp_f32 v201, v201
    v_mfma_f32_16x16x32_bf16 a[104:107], a[172:175], v[108:111], a[104:107]
    v_cvt_pk_bf16_f32 v172, v200, v201
    v_add_u32 v239, s3, v238
    v_mfma_f32_16x16x32_bf16 a[108:111], a[160:163], v[112:115], 0
    s_add_u32 s3, s4, 1
    v_exp_f32 v202, v202
    v_mfma_f32_16x16x32_bf16 a[108:111], a[164:167], v[116:119], a[108:111]
    s_and_b32 s3, s3, 3
    v_mfma_f32_16x16x32_bf16 a[108:111], a[168:171], v[120:123], a[108:111]
    s_lshl_b32 s3, s3, 10
    v_exp_f32 v203, v203
    v_mfma_f32_16x16x32_bf16 a[108:111], a[172:175], v[124:127], a[108:111]
    s_waitcnt lgkmcnt(0)
    v_cvt_pk_bf16_f32 v173, v202, v203
    v_mfma_f32_16x16x32_bf16 v[192:195], a[144:147], v[0:3], v[208:211]
    s_lshl_b32 s7, s4, 12
    v_exp_f32 v204, v204
    v_mfma_f32_16x16x32_bf16 v[192:195], a[148:151], v[4:7], v[192:195]
    s_add_u32 s3, s3, s7
    ds_read_b64_tr_b16 a[160:161], v235 offset:0
    ds_read_b64_tr_b16 a[162:163], v235 offset:4096
    v_mfma_f32_16x16x32_bf16 v[192:195], a[152:155], v[8:11], v[192:195]
    v_exp_f32 v205, v205
    v_mfma_f32_16x16x32_bf16 v[192:195], a[156:159], v[12:15], v[192:195]
    ds_read_b64_tr_b16 a[164:165], v235 offset:8192
    v_cvt_pk_bf16_f32 v188, v204, v205
    v_mfma_f32_16x16x32_bf16 v[196:199], a[144:147], v[16:19], v[212:215]
    v_exp_f32 v206, v206
    v_mfma_f32_16x16x32_bf16 v[196:199], a[148:151], v[20:23], v[196:199]
    v_add_u32 v240, s3, v238
    v_mfma_f32_16x16x32_bf16 v[196:199], a[152:155], v[24:27], v[196:199]
    s_add_u32 s3, s4, 2
    v_exp_f32 v207, v207
    v_mfma_f32_16x16x32_bf16 v[196:199], a[156:159], v[28:31], v[196:199]
    s_and_b32 s3, s3, 3
    ds_read_b64_tr_b16 a[166:167], v235 offset:12288
    v_cvt_pk_bf16_f32 v189, v206, v207
    v_mfma_f32_16x16x32_bf16 v[200:203], a[144:147], v[32:35], v[216:219]
    s_lshl_b32 s3, s3, 10
    v_exp_f32 v192, v192
    v_mfma_f32_16x16x32_bf16 v[200:203], a[148:151], v[36:39], v[200:203]
    s_lshl_b32 s7, s4, 12
    ds_read_b64_tr_b16 a[168:169], v235 offset:16384
    ds_read_b64_tr_b16 a[170:171], v235 offset:20480
    v_mfma_f32_16x16x32_bf16 v[200:203], a[152:155], v[40:43], v[200:203]
    s_add_u32 s3, s3, s7
    v_exp_f32 v193, v193
    v_mfma_f32_16x16x32_bf16 v[200:203], a[156:159], v[44:47], v[200:203]
    ds_read_b64_tr_b16 a[172:173], v235 offset:24576
    ds_read_b64_tr_b16 a[174:175], v235 offset:28672
    v_mfma_f32_16x16x32_bf16 v[204:207], a[144:147], v[48:51], v[220:223]
    v_exp_f32 v194, v194
    v_mfma_f32_16x16x32_bf16 v[204:207], a[148:151], v[52:55], v[204:207]
    v_add_u32 v241, s3, v238
    v_mfma_f32_16x16x32_bf16 v[204:207], a[152:155], v[56:59], v[204:207]
    s_add_u32 s3, s4, 3
    v_exp_f32 v195, v195
    v_mfma_f32_16x16x32_bf16 v[204:207], a[156:159], v[60:63], v[204:207]
    s_waitcnt lgkmcnt(4)
    v_cvt_pk_bf16_f32 v142, v192, v193
    v_cvt_pk_bf16_f32 v143, v194, v195
    v_mfma_f32_16x16x32_bf16 a[112:115], a[160:163], v[64:67], 0
    s_and_b32 s3, s3, 3
    v_exp_f32 v196, v196
    v_mfma_f32_16x16x32_bf16 a[112:115], a[164:167], v[68:71], a[112:115]
    s_waitcnt lgkmcnt(2)
    v_mfma_f32_16x16x32_bf16 a[112:115], a[168:171], v[72:75], a[112:115]
    s_waitcnt lgkmcnt(0)
    v_exp_f32 v197, v197
    v_mfma_f32_16x16x32_bf16 a[112:115], a[172:175], v[76:79], a[112:115]
    s_lshl_b32 s3, s3, 10
    v_cvt_pk_bf16_f32 v158, v196, v197
    v_mfma_f32_16x16x32_bf16 a[116:119], a[160:163], v[80:83], 0
    s_lshl_b32 s7, s4, 12
    v_exp_f32 v198, v198
    v_mfma_f32_16x16x32_bf16 a[116:119], a[164:167], v[84:87], a[116:119]
    s_add_u32 s3, s3, s7
    v_add_u32 v242, s3, v238
    v_mfma_f32_16x16x32_bf16 a[116:119], a[168:171], v[88:91], a[116:119]
    s_mul_i32 s3, s4, 5120
    v_exp_f32 v199, v199
    v_mfma_f32_16x16x32_bf16 a[116:119], a[172:175], v[92:95], a[116:119]
    v_cvt_pk_bf16_f32 v159, v198, v199
    v_add_u32 v243, s3, v238
    v_mfma_f32_16x16x32_bf16 a[120:123], a[160:163], v[96:99], 0
    v_exp_f32 v200, v200
    v_mfma_f32_16x16x32_bf16 a[120:123], a[164:167], v[100:103], a[120:123]
    s_waitcnt vmcnt(2)
    s_barrier
    v_add_u32 v244, 4096, v243
    v_mfma_f32_16x16x32_bf16 a[120:123], a[168:171], v[104:107], a[120:123]
    v_exp_f32 v201, v201
    v_mfma_f32_16x16x32_bf16 a[120:123], a[172:175], v[108:111], a[120:123]
    s_add_u32 s42, s42, 32768
    ds_read_b128 a[144:147], v224 offset:0
    v_cvt_pk_bf16_f32 v174, v200, v201
    v_mfma_f32_16x16x32_bf16 a[124:127], a[160:163], v[112:115], 0
    v_exp_f32 v202, v202
    v_mfma_f32_16x16x32_bf16 a[124:127], a[164:167], v[116:119], a[124:127]
    ds_read_b128 a[148:151], v225 offset:0
    ds_read_b128 a[152:155], v226 offset:0
    v_mfma_f32_16x16x32_bf16 a[124:127], a[168:171], v[120:123], a[124:127]
    v_exp_f32 v203, v203
    v_mfma_f32_16x16x32_bf16 a[124:127], a[172:175], v[124:127], a[124:127]
    ds_read_b128 a[156:159], v227 offset:0
    v_cvt_pk_bf16_f32 v175, v202, v203
    s_branch L_a_odd
L_a_loop:
    v_smfmac_f32_16x16x64_bf16 a[128:131], a[176:179], v[128:135], v253
L_padB_3:
    s_cbranch_execz L_padB_4
    v_smfmac_f32_16x16x64_bf16 a[128:131], a[176:179], v[136:143], v253
    s_add_u32 m0, s40, 98304
    v_smfmac_f32_16x16x64_bf16 a[132:135], a[176:179], v[144:151], v253
    s_add_u32 s41, s42, 0
    v_smfmac_f32_16x16x64_bf16 a[132:135], a[176:179], v[152:159], v253
    buffer_load_dwordx4 v237, s[12:15], s41 offen lds
    v_smfmac_f32_16x16x64_bf16 a[136:139], a[176:179], v[160:167], v253
    v_smfmac_f32_16x16x64_bf16 a[136:139], a[176:179], v[168:175], v253
    v_smfmac_f32_16x16x64_bf16 a[140:143], a[176:179], v[176:183], v253
    v_smfmac_f32_16x16x64_bf16 a[140:143], a[176:179], v[184:191], v253
    s_waitcnt lgkmcnt(0)
    v_mfma_f32_16x16x32_bf16 v[192:195], a[144:147], v[0:3], v[208:211]
    v_exp_f32 v204, v204
    v_mfma_f32_16x16x32_bf16 v[192:195], a[148:151], v[4:7], v[192:195]
    ds_read_b64_tr_b16 a[160:161], v228 offset:0
    ds_read_b64_tr_b16 a[162:163], v228 offset:4096
    v_mfma_f32_16x16x32_bf16 v[192:195], a[152:155], v[8:11], v[192:195]
    v_exp_f32 v205, v205
    v_mfma_f32_16x16x32_bf16 v[192:195], a[156:159], v[12:15], v[192:195]
    s_add_u32 m0, s40, 0
    ds_read_b64_tr_b16 a[164:165], v228 offset:8192
    v_cvt_pk_bf16_f32 v126, v204, v205
    v_mfma_f32_16x16x32_bf16 v[196:199], a[144:147], v[16:19], v[212:215]
    s_add_u32 s41, s42, 32768
    v_exp_f32 v206, v206
    v_mfma_f32_16x16x32_bf16 v[196:199], a[148:151], v[20:23], v[196:199]
    buffer_load_dwordx4 v236, s[8:11], s41 offen lds
    v_mfma_f32_16x16x32_bf16 v[196:199], a[152:155], v[24:27], v[196:199]
    v_exp_f32 v207, v207
    v_mfma_f32_16x16x32_bf16 v[196:199], a[156:159], v[28:31], v[196:199]
    ds_read_b64_tr_b16 a[166:167], v228 offset:12288
    v_cvt_pk_bf16_f32 v127, v206, v207
    v_mfma_f32_16x16x32_bf16 v[200:203], a[144:147], v[32:35], v[216:219]
    v_exp_f32 v192, v192
    v_mfma_f32_16x16x32_bf16 v[200:203], a[148:151], v[36:39], v[200:203]
    ds_read_b64_tr_b16 a[168:169], v228 offset:16384
    ds_read_b64_tr_b16 a[170:171], v228 offset:20480
    v_mfma_f32_16x16x32_bf16 v[200:203], a[152:155], v[40:43], v[200:203]
    v_exp_f32 v193, v193
    v_mfma_f32_16x16x32_bf16 v[200:203], a[156:159], v[44:47], v[200:203]
    s_add_u32 m0, s40, 102400
    ds_read_b64_tr_b16 a[172:173], v228 offset:24576
    ds_read_b64_tr_b16 a[174:175], v228 offset:28672
    v_mfma_f32_16x16x32_bf16 v[204:207], a[144:147], v[48:51], v[220:223]
    s_add_u32 s41, s42, 4096
    v_exp_f32 v194, v194
    v_mfma_f32_16x16x32_bf16 v[204:207], a[148:151], v[52:55], v[204:207]
    buffer_load_dwordx4 v237, s[12:15], s41 offen lds
    v_mfma_f32_16x16x32_bf16 v[204:207], a[152:155], v[56:59], v[204:207]
    v_exp_f32 v195, v195
    v_mfma_f32_16x16x32_bf16 v[204:207], a[156:159], v[60:63], v[204:207]
    s_waitcnt lgkmcnt(4)
    v_cvt_pk_bf16_f32 v128, v192, v193
    v_cvt_pk_bf16_f32 v129, v194, v195
    v_mfma_f32_16x16x32_bf16 a[0:3], a[160:163], v[64:67], a[0:3]
    v_exp_f32 v196, v196
    v_mfma_f32_16x16x32_bf16 a[0:3], a[164:167], v[68:71], a[0:3]
    s_waitcnt lgkmcnt(2)
    ds_read_b128 a[144:147], v224 offset:36864
    ds_read_b128 a[148:151], v225 offset:36864
    v_mfma_f32_16x16x32_bf16 a[0:3], a[168:171], v[72:75], a[0:3]
    s_waitcnt lgkmcnt(2)
    v_exp_f32 v197, v197
    v_mfma_f32_16x16x32_bf16 a[0:3], a[172:175], v[76:79], a[0:3]
    s_add_u32 m0, s40, 4096
    ds_read_b128 a[152:155], v226 offset:36864
    v_cvt_pk_bf16_f32 v144, v196, v197
    v_mfma_f32_16x16x32_bf16 a[4:7], a[160:163], v[80:83], a[4:7]
    s_add_u32 s41, s42, 36864
    v_exp_f32 v198, v198
    v_mfma_f32_16x16x32_bf16 a[4:7], a[164:167], v[84:87], a[4:7]
    buffer_load_dwordx4 v236, s[8:11], s41 offen lds
    v_mfma_f32_16x16x32_bf16 a[4:7], a[168:171], v[88:91], a[4:7]
    v_exp_f32 v199, v199
    v_mfma_f32_16x16x32_bf16 a[4:7], a[172:175], v[92:95], a[4:7]
    ds_read_b128 a[156:159], v227 offset:36864
    v_cvt_pk_bf16_f32 v145, v198, v199
    v_mfma_f32_16x16x32_bf16 a[8:11], a[160:163], v[96:99], a[8:11]
    v_exp_f32 v200, v200
    v_mfma_f32_16x16x32_bf16 a[8:11], a[164:167], v[100:103], a[8:11]
    v_mfma_f32_16x16x32_bf16 a[8:11], a[168:171], v[104:107], a[8:11]
    v_exp_f32 v201, v201
    v_mfma_f32_16x16x32_bf16 a[8:11], a[172:175], v[108:111], a[8:11]
    s_add_u32 m0, s40, 106496
    v_cvt_pk_bf16_f32 v160, v200, v201
    v_mfma_f32_16x16x32_bf16 a[12:15], a[160:163], v[112:115], a[12:15]
    s_add_u32 s41, s42, 8192
    v_exp_f32 v202, v202
    v_mfma_f32_16x16x32_bf16 a[12:15], a[164:167], v[116:119], a[12:15]
    buffer_load_dwordx4 v237, s[12:15], s41 offen lds
    v_mfma_f32_16x16x32_bf16 a[12:15], a[168:171], v[120:123], a[12:15]
    v_exp_f32 v203, v203
    v_mfma_f32_16x16x32_bf16 a[12:15], a[172:175], v[124:127], a[12:15]
    s_waitcnt lgkmcnt(0)
    v_cvt_pk_bf16_f32 v161, v202, v203
    v_mfma_f32_16x16x32_bf16 v[192:195], a[144:147], v[0:3], v[208:211]
    v_exp_f32 v204, v204
    v_mfma_f32_16x16x32_bf16 v[192:195], a[148:151], v[4:7], v[192:195]
    ds_read_b64_tr_b16 a[160:161], v229 offset:0
    ds_read_b64_tr_b16 a[162:163], v229 offset:4096
    v_mfma_f32_16x16x32_bf16 v[192:195], a[152:155], v[8:11], v[192:195]
    v_exp_f32 v205, v205
    v_mfma_f32_16x16x32_bf16 v[192:195], a[156:159], v[12:15], v[192:195]
    s_add_u32 m0, s40, 8192
    ds_read_b64_tr_b16 a[164:165], v229 offset:8192
    v_cvt_pk_bf16_f32 v176, v204, v205
    v_mfma_f32_16x16x32_bf16 v[196:199], a[144:147], v[16:19], v[212:215]
    s_add_u32 s41, s42, 40960
    v_exp_f32 v206, v206
    v_mfma_f32_16x16x32_bf16 v[196:199], a[148:151], v[20:23], v[196:199]
    buffer_load_dwordx4 v236, s[8:11], s41 offen lds
    v_mfma_f32_16x16x32_bf16 v[196:199], a[152:155], v[24:27], v[196:199]
    v_exp_f32 v207, v207
    v_mfma_f32_16x16x32_bf16 v[196:199], a[156:159], v[28:31], v[196:199]
    ds_read_b64_tr_b16 a[166:167], v229 offset:12288
    v_cvt_pk_bf16_f32 v177, v206, v207
    v_mfma_f32_16x16x32_bf16 v[200:203], a[144:147], v[32:35], v[216:219]
    v_exp_f32 v192, v192
    v_mfma_f32_16x16x32_bf16 v[200:203], a[148:151], v[36:39], v[200:203]
    ds_read_b64_tr_b16 a[168:169], v229 offset:16384
    ds_read_b64_tr_b16 a[170:171], v229 offset:20480
    v_mfma_f32_16x16x32_bf16 v[200:203], a[152:155], v[40:43], v[200:203]
    v_exp_f32 v193, v193
    v_mfma_f32_16x16x32_bf16 v[200:203], a[156:159], v[44:47], v[200:203]
    s_add_u32 m0, s40, 110592
    ds_read_b64_tr_b16 a[172:173], v229 offset:24576
    ds_read_b64_tr_b16 a[174:175], v229 offset:28672
    v_mfma_f32_16x16x32_bf16 v[204:207], a[144:147], v[48:51], v[220:223]
    s_add_u32 s41, s42, 12288
    v_exp_f32 v194, v194
    v_mfma_f32_16x16x32_bf16 v[204:207], a[148:151], v[52:55], v[204:207]
    buffer_load_dwordx4 v237, s[12:15], s41 offen lds
    v_mfma_f32_16x16x32_bf16 v[204:207], a[152:155], v[56:59], v[204:207]
    v_exp_f32 v195, v195
    v_mfma_f32_16x16x32_bf16 v[204:207], a[156:159], v[60:63], v[204:207]
    s_waitcnt lgkmcnt(4)
    v_cvt_pk_bf16_f32 v130, v192, v193
    v_cvt_pk_bf16_f32 v131, v194, v195
    v_mfma_f32_16x16x32_bf16 a[16:19], a[160:163], v[64:67], a[16:19]
    v_exp_f32 v196, v196
    v_mfma_f32_16x16x32_bf16 a[16:19], a[164:167], v[68:71], a[16:19]
    s_waitcnt lgkmcnt(2)
    ds_read_b128 a[144:147], v224 offset:40960
    ds_read_b128 a[148:151], v225 offset:40960
    v_mfma_f32_16x16x32_bf16 a[16:19], a[168:171], v[72:75], a[16:19]
    s_waitcnt lgkmcnt(2)
    v_exp_f32 v197, v197
    v_mfma_f32_16x16x32_bf16 a[16:19], a[172:175], v[76:79], a[16:19]
    s_add_u32 m0, s40, 12288
    ds_read_b128 a[152:155], v226 offset:40960
    v_cvt_pk_bf16_f32 v146, v196, v197
    v_mfma_f32_16x16x32_bf16 a[20:23], a[160:163], v[80:83], a[20:23]
    s_add_u32 s41, s42, 45056
    v_exp_f32 v198, v198
    v_mfma_f32_16x16x32_bf16 a[20:23], a[164:167], v[84:87], a[20:23]
    buffer_load_dwordx4 v236, s[8:11], s41 offen lds
    v_mfma_f32_16x16x32_bf16 a[20:23], a[168:171], v[88:91], a[20:23]
    v_exp_f32 v199, v199
    v_mfma_f32_16x16x32_bf16 a[20:23], a[172:175], v[92:95], a[20:23]
    ds_read_b128 a[156:159], v227 offset:40960
    v_cvt_pk_bf16_f32 v147, v198, v199
    v_mfma_f32_16x16x32_bf16 a[24:27], a[160:163], v[96:99], a[24:27]
    v_exp_f32 v200, v200
    v_mfma_f32_16x16x32_bf16 a[24:27], a[164:167], v[100:103], a[24:27]
    v_mfma_f32_16x16x32_bf16 a[24:27], a[168:171], v[104:107], a[24:27]
    v_exp_f32 v201, v201
    v_mfma_f32_16x16x32_bf16 a[24:27], a[172:175], v[108:111], a[24:27]
    s_add_u32 m0, s40, 114688
    v_cvt_pk_bf16_f32 v162, v200, v201
    v_mfma_f32_16x16x32_bf16 a[28:31], a[160:163], v[112:115], a[28:31]
    s_add_u32 s41, s42, 16384
    v_exp_f32 v202, v202
    v_mfma_f32_16x16x32_bf16 a[28:31], a[164:167], v[116:119], a[28:31]
    buffer_load_dwordx4 v237, s[12:15], s41 offen lds
    v_mfma_f32_16x16x32_bf16 a[28:31], a[168:171], v[120:123], a[28:31]
    v_exp_f32 v203, v203
    v_mfma_f32_16x16x32_bf16 a[28:31], a[172:175], v[124:127], a[28:31]
    s_waitcnt lgkmcnt(0)
    v_cvt_pk_bf16_f32 v163, v202, v203
    v_mfma_f32_16x16x32_bf16 v[192:195], a[144:147], v[0:3], v[208:211]
    v_exp_f32 v204, v204
    v_mfma_f32_16x16x32_bf16 v[192:195], a[148:151], v[4:7], v[192:195]
    ds_read_b64_tr_b16 a[160:161], v230 offset:0
    ds_read_b64_tr_b16 a[162:163], v230 offset:4096
    v_mfma_f32_16x16x32_bf16 v[192:195], a[152:155], v[8:11], v[192:195]
    v_exp_f32 v205, v205
    v_mfma_f32_16x16x32_bf16 v[192:195], a[156:159], v[12:15], v[192:195]
    s_add_u32 m0, s40, 16384
    ds_read_b64_tr_b16 a[164:165], v230 offset:8192
    v_cvt_pk_bf16_f32 v178, v204, v205
    v_mfma_f32_16x16x32_bf16 v[196:199], a[144:147], v[16:19], v[212:215]
    s_add_u32 s41, s42, 49152
    v_exp_f32 v206, v206
    v_mfma_f32_16x16x32_bf16 v[196:199], a[148:151], v[20:23], v[196:199]
    buffer_load_dwordx4 v236, s[8:11], s41 offen lds
    v_mfma_f32_16x16x32_bf16 v[196:199], a[152:155], v[24:27], v[196:199]
    v_exp_f32 v207, v207
    v_mfma_f32_16x16x32_bf16 v[196:199], a[156:159], v[28:31], v[196:199]
    ds_read_b64_tr_b16 a[166:167], v230 offset:12288
    v_cvt_pk_bf16_f32 v179, v206, v207
    v_mfma_f32_16x16x32_bf16 v[200:203], a[144:147], v[32:35], v[216:219]
    v_exp_f32 v192, v192
    v_mfma_f32_16x16x32_bf16 v[200:203], a[148:151], v[36:39], v[200:203]
L_padB_4:
    s_cbranch_execz L_padB_5
    ds_read_b64_tr_b16 a[168:169], v230 offset:16384
    ds_read_b64_tr_b16 a[170:171], v230 offset:20480
    v_mfma_f32_16x16x32_bf16 v[200:203], a[152:155], v[40:43], v[200:203]
    v_exp_f32 v193, v193
    v_mfma_f32_16x16x32_bf16 v[200:203], a[156:159], v[44:47], v[200:203]
    s_add_u32 m0, s40, 118784
    ds_read_b64_tr_b16 a[172:173], v230 offset:24576
    ds_read_b64_tr_b16 a[174:175], v230 offset:28672
    v_mfma_f32_16x16x32_bf16 v[204:207], a[144:147], v[48:51], v[220:223]
    s_add_u32 s41, s42, 20480
    v_exp_f32 v194, v194
    v_mfma_f32_16x16x32_bf16 v[204:207], a[148:151], v[52:55], v[204:207]
    buffer_load_dwordx4 v237, s[12:15], s41 offen lds
    v_mfma_f32_16x16x32_bf16 v[204:207], a[152:155], v[56:59], v[204:207]
    v_exp_f32 v195, v195
    v_mfma_f32_16x16x32_bf16 v[204:207], a[156:159], v[60:63], v[204:207]
    s_waitcnt lgkmcnt(4)
    v_cvt_pk_bf16_f32 v132, v192, v193
    v_cvt_pk_bf16_f32 v133, v194, v195
    v_mfma_f32_16x16x32_bf16 a[32:35], a[160:163], v[64:67], a[32:35]
    v_exp_f32 v196, v196
    v_mfma_f32_16x16x32_bf16 a[32:35], a[164:167], v[68:71], a[32:35]
    s_waitcnt lgkmcnt(2)
    ds_read_b128 a[144:147], v224 offset:45056
    ds_read_b128 a[148:151], v225 offset:45056
    v_mfma_f32_16x16x32_bf16 a[32:35], a[168:171], v[72:75], a[32:35]
    s_waitcnt lgkmcnt(2)
    v_exp_f32 v197, v197
    v_mfma_f32_16x16x32_bf16 a[32:35], a[172:175], v[76:79], a[32:35]
    s_add_u32 m0, s40, 20480
    ds_read_b128 a[152:155], v226 offset:45056
    v_cvt_pk_bf16_f32 v148, v196, v197
    v_mfma_f32_16x16x32_bf16 a[36:39], a[160:163], v[80:83], a[36:39]
    s_add_u32 s41, s42, 53248
    v_exp_f32 v198, v198
    v_mfma_f32_16x16x32_bf16 a[36:39], a[164:167], v[84:87], a[36:39]
    buffer_load_dwordx4 v236, s[8:11], s41 offen lds
    v_mfma_f32_16x16x32_bf16 a[36:39], a[168:171], v[88:91], a[36:39]
    v_exp_f32 v199, v199
    v_mfma_f32_16x16x32_bf16 a[36:39], a[172:175], v[92:95], a[36:39]
    ds_read_b128 a[156:159], v227 offset:45056
    v_cvt_pk_bf16_f32 v149, v198, v199
    v_mfma_f32_16x16x32_bf16 a[40:43], a[160:163], v[96:99], a[40:43]
    v_exp_f32 v200, v200
    v_mfma_f32_16x16x32_bf16 a[40:43], a[164:167], v[100:103], a[40:43]
    v_mfma_f32_16x16x32_bf16 a[40:43], a[168:171], v[104:107], a[40:43]
    v_exp_f32 v201, v201
    v_mfma_f32_16x16x32_bf16 a[40:43], a[172:175], v[108:111], a[40:43]
    s_add_u32 m0, s40, 122880
    v_cvt_pk_bf16_f32 v164, v200, v201
    v_mfma_f32_16x16x32_bf16 a[44:47], a[160:163], v[112:115], a[44:47]
    s_add_u32 s41, s42, 24576
    v_exp_f32 v202, v202
    v_mfma_f32_16x16x32_bf16 a[44:47], a[164:167], v[116:119], a[44:47]
    buffer_load_dwordx4 v237, s[12:15], s41 offen lds
    v_mfma_f32_16x16x32_bf16 a[44:47], a[168:171], v[120:123], a[44:47]
    v_exp_f32 v203, v203
    v_mfma_f32_16x16x32_bf16 a[44:47], a[172:175], v[124:127], a[44:47]
    s_waitcnt lgkmcnt(0)
    v_cvt_pk_bf16_f32 v165, v202, v203
    v_mfma_f32_16x16x32_bf16 v[192:195], a[144:147], v[0:3], v[208:211]
    v_exp_f32 v204, v204
    v_mfma_f32_16x16x32_bf16 v[192:195], a[148:151], v[4:7], v[192:195]
    ds_read_b64_tr_b16 a[160:161], v231 offset:0
    ds_read_b64_tr_b16 a[162:163], v231 offset:4096
    v_mfma_f32_16x16x32_bf16 v[192:195], a[152:155], v[8:11], v[192:195]
    v_exp_f32 v205, v205
    v_mfma_f32_16x16x32_bf16 v[192:195], a[156:159], v[12:15], v[192:195]
    s_add_u32 m0, s40, 24576
    ds_read_b64_tr_b16 a[164:165], v231 offset:8192
    v_cvt_pk_bf16_f32 v180, v204, v205
    v_mfma_f32_16x16x32_bf16 v[196:199], a[144:147], v[16:19], v[212:215]
    s_add_u32 s41, s42, 57344
    v_exp_f32 v206, v206
    v_mfma_f32_16x16x32_bf16 v[196:199], a[148:151], v[20:23], v[196:199]
    buffer_load_dwordx4 v236, s[8:11], s41 offen lds
    v_mfma_f32_16x16x32_bf16 v[196:199], a[152:155], v[24:27], v[196:199]
    v_exp_f32 v207, v207
    v_mfma_f32_16x16x32_bf16 v[196:199], a[156:159], v[28:31], v[196:199]
    ds_read_b64_tr_b16 a[166:167], v231 offset:12288
    v_cvt_pk_bf16_f32 v181, v206, v207
    v_mfma_f32_16x16x32_bf16 v[200:203], a[144:147], v[32:35], v[216:219]
    v_exp_f32 v192, v192
    v_mfma_f32_16x16x32_bf16 v[200:203], a[148:151], v[36:39], v[200:203]
    ds_read_b64_tr_b16 a[168:169], v231 offset:16384
    ds_read_b64_tr_b16 a[170:171], v231 offset:20480
    v_mfma_f32_16x16x32_bf16 v[200:203], a[152:155], v[40:43], v[200:203]
    v_exp_f32 v193, v193
    v_mfma_f32_16x16x32_bf16 v[200:203], a[156:159], v[44:47], v[200:203]
    s_add_u32 m0, s40, 126976
    ds_read_b64_tr_b16 a[172:173], v231 offset:24576
    ds_read_b64_tr_b16 a[174:175], v231 offset:28672
    v_mfma_f32_16x16x32_bf16 v[204:207], a[144:147], v[48:51], v[220:223]
    s_add_u32 s41, s42, 28672
    v_exp_f32 v194, v194
    v_mfma_f32_16x16x32_bf16 v[204:207], a[148:151], v[52:55], v[204:207]
    buffer_load_dwordx4 v237, s[12:15], s41 offen lds
    v_mfma_f32_16x16x32_bf16 v[204:207], a[152:155], v[56:59], v[204:207]
    v_exp_f32 v195, v195
    v_mfma_f32_16x16x32_bf16 v[204:207], a[156:159], v[60:63], v[204:207]
    s_waitcnt lgkmcnt(4)
    v_cvt_pk_bf16_f32 v134, v192, v193
    v_cvt_pk_bf16_f32 v135, v194, v195
    v_mfma_f32_16x16x32_bf16 a[48:51], a[160:163], v[64:67], a[48:51]
    v_exp_f32 v196, v196
    v_mfma_f32_16x16x32_bf16 a[48:51], a[164:167], v[68:71], a[48:51]
    s_waitcnt lgkmcnt(2)
    ds_read_b128 a[144:147], v224 offset:49152
    ds_read_b128 a[148:151], v225 offset:49152
    v_mfma_f32_16x16x32_bf16 a[48:51], a[168:171], v[72:75], a[48:51]
    s_waitcnt lgkmcnt(2)
    v_exp_f32 v197, v197
    v_mfma_f32_16x16x32_bf16 a[48:51], a[172:175], v[76:79], a[48:51]
    s_add_u32 m0, s40, 28672
    ds_read_b128 a[152:155], v226 offset:49152
    v_cvt_pk_bf16_f32 v150, v196, v197
    v_mfma_f32_16x16x32_bf16 a[52:55], a[160:163], v[80:83], a[52:55]
    s_add_u32 s41, s42, 61440
    v_exp_f32 v198, v198
    v_mfma_f32_16x16x32_bf16 a[52:55], a[164:167], v[84:87], a[52:55]
    buffer_load_dwordx4 v236, s[8:11], s41 offen lds
    v_mfma_f32_16x16x32_bf16 a[52:55], a[168:171], v[88:91], a[52:55]
    v_exp_f32 v199, v199
    v_mfma_f32_16x16x32_bf16 a[52:55], a[172:175], v[92:95], a[52:55]
    ds_read_b128 a[156:159], v227 offset:49152
    v_cvt_pk_bf16_f32 v151, v198, v199
    v_mfma_f32_16x16x32_bf16 a[56:59], a[160:163], v[96:99], a[56:59]
    v_exp_f32 v200, v200
    v_mfma_f32_16x16x32_bf16 a[56:59], a[164:167], v[100:103], a[56:59]
    v_mfma_f32_16x16x32_bf16 a[56:59], a[168:171], v[104:107], a[56:59]
    v_exp_f32 v201, v201
    v_mfma_f32_16x16x32_bf16 a[56:59], a[172:175], v[108:111], a[56:59]
    v_cvt_pk_bf16_f32 v166, v200, v201
    v_mfma_f32_16x16x32_bf16 a[60:63], a[160:163], v[112:115], a[60:63]
    s_add_u32 s41, s42, 32768
    v_exp_f32 v202, v202
    v_mfma_f32_16x16x32_bf16 a[60:63], a[164:167], v[116:119], a[60:63]
    buffer_load_dword v254, v252, s[12:15], s41 offen
    v_mfma_f32_16x16x32_bf16 a[60:63], a[168:171], v[120:123], a[60:63]
    v_exp_f32 v203, v203
    v_mfma_f32_16x16x32_bf16 a[60:63], a[172:175], v[124:127], a[60:63]
    s_waitcnt lgkmcnt(0)
    v_cvt_pk_bf16_f32 v167, v202, v203
    v_mfma_f32_16x16x32_bf16 v[192:195], a[144:147], v[0:3], v[208:211]
    v_exp_f32 v204, v204
    v_mfma_f32_16x16x32_bf16 v[192:195], a[148:151], v[4:7], v[192:195]
    ds_read_b64_tr_b16 a[160:161], v232 offset:0
    ds_read_b64_tr_b16 a[162:163], v232 offset:4096
    v_mfma_f32_16x16x32_bf16 v[192:195], a[152:155], v[8:11], v[192:195]
    v_exp_f32 v205, v205
    v_mfma_f32_16x16x32_bf16 v[192:195], a[156:159], v[12:15], v[192:195]
    ds_read_b64_tr_b16 a[164:165], v232 offset:8192
    v_cvt_pk_bf16_f32 v182, v204, v205
    v_mfma_f32_16x16x32_bf16 v[196:199], a[144:147], v[16:19], v[212:215]
    s_add_u32 s41, s42, 65536
    v_exp_f32 v206, v206
    v_mfma_f32_16x16x32_bf16 v[196:199], a[148:151], v[20:23], v[196:199]
    buffer_load_dword v254, v252, s[8:11], s41 offen
    v_mfma_f32_16x16x32_bf16 v[196:199], a[152:155], v[24:27], v[196:199]
    v_exp_f32 v207, v207
    v_mfma_f32_16x16x32_bf16 v[196:199], a[156:159], v[28:31], v[196:199]
    ds_read_b64_tr_b16 a[166:167], v232 offset:12288
    v_cvt_pk_bf16_f32 v183, v206, v207
    v_mfma_f32_16x16x32_bf16 v[200:203], a[144:147], v[32:35], v[216:219]
    v_exp_f32 v192, v192
    v_mfma_f32_16x16x32_bf16 v[200:203], a[148:151], v[36:39], v[200:203]
    ds_read_b64_tr_b16 a[168:169], v232 offset:16384
    ds_read_b64_tr_b16 a[170:171], v232 offset:20480
    v_mfma_f32_16x16x32_bf16 v[200:203], a[152:155], v[40:43], v[200:203]
    v_exp_f32 v193, v193
    v_mfma_f32_16x16x32_bf16 v[200:203], a[156:159], v[44:47], v[200:203]
    ds_read_b64_tr_b16 a[172:173], v232 offset:24576
    ds_read_b64_tr_b16 a[174:175], v232 offset:28672
    v_mfma_f32_16x16x32_bf16 v[204:207], a[144:147], v[48:51], v[220:223]
    v_exp_f32 v194, v194
    v_mfma_f32_16x16x32_bf16 v[204:207], a[148:151], v[52:55], v[204:207]
    v_mfma_f32_16x16x32_bf16 v[204:207], a[152:155], v[56:59], v[204:207]
    v_exp_f32 v195, v195
    v_mfma_f32_16x16x32_bf16 v[204:207], a[156:159], v[60:63], v[204:207]
    s_waitcnt lgkmcnt(4)
    v_cvt_pk_bf16_f32 v136, v192, v193
    v_cvt_pk_bf16_f32 v137, v194, v195
    v_mfma_f32_16x16x32_bf16 a[64:67], a[160:163], v[64:67], a[64:67]
    v_exp_f32 v196, v196
    v_mfma_f32_16x16x32_bf16 a[64:67], a[164:167], v[68:71], a[64:67]
    s_waitcnt lgkmcnt(2)
    ds_read_b128 a[144:147], v224 offset:53248
    ds_read_b128 a[148:151], v225 offset:53248
    v_mfma_f32_16x16x32_bf16 a[64:67], a[168:171], v[72:75], a[64:67]
    s_waitcnt lgkmcnt(2)
    v_exp_f32 v197, v197
    v_mfma_f32_16x16x32_bf16 a[64:67], a[172:175], v[76:79], a[64:67]
    ds_read_b128 a[152:155], v226 offset:53248
    v_cvt_pk_bf16_f32 v152, v196, v197
    v_mfma_f32_16x16x32_bf16 a[68:71], a[160:163], v[80:83], a[68:71]
    v_exp_f32 v198, v198
    v_mfma_f32_16x16x32_bf16 a[68:71], a[164:167], v[84:87], a[68:71]
    v_mfma_f32_16x16x32_bf16 a[68:71], a[168:171], v[88:91], a[68:71]
    v_exp_f32 v199, v199
    v_mfma_f32_16x16x32_bf16 a[68:71], a[172:175], v[92:95], a[68:71]
    ds_read_b128 a[156:159], v227 offset:53248
    v_cvt_pk_bf16_f32 v153, v198, v199
    v_mfma_f32_16x16x32_bf16 a[72:75], a[160:163], v[96:99], a[72:75]
    v_exp_f32 v200, v200
    v_mfma_f32_16x16x32_bf16 a[72:75], a[164:167], v[100:103], a[72:75]
    v_mfma_f32_16x16x32_bf16 a[72:75], a[168:171], v[104:107], a[72:75]
    v_exp_f32 v201, v201
    v_mfma_f32_16x16x32_bf16 a[72:75], a[172:175], v[108:111], a[72:75]
    v_cvt_pk_bf16_f32 v168, v200, v201
    v_mfma_f32_16x16x32_bf16 a[76:79], a[160:163], v[112:115], a[76:79]
    v_exp_f32 v202, v202
    v_mfma_f32_16x16x32_bf16 a[76:79], a[164:167], v[116:119], a[76:79]
    v_mfma_f32_16x16x32_bf16 a[76:79], a[168:171], v[120:123], a[76:79]
    v_exp_f32 v203, v203
    v_mfma_f32_16x16x32_bf16 a[76:79], a[172:175], v[124:127], a[76:79]
    s_waitcnt lgkmcnt(0)
    v_cvt_pk_bf16_f32 v169, v202, v203
    v_mfma_f32_16x16x32_bf16 v[192:195], a[144:147], v[0:3], v[208:211]
    v_exp_f32 v204, v204
    v_mfma_f32_16x16x32_bf16 v[192:195], a[148:151], v[4:7], v[192:195]
    ds_read_b64_tr_b16 a[160:161], v233 offset:0
    ds_read_b64_tr_b16 a[162:163], v233 offset:4096
    v_mfma_f32_16x16x32_bf16 v[192:195], a[152:155], v[8:11], v[192:195]
    v_exp_f32 v205, v205
    v_mfma_f32_16x16x32_bf16 v[192:195], a[156:159], v[12:15], v[192:195]
    ds_read_b64_tr_b16 a[164:165], v233 offset:8192
    v_cvt_pk_bf16_f32 v184, v204, v205
    v_mfma_f32_16x16x32_bf16 v[196:199], a[144:147], v[16:19], v[212:215]
    v_exp_f32 v206, v206
    v_mfma_f32_16x16x32_bf16 v[196:199], a[148:151], v[20:23], v[196:199]
    v_mfma_f32_16x16x32_bf16 v[196:199], a[152:155], v[24:27], v[196:199]
    v_exp_f32 v207, v207
    v_mfma_f32_16x16x32_bf16 v[196:199], a[156:159], v[28:31], v[196:199]
    ds_read_b64_tr_b16 a[166:167], v233 offset:12288
    v_cvt_pk_bf16_f32 v185, v206, v207
    v_mfma_f32_16x16x32_bf16 v[200:203], a[144:147], v[32:35], v[216:219]
    v_exp_f32 v192, v192
    v_mfma_f32_16x16x32_bf16 v[200:203], a[148:151], v[36:39], v[200:203]
    ds_read_b64_tr_b16 a[168:169], v233 offset:16384
    ds_read_b64_tr_b16 a[170:171], v233 offset:20480
    v_mfma_f32_16x16x32_bf16 v[200:203], a[152:155], v[40:43], v[200:203]
    v_exp_f32 v193, v193
    v_mfma_f32_16x16x32_bf16 v[200:203], a[156:159], v[44:47], v[200:203]
    ds_read_b64_tr_b16 a[172:173], v233 offset:24576
    ds_read_b64_tr_b16 a[174:175], v233 offset:28672
    v_mfma_f32_16x16x32_bf16 v[204:207], a[144:147], v[48:51], v[220:223]
    v_exp_f32 v194, v194
    v_mfma_f32_16x16x32_bf16 v[204:207], a[148:151], v[52:55], v[204:207]
    v_mfma_f32_16x16x32_bf16 v[204:207], a[152:155], v[56:59], v[204:207]
    v_exp_f32 v195, v195
    v_mfma_f32_16x16x32_bf16 v[204:207], a[156:159], v[60:63], v[204:207]
    s_waitcnt lgkmcnt(4)
    v_cvt_pk_bf16_f32 v138, v192, v193
    v_cvt_pk_bf16_f32 v139, v194, v195
    v_mfma_f32_16x16x32_bf16 a[80:83], a[160:163], v[64:67], a[80:83]
    v_exp_f32 v196, v196
    v_mfma_f32_16x16x32_bf16 a[80:83], a[164:167], v[68:71], a[80:83]
    s_waitcnt lgkmcnt(2)
    ds_read_b128 a[144:147], v224 offset:57344
    ds_read_b128 a[148:151], v225 offset:57344
    v_mfma_f32_16x16x32_bf16 a[80:83], a[168:171], v[72:75], a[80:83]
    s_waitcnt lgkmcnt(2)
    v_exp_f32 v197, v197
    v_mfma_f32_16x16x32_bf16 a[80:83], a[172:175], v[76:79], a[80:83]
    ds_read_b128 a[152:155], v226 offset:57344
    v_cvt_pk_bf16_f32 v154, v196, v197
    v_mfma_f32_16x16x32_bf16 a[84:87], a[160:163], v[80:83], a[84:87]
    v_exp_f32 v198, v198
    v_mfma_f32_16x16x32_bf16 a[84:87], a[164:167], v[84:87], a[84:87]
    v_mfma_f32_16x16x32_bf16 a[84:87], a[168:171], v[88:91], a[84:87]
    v_exp_f32 v199, v199
    v_mfma_f32_16x16x32_bf16 a[84:87], a[172:175], v[92:95], a[84:87]
    ds_read_b128 a[156:159], v227 offset:57344
    v_cvt_pk_bf16_f32 v155, v198, v199
    v_mfma_f32_16x16x32_bf16 a[88:91], a[160:163], v[96:99], a[88:91]
    v_exp_f32 v200, v200
    v_mfma_f32_16x16x32_bf16 a[88:91], a[164:167], v[100:103], a[88:91]
    v_mfma_f32_16x16x32_bf16 a[88:91], a[168:171], v[104:107], a[88:91]
    v_exp_f32 v201, v201
    v_mfma_f32_16x16x32_bf16 a[88:91], a[172:175], v[108:111], a[88:91]
    v_cvt_pk_bf16_f32 v170, v200, v201
    v_mfma_f32_16x16x32_bf16 a[92:95], a[160:163], v[112:115], a[92:95]
    v_exp_f32 v202, v202
    v_mfma_f32_16x16x32_bf16 a[92:95], a[164:167], v[116:119], a[92:95]
    v_mfma_f32_16x16x32_bf16 a[92:95], a[168:171], v[120:123], a[92:95]
    v_exp_f32 v203, v203
    v_mfma_f32_16x16x32_bf16 a[92:95], a[172:175], v[124:127], a[92:95]
    s_waitcnt lgkmcnt(0)
    v_cvt_pk_bf16_f32 v171, v202, v203
    v_mfma_f32_16x16x32_bf16 v[192:195], a[144:147], v[0:3], v[208:211]
    v_exp_f32 v204, v204
    v_mfma_f32_16x16x32_bf16 v[192:195], a[148:151], v[4:7], v[192:195]
    ds_read_b64_tr_b16 a[160:161], v234 offset:0
    ds_read_b64_tr_b16 a[162:163], v234 offset:4096
    v_mfma_f32_16x16x32_bf16 v[192:195], a[152:155], v[8:11], v[192:195]
    v_exp_f32 v205, v205
    v_mfma_f32_16x16x32_bf16 v[192:195], a[156:159], v[12:15], v[192:195]
    ds_read_b64_tr_b16 a[164:165], v234 offset:8192
    v_cvt_pk_bf16_f32 v186, v204, v205
    v_mfma_f32_16x16x32_bf16 v[196:199], a[144:147], v[16:19], v[212:215]
    v_exp_f32 v206, v206
    v_mfma_f32_16x16x32_bf16 v[196:199], a[148:151], v[20:23], v[196:199]
    v_mfma_f32_16x16x32_bf16 v[196:199], a[152:155], v[24:27], v[196:199]
    v_exp_f32 v207, v207
    v_mfma_f32_16x16x32_bf16 v[196:199], a[156:159], v[28:31], v[196:199]
    ds_read_b64_tr_b16 a[166:167], v234 offset:12288
    v_cvt_pk_bf16_f32 v187, v206, v207
    v_mfma_f32_16x16x32_bf16 v[200:203], a[144:147], v[32:35], v[216:219]
    v_exp_f32 v192, v192
    v_mfma_f32_16x16x32_bf16 v[200:203], a[148:151], v[36:39], v[200:203]
    ds_read_b64_tr_b16 a[168:169], v234 offset:16384
    ds_read_b64_tr_b16 a[170:171], v234 offset:20480
    v_mfma_f32_16x16x32_bf16 v[200:203], a[152:155], v[40:43], v[200:203]
    v_exp_f32 v193, v193
    v_mfma_f32_16x16x32_bf16 v[200:203], a[156:159], v[44:47], v[200:203]
    ds_read_b64_tr_b16 a[172:173], v234 offset:24576
    ds_read_b64_tr_b16 a[174:175], v234 offset:28672
    v_mfma_f32_16x16x32_bf16 v[204:207], a[144:147], v[48:51], v[220:223]
    v_exp_f32 v194, v194
    v_mfma_f32_16x16x32_bf16 v[204:207], a[148:151], v[52:55], v[204:207]
    v_mfma_f32_16x16x32_bf16 v[204:207], a[152:155], v[56:59], v[204:207]
    v_exp_f32 v195, v195
    v_mfma_f32_16x16x32_bf16 v[204:207], a[156:159], v[60:63], v[204:207]
    s_waitcnt lgkmcnt(4)
    v_cvt_pk_bf16_f32 v140, v192, v193
    v_cvt_pk_bf16_f32 v141, v194, v195
    v_mfma_f32_16x16x32_bf16 a[96:99], a[160:163], v[64:67], a[96:99]
    v_exp_f32 v196, v196
    v_mfma_f32_16x16x32_bf16 a[96:99], a[164:167], v[68:71], a[96:99]
    s_waitcnt lgkmcnt(2)
    ds_read_b128 a[144:147], v224 offset:61440
    ds_read_b128 a[148:151], v225 offset:61440
    v_mfma_f32_16x16x32_bf16 a[96:99], a[168:171], v[72:75], a[96:99]
    s_waitcnt lgkmcnt(2)
    v_exp_f32 v197, v197
    v_mfma_f32_16x16x32_bf16 a[96:99], a[172:175], v[76:79], a[96:99]
    ds_read_b128 a[152:155], v226 offset:61440
    v_cvt_pk_bf16_f32 v156, v196, v197
    v_mfma_f32_16x16x32_bf16 a[100:103], a[160:163], v[80:83], a[100:103]
    v_exp_f32 v198, v198
    v_mfma_f32_16x16x32_bf16 a[100:103], a[164:167], v[84:87], a[100:103]
    v_mfma_f32_16x16x32_bf16 a[100:103], a[168:171], v[88:91], a[100:103]
    v_exp_f32 v199, v199
    v_mfma_f32_16x16x32_bf16 a[100:103], a[172:175], v[92:95], a[100:103]
    ds_read_b128 a[156:159], v227 offset:61440
    v_cvt_pk_bf16_f32 v157, v198, v199
    v_mfma_f32_16x16x32_bf16 a[104:107], a[160:163], v[96:99], a[104:107]
    v_exp_f32 v200, v200
    v_mfma_f32_16x16x32_bf16 a[104:107], a[164:167], v[100:103], a[104:107]
    v_mfma_f32_16x16x32_bf16 a[104:107], a[168:171], v[104:107], a[104:107]
    v_exp_f32 v201, v201
    v_mfma_f32_16x16x32_bf16 a[104:107], a[172:175], v[108:111], a[104:107]
    v_cvt_pk_bf16_f32 v172, v200, v201
    v_mfma_f32_16x16x32_bf16 a[108:111], a[160:163], v[112:115], a[108:111]
    v_exp_f32 v202, v202
    v_mfma_f32_16x16x32_bf16 a[108:111], a[164:167], v[116:119], a[108:111]
    v_mfma_f32_16x16x32_bf16 a[108:111], a[168:171], v[120:123], a[108:111]
    v_exp_f32 v203, v203
    v_mfma_f32_16x16x32_bf16 a[108:111], a[172:175], v[124:127], a[108:111]
    s_waitcnt lgkmcnt(0)
    v_cvt_pk_bf16_f32 v173, v202, v203
    v_mfma_f32_16x16x32_bf16 v[192:195], a[144:147], v[0:3], v[208:211]
    v_exp_f32 v204, v204
    v_mfma_f32_16x16x32_bf16 v[192:195], a[148:151], v[4:7], v[192:195]
    ds_read_b64_tr_b16 a[160:161], v235 offset:0
    ds_read_b64_tr_b16 a[162:163], v235 offset:4096
    v_mfma_f32_16x16x32_bf16 v[192:195], a[152:155], v[8:11], v[192:195]
    v_exp_f32 v205, v205
    v_mfma_f32_16x16x32_bf16 v[192:195], a[156:159], v[12:15], v[192:195]
    ds_read_b64_tr_b16 a[164:165], v235 offset:8192
    v_cvt_pk_bf16_f32 v188, v204, v205
    v_mfma_f32_16x16x32_bf16 v[196:199], a[144:147], v[16:19], v[212:215]
    v_exp_f32 v206, v206
    v_mfma_f32_16x16x32_bf16 v[196:199], a[148:151], v[20:23], v[196:199]
    v_mfma_f32_16x16x32_bf16 v[196:199], a[152:155], v[24:27], v[196:199]
    v_exp_f32 v207, v207
    v_mfma_f32_16x16x32_bf16 v[196:199], a[156:159], v[28:31], v[196:199]
    ds_read_b64_tr_b16 a[166:167], v235 offset:12288
    v_cvt_pk_bf16_f32 v189, v206, v207
    v_mfma_f32_16x16x32_bf16 v[200:203], a[144:147], v[32:35], v[216:219]
    v_exp_f32 v192, v192
    v_mfma_f32_16x16x32_bf16 v[200:203], a[148:151], v[36:39], v[200:203]
    ds_read_b64_tr_b16 a[168:169], v235 offset:16384
    ds_read_b64_tr_b16 a[170:171], v235 offset:20480
    v_mfma_f32_16x16x32_bf16 v[200:203], a[152:155], v[40:43], v[200:203]
    v_exp_f32 v193, v193
    v_mfma_f32_16x16x32_bf16 v[200:203], a[156:159], v[44:47], v[200:203]
    ds_read_b64_tr_b16 a[172:173], v235 offset:24576
    ds_read_b64_tr_b16 a[174:175], v235 offset:28672
    v_mfma_f32_16x16x32_bf16 v[204:207], a[144:147], v[48:51], v[220:223]
    v_exp_f32 v194, v194
    v_mfma_f32_16x16x32_bf16 v[204:207], a[148:151], v[52:55], v[204:207]
    v_mfma_f32_16x16x32_bf16 v[204:207], a[152:155], v[56:59], v[204:207]
    v_exp_f32 v195, v195
    v_mfma_f32_16x16x32_bf16 v[204:207], a[156:159], v[60:63], v[204:207]
    s_waitcnt lgkmcnt(4)
    v_cvt_pk_bf16_f32 v142, v192, v193
    v_cvt_pk_bf16_f32 v143, v194, v195
    v_mfma_f32_16x16x32_bf16 a[112:115], a[160:163], v[64:67], a[112:115]
    v_exp_f32 v196, v196
    v_mfma_f32_16x16x32_bf16 a[112:115], a[164:167], v[68:71], a[112:115]
    s_waitcnt lgkmcnt(2)
    v_mfma_f32_16x16x32_bf16 a[112:115], a[168:171], v[72:75], a[112:115]
    s_waitcnt lgkmcnt(0)
    v_exp_f32 v197, v197
    v_mfma_f32_16x16x32_bf16 a[112:115], a[172:175], v[76:79], a[112:115]
    v_cvt_pk_bf16_f32 v158, v196, v197
    v_mfma_f32_16x16x32_bf16 a[116:119], a[160:163], v[80:83], a[116:119]
    v_exp_f32 v198, v198
    v_mfma_f32_16x16x32_bf16 a[116:119], a[164:167], v[84:87], a[116:119]
    v_mfma_f32_16x16x32_bf16 a[116:119], a[168:171], v[88:91], a[116:119]
    v_exp_f32 v199, v199
    v_mfma_f32_16x16x32_bf16 a[116:119], a[172:175], v[92:95], a[116:119]
    v_cvt_pk_bf16_f32 v159, v198, v199
    v_mfma_f32_16x16x32_bf16 a[120:123], a[160:163], v[96:99], a[120:123]
    v_exp_f32 v200, v200
    v_mfma_f32_16x16x32_bf16 a[120:123], a[164:167], v[100:103], a[120:123]
    s_waitcnt vmcnt(2)
    s_barrier
    v_mfma_f32_16x16x32_bf16 a[120:123], a[168:171], v[104:107], a[120:123]
    v_exp_f32 v201, v201
    v_mfma_f32_16x16x32_bf16 a[120:123], a[172:175], v[108:111], a[120:123]
    s_add_u32 s42, s42, 32768
    ds_read_b128 a[144:147], v224 offset:0
    v_cvt_pk_bf16_f32 v174, v200, v201
    v_mfma_f32_16x16x32_bf16 a[124:127], a[160:163], v[112:115], a[124:127]
    v_exp_f32 v202, v202
    v_mfma_f32_16x16x32_bf16 a[124:127], a[164:167], v[116:119], a[124:127]
    ds_read_b128 a[148:151], v225 offset:0
    ds_read_b128 a[152:155], v226 offset:0
    v_mfma_f32_16x16x32_bf16 a[124:127], a[168:171], v[120:123], a[124:127]
    v_exp_f32 v203, v203
    v_mfma_f32_16x16x32_bf16 a[124:127], a[172:175], v[124:127], a[124:127]
    ds_read_b128 a[156:159], v227 offset:0
    v_cvt_pk_bf16_f32 v175, v202, v203
L_a_odd:
    v_smfmac_f32_16x16x64_bf16 a[128:131], a[176:179], v[64:71], v253
L_padB_5:
    s_cbranch_execz L_padB_6
    v_smfmac_f32_16x16x64_bf16 a[128:131], a[176:179], v[72:79], v253
    s_add_u32 m0, s40, 65536
    v_smfmac_f32_16x16x64_bf16 a[132:135], a[176:179], v[80:87], v253
    s_add_u32 s41, s42, 0
    v_smfmac_f32_16x16x64_bf16 a[132:135], a[176:179], v[88:95], v253
    buffer_load_dwordx4 v237, s[12:15], s41 offen lds
    v_smfmac_f32_16x16x64_bf16 a[136:139], a[176:179], v[96:103], v253
    s_cmp_eq_u32 s43, s67
    s_cselect_b32 s7, 0, 0x40000000
    v_smfmac_f32_16x16x64_bf16 a[136:139], a[176:179], v[104:111], v253
    s_cmp_eq_u32 s43, 1
    s_cselect_b32 s3, 0, 0x40000000
    v_smfmac_f32_16x16x64_bf16 a[140:143], a[176:179], v[112:119], v253
    v_smfmac_f32_16x16x64_bf16 a[140:143], a[176:179], v[120:127], v253
    s_waitcnt lgkmcnt(0)
    v_mfma_f32_16x16x32_bf16 v[192:195], a[144:147], v[0:3], v[208:211]
    v_exp_f32 v204, v204
    v_mfma_f32_16x16x32_bf16 v[192:195], a[148:151], v[4:7], v[192:195]
    ds_read_b64_tr_b16 a[160:161], v228 offset:32768
    ds_read_b64_tr_b16 a[162:163], v228 offset:36864
    v_mfma_f32_16x16x32_bf16 v[192:195], a[152:155], v[8:11], v[192:195]
    v_exp_f32 v205, v205
    v_mfma_f32_16x16x32_bf16 v[192:195], a[156:159], v[12:15], v[192:195]
    s_add_u32 m0, s40, 32768
    ds_read_b64_tr_b16 a[164:165], v228 offset:40960
    v_cvt_pk_bf16_f32 v190, v204, v205
    v_mfma_f32_16x16x32_bf16 v[196:199], a[144:147], v[16:19], v[212:215]
    s_add_u32 s41, s42, 32768
    v_exp_f32 v206, v206
    v_mfma_f32_16x16x32_bf16 v[196:199], a[148:151], v[20:23], v[196:199]
    buffer_load_dwordx4 v236, s[8:11], s41 offen lds
    v_mfma_f32_16x16x32_bf16 v[196:199], a[152:155], v[24:27], v[196:199]
    v_exp_f32 v207, v207
    v_mfma_f32_16x16x32_bf16 v[196:199], a[156:159], v[28:31], v[196:199]
    ds_read_b64_tr_b16 a[166:167], v228 offset:45056
    v_cvt_pk_bf16_f32 v191, v206, v207
    v_mfma_f32_16x16x32_bf16 v[200:203], a[144:147], v[32:35], v[216:219]
    v_exp_f32 v192, v192
    v_mfma_f32_16x16x32_bf16 v[200:203], a[148:151], v[36:39], v[200:203]
    ds_read_b64_tr_b16 a[168:169], v228 offset:49152
    ds_read_b64_tr_b16 a[170:171], v228 offset:53248
    v_mfma_f32_16x16x32_bf16 v[200:203], a[152:155], v[40:43], v[200:203]
    v_exp_f32 v193, v193
    v_mfma_f32_16x16x32_bf16 v[200:203], a[156:159], v[44:47], v[200:203]
    s_add_u32 m0, s40, 69632
    ds_read_b64_tr_b16 a[172:173], v228 offset:57344
    ds_read_b64_tr_b16 a[174:175], v228 offset:61440
    v_mfma_f32_16x16x32_bf16 v[204:207], a[144:147], v[48:51], v[220:223]
    s_add_u32 s41, s42, 4096
    v_exp_f32 v194, v194
    v_mfma_f32_16x16x32_bf16 v[204:207], a[148:151], v[52:55], v[204:207]
    buffer_load_dwordx4 v237, s[12:15], s41 offen lds
    v_mfma_f32_16x16x32_bf16 v[204:207], a[152:155], v[56:59], v[204:207]
    v_exp_f32 v195, v195
    v_mfma_f32_16x16x32_bf16 v[204:207], a[156:159], v[60:63], v[204:207]
    s_waitcnt lgkmcnt(4)
    v_cvt_pk_bf16_f32 v64, v192, v193
    v_cvt_pk_bf16_f32 v65, v194, v195
    v_mfma_f32_16x16x32_bf16 a[0:3], a[160:163], v[128:131], a[0:3]
    v_exp_f32 v196, v196
    v_mfma_f32_16x16x32_bf16 a[0:3], a[164:167], v[132:135], a[0:3]
    s_waitcnt lgkmcnt(2)
    ds_read_b128 a[144:147], v224 offset:4096
    ds_read_b128 a[148:151], v225 offset:4096
    v_mfma_f32_16x16x32_bf16 a[0:3], a[168:171], v[136:139], a[0:3]
    s_waitcnt lgkmcnt(2)
    v_exp_f32 v197, v197
    v_mfma_f32_16x16x32_bf16 a[0:3], a[172:175], v[140:143], a[0:3]
    s_add_u32 m0, s40, 36864
    ds_read_b128 a[152:155], v226 offset:4096
    v_cvt_pk_bf16_f32 v80, v196, v197
    v_mfma_f32_16x16x32_bf16 a[4:7], a[160:163], v[144:147], a[4:7]
    s_add_u32 s41, s42, 36864
    v_exp_f32 v198, v198
    v_mfma_f32_16x16x32_bf16 a[4:7], a[164:167], v[148:151], a[4:7]
    buffer_load_dwordx4 v236, s[8:11], s41 offen lds
    v_mfma_f32_16x16x32_bf16 a[4:7], a[168:171], v[152:155], a[4:7]
    v_exp_f32 v199, v199
    v_mfma_f32_16x16x32_bf16 a[4:7], a[172:175], v[156:159], a[4:7]
    ds_read_b128 a[156:159], v227 offset:4096
    v_cvt_pk_bf16_f32 v81, v198, v199
    v_mfma_f32_16x16x32_bf16 a[8:11], a[160:163], v[160:163], a[8:11]
    v_exp_f32 v200, v200
    v_mfma_f32_16x16x32_bf16 a[8:11], a[164:167], v[164:167], a[8:11]
    v_mfma_f32_16x16x32_bf16 a[8:11], a[168:171], v[168:171], a[8:11]
    v_exp_f32 v201, v201
    v_mfma_f32_16x16x32_bf16 a[8:11], a[172:175], v[172:175], a[8:11]
    s_add_u32 m0, s40, 73728
    v_cvt_pk_bf16_f32 v96, v200, v201
    v_mfma_f32_16x16x32_bf16 a[12:15], a[160:163], v[176:179], a[12:15]
    s_add_u32 s41, s42, 8192
    v_exp_f32 v202, v202
    v_mfma_f32_16x16x32_bf16 a[12:15], a[164:167], v[180:183], a[12:15]
    buffer_load_dwordx4 v237, s[12:15], s41 offen lds
    v_mfma_f32_16x16x32_bf16 a[12:15], a[168:171], v[184:187], a[12:15]
    v_exp_f32 v203, v203
    v_mfma_f32_16x16x32_bf16 a[12:15], a[172:175], v[188:191], a[12:15]
    s_waitcnt lgkmcnt(0)
    v_cvt_pk_bf16_f32 v97, v202, v203
    v_mfma_f32_16x16x32_bf16 v[192:195], a[144:147], v[0:3], v[208:211]
    v_exp_f32 v204, v204
    v_mfma_f32_16x16x32_bf16 v[192:195], a[148:151], v[4:7], v[192:195]
    ds_read_b64_tr_b16 a[160:161], v229 offset:32768
    ds_read_b64_tr_b16 a[162:163], v229 offset:36864
    v_mfma_f32_16x16x32_bf16 v[192:195], a[152:155], v[8:11], v[192:195]
    v_exp_f32 v205, v205
    v_mfma_f32_16x16x32_bf16 v[192:195], a[156:159], v[12:15], v[192:195]
    s_add_u32 m0, s40, 40960
    ds_read_b64_tr_b16 a[164:165], v229 offset:40960
    v_cvt_pk_bf16_f32 v112, v204, v205
    v_mfma_f32_16x16x32_bf16 v[196:199], a[144:147], v[16:19], v[212:215]
    s_add_u32 s41, s42, 40960
    v_exp_f32 v206, v206
    v_mfma_f32_16x16x32_bf16 v[196:199], a[148:151], v[20:23], v[196:199]
    buffer_load_dwordx4 v236, s[8:11], s41 offen lds
    v_mfma_f32_16x16x32_bf16 v[196:199], a[152:155], v[24:27], v[196:199]
    v_exp_f32 v207, v207
    v_mfma_f32_16x16x32_bf16 v[196:199], a[156:159], v[28:31], v[196:199]
    ds_read_b64_tr_b16 a[166:167], v229 offset:45056
    v_cvt_pk_bf16_f32 v113, v206, v207
    v_mfma_f32_16x16x32_bf16 v[200:203], a[144:147], v[32:35], v[216:219]
    v_exp_f32 v192, v192
    v_mfma_f32_16x16x32_bf16 v[200:203], a[148:151], v[36:39], v[200:203]
    ds_read_b64_tr_b16 a[168:169], v229 offset:49152
    ds_read_b64_tr_b16 a[170:171], v229 offset:53248
    v_mfma_f32_16x16x32_bf16 v[200:203], a[152:155], v[40:43], v[200:203]
    v_exp_f32 v193, v193
    v_mfma_f32_16x16x32_bf16 v[200:203], a[156:159], v[44:47], v[200:203]
    s_add_u32 m0, s40, 77824
    ds_read_b64_tr_b16 a[172:173], v229 offset:57344
    ds_read_b64_tr_b16 a[174:175], v229 offset:61440
    v_mfma_f32_16x16x32_bf16 v[204:207], a[144:147], v[48:51], v[220:223]
    s_add_u32 s41, s42, 12288
    v_exp_f32 v194, v194
    v_mfma_f32_16x16x32_bf16 v[204:207], a[148:151], v[52:55], v[204:207]
    buffer_load_dwordx4 v237, s[12:15], s41 offen lds
    v_mfma_f32_16x16x32_bf16 v[204:207], a[152:155], v[56:59], v[204:207]
    v_exp_f32 v195, v195
    v_mfma_f32_16x16x32_bf16 v[204:207], a[156:159], v[60:63], v[204:207]
    s_waitcnt lgkmcnt(4)
    v_cvt_pk_bf16_f32 v66, v192, v193
    v_cvt_pk_bf16_f32 v67, v194, v195
    v_mfma_f32_16x16x32_bf16 a[16:19], a[160:163], v[128:131], a[16:19]
    v_exp_f32 v196, v196
    v_mfma_f32_16x16x32_bf16 a[16:19], a[164:167], v[132:135], a[16:19]
    s_waitcnt lgkmcnt(2)
    ds_read_b128 a[144:147], v224 offset:8192
    ds_read_b128 a[148:151], v225 offset:8192
    v_mfma_f32_16x16x32_bf16 a[16:19], a[168:171], v[136:139], a[16:19]
    s_waitcnt lgkmcnt(2)
    v_exp_f32 v197, v197
    v_mfma_f32_16x16x32_bf16 a[16:19], a[172:175], v[140:143], a[16:19]
    s_add_u32 m0, s40, 45056
    ds_read_b128 a[152:155], v226 offset:8192
    v_cvt_pk_bf16_f32 v82, v196, v197
    v_mfma_f32_16x16x32_bf16 a[20:23], a[160:163], v[144:147], a[20:23]
    s_add_u32 s41, s42, 45056
    v_exp_f32 v198, v198
    v_mfma_f32_16x16x32_bf16 a[20:23], a[164:167], v[148:151], a[20:23]
L_padB_6:
    s_cbranch_execz L_padB_7
    buffer_load_dwordx4 v236, s[8:11], s41 offen lds
    v_mfma_f32_16x16x32_bf16 a[20:23], a[168:171], v[152:155], a[20:23]
    v_exp_f32 v199, v199
    v_mfma_f32_16x16x32_bf16 a[20:23], a[172:175], v[156:159], a[20:23]
    ds_read_b128 a[156:159], v227 offset:8192
    v_cvt_pk_bf16_f32 v83, v198, v199
    v_mfma_f32_16x16x32_bf16 a[24:27], a[160:163], v[160:163], a[24:27]
    v_exp_f32 v200, v200
    v_mfma_f32_16x16x32_bf16 a[24:27], a[164:167], v[164:167], a[24:27]
    v_mfma_f32_16x16x32_bf16 a[24:27], a[168:171], v[168:171], a[24:27]
    v_exp_f32 v201, v201
    v_mfma_f32_16x16x32_bf16 a[24:27], a[172:175], v[172:175], a[24:27]
    s_add_u32 m0, s40, 81920
    v_cvt_pk_bf16_f32 v98, v200, v201
    v_mfma_f32_16x16x32_bf16 a[28:31], a[160:163], v[176:179], a[28:31]
    s_add_u32 s41, s42, 16384
    v_exp_f32 v202, v202
    v_mfma_f32_16x16x32_bf16 a[28:31], a[164:167], v[180:183], a[28:31]
    buffer_load_dwordx4 v237, s[12:15], s41 offen lds
    v_mfma_f32_16x16x32_bf16 a[28:31], a[168:171], v[184:187], a[28:31]
    v_exp_f32 v203, v203
    v_mfma_f32_16x16x32_bf16 a[28:31], a[172:175], v[188:191], a[28:31]
    s_waitcnt lgkmcnt(0)
    v_cvt_pk_bf16_f32 v99, v202, v203
    v_mfma_f32_16x16x32_bf16 v[192:195], a[144:147], v[0:3], v[208:211]
    v_exp_f32 v204, v204
    v_mfma_f32_16x16x32_bf16 v[192:195], a[148:151], v[4:7], v[192:195]
    ds_read_b64_tr_b16 a[160:161], v230 offset:32768
    ds_read_b64_tr_b16 a[162:163], v230 offset:36864
    v_mfma_f32_16x16x32_bf16 v[192:195], a[152:155], v[8:11], v[192:195]
    v_exp_f32 v205, v205
    v_mfma_f32_16x16x32_bf16 v[192:195], a[156:159], v[12:15], v[192:195]
    s_add_u32 m0, s40, 49152
    ds_read_b64_tr_b16 a[164:165], v230 offset:40960
    v_cvt_pk_bf16_f32 v114, v204, v205
    v_mfma_f32_16x16x32_bf16 v[196:199], a[144:147], v[16:19], v[212:215]
    s_add_u32 s41, s42, 49152
    v_exp_f32 v206, v206
    v_mfma_f32_16x16x32_bf16 v[196:199], a[148:151], v[20:23], v[196:199]
    buffer_load_dwordx4 v236, s[8:11], s41 offen lds
    v_mfma_f32_16x16x32_bf16 v[196:199], a[152:155], v[24:27], v[196:199]
    v_exp_f32 v207, v207
    v_mfma_f32_16x16x32_bf16 v[196:199], a[156:159], v[28:31], v[196:199]
    ds_read_b64_tr_b16 a[166:167], v230 offset:45056
    v_cvt_pk_bf16_f32 v115, v206, v207
    v_mfma_f32_16x16x32_bf16 v[200:203], a[144:147], v[32:35], v[216:219]
    v_exp_f32 v192, v192
    v_mfma_f32_16x16x32_bf16 v[200:203], a[148:151], v[36:39], v[200:203]
    ds_read_b64_tr_b16 a[168:169], v230 offset:49152
    ds_read_b64_tr_b16 a[170:171], v230 offset:53248
    v_mfma_f32_16x16x32_bf16 v[200:203], a[152:155], v[40:43], v[200:203]
    v_exp_f32 v193, v193
    v_mfma_f32_16x16x32_bf16 v[200:203], a[156:159], v[44:47], v[200:203]
    s_add_u32 m0, s40, 86016
    ds_read_b64_tr_b16 a[172:173], v230 offset:57344
    ds_read_b64_tr_b16 a[174:175], v230 offset:61440
    v_mfma_f32_16x16x32_bf16 v[204:207], a[144:147], v[48:51], v[220:223]
    s_add_u32 s41, s42, 20480
    v_exp_f32 v194, v194
    v_mfma_f32_16x16x32_bf16 v[204:207], a[148:151], v[52:55], v[204:207]
    buffer_load_dwordx4 v237, s[12:15], s41 offen lds
    v_mfma_f32_16x16x32_bf16 v[204:207], a[152:155], v[56:59], v[204:207]
    v_exp_f32 v195, v195
    v_mfma_f32_16x16x32_bf16 v[204:207], a[156:159], v[60:63], v[204:207]
    s_waitcnt lgkmcnt(4)
    v_cvt_pk_bf16_f32 v68, v192, v193
    v_cvt_pk_bf16_f32 v69, v194, v195
    v_mfma_f32_16x16x32_bf16 a[32:35], a[160:163], v[128:131], a[32:35]
    v_exp_f32 v196, v196
    v_mfma_f32_16x16x32_bf16 a[32:35], a[164:167], v[132:135], a[32:35]
    s_waitcnt lgkmcnt(2)
    ds_read_b128 a[144:147], v224 offset:12288
    ds_read_b128 a[148:151], v225 offset:12288
    v_mfma_f32_16x16x32_bf16 a[32:35], a[168:171], v[136:139], a[32:35]
    s_waitcnt lgkmcnt(2)
    v_exp_f32 v197, v197
    v_mfma_f32_16x16x32_bf16 a[32:35], a[172:175], v[140:143], a[32:35]
    s_add_u32 m0, s40, 53248
    ds_read_b128 a[152:155], v226 offset:12288
    v_cvt_pk_bf16_f32 v84, v196, v197
    v_mfma_f32_16x16x32_bf16 a[36:39], a[160:163], v[144:147], a[36:39]
    s_add_u32 s41, s42, 53248
    v_exp_f32 v198, v198
    v_mfma_f32_16x16x32_bf16 a[36:39], a[164:167], v[148:151], a[36:39]
    buffer_load_dwordx4 v236, s[8:11], s41 offen lds
    v_mfma_f32_16x16x32_bf16 a[36:39], a[168:171], v[152:155], a[36:39]
    v_exp_f32 v199, v199
    v_mfma_f32_16x16x32_bf16 a[36:39], a[172:175], v[156:159], a[36:39]
    ds_read_b128 a[156:159], v227 offset:12288
    v_cvt_pk_bf16_f32 v85, v198, v199
    v_mfma_f32_16x16x32_bf16 a[40:43], a[160:163], v[160:163], a[40:43]
    v_exp_f32 v200, v200
    v_mfma_f32_16x16x32_bf16 a[40:43], a[164:167], v[164:167], a[40:43]
    v_mfma_f32_16x16x32_bf16 a[40:43], a[168:171], v[168:171], a[40:43]
    v_exp_f32 v201, v201
    v_mfma_f32_16x16x32_bf16 a[40:43], a[172:175], v[172:175], a[40:43]
    s_add_u32 m0, s40, 90112
    v_cvt_pk_bf16_f32 v100, v200, v201
    v_mfma_f32_16x16x32_bf16 a[44:47], a[160:163], v[176:179], a[44:47]
    s_add_u32 s41, s42, 24576
    v_exp_f32 v202, v202
    v_mfma_f32_16x16x32_bf16 a[44:47], a[164:167], v[180:183], a[44:47]
    buffer_load_dwordx4 v237, s[12:15], s41 offen lds
    v_mfma_f32_16x16x32_bf16 a[44:47], a[168:171], v[184:187], a[44:47]
    v_exp_f32 v203, v203
    v_mfma_f32_16x16x32_bf16 a[44:47], a[172:175], v[188:191], a[44:47]
    s_waitcnt lgkmcnt(0)
    v_cvt_pk_bf16_f32 v101, v202, v203
    v_mfma_f32_16x16x32_bf16 v[192:195], a[144:147], v[0:3], v[208:211]
    v_exp_f32 v204, v204
    v_mfma_f32_16x16x32_bf16 v[192:195], a[148:151], v[4:7], v[192:195]
    ds_read_b64_tr_b16 a[160:161], v231 offset:32768
    ds_read_b64_tr_b16 a[162:163], v231 offset:36864
    v_mfma_f32_16x16x32_bf16 v[192:195], a[152:155], v[8:11], v[192:195]
    v_exp_f32 v205, v205
    v_mfma_f32_16x16x32_bf16 v[192:195], a[156:159], v[12:15], v[192:195]
    s_add_u32 m0, s40, 57344
    ds_read_b64_tr_b16 a[164:165], v231 offset:40960
    v_cvt_pk_bf16_f32 v116, v204, v205
    v_mfma_f32_16x16x32_bf16 v[196:199], a[144:147], v[16:19], v[212:215]
    s_add_u32 s41, s42, 57344
    v_exp_f32 v206, v206
    v_mfma_f32_16x16x32_bf16 v[196:199], a[148:151], v[20:23], v[196:199]
    buffer_load_dwordx4 v236, s[8:11], s41 offen lds
    v_mfma_f32_16x16x32_bf16 v[196:199], a[152:155], v[24:27], v[196:199]
    v_exp_f32 v207, v207
    v_mfma_f32_16x16x32_bf16 v[196:199], a[156:159], v[28:31], v[196:199]
    ds_read_b64_tr_b16 a[166:167], v231 offset:45056
    v_cvt_pk_bf16_f32 v117, v206, v207
    v_mfma_f32_16x16x32_bf16 v[200:203], a[144:147], v[32:35], v[216:219]
    v_exp_f32 v192, v192
    v_mfma_f32_16x16x32_bf16 v[200:203], a[148:151], v[36:39], v[200:203]
    ds_read_b64_tr_b16 a[168:169], v231 offset:49152
    ds_read_b64_tr_b16 a[170:171], v231 offset:53248
    v_mfma_f32_16x16x32_bf16 v[200:203], a[152:155], v[40:43], v[200:203]
    v_exp_f32 v193, v193
    v_mfma_f32_16x16x32_bf16 v[200:203], a[156:159], v[44:47], v[200:203]
    s_add_u32 m0, s40, 94208
    ds_read_b64_tr_b16 a[172:173], v231 offset:57344
    ds_read_b64_tr_b16 a[174:175], v231 offset:61440
    v_mfma_f32_16x16x32_bf16 v[204:207], a[144:147], v[48:51], v[220:223]
    s_add_u32 s41, s42, 28672
    v_exp_f32 v194, v194
    v_mfma_f32_16x16x32_bf16 v[204:207], a[148:151], v[52:55], v[204:207]
    buffer_load_dwordx4 v237, s[12:15], s41 offen lds
    v_mfma_f32_16x16x32_bf16 v[204:207], a[152:155], v[56:59], v[204:207]
    v_exp_f32 v195, v195
    v_mfma_f32_16x16x32_bf16 v[204:207], a[156:159], v[60:63], v[204:207]
    s_waitcnt lgkmcnt(4)
    v_cvt_pk_bf16_f32 v70, v192, v193
    v_cvt_pk_bf16_f32 v71, v194, v195
    v_mfma_f32_16x16x32_bf16 a[48:51], a[160:163], v[128:131], a[48:51]
    v_exp_f32 v196, v196
    v_mfma_f32_16x16x32_bf16 a[48:51], a[164:167], v[132:135], a[48:51]
    s_waitcnt lgkmcnt(2)
    ds_read_b128 a[144:147], v224 offset:16384
    ds_read_b128 a[148:151], v225 offset:16384
    v_mfma_f32_16x16x32_bf16 a[48:51], a[168:171], v[136:139], a[48:51]
    s_waitcnt lgkmcnt(2)
    v_exp_f32 v197, v197
    v_mfma_f32_16x16x32_bf16 a[48:51], a[172:175], v[140:143], a[48:51]
    s_add_u32 m0, s40, 61440
    ds_read_b128 a[152:155], v226 offset:16384
    v_cvt_pk_bf16_f32 v86, v196, v197
    v_mfma_f32_16x16x32_bf16 a[52:55], a[160:163], v[144:147], a[52:55]
    s_add_u32 s41, s42, 61440
    v_exp_f32 v198, v198
    v_mfma_f32_16x16x32_bf16 a[52:55], a[164:167], v[148:151], a[52:55]
    buffer_load_dwordx4 v236, s[8:11], s41 offen lds
    v_mfma_f32_16x16x32_bf16 a[52:55], a[168:171], v[152:155], a[52:55]
    v_exp_f32 v199, v199
    v_mfma_f32_16x16x32_bf16 a[52:55], a[172:175], v[156:159], a[52:55]
    ds_read_b128 a[156:159], v227 offset:16384
    v_cvt_pk_bf16_f32 v87, v198, v199
    v_mfma_f32_16x16x32_bf16 a[56:59], a[160:163], v[160:163], a[56:59]
    v_exp_f32 v200, v200
    v_mfma_f32_16x16x32_bf16 a[56:59], a[164:167], v[164:167], a[56:59]
    v_mfma_f32_16x16x32_bf16 a[56:59], a[168:171], v[168:171], a[56:59]
    v_exp_f32 v201, v201
    v_mfma_f32_16x16x32_bf16 a[56:59], a[172:175], v[172:175], a[56:59]
    v_cvt_pk_bf16_f32 v102, v200, v201
    v_mfma_f32_16x16x32_bf16 a[60:63], a[160:163], v[176:179], a[60:63]
    v_exp_f32 v202, v202
    v_mfma_f32_16x16x32_bf16 a[60:63], a[164:167], v[180:183], a[60:63]
    buffer_load_dword v245, off, s[88:91], s3 sc1
    v_mfma_f32_16x16x32_bf16 a[60:63], a[168:171], v[184:187], a[60:63]
    v_exp_f32 v203, v203
    v_mfma_f32_16x16x32_bf16 a[60:63], a[172:175], v[188:191], a[60:63]
    s_waitcnt lgkmcnt(0)
    v_cvt_pk_bf16_f32 v103, v202, v203
    v_mfma_f32_16x16x32_bf16 v[192:195], a[144:147], v[0:3], v[208:211]
    v_exp_f32 v204, v204
    v_mfma_f32_16x16x32_bf16 v[192:195], a[148:151], v[4:7], v[192:195]
    ds_read_b64_tr_b16 a[160:161], v232 offset:32768
    ds_read_b64_tr_b16 a[162:163], v232 offset:36864
    v_mfma_f32_16x16x32_bf16 v[192:195], a[152:155], v[8:11], v[192:195]
    v_exp_f32 v205, v205
    v_mfma_f32_16x16x32_bf16 v[192:195], a[156:159], v[12:15], v[192:195]
    ds_read_b64_tr_b16 a[164:165], v232 offset:40960
    v_cvt_pk_bf16_f32 v118, v204, v205
    v_mfma_f32_16x16x32_bf16 v[196:199], a[144:147], v[16:19], v[212:215]
    v_exp_f32 v206, v206
    v_mfma_f32_16x16x32_bf16 v[196:199], a[148:151], v[20:23], v[196:199]
    buffer_atomic_add v249, v248, s[88:91], s7 offen sc1
    v_mfma_f32_16x16x32_bf16 v[196:199], a[152:155], v[24:27], v[196:199]
    v_exp_f32 v207, v207
    v_mfma_f32_16x16x32_bf16 v[196:199], a[156:159], v[28:31], v[196:199]
    ds_read_b64_tr_b16 a[166:167], v232 offset:45056
    v_cvt_pk_bf16_f32 v119, v206, v207
    v_mfma_f32_16x16x32_bf16 v[200:203], a[144:147], v[32:35], v[216:219]
    v_exp_f32 v192, v192
    v_mfma_f32_16x16x32_bf16 v[200:203], a[148:151], v[36:39], v[200:203]
    ds_read_b64_tr_b16 a[168:169], v232 offset:49152
    ds_read_b64_tr_b16 a[170:171], v232 offset:53248
    v_mfma_f32_16x16x32_bf16 v[200:203], a[152:155], v[40:43], v[200:203]
    v_exp_f32 v193, v193
    v_mfma_f32_16x16x32_bf16 v[200:203], a[156:159], v[44:47], v[200:203]
    ds_read_b64_tr_b16 a[172:173], v232 offset:57344
    ds_read_b64_tr_b16 a[174:175], v232 offset:61440
    v_mfma_f32_16x16x32_bf16 v[204:207], a[144:147], v[48:51], v[220:223]
    s_add_u32 s41, s42, 32768
    v_exp_f32 v194, v194
    v_mfma_f32_16x16x32_bf16 v[204:207], a[148:151], v[52:55], v[204:207]
    buffer_load_dword v254, v252, s[12:15], s41 offen
    v_mfma_f32_16x16x32_bf16 v[204:207], a[152:155], v[56:59], v[204:207]
    v_exp_f32 v195, v195
    v_mfma_f32_16x16x32_bf16 v[204:207], a[156:159], v[60:63], v[204:207]
    s_waitcnt lgkmcnt(4)
    v_cvt_pk_bf16_f32 v72, v192, v193
    v_cvt_pk_bf16_f32 v73, v194, v195
    v_mfma_f32_16x16x32_bf16 a[64:67], a[160:163], v[128:131], a[64:67]
    v_exp_f32 v196, v196
    v_mfma_f32_16x16x32_bf16 a[64:67], a[164:167], v[132:135], a[64:67]
    s_waitcnt lgkmcnt(2)
    ds_read_b128 a[144:147], v224 offset:20480
    ds_read_b128 a[148:151], v225 offset:20480
    v_mfma_f32_16x16x32_bf16 a[64:67], a[168:171], v[136:139], a[64:67]
    s_waitcnt lgkmcnt(2)
    v_exp_f32 v197, v197
    v_mfma_f32_16x16x32_bf16 a[64:67], a[172:175], v[140:143], a[64:67]
    ds_read_b128 a[152:155], v226 offset:20480
    v_cvt_pk_bf16_f32 v88, v196, v197
    v_mfma_f32_16x16x32_bf16 a[68:71], a[160:163], v[144:147], a[68:71]
    s_add_u32 s41, s42, 65536
    v_exp_f32 v198, v198
    v_mfma_f32_16x16x32_bf16 a[68:71], a[164:167], v[148:151], a[68:71]
    buffer_load_dword v254, v252, s[8:11], s41 offen
    v_mfma_f32_16x16x32_bf16 a[68:71], a[168:171], v[152:155], a[68:71]
    v_exp_f32 v199, v199
    v_mfma_f32_16x16x32_bf16 a[68:71], a[172:175], v[156:159], a[68:71]
    ds_read_b128 a[156:159], v227 offset:20480
    v_cvt_pk_bf16_f32 v89, v198, v199
    v_mfma_f32_16x16x32_bf16 a[72:75], a[160:163], v[160:163], a[72:75]
    v_exp_f32 v200, v200
    v_mfma_f32_16x16x32_bf16 a[72:75], a[164:167], v[164:167], a[72:75]
    v_mfma_f32_16x16x32_bf16 a[72:75], a[168:171], v[168:171], a[72:75]
    v_exp_f32 v201, v201
    v_mfma_f32_16x16x32_bf16 a[72:75], a[172:175], v[172:175], a[72:75]
    v_cvt_pk_bf16_f32 v104, v200, v201
    v_mfma_f32_16x16x32_bf16 a[76:79], a[160:163], v[176:179], a[76:79]
    v_exp_f32 v202, v202
    v_mfma_f32_16x16x32_bf16 a[76:79], a[164:167], v[180:183], a[76:79]
    v_mfma_f32_16x16x32_bf16 a[76:79], a[168:171], v[184:187], a[76:79]
    v_exp_f32 v203, v203
    v_mfma_f32_16x16x32_bf16 a[76:79], a[172:175], v[188:191], a[76:79]
    s_waitcnt lgkmcnt(0)
    v_cvt_pk_bf16_f32 v105, v202, v203
    v_mfma_f32_16x16x32_bf16 v[192:195], a[144:147], v[0:3], v[208:211]
    v_exp_f32 v204, v204
    v_mfma_f32_16x16x32_bf16 v[192:195], a[148:151], v[4:7], v[192:195]
    ds_read_b64_tr_b16 a[160:161], v233 offset:32768
    ds_read_b64_tr_b16 a[162:163], v233 offset:36864
    v_mfma_f32_16x16x32_bf16 v[192:195], a[152:155], v[8:11], v[192:195]
    v_exp_f32 v205, v205
    v_mfma_f32_16x16x32_bf16 v[192:195], a[156:159], v[12:15], v[192:195]
    ds_read_b64_tr_b16 a[164:165], v233 offset:40960
    v_cvt_pk_bf16_f32 v120, v204, v205
    v_mfma_f32_16x16x32_bf16 v[196:199], a[144:147], v[16:19], v[212:215]
    v_exp_f32 v206, v206
    v_mfma_f32_16x16x32_bf16 v[196:199], a[148:151], v[20:23], v[196:199]
    v_mfma_f32_16x16x32_bf16 v[196:199], a[152:155], v[24:27], v[196:199]
    v_exp_f32 v207, v207
    v_mfma_f32_16x16x32_bf16 v[196:199], a[156:159], v[28:31], v[196:199]
    ds_read_b64_tr_b16 a[166:167], v233 offset:45056
    v_cvt_pk_bf16_f32 v121, v206, v207
    v_mfma_f32_16x16x32_bf16 v[200:203], a[144:147], v[32:35], v[216:219]
    v_exp_f32 v192, v192
    v_mfma_f32_16x16x32_bf16 v[200:203], a[148:151], v[36:39], v[200:203]
    ds_read_b64_tr_b16 a[168:169], v233 offset:49152
    ds_read_b64_tr_b16 a[170:171], v233 offset:53248
    v_mfma_f32_16x16x32_bf16 v[200:203], a[152:155], v[40:43], v[200:203]
    v_exp_f32 v193, v193
    v_mfma_f32_16x16x32_bf16 v[200:203], a[156:159], v[44:47], v[200:203]
    ds_read_b64_tr_b16 a[172:173], v233 offset:57344
    ds_read_b64_tr_b16 a[174:175], v233 offset:61440
    v_mfma_f32_16x16x32_bf16 v[204:207], a[144:147], v[48:51], v[220:223]
    v_exp_f32 v194, v194
    v_mfma_f32_16x16x32_bf16 v[204:207], a[148:151], v[52:55], v[204:207]
    v_mfma_f32_16x16x32_bf16 v[204:207], a[152:155], v[56:59], v[204:207]
    v_exp_f32 v195, v195
    v_mfma_f32_16x16x32_bf16 v[204:207], a[156:159], v[60:63], v[204:207]
    s_waitcnt lgkmcnt(4)
    v_cvt_pk_bf16_f32 v74, v192, v193
    v_cvt_pk_bf16_f32 v75, v194, v195
    v_mfma_f32_16x16x32_bf16 a[80:83], a[160:163], v[128:131], a[80:83]
    v_exp_f32 v196, v196
    v_mfma_f32_16x16x32_bf16 a[80:83], a[164:167], v[132:135], a[80:83]
    s_waitcnt lgkmcnt(2)
    ds_read_b128 a[144:147], v224 offset:24576
    ds_read_b128 a[148:151], v225 offset:24576
    v_mfma_f32_16x16x32_bf16 a[80:83], a[168:171], v[136:139], a[80:83]
    s_waitcnt lgkmcnt(2)
    v_exp_f32 v197, v197
    v_mfma_f32_16x16x32_bf16 a[80:83], a[172:175], v[140:143], a[80:83]
    ds_read_b128 a[152:155], v226 offset:24576
    v_cvt_pk_bf16_f32 v90, v196, v197
    v_mfma_f32_16x16x32_bf16 a[84:87], a[160:163], v[144:147], a[84:87]
    v_exp_f32 v198, v198
    v_mfma_f32_16x16x32_bf16 a[84:87], a[164:167], v[148:151], a[84:87]
    v_mfma_f32_16x16x32_bf16 a[84:87], a[168:171], v[152:155], a[84:87]
    v_exp_f32 v199, v199
    v_mfma_f32_16x16x32_bf16 a[84:87], a[172:175], v[156:159], a[84:87]
    ds_read_b128 a[156:159], v227 offset:24576
    v_cvt_pk_bf16_f32 v91, v198, v199
    v_mfma_f32_16x16x32_bf16 a[88:91], a[160:163], v[160:163], a[88:91]
    v_exp_f32 v200, v200
    v_mfma_f32_16x16x32_bf16 a[88:91], a[164:167], v[164:167], a[88:91]
    v_mfma_f32_16x16x32_bf16 a[88:91], a[168:171], v[168:171], a[88:91]
    v_exp_f32 v201, v201
    v_mfma_f32_16x16x32_bf16 a[88:91], a[172:175], v[172:175], a[88:91]
    v_cvt_pk_bf16_f32 v106, v200, v201
    v_mfma_f32_16x16x32_bf16 a[92:95], a[160:163], v[176:179], a[92:95]
    v_exp_f32 v202, v202
    v_mfma_f32_16x16x32_bf16 a[92:95], a[164:167], v[180:183], a[92:95]
    v_mfma_f32_16x16x32_bf16 a[92:95], a[168:171], v[184:187], a[92:95]
    v_exp_f32 v203, v203
    v_mfma_f32_16x16x32_bf16 a[92:95], a[172:175], v[188:191], a[92:95]
    s_waitcnt lgkmcnt(0)
    v_cvt_pk_bf16_f32 v107, v202, v203
    v_mfma_f32_16x16x32_bf16 v[192:195], a[144:147], v[0:3], v[208:211]
    v_exp_f32 v204, v204
    v_mfma_f32_16x16x32_bf16 v[192:195], a[148:151], v[4:7], v[192:195]
    ds_read_b64_tr_b16 a[160:161], v234 offset:32768
    ds_read_b64_tr_b16 a[162:163], v234 offset:36864
    v_mfma_f32_16x16x32_bf16 v[192:195], a[152:155], v[8:11], v[192:195]
    v_exp_f32 v205, v205
    v_mfma_f32_16x16x32_bf16 v[192:195], a[156:159], v[12:15], v[192:195]
    ds_read_b64_tr_b16 a[164:165], v234 offset:40960
    v_cvt_pk_bf16_f32 v122, v204, v205
    v_mfma_f32_16x16x32_bf16 v[196:199], a[144:147], v[16:19], v[212:215]
    v_exp_f32 v206, v206
    v_mfma_f32_16x16x32_bf16 v[196:199], a[148:151], v[20:23], v[196:199]
    v_mfma_f32_16x16x32_bf16 v[196:199], a[152:155], v[24:27], v[196:199]
    v_exp_f32 v207, v207
    v_mfma_f32_16x16x32_bf16 v[196:199], a[156:159], v[28:31], v[196:199]
    ds_read_b64_tr_b16 a[166:167], v234 offset:45056
    v_cvt_pk_bf16_f32 v123, v206, v207
    v_mfma_f32_16x16x32_bf16 v[200:203], a[144:147], v[32:35], v[216:219]
    v_exp_f32 v192, v192
    v_mfma_f32_16x16x32_bf16 v[200:203], a[148:151], v[36:39], v[200:203]
    ds_read_b64_tr_b16 a[168:169], v234 offset:49152
    ds_read_b64_tr_b16 a[170:171], v234 offset:53248
    v_mfma_f32_16x16x32_bf16 v[200:203], a[152:155], v[40:43], v[200:203]
    v_exp_f32 v193, v193
    v_mfma_f32_16x16x32_bf16 v[200:203], a[156:159], v[44:47], v[200:203]
    ds_read_b64_tr_b16 a[172:173], v234 offset:57344
    ds_read_b64_tr_b16 a[174:175], v234 offset:61440
    v_mfma_f32_16x16x32_bf16 v[204:207], a[144:147], v[48:51], v[220:223]
    v_exp_f32 v194, v194
    v_mfma_f32_16x16x32_bf16 v[204:207], a[148:151], v[52:55], v[204:207]
    v_mfma_f32_16x16x32_bf16 v[204:207], a[152:155], v[56:59], v[204:207]
    v_exp_f32 v195, v195
    v_mfma_f32_16x16x32_bf16 v[204:207], a[156:159], v[60:63], v[204:207]
    s_waitcnt lgkmcnt(4)
    v_cvt_pk_bf16_f32 v76, v192, v193
    v_cvt_pk_bf16_f32 v77, v194, v195
    v_mfma_f32_16x16x32_bf16 a[96:99], a[160:163], v[128:131], a[96:99]
    v_exp_f32 v196, v196
    v_mfma_f32_16x16x32_bf16 a[96:99], a[164:167], v[132:135], a[96:99]
    s_waitcnt lgkmcnt(2)
    ds_read_b128 a[144:147], v224 offset:28672
    ds_read_b128 a[148:151], v225 offset:28672
    v_mfma_f32_16x16x32_bf16 a[96:99], a[168:171], v[136:139], a[96:99]
    s_waitcnt lgkmcnt(2)
    v_exp_f32 v197, v197
    v_mfma_f32_16x16x32_bf16 a[96:99], a[172:175], v[140:143], a[96:99]
    ds_read_b128 a[152:155], v226 offset:28672
    v_cvt_pk_bf16_f32 v92, v196, v197
    v_mfma_f32_16x16x32_bf16 a[100:103], a[160:163], v[144:147], a[100:103]
    v_exp_f32 v198, v198
    v_mfma_f32_16x16x32_bf16 a[100:103], a[164:167], v[148:151], a[100:103]
    v_mfma_f32_16x16x32_bf16 a[100:103], a[168:171], v[152:155], a[100:103]
    v_exp_f32 v199, v199
    v_mfma_f32_16x16x32_bf16 a[100:103], a[172:175], v[156:159], a[100:103]
    ds_read_b128 a[156:159], v227 offset:28672
    v_cvt_pk_bf16_f32 v93, v198, v199
    v_mfma_f32_16x16x32_bf16 a[104:107], a[160:163], v[160:163], a[104:107]
    v_exp_f32 v200, v200
    v_mfma_f32_16x16x32_bf16 a[104:107], a[164:167], v[164:167], a[104:107]
    v_mfma_f32_16x16x32_bf16 a[104:107], a[168:171], v[168:171], a[104:107]
    v_exp_f32 v201, v201
    v_mfma_f32_16x16x32_bf16 a[104:107], a[172:175], v[172:175], a[104:107]
    v_cvt_pk_bf16_f32 v108, v200, v201
    v_mfma_f32_16x16x32_bf16 a[108:111], a[160:163], v[176:179], a[108:111]
    v_exp_f32 v202, v202
    v_mfma_f32_16x16x32_bf16 a[108:111], a[164:167], v[180:183], a[108:111]
    v_mfma_f32_16x16x32_bf16 a[108:111], a[168:171], v[184:187], a[108:111]
    v_exp_f32 v203, v203
    v_mfma_f32_16x16x32_bf16 a[108:111], a[172:175], v[188:191], a[108:111]
    s_waitcnt lgkmcnt(0)
    v_cvt_pk_bf16_f32 v109, v202, v203
    v_mfma_f32_16x16x32_bf16 v[192:195], a[144:147], v[0:3], v[208:211]
    v_exp_f32 v204, v204
    v_mfma_f32_16x16x32_bf16 v[192:195], a[148:151], v[4:7], v[192:195]
    ds_read_b64_tr_b16 a[160:161], v235 offset:32768
    ds_read_b64_tr_b16 a[162:163], v235 offset:36864
    v_mfma_f32_16x16x32_bf16 v[192:195], a[152:155], v[8:11], v[192:195]
    v_exp_f32 v205, v205
    v_mfma_f32_16x16x32_bf16 v[192:195], a[156:159], v[12:15], v[192:195]
    ds_read_b64_tr_b16 a[164:165], v235 offset:40960
    v_cvt_pk_bf16_f32 v124, v204, v205
    v_mfma_f32_16x16x32_bf16 v[196:199], a[144:147], v[16:19], v[212:215]
    v_exp_f32 v206, v206
    v_mfma_f32_16x16x32_bf16 v[196:199], a[148:151], v[20:23], v[196:199]
    v_mfma_f32_16x16x32_bf16 v[196:199], a[152:155], v[24:27], v[196:199]
    v_exp_f32 v207, v207
    v_mfma_f32_16x16x32_bf16 v[196:199], a[156:159], v[28:31], v[196:199]
    ds_read_b64_tr_b16 a[166:167], v235 offset:45056
    v_cvt_pk_bf16_f32 v125, v206, v207
    v_mfma_f32_16x16x32_bf16 v[200:203], a[144:147], v[32:35], v[216:219]
    v_exp_f32 v192, v192
    v_mfma_f32_16x16x32_bf16 v[200:203], a[148:151], v[36:39], v[200:203]
    ds_read_b64_tr_b16 a[168:169], v235 offset:49152
    ds_read_b64_tr_b16 a[170:171], v235 offset:53248
    v_mfma_f32_16x16x32_bf16 v[200:203], a[152:155], v[40:43], v[200:203]
    v_exp_f32 v193, v193
    v_mfma_f32_16x16x32_bf16 v[200:203], a[156:159], v[44:47], v[200:203]
    ds_read_b64_tr_b16 a[172:173], v235 offset:57344
    ds_read_b64_tr_b16 a[174:175], v235 offset:61440
    v_mfma_f32_16x16x32_bf16 v[204:207], a[144:147], v[48:51], v[220:223]
    v_exp_f32 v194, v194
    v_mfma_f32_16x16x32_bf16 v[204:207], a[148:151], v[52:55], v[204:207]
    v_mfma_f32_16x16x32_bf16 v[204:207], a[152:155], v[56:59], v[204:207]
    v_exp_f32 v195, v195
    v_mfma_f32_16x16x32_bf16 v[204:207], a[156:159], v[60:63], v[204:207]
    s_waitcnt lgkmcnt(4)
    v_cvt_pk_bf16_f32 v78, v192, v193
    v_cvt_pk_bf16_f32 v79, v194, v195
    v_mfma_f32_16x16x32_bf16 a[112:115], a[160:163], v[128:131], a[112:115]
    v_exp_f32 v196, v196
    v_mfma_f32_16x16x32_bf16 a[112:115], a[164:167], v[132:135], a[112:115]
    s_waitcnt lgkmcnt(2)
    v_mfma_f32_16x16x32_bf16 a[112:115], a[168:171], v[136:139], a[112:115]
    s_waitcnt lgkmcnt(0)
    v_exp_f32 v197, v197
    v_mfma_f32_16x16x32_bf16 a[112:115], a[172:175], v[140:143], a[112:115]
    v_cvt_pk_bf16_f32 v94, v196, v197
    v_mfma_f32_16x16x32_bf16 a[116:119], a[160:163], v[144:147], a[116:119]
    v_exp_f32 v198, v198
    v_mfma_f32_16x16x32_bf16 a[116:119], a[164:167], v[148:151], a[116:119]
    v_mfma_f32_16x16x32_bf16 a[116:119], a[168:171], v[152:155], a[116:119]
    v_exp_f32 v199, v199
    v_mfma_f32_16x16x32_bf16 a[116:119], a[172:175], v[156:159], a[116:119]
    v_cvt_pk_bf16_f32 v95, v198, v199
    v_mfma_f32_16x16x32_bf16 a[120:123], a[160:163], v[160:163], a[120:123]
    v_exp_f32 v200, v200
    v_mfma_f32_16x16x32_bf16 a[120:123], a[164:167], v[164:167], a[120:123]
    s_waitcnt vmcnt(2)
    s_barrier
    v_mfma_f32_16x16x32_bf16 a[120:123], a[168:171], v[168:171], a[120:123]
    v_exp_f32 v201, v201
    v_mfma_f32_16x16x32_bf16 a[120:123], a[172:175], v[172:175], a[120:123]
    s_add_u32 s42, s42, 32768
    ds_read_b128 a[144:147], v224 offset:32768
    v_cvt_pk_bf16_f32 v110, v200, v201
    v_mfma_f32_16x16x32_bf16 a[124:127], a[160:163], v[176:179], a[124:127]
    v_exp_f32 v202, v202
    v_mfma_f32_16x16x32_bf16 a[124:127], a[164:167], v[180:183], a[124:127]
    s_sub_u32 s43, s43, 1
    ds_read_b128 a[148:151], v225 offset:32768
    ds_read_b128 a[152:155], v226 offset:32768
    v_mfma_f32_16x16x32_bf16 a[124:127], a[168:171], v[184:187], a[124:127]
    s_cmp_lg_u32 s43, 0
    v_exp_f32 v203, v203
    v_mfma_f32_16x16x32_bf16 a[124:127], a[172:175], v[188:191], a[124:127]
    ds_read_b128 a[156:159], v227 offset:32768
    v_cvt_pk_bf16_f32 v111, v202, v203
    s_cbranch_scc1 L_a_loop
    v_smfmac_f32_16x16x64_bf16 a[128:131], a[176:179], v[128:135], v253
    v_smfmac_f32_16x16x64_bf16 a[128:131], a[176:179], v[136:143], v253
    s_add_u32 m0, s40, 98304
    v_smfmac_f32_16x16x64_bf16 a[132:135], a[176:179], v[144:151], v253
    s_add_u32 s41, s42, 0
    v_smfmac_f32_16x16x64_bf16 a[132:135], a[176:179], v[152:159], v253
    buffer_load_dwordx4 v237, s[12:15], s41 offen lds
    v_smfmac_f32_16x16x64_bf16 a[136:139], a[176:179], v[160:167], v253
    v_readfirstlane_b32 s3, v245
    v_smfmac_f32_16x16x64_bf16 a[136:139], a[176:179], v[168:175], v253
    v_smfmac_f32_16x16x64_bf16 a[140:143], a[176:179], v[176:183], v253
    s_cmp_lt_u32 s3, 256
    s_cbranch_scc1 L_s2
L_s2_back:
    v_smfmac_f32_16x16x64_bf16 a[140:143], a[176:179], v[184:191], v253
    s_waitcnt lgkmcnt(0)
    v_mfma_f32_16x16x32_bf16 v[192:195], a[144:147], v[0:3], v[208:211]
    v_exp_f32 v204, v204
    v_mfma_f32_16x16x32_bf16 v[192:195], a[148:151], v[4:7], v[192:195]
    ds_read_b64_tr_b16 a[160:161], v228 offset:0
    ds_read_b64_tr_b16 a[162:163], v228 offset:4096
    v_mfma_f32_16x16x32_bf16 v[192:195], a[152:155], v[8:11], v[192:195]
    v_exp_f32 v205, v205
    v_mfma_f32_16x16x32_bf16 v[192:195], a[156:159], v[12:15], v[192:195]
    s_add_u32 m0, s40, 102400
    ds_read_b64_tr_b16 a[164:165], v228 offset:8192
    v_cvt_pk_bf16_f32 v126, v204, v205
    v_mfma_f32_16x16x32_bf16 v[196:199], a[144:147], v[16:19], v[212:215]
    s_add_u32 s41, s42, 4096
    v_exp_f32 v206, v206
    v_mfma_f32_16x16x32_bf16 v[196:199], a[148:151], v[20:23], v[196:199]
    buffer_load_dwordx4 v237, s[12:15], s41 offen lds
    v_mfma_f32_16x16x32_bf16 v[196:199], a[152:155], v[24:27], v[196:199]
    v_exp_f32 v207, v207
    v_mfma_f32_16x16x32_bf16 v[196:199], a[156:159], v[28:31], v[196:199]
    ds_read_b64_tr_b16 a[166:167], v228 offset:12288
    v_cvt_pk_bf16_f32 v127, v206, v207
    v_mfma_f32_16x16x32_bf16 v[200:203], a[144:147], v[32:35], v[216:219]
    v_exp_f32 v192, v192
    v_mfma_f32_16x16x32_bf16 v[200:203], a[148:151], v[36:39], v[200:203]
    ds_read_b64_tr_b16 a[168:169], v228 offset:16384
    ds_read_b64_tr_b16 a[170:171], v228 offset:20480
    v_mfma_f32_16x16x32_bf16 v[200:203], a[152:155], v[40:43], v[200:203]
    v_exp_f32 v193, v193
    v_mfma_f32_16x16x32_bf16 v[200:203], a[156:159], v[44:47], v[200:203]
    s_add_u32 m0, s40, 106496
    ds_read_b64_tr_b16 a[172:173], v228 offset:24576
    ds_read_b64_tr_b16 a[174:175], v228 offset:28672
    v_mfma_f32_16x16x32_bf16 v[204:207], a[144:147], v[48:51], v[220:223]
    s_add_u32 s41, s42, 8192
    v_exp_f32 v194, v194
    v_mfma_f32_16x16x32_bf16 v[204:207], a[148:151], v[52:55], v[204:207]
    buffer_load_dwordx4 v237, s[12:15], s41 offen lds
    v_mfma_f32_16x16x32_bf16 v[204:207], a[152:155], v[56:59], v[204:207]
    v_exp_f32 v195, v195
    v_mfma_f32_16x16x32_bf16 v[204:207], a[156:159], v[60:63], v[204:207]
    s_waitcnt lgkmcnt(4)
    v_cvt_pk_bf16_f32 v128, v192, v193
    v_cvt_pk_bf16_f32 v129, v194, v195
    v_mfma_f32_16x16x32_bf16 a[0:3], a[160:163], v[64:67], a[0:3]
    v_exp_f32 v196, v196
    v_mfma_f32_16x16x32_bf16 a[0:3], a[164:167], v[68:71], a[0:3]
    s_waitcnt lgkmcnt(2)
    ds_read_b128 a[144:147], v224 offset:36864
    ds_read_b128 a[148:151], v225 offset:36864
    v_mfma_f32_16x16x32_bf16 a[0:3], a[168:171], v[72:75], a[0:3]
    s_waitcnt lgkmcnt(2)
    v_exp_f32 v197, v197
    v_mfma_f32_16x16x32_bf16 a[0:3], a[172:175], v[76:79], a[0:3]
    s_add_u32 m0, s40, 110592
    ds_read_b128 a[152:155], v226 offset:36864
    v_cvt_pk_bf16_f32 v144, v196, v197
    v_mfma_f32_16x16x32_bf16 a[4:7], a[160:163], v[80:83], a[4:7]
    s_add_u32 s41, s42, 12288
    v_exp_f32 v198, v198
    v_mfma_f32_16x16x32_bf16 a[4:7], a[164:167], v[84:87], a[4:7]
    buffer_load_dwordx4 v237, s[12:15], s41 offen lds
    v_mfma_f32_16x16x32_bf16 a[4:7], a[168:171], v[88:91], a[4:7]
    v_exp_f32 v199, v199
    v_mfma_f32_16x16x32_bf16 a[4:7], a[172:175], v[92:95], a[4:7]
    s_add_u32 m0, s40, 114688
    ds_read_b128 a[156:159], v227 offset:36864
    v_cvt_pk_bf16_f32 v145, v198, v199
    v_mfma_f32_16x16x32_bf16 a[8:11], a[160:163], v[96:99], a[8:11]
    s_add_u32 s41, s42, 16384
    v_exp_f32 v200, v200
    v_mfma_f32_16x16x32_bf16 a[8:11], a[164:167], v[100:103], a[8:11]
    buffer_load_dwordx4 v237, s[12:15], s41 offen lds
    v_mfma_f32_16x16x32_bf16 a[8:11], a[168:171], v[104:107], a[8:11]
    v_exp_f32 v201, v201
    v_mfma_f32_16x16x32_bf16 a[8:11], a[172:175], v[108:111], a[8:11]
    s_add_u32 m0, s40, 118784
    v_cvt_pk_bf16_f32 v160, v200, v201
    v_mfma_f32_16x16x32_bf16 a[12:15], a[160:163], v[112:115], a[12:15]
    s_add_u32 s41, s42, 20480
    v_exp_f32 v202, v202
    v_mfma_f32_16x16x32_bf16 a[12:15], a[164:167], v[116:119], a[12:15]
    buffer_load_dwordx4 v237, s[12:15], s41 offen lds
    v_mfma_f32_16x16x32_bf16 a[12:15], a[168:171], v[120:123], a[12:15]
L_padB_7:
    s_cbranch_execz L_padB_8
    v_exp_f32 v203, v203
    v_mfma_f32_16x16x32_bf16 a[12:15], a[172:175], v[124:127], a[12:15]
    s_waitcnt lgkmcnt(0)
    v_cvt_pk_bf16_f32 v161, v202, v203
    v_mfma_f32_16x16x32_bf16 v[192:195], a[144:147], v[0:3], v[208:211]
    v_exp_f32 v204, v204
    v_mfma_f32_16x16x32_bf16 v[192:195], a[148:151], v[4:7], v[192:195]
    ds_read_b64_tr_b16 a[160:161], v229 offset:0
    ds_read_b64_tr_b16 a[162:163], v229 offset:4096
    v_mfma_f32_16x16x32_bf16 v[192:195], a[152:155], v[8:11], v[192:195]
    v_exp_f32 v205, v205
    v_mfma_f32_16x16x32_bf16 v[192:195], a[156:159], v[12:15], v[192:195]
    s_add_u32 m0, s40, 122880
    ds_read_b64_tr_b16 a[164:165], v229 offset:8192
    v_cvt_pk_bf16_f32 v176, v204, v205
    v_mfma_f32_16x16x32_bf16 v[196:199], a[144:147], v[16:19], v[212:215]
    s_add_u32 s41, s42, 24576
    v_exp_f32 v206, v206
    v_mfma_f32_16x16x32_bf16 v[196:199], a[148:151], v[20:23], v[196:199]
    buffer_load_dwordx4 v237, s[12:15], s41 offen lds
    v_mfma_f32_16x16x32_bf16 v[196:199], a[152:155], v[24:27], v[196:199]
    v_exp_f32 v207, v207
    v_mfma_f32_16x16x32_bf16 v[196:199], a[156:159], v[28:31], v[196:199]
    ds_read_b64_tr_b16 a[166:167], v229 offset:12288
    v_cvt_pk_bf16_f32 v177, v206, v207
    v_mfma_f32_16x16x32_bf16 v[200:203], a[144:147], v[32:35], v[216:219]
    v_exp_f32 v192, v192
    v_mfma_f32_16x16x32_bf16 v[200:203], a[148:151], v[36:39], v[200:203]
    ds_read_b64_tr_b16 a[168:169], v229 offset:16384
    ds_read_b64_tr_b16 a[170:171], v229 offset:20480
    v_mfma_f32_16x16x32_bf16 v[200:203], a[152:155], v[40:43], v[200:203]
    v_exp_f32 v193, v193
    v_mfma_f32_16x16x32_bf16 v[200:203], a[156:159], v[44:47], v[200:203]
    s_add_u32 m0, s40, 126976
    ds_read_b64_tr_b16 a[172:173], v229 offset:24576
    ds_read_b64_tr_b16 a[174:175], v229 offset:28672
    v_mfma_f32_16x16x32_bf16 v[204:207], a[144:147], v[48:51], v[220:223]
    s_add_u32 s41, s42, 28672
    v_exp_f32 v194, v194
    v_mfma_f32_16x16x32_bf16 v[204:207], a[148:151], v[52:55], v[204:207]
    buffer_load_dwordx4 v237, s[12:15], s41 offen lds
    v_mfma_f32_16x16x32_bf16 v[204:207], a[152:155], v[56:59], v[204:207]
    v_exp_f32 v195, v195
    v_mfma_f32_16x16x32_bf16 v[204:207], a[156:159], v[60:63], v[204:207]
    s_waitcnt lgkmcnt(4)
    v_cvt_pk_bf16_f32 v130, v192, v193
    v_cvt_pk_bf16_f32 v131, v194, v195
    v_mfma_f32_16x16x32_bf16 a[16:19], a[160:163], v[64:67], a[16:19]
    v_exp_f32 v196, v196
    v_mfma_f32_16x16x32_bf16 a[16:19], a[164:167], v[68:71], a[16:19]
    s_waitcnt lgkmcnt(2)
    ds_read_b128 a[144:147], v224 offset:40960
    ds_read_b128 a[148:151], v225 offset:40960
    v_mfma_f32_16x16x32_bf16 a[16:19], a[168:171], v[72:75], a[16:19]
    s_waitcnt lgkmcnt(2)
    v_exp_f32 v197, v197
    v_mfma_f32_16x16x32_bf16 a[16:19], a[172:175], v[76:79], a[16:19]
    ds_read_b128 a[152:155], v226 offset:40960
    v_cvt_pk_bf16_f32 v146, v196, v197
    v_mfma_f32_16x16x32_bf16 a[20:23], a[160:163], v[80:83], a[20:23]
    s_mov_b32 s41, 0
    v_exp_f32 v198, v198
    v_mfma_f32_16x16x32_bf16 a[20:23], a[164:167], v[84:87], a[20:23]
    buffer_load_dwordx4 a[180:183], v243, s[20:23], s41 offen sc1
    v_mfma_f32_16x16x32_bf16 a[20:23], a[168:171], v[88:91], a[20:23]
    v_exp_f32 v199, v199
    v_mfma_f32_16x16x32_bf16 a[20:23], a[172:175], v[92:95], a[20:23]
    ds_read_b128 a[156:159], v227 offset:40960
    v_cvt_pk_bf16_f32 v147, v198, v199
    v_mfma_f32_16x16x32_bf16 a[24:27], a[160:163], v[96:99], a[24:27]
    s_mov_b32 s41, 1024
    v_exp_f32 v200, v200
    v_mfma_f32_16x16x32_bf16 a[24:27], a[164:167], v[100:103], a[24:27]
    buffer_load_dwordx4 a[184:187], v243, s[20:23], s41 offen sc1
    v_mfma_f32_16x16x32_bf16 a[24:27], a[168:171], v[104:107], a[24:27]
    v_exp_f32 v201, v201
    v_mfma_f32_16x16x32_bf16 a[24:27], a[172:175], v[108:111], a[24:27]
    v_cvt_pk_bf16_f32 v162, v200, v201
    v_mfma_f32_16x16x32_bf16 a[28:31], a[160:163], v[112:115], a[28:31]
    s_mov_b32 s41, 0
    v_exp_f32 v202, v202
    v_mfma_f32_16x16x32_bf16 a[28:31], a[164:167], v[116:119], a[28:31]
    buffer_load_dwordx4 a[200:203], v239, s[16:19], s41 offen sc1
    v_mfma_f32_16x16x32_bf16 a[28:31], a[168:171], v[120:123], a[28:31]
    v_exp_f32 v203, v203
    v_mfma_f32_16x16x32_bf16 a[28:31], a[172:175], v[124:127], a[28:31]
    s_waitcnt lgkmcnt(0)
    v_cvt_pk_bf16_f32 v163, v202, v203
    v_mfma_f32_16x16x32_bf16 v[192:195], a[144:147], v[0:3], v[208:211]
    v_exp_f32 v204, v204
    v_mfma_f32_16x16x32_bf16 v[192:195], a[148:151], v[4:7], v[192:195]
    ds_read_b64_tr_b16 a[160:161], v230 offset:0
    ds_read_b64_tr_b16 a[162:163], v230 offset:4096
    v_mfma_f32_16x16x32_bf16 v[192:195], a[152:155], v[8:11], v[192:195]
    v_exp_f32 v205, v205
    v_mfma_f32_16x16x32_bf16 v[192:195], a[156:159], v[12:15], v[192:195]
    ds_read_b64_tr_b16 a[164:165], v230 offset:8192
    v_cvt_pk_bf16_f32 v178, v204, v205
    v_mfma_f32_16x16x32_bf16 v[196:199], a[144:147], v[16:19], v[212:215]
    s_mov_b32 s41, 2048
    v_exp_f32 v206, v206
    v_mfma_f32_16x16x32_bf16 v[196:199], a[148:151], v[20:23], v[196:199]
    buffer_load_dwordx4 a[188:191], v243, s[20:23], s41 offen sc1
    v_mfma_f32_16x16x32_bf16 v[196:199], a[152:155], v[24:27], v[196:199]
    v_exp_f32 v207, v207
    v_mfma_f32_16x16x32_bf16 v[196:199], a[156:159], v[28:31], v[196:199]
    ds_read_b64_tr_b16 a[166:167], v230 offset:12288
    v_cvt_pk_bf16_f32 v179, v206, v207
    v_mfma_f32_16x16x32_bf16 v[200:203], a[144:147], v[32:35], v[216:219]
    v_exp_f32 v192, v192
    v_mfma_f32_16x16x32_bf16 v[200:203], a[148:151], v[36:39], v[200:203]
    ds_read_b64_tr_b16 a[168:169], v230 offset:16384
    ds_read_b64_tr_b16 a[170:171], v230 offset:20480
    v_mfma_f32_16x16x32_bf16 v[200:203], a[152:155], v[40:43], v[200:203]
    v_exp_f32 v193, v193
    v_mfma_f32_16x16x32_bf16 v[200:203], a[156:159], v[44:47], v[200:203]
    ds_read_b64_tr_b16 a[172:173], v230 offset:24576
    ds_read_b64_tr_b16 a[174:175], v230 offset:28672
    v_mfma_f32_16x16x32_bf16 v[204:207], a[144:147], v[48:51], v[220:223]
    s_mov_b32 s41, 0
    v_exp_f32 v194, v194
    v_mfma_f32_16x16x32_bf16 v[204:207], a[148:151], v[52:55], v[204:207]
    buffer_load_dwordx4 a[204:207], v240, s[16:19], s41 offen sc1
    v_mfma_f32_16x16x32_bf16 v[204:207], a[152:155], v[56:59], v[204:207]
    v_exp_f32 v195, v195
    v_mfma_f32_16x16x32_bf16 v[204:207], a[156:159], v[60:63], v[204:207]
    s_waitcnt lgkmcnt(4)
    v_cvt_pk_bf16_f32 v132, v192, v193
    v_cvt_pk_bf16_f32 v133, v194, v195
    v_mfma_f32_16x16x32_bf16 a[32:35], a[160:163], v[64:67], a[32:35]
    v_exp_f32 v196, v196
    v_mfma_f32_16x16x32_bf16 a[32:35], a[164:167], v[68:71], a[32:35]
    s_waitcnt lgkmcnt(2)
    ds_read_b128 a[144:147], v224 offset:45056
    ds_read_b128 a[148:151], v225 offset:45056
    v_mfma_f32_16x16x32_bf16 a[32:35], a[168:171], v[72:75], a[32:35]
    s_waitcnt lgkmcnt(2)
    v_exp_f32 v197, v197
    v_mfma_f32_16x16x32_bf16 a[32:35], a[172:175], v[76:79], a[32:35]
    ds_read_b128 a[152:155], v226 offset:45056
    v_cvt_pk_bf16_f32 v148, v196, v197
    v_mfma_f32_16x16x32_bf16 a[36:39], a[160:163], v[80:83], a[36:39]
    s_mov_b32 s41, 3072
    v_exp_f32 v198, v198
    v_mfma_f32_16x16x32_bf16 a[36:39], a[164:167], v[84:87], a[36:39]
    buffer_load_dwordx4 a[192:195], v243, s[20:23], s41 offen sc1
    v_mfma_f32_16x16x32_bf16 a[36:39], a[168:171], v[88:91], a[36:39]
    v_exp_f32 v199, v199
    v_mfma_f32_16x16x32_bf16 a[36:39], a[172:175], v[92:95], a[36:39]
    ds_read_b128 a[156:159], v227 offset:45056
    v_cvt_pk_bf16_f32 v149, v198, v199
    v_mfma_f32_16x16x32_bf16 a[40:43], a[160:163], v[96:99], a[40:43]
    s_mov_b32 s41, 0
    v_exp_f32 v200, v200
    v_mfma_f32_16x16x32_bf16 a[40:43], a[164:167], v[100:103], a[40:43]
    buffer_load_dwordx4 a[208:211], v241, s[16:19], s41 offen sc1
    v_mfma_f32_16x16x32_bf16 a[40:43], a[168:171], v[104:107], a[40:43]
    v_exp_f32 v201, v201
    v_mfma_f32_16x16x32_bf16 a[40:43], a[172:175], v[108:111], a[40:43]
    v_cvt_pk_bf16_f32 v164, v200, v201
    v_mfma_f32_16x16x32_bf16 a[44:47], a[160:163], v[112:115], a[44:47]
    s_mov_b32 s41, 4096
    v_exp_f32 v202, v202
    v_mfma_f32_16x16x32_bf16 a[44:47], a[164:167], v[116:119], a[44:47]
    buffer_load_dwordx4 a[196:199], v243, s[20:23], s41 offen sc1
    v_mfma_f32_16x16x32_bf16 a[44:47], a[168:171], v[120:123], a[44:47]
    v_exp_f32 v203, v203
    v_mfma_f32_16x16x32_bf16 a[44:47], a[172:175], v[124:127], a[44:47]
    s_waitcnt lgkmcnt(0)
    v_cvt_pk_bf16_f32 v165, v202, v203
    v_mfma_f32_16x16x32_bf16 v[192:195], a[144:147], v[0:3], v[208:211]
    v_exp_f32 v204, v204
    v_mfma_f32_16x16x32_bf16 v[192:195], a[148:151], v[4:7], v[192:195]
    ds_read_b64_tr_b16 a[160:161], v231 offset:0
    ds_read_b64_tr_b16 a[162:163], v231 offset:4096
    v_mfma_f32_16x16x32_bf16 v[192:195], a[152:155], v[8:11], v[192:195]
    v_exp_f32 v205, v205
    v_mfma_f32_16x16x32_bf16 v[192:195], a[156:159], v[12:15], v[192:195]
    ds_read_b64_tr_b16 a[164:165], v231 offset:8192
    v_cvt_pk_bf16_f32 v180, v204, v205
    v_mfma_f32_16x16x32_bf16 v[196:199], a[144:147], v[16:19], v[212:215]
    s_mov_b32 s41, 0
    v_exp_f32 v206, v206
    v_mfma_f32_16x16x32_bf16 v[196:199], a[148:151], v[20:23], v[196:199]
    buffer_load_dwordx4 a[212:215], v242, s[16:19], s41 offen sc1
    v_mfma_f32_16x16x32_bf16 v[196:199], a[152:155], v[24:27], v[196:199]
    v_exp_f32 v207, v207
    v_mfma_f32_16x16x32_bf16 v[196:199], a[156:159], v[28:31], v[196:199]
    ds_read_b64_tr_b16 a[166:167], v231 offset:12288
    v_cvt_pk_bf16_f32 v181, v206, v207
    v_mfma_f32_16x16x32_bf16 v[200:203], a[144:147], v[32:35], v[216:219]
    v_exp_f32 v192, v192
    v_mfma_f32_16x16x32_bf16 v[200:203], a[148:151], v[36:39], v[200:203]
    ds_read_b64_tr_b16 a[168:169], v231 offset:16384
    ds_read_b64_tr_b16 a[170:171], v231 offset:20480
    v_mfma_f32_16x16x32_bf16 v[200:203], a[152:155], v[40:43], v[200:203]
    v_exp_f32 v193, v193
    v_mfma_f32_16x16x32_bf16 v[200:203], a[156:159], v[44:47], v[200:203]
    ds_read_b64_tr_b16 a[172:173], v231 offset:24576
    ds_read_b64_tr_b16 a[174:175], v231 offset:28672
    v_mfma_f32_16x16x32_bf16 v[204:207], a[144:147], v[48:51], v[220:223]
    s_mov_b32 s41, 20480
    v_exp_f32 v194, v194
    v_mfma_f32_16x16x32_bf16 v[204:207], a[148:151], v[52:55], v[204:207]
    buffer_load_dwordx4 a[216:219], v243, s[20:23], s41 offen sc1
    v_mfma_f32_16x16x32_bf16 v[204:207], a[152:155], v[56:59], v[204:207]
    v_exp_f32 v195, v195
    v_mfma_f32_16x16x32_bf16 v[204:207], a[156:159], v[60:63], v[204:207]
    s_waitcnt lgkmcnt(4)
    v_cvt_pk_bf16_f32 v134, v192, v193
    v_cvt_pk_bf16_f32 v135, v194, v195
    v_mfma_f32_16x16x32_bf16 a[48:51], a[160:163], v[64:67], a[48:51]
    v_exp_f32 v196, v196
    v_mfma_f32_16x16x32_bf16 a[48:51], a[164:167], v[68:71], a[48:51]
    s_waitcnt lgkmcnt(2)
    ds_read_b128 a[144:147], v224 offset:49152
    ds_read_b128 a[148:151], v225 offset:49152
    v_mfma_f32_16x16x32_bf16 a[48:51], a[168:171], v[72:75], a[48:51]
    s_waitcnt lgkmcnt(2)
    v_exp_f32 v197, v197
    v_mfma_f32_16x16x32_bf16 a[48:51], a[172:175], v[76:79], a[48:51]
    ds_read_b128 a[152:155], v226 offset:49152
    v_cvt_pk_bf16_f32 v150, v196, v197
    v_mfma_f32_16x16x32_bf16 a[52:55], a[160:163], v[80:83], a[52:55]
    s_mov_b32 s41, 21504
    v_exp_f32 v198, v198
    v_mfma_f32_16x16x32_bf16 a[52:55], a[164:167], v[84:87], a[52:55]
    buffer_load_dwordx4 a[220:223], v243, s[20:23], s41 offen sc1
    v_mfma_f32_16x16x32_bf16 a[52:55], a[168:171], v[88:91], a[52:55]
    v_exp_f32 v199, v199
    v_mfma_f32_16x16x32_bf16 a[52:55], a[172:175], v[92:95], a[52:55]
    ds_read_b128 a[156:159], v227 offset:49152
    v_cvt_pk_bf16_f32 v151, v198, v199
    v_mfma_f32_16x16x32_bf16 a[56:59], a[160:163], v[96:99], a[56:59]
    s_mov_b32 s41, 16384
    v_exp_f32 v200, v200
    v_mfma_f32_16x16x32_bf16 a[56:59], a[164:167], v[100:103], a[56:59]
    buffer_load_dwordx4 a[236:239], v239, s[16:19], s41 offen sc1
    v_mfma_f32_16x16x32_bf16 a[56:59], a[168:171], v[104:107], a[56:59]
    v_exp_f32 v201, v201
    v_mfma_f32_16x16x32_bf16 a[56:59], a[172:175], v[108:111], a[56:59]
    v_cvt_pk_bf16_f32 v166, v200, v201
    v_mfma_f32_16x16x32_bf16 a[60:63], a[160:163], v[112:115], a[60:63]
    s_mov_b32 s41, 22528
    v_exp_f32 v202, v202
    v_mfma_f32_16x16x32_bf16 a[60:63], a[164:167], v[116:119], a[60:63]
    buffer_load_dwordx4 a[224:227], v243, s[20:23], s41 offen sc1
    v_mfma_f32_16x16x32_bf16 a[60:63], a[168:171], v[120:123], a[60:63]
    v_exp_f32 v203, v203
    v_mfma_f32_16x16x32_bf16 a[60:63], a[172:175], v[124:127], a[60:63]
    s_waitcnt lgkmcnt(0)
    v_cvt_pk_bf16_f32 v167, v202, v203
    v_mfma_f32_16x16x32_bf16 v[192:195], a[144:147], v[0:3], v[208:211]
    v_exp_f32 v204, v204
    v_mfma_f32_16x16x32_bf16 v[192:195], a[148:151], v[4:7], v[192:195]
    ds_read_b64_tr_b16 a[160:161], v232 offset:0
    ds_read_b64_tr_b16 a[162:163], v232 offset:4096
    v_mfma_f32_16x16x32_bf16 v[192:195], a[152:155], v[8:11], v[192:195]
    v_exp_f32 v205, v205
    v_mfma_f32_16x16x32_bf16 v[192:195], a[156:159], v[12:15], v[192:195]
    ds_read_b64_tr_b16 a[164:165], v232 offset:8192
    v_cvt_pk_bf16_f32 v182, v204, v205
    v_mfma_f32_16x16x32_bf16 v[196:199], a[144:147], v[16:19], v[212:215]
    s_mov_b32 s41, 16384
    v_exp_f32 v206, v206
    v_mfma_f32_16x16x32_bf16 v[196:199], a[148:151], v[20:23], v[196:199]
    buffer_load_dwordx4 a[240:243], v240, s[16:19], s41 offen sc1
    v_mfma_f32_16x16x32_bf16 v[196:199], a[152:155], v[24:27], v[196:199]
    v_exp_f32 v207, v207
    v_mfma_f32_16x16x32_bf16 v[196:199], a[156:159], v[28:31], v[196:199]
    ds_read_b64_tr_b16 a[166:167], v232 offset:12288
    v_cvt_pk_bf16_f32 v183, v206, v207
    v_mfma_f32_16x16x32_bf16 v[200:203], a[144:147], v[32:35], v[216:219]
    v_exp_f32 v192, v192
    v_mfma_f32_16x16x32_bf16 v[200:203], a[148:151], v[36:39], v[200:203]
    ds_read_b64_tr_b16 a[168:169], v232 offset:16384
    ds_read_b64_tr_b16 a[170:171], v232 offset:20480
    v_mfma_f32_16x16x32_bf16 v[200:203], a[152:155], v[40:43], v[200:203]
    v_exp_f32 v193, v193
    v_mfma_f32_16x16x32_bf16 v[200:203], a[156:159], v[44:47], v[200:203]
    ds_read_b64_tr_b16 a[172:173], v232 offset:24576
    ds_read_b64_tr_b16 a[174:175], v232 offset:28672
    v_mfma_f32_16x16x32_bf16 v[204:207], a[144:147], v[48:51], v[220:223]
    s_mov_b32 s41, 23552
    v_exp_f32 v194, v194
    v_mfma_f32_16x16x32_bf16 v[204:207], a[148:151], v[52:55], v[204:207]
    buffer_load_dwordx4 a[228:231], v243, s[20:23], s41 offen sc1
    v_mfma_f32_16x16x32_bf16 v[204:207], a[152:155], v[56:59], v[204:207]
    v_exp_f32 v195, v195
    v_mfma_f32_16x16x32_bf16 v[204:207], a[156:159], v[60:63], v[204:207]
    s_waitcnt lgkmcnt(4)
    v_cvt_pk_bf16_f32 v136, v192, v193
    v_cvt_pk_bf16_f32 v137, v194, v195
    v_mfma_f32_16x16x32_bf16 a[64:67], a[160:163], v[64:67], a[64:67]
    v_exp_f32 v196, v196
    v_mfma_f32_16x16x32_bf16 a[64:67], a[164:167], v[68:71], a[64:67]
    s_waitcnt lgkmcnt(2)
    ds_read_b128 a[144:147], v224 offset:53248
    ds_read_b128 a[148:151], v225 offset:53248
    v_mfma_f32_16x16x32_bf16 a[64:67], a[168:171], v[72:75], a[64:67]
    s_waitcnt lgkmcnt(2)
    v_exp_f32 v197, v197
    v_mfma_f32_16x16x32_bf16 a[64:67], a[172:175], v[76:79], a[64:67]
    ds_read_b128 a[152:155], v226 offset:53248
    v_cvt_pk_bf16_f32 v152, v196, v197
    v_mfma_f32_16x16x32_bf16 a[68:71], a[160:163], v[80:83], a[68:71]
    s_mov_b32 s41, 16384
    v_exp_f32 v198, v198
    v_mfma_f32_16x16x32_bf16 a[68:71], a[164:167], v[84:87], a[68:71]
    buffer_load_dwordx4 a[244:247], v241, s[16:19], s41 offen sc1
    v_mfma_f32_16x16x32_bf16 a[68:71], a[168:171], v[88:91], a[68:71]
    v_exp_f32 v199, v199
    v_mfma_f32_16x16x32_bf16 a[68:71], a[172:175], v[92:95], a[68:71]
    ds_read_b128 a[156:159], v227 offset:53248
    v_cvt_pk_bf16_f32 v153, v198, v199
    v_mfma_f32_16x16x32_bf16 a[72:75], a[160:163], v[96:99], a[72:75]
    s_mov_b32 s41, 24576
    v_exp_f32 v200, v200
    v_mfma_f32_16x16x32_bf16 a[72:75], a[164:167], v[100:103], a[72:75]
    buffer_load_dwordx4 a[232:235], v243, s[20:23], s41 offen sc1
    v_mfma_f32_16x16x32_bf16 a[72:75], a[168:171], v[104:107], a[72:75]
    v_exp_f32 v201, v201
    v_mfma_f32_16x16x32_bf16 a[72:75], a[172:175], v[108:111], a[72:75]
    v_cvt_pk_bf16_f32 v168, v200, v201
    v_mfma_f32_16x16x32_bf16 a[76:79], a[160:163], v[112:115], a[76:79]
    s_mov_b32 s41, 16384
    v_exp_f32 v202, v202
    v_mfma_f32_16x16x32_bf16 a[76:79], a[164:167], v[116:119], a[76:79]
    buffer_load_dwordx4 a[248:251], v242, s[16:19], s41 offen sc1
    v_mfma_f32_16x16x32_bf16 a[76:79], a[168:171], v[120:123], a[76:79]
    v_exp_f32 v203, v203
    v_mfma_f32_16x16x32_bf16 a[76:79], a[172:175], v[124:127], a[76:79]
    s_waitcnt lgkmcnt(0)
    v_cvt_pk_bf16_f32 v169, v202, v203
    v_mfma_f32_16x16x32_bf16 v[192:195], a[144:147], v[0:3], v[208:211]
    v_exp_f32 v204, v204
    v_mfma_f32_16x16x32_bf16 v[192:195], a[148:151], v[4:7], v[192:195]
    ds_read_b64_tr_b16 a[160:161], v233 offset:0
    ds_read_b64_tr_b16 a[162:163], v233 offset:4096
    v_mfma_f32_16x16x32_bf16 v[192:195], a[152:155], v[8:11], v[192:195]
    v_exp_f32 v205, v205
    v_mfma_f32_16x16x32_bf16 v[192:195], a[156:159], v[12:15], v[192:195]
    s_add_u32 m0, s40, 0
    ds_read_b64_tr_b16 a[164:165], v233 offset:8192
    v_cvt_pk_bf16_f32 v184, v204, v205
    v_mfma_f32_16x16x32_bf16 v[196:199], a[144:147], v[16:19], v[212:215]
    s_mov_b32 s41, 40960
    v_exp_f32 v206, v206
    v_mfma_f32_16x16x32_bf16 v[196:199], a[148:151], v[20:23], v[196:199]
    buffer_load_dwordx4 v243, s[20:23], s41 offen sc1 lds
    v_mfma_f32_16x16x32_bf16 v[196:199], a[152:155], v[24:27], v[196:199]
    v_exp_f32 v207, v207
    v_mfma_f32_16x16x32_bf16 v[196:199], a[156:159], v[28:31], v[196:199]
    ds_read_b64_tr_b16 a[166:167], v233 offset:12288
    v_cvt_pk_bf16_f32 v185, v206, v207
    v_mfma_f32_16x16x32_bf16 v[200:203], a[144:147], v[32:35], v[216:219]
    v_exp_f32 v192, v192
    v_mfma_f32_16x16x32_bf16 v[200:203], a[148:151], v[36:39], v[200:203]
    ds_read_b64_tr_b16 a[168:169], v233 offset:16384
    ds_read_b64_tr_b16 a[170:171], v233 offset:20480
    v_mfma_f32_16x16x32_bf16 v[200:203], a[152:155], v[40:43], v[200:203]
    v_exp_f32 v193, v193
    v_mfma_f32_16x16x32_bf16 v[200:203], a[156:159], v[44:47], v[200:203]
    s_add_u32 m0, s40, 4096
    ds_read_b64_tr_b16 a[172:173], v233 offset:24576
    ds_read_b64_tr_b16 a[174:175], v233 offset:28672
    v_mfma_f32_16x16x32_bf16 v[204:207], a[144:147], v[48:51], v[220:223]
    s_mov_b32 s41, 41984
    v_exp_f32 v194, v194
    v_mfma_f32_16x16x32_bf16 v[204:207], a[148:151], v[52:55], v[204:207]
    buffer_load_dwordx4 v243, s[20:23], s41 offen sc1 lds
    v_mfma_f32_16x16x32_bf16 v[204:207], a[152:155], v[56:59], v[204:207]
    v_exp_f32 v195, v195
    v_mfma_f32_16x16x32_bf16 v[204:207], a[156:159], v[60:63], v[204:207]
    s_waitcnt lgkmcnt(4)
    v_cvt_pk_bf16_f32 v138, v192, v193
    v_cvt_pk_bf16_f32 v139, v194, v195
    v_mfma_f32_16x16x32_bf16 a[80:83], a[160:163], v[64:67], a[80:83]
    v_exp_f32 v196, v196
    v_mfma_f32_16x16x32_bf16 a[80:83], a[164:167], v[68:71], a[80:83]
    s_waitcnt lgkmcnt(2)
    ds_read_b128 a[144:147], v224 offset:57344
    ds_read_b128 a[148:151], v225 offset:57344
    v_mfma_f32_16x16x32_bf16 a[80:83], a[168:171], v[72:75], a[80:83]
    s_waitcnt lgkmcnt(2)
    v_exp_f32 v197, v197
    v_mfma_f32_16x16x32_bf16 a[80:83], a[172:175], v[76:79], a[80:83]
    s_add_u32 m0, s40, 8192
    ds_read_b128 a[152:155], v226 offset:57344
    v_cvt_pk_bf16_f32 v154, v196, v197
    v_mfma_f32_16x16x32_bf16 a[84:87], a[160:163], v[80:83], a[84:87]
    s_mov_b32 s41, 32768
    v_exp_f32 v198, v198
    v_mfma_f32_16x16x32_bf16 a[84:87], a[164:167], v[84:87], a[84:87]
    buffer_load_dwordx4 v239, s[16:19], s41 offen sc1 lds
    v_mfma_f32_16x16x32_bf16 a[84:87], a[168:171], v[88:91], a[84:87]
    v_exp_f32 v199, v199
    v_mfma_f32_16x16x32_bf16 a[84:87], a[172:175], v[92:95], a[84:87]
    s_add_u32 m0, s40, 12288
    ds_read_b128 a[156:159], v227 offset:57344
    v_cvt_pk_bf16_f32 v155, v198, v199
    v_mfma_f32_16x16x32_bf16 a[88:91], a[160:163], v[96:99], a[88:91]
    s_mov_b32 s41, 43008
    v_exp_f32 v200, v200
    v_mfma_f32_16x16x32_bf16 a[88:91], a[164:167], v[100:103], a[88:91]
    buffer_load_dwordx4 v243, s[20:23], s41 offen sc1 lds
    v_mfma_f32_16x16x32_bf16 a[88:91], a[168:171], v[104:107], a[88:91]
    v_exp_f32 v201, v201
    v_mfma_f32_16x16x32_bf16 a[88:91], a[172:175], v[108:111], a[88:91]
    s_add_u32 m0, s40, 16384
    v_cvt_pk_bf16_f32 v170, v200, v201
    v_mfma_f32_16x16x32_bf16 a[92:95], a[160:163], v[112:115], a[92:95]
    s_mov_b32 s41, 32768
    v_exp_f32 v202, v202
    v_mfma_f32_16x16x32_bf16 a[92:95], a[164:167], v[116:119], a[92:95]
    buffer_load_dwordx4 v240, s[16:19], s41 offen sc1 lds
    v_mfma_f32_16x16x32_bf16 a[92:95], a[168:171], v[120:123], a[92:95]
    v_exp_f32 v203, v203
    v_mfma_f32_16x16x32_bf16 a[92:95], a[172:175], v[124:127], a[92:95]
    s_waitcnt lgkmcnt(0)
    v_cvt_pk_bf16_f32 v171, v202, v203
    v_mfma_f32_16x16x32_bf16 v[192:195], a[144:147], v[0:3], v[208:211]
    v_exp_f32 v204, v204
    v_mfma_f32_16x16x32_bf16 v[192:195], a[148:151], v[4:7], v[192:195]
    ds_read_b64_tr_b16 a[160:161], v234 offset:0
    ds_read_b64_tr_b16 a[162:163], v234 offset:4096
    v_mfma_f32_16x16x32_bf16 v[192:195], a[152:155], v[8:11], v[192:195]
    v_exp_f32 v205, v205
    v_mfma_f32_16x16x32_bf16 v[192:195], a[156:159], v[12:15], v[192:195]
    s_add_u32 m0, s40, 20480
    ds_read_b64_tr_b16 a[164:165], v234 offset:8192
    v_cvt_pk_bf16_f32 v186, v204, v205
    v_mfma_f32_16x16x32_bf16 v[196:199], a[144:147], v[16:19], v[212:215]
    s_mov_b32 s41, 44032
    v_exp_f32 v206, v206
    v_mfma_f32_16x16x32_bf16 v[196:199], a[148:151], v[20:23], v[196:199]
    buffer_load_dwordx4 v243, s[20:23], s41 offen sc1 lds
    v_mfma_f32_16x16x32_bf16 v[196:199], a[152:155], v[24:27], v[196:199]
    v_exp_f32 v207, v207
    v_mfma_f32_16x16x32_bf16 v[196:199], a[156:159], v[28:31], v[196:199]
    ds_read_b64_tr_b16 a[166:167], v234 offset:12288
    v_cvt_pk_bf16_f32 v187, v206, v207
    v_mfma_f32_16x16x32_bf16 v[200:203], a[144:147], v[32:35], v[216:219]
    v_exp_f32 v192, v192
    v_mfma_f32_16x16x32_bf16 v[200:203], a[148:151], v[36:39], v[200:203]
    ds_read_b64_tr_b16 a[168:169], v234 offset:16384
    ds_read_b64_tr_b16 a[170:171], v234 offset:20480
    v_mfma_f32_16x16x32_bf16 v[200:203], a[152:155], v[40:43], v[200:203]
    v_exp_f32 v193, v193
    v_mfma_f32_16x16x32_bf16 v[200:203], a[156:159], v[44:47], v[200:203]
    s_add_u32 m0, s40, 24576
    ds_read_b64_tr_b16 a[172:173], v234 offset:24576
    ds_read_b64_tr_b16 a[174:175], v234 offset:28672
    v_mfma_f32_16x16x32_bf16 v[204:207], a[144:147], v[48:51], v[220:223]
    s_mov_b32 s41, 32768
    v_exp_f32 v194, v194
    v_mfma_f32_16x16x32_bf16 v[204:207], a[148:151], v[52:55], v[204:207]
    buffer_load_dwordx4 v241, s[16:19], s41 offen sc1 lds
    v_mfma_f32_16x16x32_bf16 v[204:207], a[152:155], v[56:59], v[204:207]
    v_exp_f32 v195, v195
    v_mfma_f32_16x16x32_bf16 v[204:207], a[156:159], v[60:63], v[204:207]
    s_waitcnt lgkmcnt(4)
    v_cvt_pk_bf16_f32 v140, v192, v193
    v_cvt_pk_bf16_f32 v141, v194, v195
    v_mfma_f32_16x16x32_bf16 a[96:99], a[160:163], v[64:67], a[96:99]
    v_exp_f32 v196, v196
    v_mfma_f32_16x16x32_bf16 a[96:99], a[164:167], v[68:71], a[96:99]
    s_waitcnt lgkmcnt(2)
    ds_read_b128 a[144:147], v224 offset:61440
    ds_read_b128 a[148:151], v225 offset:61440
    v_mfma_f32_16x16x32_bf16 a[96:99], a[168:171], v[72:75], a[96:99]
    s_waitcnt lgkmcnt(2)
    v_exp_f32 v197, v197
    v_mfma_f32_16x16x32_bf16 a[96:99], a[172:175], v[76:79], a[96:99]
    s_add_u32 m0, s40, 28672
    ds_read_b128 a[152:155], v226 offset:61440
    v_cvt_pk_bf16_f32 v156, v196, v197
    v_mfma_f32_16x16x32_bf16 a[100:103], a[160:163], v[80:83], a[100:103]
    s_mov_b32 s41, 45056
    v_exp_f32 v198, v198
    v_mfma_f32_16x16x32_bf16 a[100:103], a[164:167], v[84:87], a[100:103]
    buffer_load_dwordx4 v243, s[20:23], s41 offen sc1 lds
    v_mfma_f32_16x16x32_bf16 a[100:103], a[168:171], v[88:91], a[100:103]
    v_exp_f32 v199, v199
    v_mfma_f32_16x16x32_bf16 a[100:103], a[172:175], v[92:95], a[100:103]
    s_add_u32 m0, s66, 3072
    ds_read_b128 a[156:159], v227 offset:61440
    v_cvt_pk_bf16_f32 v157, v198, v199
    v_mfma_f32_16x16x32_bf16 a[104:107], a[160:163], v[96:99], a[104:107]
    s_mov_b32 s41, 32768
    v_exp_f32 v200, v200
    v_mfma_f32_16x16x32_bf16 a[104:107], a[164:167], v[100:103], a[104:107]
    buffer_load_dwordx4 v242, s[16:19], s41 offen sc1 lds
    v_mfma_f32_16x16x32_bf16 a[104:107], a[168:171], v[104:107], a[104:107]
    v_exp_f32 v201, v201
    v_mfma_f32_16x16x32_bf16 a[104:107], a[172:175], v[108:111], a[104:107]
    s_add_u32 m0, s66, 4096
    v_cvt_pk_bf16_f32 v172, v200, v201
    v_mfma_f32_16x16x32_bf16 a[108:111], a[160:163], v[112:115], a[108:111]
    s_mov_b32 s41, 61440
    v_exp_f32 v202, v202
    v_mfma_f32_16x16x32_bf16 a[108:111], a[164:167], v[116:119], a[108:111]
    buffer_load_dwordx4 v243, s[20:23], s41 offen sc1 lds
    v_mfma_f32_16x16x32_bf16 a[108:111], a[168:171], v[120:123], a[108:111]
    v_exp_f32 v203, v203
    v_mfma_f32_16x16x32_bf16 a[108:111], a[172:175], v[124:127], a[108:111]
    s_waitcnt lgkmcnt(0)
    v_cvt_pk_bf16_f32 v173, v202, v203
    v_mfma_f32_16x16x32_bf16 v[192:195], a[144:147], v[0:3], v[208:211]
    v_exp_f32 v204, v204
    v_mfma_f32_16x16x32_bf16 v[192:195], a[148:151], v[4:7], v[192:195]
    ds_read_b64_tr_b16 a[160:161], v235 offset:0
    ds_read_b64_tr_b16 a[162:163], v235 offset:4096
    v_mfma_f32_16x16x32_bf16 v[192:195], a[152:155], v[8:11], v[192:195]
    v_exp_f32 v205, v205
    v_mfma_f32_16x16x32_bf16 v[192:195], a[156:159], v[12:15], v[192:195]
    s_add_u32 m0, s66, 5120
    ds_read_b64_tr_b16 a[164:165], v235 offset:8192
    v_cvt_pk_bf16_f32 v188, v204, v205
    v_mfma_f32_16x16x32_bf16 v[196:199], a[144:147], v[16:19], v[212:215]
    s_mov_b32 s41, 62464
    v_exp_f32 v206, v206
    v_mfma_f32_16x16x32_bf16 v[196:199], a[148:151], v[20:23], v[196:199]
    buffer_load_dwordx4 v243, s[20:23], s41 offen sc1 lds
    v_mfma_f32_16x16x32_bf16 v[196:199], a[152:155], v[24:27], v[196:199]
    v_exp_f32 v207, v207
    v_mfma_f32_16x16x32_bf16 v[196:199], a[156:159], v[28:31], v[196:199]
    ds_read_b64_tr_b16 a[166:167], v235 offset:12288
    v_cvt_pk_bf16_f32 v189, v206, v207
    v_mfma_f32_16x16x32_bf16 v[200:203], a[144:147], v[32:35], v[216:219]
    v_exp_f32 v192, v192
    v_mfma_f32_16x16x32_bf16 v[200:203], a[148:151], v[36:39], v[200:203]
    ds_read_b64_tr_b16 a[168:169], v235 offset:16384
    ds_read_b64_tr_b16 a[170:171], v235 offset:20480
    v_mfma_f32_16x16x32_bf16 v[200:203], a[152:155], v[40:43], v[200:203]
    v_exp_f32 v193, v193
    v_mfma_f32_16x16x32_bf16 v[200:203], a[156:159], v[44:47], v[200:203]
    s_add_u32 m0, s66, 6144
    ds_read_b64_tr_b16 a[172:173], v235 offset:24576
    ds_read_b64_tr_b16 a[174:175], v235 offset:28672
    v_mfma_f32_16x16x32_bf16 v[204:207], a[144:147], v[48:51], v[220:223]
    s_mov_b32 s41, 49152
    v_exp_f32 v194, v194
    v_mfma_f32_16x16x32_bf16 v[204:207], a[148:151], v[52:55], v[204:207]
    buffer_load_dwordx4 v239, s[16:19], s41 offen sc1 lds
    v_mfma_f32_16x16x32_bf16 v[204:207], a[152:155], v[56:59], v[204:207]
    v_exp_f32 v195, v195
    v_mfma_f32_16x16x32_bf16 v[204:207], a[156:159], v[60:63], v[204:207]
    s_waitcnt lgkmcnt(4)
    v_cvt_pk_bf16_f32 v142, v192, v193
    v_cvt_pk_bf16_f32 v143, v194, v195
    v_mfma_f32_16x16x32_bf16 a[112:115], a[160:163], v[64:67], a[112:115]
    v_exp_f32 v196, v196
    v_mfma_f32_16x16x32_bf16 a[112:115], a[164:167], v[68:71], a[112:115]
    s_waitcnt lgkmcnt(2)
    v_mfma_f32_16x16x32_bf16 a[112:115], a[168:171], v[72:75], a[112:115]
    s_waitcnt lgkmcnt(0)
    v_exp_f32 v197, v197
    v_mfma_f32_16x16x32_bf16 a[112:115], a[172:175], v[76:79], a[112:115]
    v_cvt_pk_bf16_f32 v158, v196, v197
    v_mfma_f32_16x16x32_bf16 a[116:119], a[160:163], v[80:83], a[116:119]
    v_exp_f32 v198, v198
    v_mfma_f32_16x16x32_bf16 a[116:119], a[164:167], v[84:87], a[116:119]
    v_mfma_f32_16x16x32_bf16 a[116:119], a[168:171], v[88:91], a[116:119]
    v_exp_f32 v199, v199
    v_mfma_f32_16x16x32_bf16 a[116:119], a[172:175], v[92:95], a[116:119]
    v_cvt_pk_bf16_f32 v159, v198, v199
    v_mfma_f32_16x16x32_bf16 a[120:123], a[160:163], v[96:99], a[120:123]
    v_exp_f32 v200, v200
    v_mfma_f32_16x16x32_bf16 a[120:123], a[164:167], v[100:103], a[120:123]
    s_waitcnt vmcnt(30)
    s_barrier
    v_mfma_f32_16x16x32_bf16 a[120:123], a[168:171], v[104:107], a[120:123]
    v_exp_f32 v201, v201
    v_mfma_f32_16x16x32_bf16 a[120:123], a[172:175], v[108:111], a[120:123]
    s_add_u32 s42, s42, 32768
    ds_read_b64_tr_b16 a[144:145], v228 offset:32768
    v_cvt_pk_bf16_f32 v174, v200, v201
    v_mfma_f32_16x16x32_bf16 a[124:127], a[160:163], v[112:115], a[124:127]
    v_exp_f32 v202, v202
    v_mfma_f32_16x16x32_bf16 a[124:127], a[164:167], v[116:119], a[124:127]
L_padB_8:
    s_cbranch_execz L_padB_9
    ds_read_b64_tr_b16 a[146:147], v228 offset:36864
    ds_read_b64_tr_b16 a[148:149], v228 offset:40960
    v_mfma_f32_16x16x32_bf16 a[124:127], a[168:171], v[120:123], a[124:127]
    v_exp_f32 v203, v203
    v_mfma_f32_16x16x32_bf16 a[124:127], a[172:175], v[124:127], a[124:127]
    ds_read_b64_tr_b16 a[150:151], v228 offset:45056
    v_cvt_pk_bf16_f32 v175, v202, v203
    v_smfmac_f32_16x16x64_bf16 a[128:131], a[176:179], v[64:71], v253
    ds_read_b64_tr_b16 a[152:153], v228 offset:49152
    ds_read_b64_tr_b16 a[154:155], v228 offset:53248
    v_smfmac_f32_16x16x64_bf16 a[128:131], a[176:179], v[72:79], v253
    s_add_u32 m0, s40, 32768
    ds_read_b64_tr_b16 a[156:157], v228 offset:57344
    ds_read_b64_tr_b16 a[158:159], v228 offset:61440
    v_smfmac_f32_16x16x64_bf16 a[132:135], a[176:179], v[80:87], v253
    s_mov_b32 s41, 63488
    v_smfmac_f32_16x16x64_bf16 a[132:135], a[176:179], v[88:95], v253
    buffer_load_dwordx4 v243, s[20:23], s41 offen sc1 lds
    v_smfmac_f32_16x16x64_bf16 a[136:139], a[176:179], v[96:103], v253
    s_add_u32 m0, s40, 36864
    v_smfmac_f32_16x16x64_bf16 a[136:139], a[176:179], v[104:111], v253
    s_mov_b32 s41, 49152
    v_smfmac_f32_16x16x64_bf16 a[140:143], a[176:179], v[112:119], v253
    buffer_load_dwordx4 v240, s[16:19], s41 offen sc1 lds
    v_smfmac_f32_16x16x64_bf16 a[140:143], a[176:179], v[120:127], v253
    s_waitcnt lgkmcnt(0)
    v_mfma_f32_16x16x32_bf16 a[0:3], a[144:147], v[128:131], a[0:3]
    v_exp_f32 v204, v204
    v_mfma_f32_16x16x32_bf16 a[0:3], a[148:151], v[132:135], a[0:3]
    ds_read_b64_tr_b16 a[160:161], v229 offset:32768
    ds_read_b64_tr_b16 a[162:163], v229 offset:36864
    v_mfma_f32_16x16x32_bf16 a[0:3], a[152:155], v[136:139], a[0:3]
    v_exp_f32 v205, v205
    v_mfma_f32_16x16x32_bf16 a[0:3], a[156:159], v[140:143], a[0:3]
    ds_read_b64_tr_b16 a[164:165], v229 offset:40960
    v_cvt_pk_bf16_f32 v190, v204, v205
    v_mfma_f32_16x16x32_bf16 a[4:7], a[144:147], v[144:147], a[4:7]
    v_exp_f32 v206, v206
    v_mfma_f32_16x16x32_bf16 a[4:7], a[148:151], v[148:151], a[4:7]
    ds_read_b64_tr_b16 a[166:167], v229 offset:45056
    ds_read_b64_tr_b16 a[168:169], v229 offset:49152
    v_mfma_f32_16x16x32_bf16 a[4:7], a[152:155], v[152:155], a[4:7]
    s_add_u32 m0, s40, 40960
    v_exp_f32 v207, v207
    v_mfma_f32_16x16x32_bf16 a[4:7], a[156:159], v[156:159], a[4:7]
    s_mov_b32 s41, 64512
    ds_read_b64_tr_b16 a[170:171], v229 offset:53248
    v_cvt_pk_bf16_f32 v191, v206, v207
    v_mfma_f32_16x16x32_bf16 a[8:11], a[144:147], v[160:163], a[8:11]
    buffer_load_dwordx4 v243, s[20:23], s41 offen sc1 lds
    v_mfma_f32_16x16x32_bf16 a[8:11], a[148:151], v[164:167], a[8:11]
    s_add_u32 m0, s40, 45056
    ds_read_b64_tr_b16 a[172:173], v229 offset:57344
    ds_read_b64_tr_b16 a[174:175], v229 offset:61440
    v_mfma_f32_16x16x32_bf16 a[8:11], a[152:155], v[168:171], a[8:11]
    s_mov_b32 s41, 49152
    v_mfma_f32_16x16x32_bf16 a[8:11], a[156:159], v[172:175], a[8:11]
    buffer_load_dwordx4 v241, s[16:19], s41 offen sc1 lds
    v_mfma_f32_16x16x32_bf16 a[12:15], a[144:147], v[176:179], a[12:15]
    s_add_u32 m0, s40, 49152
    v_mfma_f32_16x16x32_bf16 a[12:15], a[148:151], v[180:183], a[12:15]
    s_mov_b32 s41, 65536
    v_mfma_f32_16x16x32_bf16 a[12:15], a[152:155], v[184:187], a[12:15]
    buffer_load_dwordx4 v243, s[20:23], s41 offen sc1 lds
    v_mfma_f32_16x16x32_bf16 a[12:15], a[156:159], v[188:191], a[12:15]
    s_waitcnt lgkmcnt(0)
    v_smfmac_f32_16x16x64_bf16 a[128:131], a[176:179], v[128:135], v253
    s_add_u32 m0, s40, 53248
    s_mov_b32 s41, 49152
    v_smfmac_f32_16x16x64_bf16 a[128:131], a[176:179], v[136:143], v253
    buffer_load_dwordx4 v242, s[16:19], s41 offen sc1 lds
    v_smfmac_f32_16x16x64_bf16 a[132:135], a[176:179], v[144:151], v253
    s_add_u32 m0, s40, 57344
    v_smfmac_f32_16x16x64_bf16 a[132:135], a[176:179], v[152:159], v253
    s_mov_b32 s41, 81920
    v_smfmac_f32_16x16x64_bf16 a[136:139], a[176:179], v[160:167], v253
    buffer_load_dwordx4 v243, s[20:23], s41 offen sc1 lds
    v_smfmac_f32_16x16x64_bf16 a[136:139], a[176:179], v[168:175], v253
    s_add_u32 m0, s40, 61440
    v_smfmac_f32_16x16x64_bf16 a[140:143], a[176:179], v[176:183], v253
    s_mov_b32 s41, 82944
    v_smfmac_f32_16x16x64_bf16 a[140:143], a[176:179], v[184:191], v253
    buffer_load_dwordx4 v243, s[20:23], s41 offen sc1 lds
    v_mfma_f32_16x16x32_bf16 a[16:19], a[160:163], v[128:131], a[16:19]
    v_mfma_f32_16x16x32_bf16 a[16:19], a[164:167], v[132:135], a[16:19]
    ds_read_b64_tr_b16 a[144:145], v230 offset:32768
    ds_read_b64_tr_b16 a[146:147], v230 offset:36864
    v_mfma_f32_16x16x32_bf16 a[16:19], a[168:171], v[136:139], a[16:19]
    s_add_u32 m0, s40, 65536
    v_mfma_f32_16x16x32_bf16 a[16:19], a[172:175], v[140:143], a[16:19]
    s_mov_b32 s41, 65536
    ds_read_b64_tr_b16 a[148:149], v230 offset:40960
    ds_read_b64_tr_b16 a[150:151], v230 offset:45056
    v_mfma_f32_16x16x32_bf16 a[20:23], a[160:163], v[144:147], a[20:23]
    buffer_load_dwordx4 v239, s[16:19], s41 offen sc1 lds
    v_mfma_f32_16x16x32_bf16 a[20:23], a[164:167], v[148:151], a[20:23]
    ds_read_b64_tr_b16 a[152:153], v230 offset:49152
    ds_read_b64_tr_b16 a[154:155], v230 offset:53248
    v_mfma_f32_16x16x32_bf16 a[20:23], a[168:171], v[152:155], a[20:23]
    s_add_u32 m0, s40, 69632
    v_accvgpr_read_b32 v192, a128
    v_accvgpr_read_b32 v196, a129
    v_accvgpr_read_b32 v193, a132
    v_mfma_f32_16x16x32_bf16 a[20:23], a[172:175], v[156:159], a[20:23]
    s_mov_b32 s41, 83968
    ds_read_b64_tr_b16 a[156:157], v230 offset:57344
    ds_read_b64_tr_b16 a[158:159], v230 offset:61440
    v_mfma_f32_16x16x32_bf16 a[24:27], a[160:163], v[160:163], a[24:27]
    buffer_load_dwordx4 v243, s[20:23], s41 offen sc1 lds
    v_accvgpr_read_b32 v197, a133
    v_mfma_f32_16x16x32_bf16 a[24:27], a[164:167], v[164:167], a[24:27]
    s_add_u32 m0, s40, 73728
    v_accvgpr_read_b32 v194, a136
    v_accvgpr_read_b32 v198, a137
    v_accvgpr_read_b32 v195, a140
    v_mfma_f32_16x16x32_bf16 a[24:27], a[168:171], v[168:171], a[24:27]
    s_mov_b32 s41, 65536
    v_accvgpr_read_b32 v199, a141
    v_add_f32 v192, v192, v196
    v_mfma_f32_16x16x32_bf16 a[24:27], a[172:175], v[172:175], a[24:27]
    buffer_load_dwordx4 v240, s[16:19], s41 offen sc1 lds
    v_add_f32 v193, v193, v197
    v_mfma_f32_16x16x32_bf16 a[28:31], a[160:163], v[176:179], a[28:31]
    s_add_u32 m0, s40, 77824
    v_add_f32 v194, v194, v198
    v_add_f32 v195, v195, v199
    v_mfma_f32_16x16x32_bf16 a[28:31], a[164:167], v[180:183], a[28:31]
    s_mov_b32 s41, 84992
    v_rcp_f32 v248, v192
    v_mfma_f32_16x16x32_bf16 a[28:31], a[168:171], v[184:187], a[28:31]
    buffer_load_dwordx4 v243, s[20:23], s41 offen sc1 lds
    v_rcp_f32 v249, v193
    v_mfma_f32_16x16x32_bf16 a[28:31], a[172:175], v[188:191], a[28:31]
    s_waitcnt lgkmcnt(0)
    v_rcp_f32 v250, v194
    v_mfma_f32_16x16x32_bf16 a[32:35], a[144:147], v[128:131], a[32:35]
    v_rcp_f32 v251, v195
    v_add_f32 v197, v192, v193
    v_mfma_f32_16x16x32_bf16 a[32:35], a[148:151], v[132:135], a[32:35]
    ds_read_b64_tr_b16 a[160:161], v231 offset:32768
    ds_read_b64_tr_b16 a[162:163], v231 offset:36864
    v_mfma_f32_16x16x32_bf16 a[32:35], a[152:155], v[136:139], a[32:35]
    s_add_u32 m0, s40, 81920
    v_add_f32 v197, v197, v194
    v_add_f32 v197, v197, v195
    v_cmp_ngt_f32 vcc, 0x5f800000, v197
    v_mfma_f32_16x16x32_bf16 a[32:35], a[156:159], v[140:143], a[32:35]
    s_mov_b32 s41, 65536
    ds_read_b64_tr_b16 a[164:165], v231 offset:40960
    ds_read_b64_tr_b16 a[166:167], v231 offset:45056
    v_mov_b32 v196, 138752
    v_mfma_f32_16x16x32_bf16 a[36:39], a[144:147], v[144:147], a[36:39]
    buffer_load_dwordx4 v241, s[16:19], s41 offen sc1 lds
    v_accvgpr_read_b32 v64, a0
    v_mfma_f32_16x16x32_bf16 a[36:39], a[148:151], v[148:151], a[36:39]
    s_cmp_lg_u64 vcc, 0
    s_cselect_b32 s3, 1, 0
    ds_read_b64_tr_b16 a[168:169], v231 offset:49152
    ds_read_b64_tr_b16 a[170:171], v231 offset:53248
    v_accvgpr_read_b32 v65, a1
    v_mfma_f32_16x16x32_bf16 a[36:39], a[152:155], v[152:155], a[36:39]
    s_add_u32 m0, s40, 86016
    s_lshl_b32 s7, s4, 2
    v_accvgpr_read_b32 v66, a2
    v_accvgpr_read_b32 v67, a3
    v_accvgpr_read_b32 v68, a16
    v_mfma_f32_16x16x32_bf16 a[36:39], a[156:159], v[156:159], a[36:39]
    s_mov_b32 s41, 86016
    ds_read_b64_tr_b16 a[172:173], v231 offset:57344
    ds_read_b64_tr_b16 a[174:175], v231 offset:61440
    v_accvgpr_read_b32 v69, a17
    v_accvgpr_read_b32 v70, a18
    v_mfma_f32_16x16x32_bf16 a[40:43], a[144:147], v[160:163], a[40:43]
    buffer_load_dwordx4 v243, s[20:23], s41 offen sc1 lds
    v_accvgpr_read_b32 v71, a19
    v_mul_f32 v64, v64, v248
    v_mfma_f32_16x16x32_bf16 a[40:43], a[148:151], v[164:167], a[40:43]
    v_mov_b32 v198, s3
    v_add_u32 v199, s7, v196
    v_mul_f32 v65, v65, v248
    v_mul_f32 v66, v66, v248
    v_mfma_f32_16x16x32_bf16 a[40:43], a[152:155], v[168:171], a[40:43]
    s_add_u32 m0, s40, 90112
    ds_write_b32 v199, v198
    v_mul_f32 v67, v67, v248
    v_mul_f32 v68, v68, v248
    v_mul_f32 v69, v69, v248
    v_mfma_f32_16x16x32_bf16 a[40:43], a[156:159], v[172:175], a[40:43]
    s_mov_b32 s41, 65536
    v_mul_f32 v70, v70, v248
    v_mul_f32 v71, v71, v248
    v_cvt_pk_bf16_f32 v72, v64, v65
    v_mfma_f32_16x16x32_bf16 a[44:47], a[144:147], v[176:179], a[44:47]
    buffer_load_dwordx4 v242, s[16:19], s41 offen sc1 lds
    v_cvt_pk_bf16_f32 v73, v66, v67
    v_cvt_pk_bf16_f32 v74, v68, v69
    v_mfma_f32_16x16x32_bf16 a[44:47], a[148:151], v[180:183], a[44:47]
    v_cvt_pk_bf16_f32 v75, v70, v71
    buffer_store_dwordx4 v[72:75], v246, s[36:39], 0 offen offset:0 sc1
    v_accvgpr_read_b32 v76, a4
    v_accvgpr_read_b32 v77, a5
    v_mfma_f32_16x16x32_bf16 a[44:47], a[152:155], v[184:187], a[44:47]
    v_accvgpr_read_b32 v78, a6
    v_accvgpr_read_b32 v79, a7
    v_accvgpr_read_b32 v80, a20
    v_accvgpr_read_b32 v81, a21
    v_mfma_f32_16x16x32_bf16 a[44:47], a[156:159], v[188:191], a[44:47]
    s_waitcnt lgkmcnt(0)
    v_accvgpr_read_b32 v82, a22
    v_accvgpr_read_b32 v83, a23
    v_mul_f32 v76, v76, v249
    v_mul_f32 v77, v77, v249
    v_mfma_f32_16x16x32_bf16 a[48:51], a[160:163], v[128:131], a[48:51]
    s_barrier
    v_mul_f32 v78, v78, v249
    v_mul_f32 v79, v79, v249
    v_mul_f32 v80, v80, v249
    v_mul_f32 v81, v81, v249
    v_mfma_f32_16x16x32_bf16 a[48:51], a[164:167], v[132:135], a[48:51]
    ds_read_b64_tr_b16 a[144:145], v232 offset:32768
    ds_read_b64_tr_b16 a[146:147], v232 offset:36864
    v_mul_f32 v82, v82, v249
    v_mul_f32 v83, v83, v249
    v_mfma_f32_16x16x32_bf16 a[48:51], a[168:171], v[136:139], a[48:51]
    v_cvt_pk_bf16_f32 v84, v76, v77
    v_cvt_pk_bf16_f32 v85, v78, v79
    v_cvt_pk_bf16_f32 v86, v80, v81
    v_mfma_f32_16x16x32_bf16 a[48:51], a[172:175], v[140:143], a[48:51]
    ds_read_b64_tr_b16 a[148:149], v232 offset:40960
    ds_read_b64_tr_b16 a[150:151], v232 offset:45056
    v_cvt_pk_bf16_f32 v87, v82, v83
    buffer_store_dwordx4 v[84:87], v246, s[36:39], 0 offen offset:1024 sc1
    v_mfma_f32_16x16x32_bf16 a[52:55], a[160:163], v[144:147], a[52:55]
    v_accvgpr_read_b32 v88, a8
    v_accvgpr_read_b32 v89, a9
    v_accvgpr_read_b32 v90, a10
    v_accvgpr_read_b32 v91, a11
    v_mfma_f32_16x16x32_bf16 a[52:55], a[164:167], v[148:151], a[52:55]
    ds_read_b64_tr_b16 a[152:153], v232 offset:49152
    ds_read_b64_tr_b16 a[154:155], v232 offset:53248
    v_accvgpr_read_b32 v92, a24
    v_accvgpr_read_b32 v93, a25
    v_mfma_f32_16x16x32_bf16 a[52:55], a[168:171], v[152:155], a[52:55]
    v_accvgpr_read_b32 v94, a26
    v_accvgpr_read_b32 v95, a27
    v_mul_f32 v88, v88, v250
    v_mul_f32 v89, v89, v250
    v_mfma_f32_16x16x32_bf16 a[52:55], a[172:175], v[156:159], a[52:55]
    ds_read_b64_tr_b16 a[156:157], v232 offset:57344
    ds_read_b64_tr_b16 a[158:159], v232 offset:61440
    v_mul_f32 v90, v90, v250
    v_mul_f32 v91, v91, v250
    v_mfma_f32_16x16x32_bf16 a[56:59], a[160:163], v[160:163], a[56:59]
    v_mul_f32 v92, v92, v250
    v_mul_f32 v93, v93, v250
    v_mul_f32 v94, v94, v250
    v_mul_f32 v95, v95, v250
    v_mfma_f32_16x16x32_bf16 a[56:59], a[164:167], v[164:167], a[56:59]
    ds_read_b128 v[200:203], v196
    v_cvt_pk_bf16_f32 v96, v88, v89
    v_cvt_pk_bf16_f32 v97, v90, v91
    v_mfma_f32_16x16x32_bf16 a[56:59], a[168:171], v[168:171], a[56:59]
    s_waitcnt vmcnt(20)
    v_cvt_pk_bf16_f32 v98, v92, v93
    v_cvt_pk_bf16_f32 v99, v94, v95
    buffer_store_dwordx4 v[96:99], v246, s[36:39], 0 offen offset:2048 sc1
    v_accvgpr_read_b32 v100, a12
    v_mfma_f32_16x16x32_bf16 a[56:59], a[172:175], v[172:175], a[56:59]
    v_accvgpr_read_b32 v101, a13
    v_accvgpr_read_b32 v102, a14
    v_accvgpr_read_b32 v103, a15
    v_accvgpr_read_b32 v104, a28
    v_mfma_f32_16x16x32_bf16 a[60:63], a[160:163], v[176:179], a[60:63]
    v_accvgpr_read_b32 v105, a29
    v_accvgpr_read_b32 v106, a30
    v_accvgpr_read_b32 v107, a31
    v_mul_f32 v100, v100, v251
    v_mfma_f32_16x16x32_bf16 a[60:63], a[164:167], v[180:183], a[60:63]
    v_mul_f32 v101, v101, v251
    v_mul_f32 v102, v102, v251
    v_mul_f32 v103, v103, v251
    v_mul_f32 v104, v104, v251
    v_mfma_f32_16x16x32_bf16 a[60:63], a[168:171], v[184:187], a[60:63]
    v_mul_f32 v105, v105, v251
    v_mul_f32 v106, v106, v251
    v_mul_f32 v107, v107, v251
    v_cvt_pk_bf16_f32 v108, v100, v101
    v_mfma_f32_16x16x32_bf16 a[60:63], a[172:175], v[188:191], a[60:63]
    s_waitcnt lgkmcnt(0)
    v_cvt_pk_bf16_f32 v109, v102, v103
    v_cvt_pk_bf16_f32 v110, v104, v105
    v_cvt_pk_bf16_f32 v111, v106, v107
    buffer_store_dwordx4 v[108:111], v246, s[36:39], 0 offen offset:3072 sc1
    v_mfma_f32_16x16x32_bf16 a[64:67], a[144:147], v[128:131], a[64:67]
    v_or3_b32 v200, v200, v201, v202
    v_or_b32 v200, v200, v203
    v_mfma_f32_16x16x32_bf16 a[64:67], a[148:151], v[132:135], a[64:67]
    ds_read_b64_tr_b16 a[160:161], v233 offset:32768
    ds_read_b64_tr_b16 a[162:163], v233 offset:36864
    v_readfirstlane_b32 s3, v200
    v_mfma_f32_16x16x32_bf16 a[64:67], a[152:155], v[136:139], a[64:67]
    v_mfma_f32_16x16x32_bf16 a[64:67], a[156:159], v[140:143], a[64:67]
    s_andn2_b32 s3, s3, s48
    s_cbranch_scc1 L_a_truemax
    ds_read_b64_tr_b16 a[164:165], v233 offset:40960
    ds_read_b64_tr_b16 a[166:167], v233 offset:45056
    v_mfma_f32_16x16x32_bf16 a[68:71], a[144:147], v[144:147], a[68:71]
    v_accvgpr_read_b32 v64, a32
    v_accvgpr_read_b32 v65, a33
    v_accvgpr_read_b32 v66, a34
    v_mfma_f32_16x16x32_bf16 a[68:71], a[148:151], v[148:151], a[68:71]
    ds_read_b64_tr_b16 a[168:169], v233 offset:49152
    ds_read_b64_tr_b16 a[170:171], v233 offset:53248
    v_accvgpr_read_b32 v67, a35
    v_mfma_f32_16x16x32_bf16 a[68:71], a[152:155], v[152:155], a[68:71]
    v_accvgpr_read_b32 v68, a48
    v_accvgpr_read_b32 v69, a49
    v_accvgpr_read_b32 v70, a50
    v_accvgpr_read_b32 v71, a51
    v_mfma_f32_16x16x32_bf16 a[68:71], a[156:159], v[156:159], a[68:71]
    ds_read_b64_tr_b16 a[172:173], v233 offset:57344
    ds_read_b64_tr_b16 a[174:175], v233 offset:61440
    v_mul_f32 v64, v64, v248
    v_mfma_f32_16x16x32_bf16 a[72:75], a[144:147], v[160:163], a[72:75]
    v_mul_f32 v65, v65, v248
    v_mul_f32 v66, v66, v248
    v_mul_f32 v67, v67, v248
    v_mul_f32 v68, v68, v248
    v_mfma_f32_16x16x32_bf16 a[72:75], a[148:151], v[164:167], a[72:75]
    v_mul_f32 v69, v69, v248
    v_mul_f32 v70, v70, v248
    v_mul_f32 v71, v71, v248
    v_mfma_f32_16x16x32_bf16 a[72:75], a[152:155], v[168:171], a[72:75]
    v_cvt_pk_bf16_f32 v72, v64, v65
    v_cvt_pk_bf16_f32 v73, v66, v67
    v_cvt_pk_bf16_f32 v74, v68, v69
    v_cvt_pk_bf16_f32 v75, v70, v71
    v_mfma_f32_16x16x32_bf16 a[72:75], a[156:159], v[172:175], a[72:75]
    buffer_store_dwordx4 v[72:75], v246, s[36:39], s45 offen offset:0 sc1
    v_accvgpr_read_b32 v76, a36
    v_accvgpr_read_b32 v77, a37
    v_mfma_f32_16x16x32_bf16 a[76:79], a[144:147], v[176:179], a[76:79]
    v_accvgpr_read_b32 v78, a38
    v_accvgpr_read_b32 v79, a39
    v_accvgpr_read_b32 v80, a52
    v_mfma_f32_16x16x32_bf16 a[76:79], a[148:151], v[180:183], a[76:79]
    v_accvgpr_read_b32 v81, a53
    v_accvgpr_read_b32 v82, a54
    v_accvgpr_read_b32 v83, a55
    v_mul_f32 v76, v76, v249
    v_mfma_f32_16x16x32_bf16 a[76:79], a[152:155], v[184:187], a[76:79]
    v_mul_f32 v77, v77, v249
    v_mul_f32 v78, v78, v249
    v_mul_f32 v79, v79, v249
    v_mfma_f32_16x16x32_bf16 a[76:79], a[156:159], v[188:191], a[76:79]
    s_waitcnt lgkmcnt(0)
    v_mul_f32 v80, v80, v249
    v_mul_f32 v81, v81, v249
    v_mul_f32 v82, v82, v249
    v_mul_f32 v83, v83, v249
    v_mfma_f32_16x16x32_bf16 a[80:83], a[160:163], v[128:131], a[80:83]
    v_cvt_pk_bf16_f32 v84, v76, v77
    v_cvt_pk_bf16_f32 v85, v78, v79
    v_cvt_pk_bf16_f32 v86, v80, v81
    v_mfma_f32_16x16x32_bf16 a[80:83], a[164:167], v[132:135], a[80:83]
    ds_read_b64_tr_b16 a[144:145], v234 offset:32768
    ds_read_b64_tr_b16 a[146:147], v234 offset:36864
    v_cvt_pk_bf16_f32 v87, v82, v83
    buffer_store_dwordx4 v[84:87], v246, s[36:39], s45 offen offset:1024 sc1
    v_mfma_f32_16x16x32_bf16 a[80:83], a[168:171], v[136:139], a[80:83]
    v_accvgpr_read_b32 v88, a40
    v_accvgpr_read_b32 v89, a41
    v_accvgpr_read_b32 v90, a42
    v_mfma_f32_16x16x32_bf16 a[80:83], a[172:175], v[140:143], a[80:83]
    ds_read_b64_tr_b16 a[148:149], v234 offset:40960
    ds_read_b64_tr_b16 a[150:151], v234 offset:45056
    v_accvgpr_read_b32 v91, a43
    v_mfma_f32_16x16x32_bf16 a[84:87], a[160:163], v[144:147], a[84:87]
    v_accvgpr_read_b32 v92, a56
    v_accvgpr_read_b32 v93, a57
    v_accvgpr_read_b32 v94, a58
    v_accvgpr_read_b32 v95, a59
    v_mfma_f32_16x16x32_bf16 a[84:87], a[164:167], v[148:151], a[84:87]
    ds_read_b64_tr_b16 a[152:153], v234 offset:49152
    ds_read_b64_tr_b16 a[154:155], v234 offset:53248
    v_mul_f32 v88, v88, v250
    v_mfma_f32_16x16x32_bf16 a[84:87], a[168:171], v[152:155], a[84:87]
    v_mul_f32 v89, v89, v250
    v_mul_f32 v90, v90, v250
    v_mul_f32 v91, v91, v250
    v_mul_f32 v92, v92, v250
    v_mfma_f32_16x16x32_bf16 a[84:87], a[172:175], v[156:159], a[84:87]
    ds_read_b64_tr_b16 a[156:157], v234 offset:57344
    ds_read_b64_tr_b16 a[158:159], v234 offset:61440
    v_mul_f32 v93, v93, v250
    v_mfma_f32_16x16x32_bf16 a[88:91], a[160:163], v[160:163], a[88:91]
    v_mul_f32 v94, v94, v250
    v_mul_f32 v95, v95, v250
    v_cvt_pk_bf16_f32 v96, v88, v89
    v_cvt_pk_bf16_f32 v97, v90, v91
    v_mfma_f32_16x16x32_bf16 a[88:91], a[164:167], v[164:167], a[88:91]
    v_cvt_pk_bf16_f32 v98, v92, v93
    v_cvt_pk_bf16_f32 v99, v94, v95
    buffer_store_dwordx4 v[96:99], v246, s[36:39], s45 offen offset:2048 sc1
    v_mfma_f32_16x16x32_bf16 a[88:91], a[168:171], v[168:171], a[88:91]
    v_accvgpr_read_b32 v100, a44
    v_accvgpr_read_b32 v101, a45
    v_accvgpr_read_b32 v102, a46
    v_mfma_f32_16x16x32_bf16 a[88:91], a[172:175], v[172:175], a[88:91]
    v_accvgpr_read_b32 v103, a47
    v_accvgpr_read_b32 v104, a60
    v_accvgpr_read_b32 v105, a61
    v_accvgpr_read_b32 v106, a62
    v_mfma_f32_16x16x32_bf16 a[92:95], a[160:163], v[176:179], a[92:95]
    v_accvgpr_read_b32 v107, a63
    v_mul_f32 v100, v100, v251
    v_mul_f32 v101, v101, v251
    v_mfma_f32_16x16x32_bf16 a[92:95], a[164:167], v[180:183], a[92:95]
    v_mul_f32 v102, v102, v251
    v_mul_f32 v103, v103, v251
    v_mul_f32 v104, v104, v251
    v_mul_f32 v105, v105, v251
    v_mfma_f32_16x16x32_bf16 a[92:95], a[168:171], v[184:187], a[92:95]
    v_mul_f32 v106, v106, v251
    v_mul_f32 v107, v107, v251
    v_cvt_pk_bf16_f32 v108, v100, v101
    v_mfma_f32_16x16x32_bf16 a[92:95], a[172:175], v[188:191], a[92:95]
    s_waitcnt lgkmcnt(0)
    v_cvt_pk_bf16_f32 v109, v102, v103
    v_cvt_pk_bf16_f32 v110, v104, v105
    v_cvt_pk_bf16_f32 v111, v106, v107
    buffer_store_dwordx4 v[108:111], v246, s[36:39], s45 offen offset:3072 sc1
    v_mfma_f32_16x16x32_bf16 a[96:99], a[144:147], v[128:131], a[96:99]
    v_mfma_f32_16x16x32_bf16 a[96:99], a[148:151], v[132:135], a[96:99]
    ds_read_b64_tr_b16 a[160:161], v235 offset:32768
    ds_read_b64_tr_b16 a[162:163], v235 offset:36864
    v_mfma_f32_16x16x32_bf16 a[96:99], a[152:155], v[136:139], a[96:99]
    v_mfma_f32_16x16x32_bf16 a[96:99], a[156:159], v[140:143], a[96:99]
    ds_read_b64_tr_b16 a[164:165], v235 offset:40960
    ds_read_b64_tr_b16 a[166:167], v235 offset:45056
    v_mfma_f32_16x16x32_bf16 a[100:103], a[144:147], v[144:147], a[100:103]
    v_accvgpr_read_b32 v64, a64
    v_accvgpr_read_b32 v65, a65
    v_accvgpr_read_b32 v66, a66
    v_mfma_f32_16x16x32_bf16 a[100:103], a[148:151], v[148:151], a[100:103]
    ds_read_b64_tr_b16 a[168:169], v235 offset:49152
    ds_read_b64_tr_b16 a[170:171], v235 offset:53248
    v_accvgpr_read_b32 v67, a67
    v_mfma_f32_16x16x32_bf16 a[100:103], a[152:155], v[152:155], a[100:103]
    v_accvgpr_read_b32 v68, a80
    v_accvgpr_read_b32 v69, a81
    v_accvgpr_read_b32 v70, a82
    v_mfma_f32_16x16x32_bf16 a[100:103], a[156:159], v[156:159], a[100:103]
    ds_read_b64_tr_b16 a[172:173], v235 offset:57344
    ds_read_b64_tr_b16 a[174:175], v235 offset:61440
    v_accvgpr_read_b32 v71, a83
    v_mfma_f32_16x16x32_bf16 a[104:107], a[144:147], v[160:163], a[104:107]
    v_mul_f32 v64, v64, v248
    v_mul_f32 v65, v65, v248
    v_mul_f32 v66, v66, v248
    v_mfma_f32_16x16x32_bf16 a[104:107], a[148:151], v[164:167], a[104:107]
    v_mul_f32 v67, v67, v248
    v_mul_f32 v68, v68, v248
    v_mul_f32 v69, v69, v248
    v_mfma_f32_16x16x32_bf16 a[104:107], a[152:155], v[168:171], a[104:107]
    v_mul_f32 v70, v70, v248
    v_mul_f32 v71, v71, v248
    v_cvt_pk_bf16_f32 v72, v64, v65
    v_cvt_pk_bf16_f32 v73, v66, v67
    v_mfma_f32_16x16x32_bf16 a[104:107], a[156:159], v[172:175], a[104:107]
    v_cvt_pk_bf16_f32 v74, v68, v69
    v_cvt_pk_bf16_f32 v75, v70, v71
    buffer_store_dwordx4 v[72:75], v246, s[36:39], s46 offen offset:0 sc1
    v_mfma_f32_16x16x32_bf16 a[108:111], a[144:147], v[176:179], a[108:111]
    v_accvgpr_read_b32 v76, a68
    v_accvgpr_read_b32 v77, a69
    v_accvgpr_read_b32 v78, a70
    v_mfma_f32_16x16x32_bf16 a[108:111], a[148:151], v[180:183], a[108:111]
    v_accvgpr_read_b32 v79, a71
    v_accvgpr_read_b32 v80, a84
    v_accvgpr_read_b32 v81, a85
    v_mfma_f32_16x16x32_bf16 a[108:111], a[152:155], v[184:187], a[108:111]
    v_accvgpr_read_b32 v82, a86
    v_accvgpr_read_b32 v83, a87
    v_mul_f32 v76, v76, v249
    v_mfma_f32_16x16x32_bf16 a[108:111], a[156:159], v[188:191], a[108:111]
    s_waitcnt lgkmcnt(0)
    v_mul_f32 v77, v77, v249
    v_mul_f32 v78, v78, v249
    v_mul_f32 v79, v79, v249
    v_mfma_f32_16x16x32_bf16 a[112:115], a[160:163], v[128:131], a[112:115]
    v_mul_f32 v80, v80, v249
    v_mul_f32 v81, v81, v249
    v_mul_f32 v82, v82, v249
    v_mfma_f32_16x16x32_bf16 a[112:115], a[164:167], v[132:135], a[112:115]
    v_mul_f32 v83, v83, v249
    v_cvt_pk_bf16_f32 v84, v76, v77
    v_cvt_pk_bf16_f32 v85, v78, v79
    v_cvt_pk_bf16_f32 v86, v80, v81
    v_mfma_f32_16x16x32_bf16 a[112:115], a[168:171], v[136:139], a[112:115]
    v_cvt_pk_bf16_f32 v87, v82, v83
    buffer_store_dwordx4 v[84:87], v246, s[36:39], s46 offen offset:1024 sc1
    v_accvgpr_read_b32 v88, a72
    v_mfma_f32_16x16x32_bf16 a[112:115], a[172:175], v[140:143], a[112:115]
    v_accvgpr_read_b32 v89, a73
    v_accvgpr_read_b32 v90, a74
    v_accvgpr_read_b32 v91, a75
    v_mfma_f32_16x16x32_bf16 a[116:119], a[160:163], v[144:147], a[116:119]
    v_accvgpr_read_b32 v92, a88
    v_accvgpr_read_b32 v93, a89
    v_accvgpr_read_b32 v94, a90
    v_mfma_f32_16x16x32_bf16 a[116:119], a[164:167], v[148:151], a[116:119]
    v_accvgpr_read_b32 v95, a91
    v_mul_f32 v88, v88, v250
    v_mul_f32 v89, v89, v250
    v_mfma_f32_16x16x32_bf16 a[116:119], a[168:171], v[152:155], a[116:119]
    v_mul_f32 v90, v90, v250
    v_mul_f32 v91, v91, v250
    v_mul_f32 v92, v92, v250
    v_mfma_f32_16x16x32_bf16 a[116:119], a[172:175], v[156:159], a[116:119]
    v_mul_f32 v93, v93, v250
    v_mul_f32 v94, v94, v250
    v_mul_f32 v95, v95, v250
    v_mfma_f32_16x16x32_bf16 a[120:123], a[160:163], v[160:163], a[120:123]
    v_cvt_pk_bf16_f32 v96, v88, v89
    v_cvt_pk_bf16_f32 v97, v90, v91
    v_cvt_pk_bf16_f32 v98, v92, v93
    v_cvt_pk_bf16_f32 v99, v94, v95
    v_mfma_f32_16x16x32_bf16 a[120:123], a[164:167], v[164:167], a[120:123]
    buffer_store_dwordx4 v[96:99], v246, s[36:39], s46 offen offset:2048 sc1
    v_accvgpr_read_b32 v100, a76
    v_accvgpr_read_b32 v101, a77
    v_mfma_f32_16x16x32_bf16 a[120:123], a[168:171], v[168:171], a[120:123]
    v_accvgpr_read_b32 v102, a78
    v_accvgpr_read_b32 v103, a79
    v_accvgpr_read_b32 v104, a92
    v_mfma_f32_16x16x32_bf16 a[120:123], a[172:175], v[172:175], a[120:123]
    v_accvgpr_read_b32 v105, a93
    v_accvgpr_read_b32 v106, a94
    v_accvgpr_read_b32 v107, a95
    v_mfma_f32_16x16x32_bf16 a[124:127], a[160:163], v[176:179], a[124:127]
    v_mul_f32 v100, v100, v251
    v_mul_f32 v101, v101, v251
    v_mul_f32 v102, v102, v251
    v_mfma_f32_16x16x32_bf16 a[124:127], a[164:167], v[180:183], a[124:127]
    v_mul_f32 v103, v103, v251
    v_mul_f32 v104, v104, v251
    v_mul_f32 v105, v105, v251
    v_mfma_f32_16x16x32_bf16 a[124:127], a[168:171], v[184:187], a[124:127]
    v_mul_f32 v106, v106, v251
    v_mul_f32 v107, v107, v251
    v_cvt_pk_bf16_f32 v108, v100, v101
    v_mfma_f32_16x16x32_bf16 a[124:127], a[172:175], v[188:191], a[124:127]
    v_cvt_pk_bf16_f32 v109, v102, v103
    v_cvt_pk_bf16_f32 v110, v104, v105
    v_cvt_pk_bf16_f32 v111, v106, v107
    buffer_store_dwordx4 v[108:111], v246, s[36:39], s46 offen offset:3072 sc1
    v_accvgpr_read_b32 v64, a96
    v_accvgpr_read_b32 v65, a97
    v_accvgpr_read_b32 v66, a98
    v_accvgpr_read_b32 v67, a99
    v_accvgpr_read_b32 v68, a112
    v_accvgpr_read_b32 v69, a113
    v_accvgpr_read_b32 v70, a114
    v_accvgpr_read_b32 v71, a115
    v_mul_f32 v64, v64, v248
    v_mul_f32 v65, v65, v248
    v_mul_f32 v66, v66, v248
    v_mul_f32 v67, v67, v248
    v_mul_f32 v68, v68, v248
    v_mul_f32 v69, v69, v248
    v_mul_f32 v70, v70, v248
    v_mul_f32 v71, v71, v248
    v_cvt_pk_bf16_f32 v72, v64, v65
    v_cvt_pk_bf16_f32 v73, v66, v67
    v_cvt_pk_bf16_f32 v74, v68, v69
    v_cvt_pk_bf16_f32 v75, v70, v71
    buffer_store_dwordx4 v[72:75], v246, s[36:39], s47 offen offset:0 sc1
    v_accvgpr_read_b32 v76, a100
    v_accvgpr_read_b32 v77, a101
    v_accvgpr_read_b32 v78, a102
    v_accvgpr_read_b32 v79, a103
    v_accvgpr_read_b32 v80, a116
    v_accvgpr_read_b32 v81, a117
    v_accvgpr_read_b32 v82, a118
    v_accvgpr_read_b32 v83, a119
    v_mul_f32 v76, v76, v249
    v_mul_f32 v77, v77, v249
L_padB_9:
    s_cbranch_execz L_vis_ret
    v_mul_f32 v78, v78, v249
    v_mul_f32 v79, v79, v249
    v_mul_f32 v80, v80, v249
    v_mul_f32 v81, v81, v249
    v_mul_f32 v82, v82, v249
    v_mul_f32 v83, v83, v249
    v_cvt_pk_bf16_f32 v84, v76, v77
    v_cvt_pk_bf16_f32 v85, v78, v79
    v_cvt_pk_bf16_f32 v86, v80, v81
    v_cvt_pk_bf16_f32 v87, v82, v83
    buffer_store_dwordx4 v[84:87], v246, s[36:39], s47 offen offset:1024 sc1
    v_accvgpr_read_b32 v88, a104
    v_accvgpr_read_b32 v89, a105
    v_accvgpr_read_b32 v90, a106
    v_accvgpr_read_b32 v91, a107
    v_accvgpr_read_b32 v92, a120
    v_accvgpr_read_b32 v93, a121
    v_accvgpr_read_b32 v94, a122
    v_accvgpr_read_b32 v95, a123
    v_mul_f32 v88, v88, v250
    v_mul_f32 v89, v89, v250
    v_mul_f32 v90, v90, v250
    v_mul_f32 v91, v91, v250
    v_mul_f32 v92, v92, v250
    v_mul_f32 v93, v93, v250
    v_mul_f32 v94, v94, v250
    v_mul_f32 v95, v95, v250
    v_cvt_pk_bf16_f32 v96, v88, v89
    v_cvt_pk_bf16_f32 v97, v90, v91
    v_cvt_pk_bf16_f32 v98, v92, v93
    v_cvt_pk_bf16_f32 v99, v94, v95
    buffer_store_dwordx4 v[96:99], v246, s[36:39], s47 offen offset:2048 sc1
    v_accvgpr_read_b32 v100, a108
    v_accvgpr_read_b32 v101, a109
    v_accvgpr_read_b32 v102, a110
    v_accvgpr_read_b32 v103, a111
    v_accvgpr_read_b32 v104, a124
    v_accvgpr_read_b32 v105, a125
    v_accvgpr_read_b32 v106, a126
    v_accvgpr_read_b32 v107, a127
    v_mul_f32 v100, v100, v251
    v_mul_f32 v101, v101, v251
    v_mul_f32 v102, v102, v251
    v_mul_f32 v103, v103, v251
    v_mul_f32 v104, v104, v251
    v_mul_f32 v105, v105, v251
    v_mul_f32 v106, v106, v251
    v_mul_f32 v107, v107, v251
    v_cvt_pk_bf16_f32 v108, v100, v101
    v_cvt_pk_bf16_f32 v109, v102, v103
    v_cvt_pk_bf16_f32 v110, v104, v105
    v_cvt_pk_bf16_f32 v111, v106, v107
    buffer_store_dwordx4 v[108:111], v246, s[36:39], s47 offen offset:3072 sc1
    s_waitcnt vmcnt(52)
    v_mfma_f32_16x16x32_bf16 a[0:3], a[180:183], a[200:203], 0
    v_add_u32 v232, s40, v238
    v_add_u32 v235, s66, v238
    v_mfma_f32_16x16x32_bf16 a[4:7], a[184:187], a[200:203], 0
    v_mfma_f32_16x16x32_bf16 a[8:11], a[188:191], a[200:203], 0
    s_and_b32 s3, s53, 1
    v_add_u32 v233, 0x10000, v232
    v_accvgpr_write_b32 a252, s92
    v_mfma_f32_16x16x32_bf16 a[12:15], a[192:195], a[200:203], 0
    s_lshl_b32 s3, s3, 18
    v_accvgpr_write_b32 a253, s93
    v_accvgpr_write_b32 a254, s92
    v_mfma_f32_16x16x32_bf16 a[16:19], a[196:199], a[200:203], 0
    s_lshl_b32 s7, s53, 19
    v_accvgpr_write_b32 a255, s93
    v_and_b32 v234, 0x380, v238
    v_mfma_f32_16x16x32_bf16 a[20:23], a[180:183], a[204:207], 0
    s_add_u32 s7, s7, s3
    v_lshl_add_u32 v234, v234, 17, v238
    v_and_b32 v229, 0xf0, v238
    v_mfma_f32_16x16x32_bf16 a[24:27], a[184:187], a[204:207], 0
    s_add_u32 s28, s82, 0xa00000
    s_addc_u32 s29, s83, 0
    v_lshlrev_b32 v229, 3, v229
    v_and_b32 v192, 0x100, v238
    v_mfma_f32_16x16x32_bf16 a[28:31], a[188:191], a[204:207], 0
    s_add_u32 s28, s28, s7
    s_addc_u32 s29, s29, 0
    v_lshl_add_u32 v229, v192, 4, v229
    v_mfma_f32_16x16x32_bf16 a[32:35], a[192:195], a[204:207], 0
    s_mov_b32 s30, 0x40000
    v_mfma_f32_16x16x32_bf16 a[36:39], a[196:199], a[204:207], 0
    s_mov_b32 s31, 0x20000
    v_mfma_f32_16x16x32_bf16 a[40:43], a[180:183], a[208:211], 0
    s_xor_b32 s7, s7, 524288
    v_mfma_f32_16x16x32_bf16 a[44:47], a[184:187], a[208:211], 0
    s_add_u32 s8, s82, 0xa00000
    s_addc_u32 s9, s83, 0
    v_mfma_f32_16x16x32_bf16 a[48:51], a[188:191], a[208:211], 0
    s_add_u32 s8, s8, s7
    s_addc_u32 s9, s9, 0
    v_mfma_f32_16x16x32_bf16 a[52:55], a[192:195], a[208:211], 0
    s_mov_b32 s10, 0x40000
    v_mfma_f32_16x16x32_bf16 a[56:59], a[196:199], a[208:211], 0
    s_mov_b32 s11, 0x20000
    v_mfma_f32_16x16x32_bf16 a[60:63], a[180:183], a[212:215], 0
    s_lshr_b32 s3, s3, 7
    v_mfma_f32_16x16x32_bf16 a[64:67], a[184:187], a[212:215], 0
    s_lshr_b32 s41, s53, 1
    v_mfma_f32_16x16x32_bf16 a[68:71], a[188:191], a[212:215], 0
    s_lshl_b32 s41, s41, 13
    v_mfma_f32_16x16x32_bf16 a[72:75], a[192:195], a[212:215], 0
    s_add_u32 s41, s41, s3
    v_mfma_f32_16x16x32_bf16 a[76:79], a[196:199], a[212:215], 0
    s_waitcnt vmcnt(43)
    v_mfma_f32_16x16x32_bf16 a[0:3], a[216:219], a[236:239], a[0:3]
    s_waitcnt vmcnt(34)
    ds_read_b128 a[180:183], v232 offset:0
    v_mfma_f32_16x16x32_bf16 a[4:7], a[220:223], a[236:239], a[4:7]
    s_add_u32 s41, s41, 131072
    ds_read_b128 a[184:187], v232 offset:4096
    v_mfma_f32_16x16x32_bf16 a[8:11], a[224:227], a[236:239], a[8:11]
    ds_read_b128 a[200:203], v232 offset:8192
    v_mfma_f32_16x16x32_bf16 a[12:15], a[228:231], a[236:239], a[12:15]
    ds_read_b128 a[188:191], v232 offset:12288
    v_mfma_f32_16x16x32_bf16 a[16:19], a[232:235], a[236:239], a[16:19]
    ds_read_b128 a[204:207], v232 offset:16384
    v_mfma_f32_16x16x32_bf16 a[20:23], a[216:219], a[240:243], a[20:23]
    ds_read_b128 a[192:195], v232 offset:20480
    v_mfma_f32_16x16x32_bf16 a[24:27], a[220:223], a[240:243], a[24:27]
    ds_read_b128 a[208:211], v232 offset:24576
    v_mfma_f32_16x16x32_bf16 a[28:31], a[224:227], a[240:243], a[28:31]
    ds_read_b128 a[196:199], v232 offset:28672
    v_mfma_f32_16x16x32_bf16 a[32:35], a[228:231], a[240:243], a[32:35]
    ds_read_b128 a[212:215], v235 offset:3072
    v_mfma_f32_16x16x32_bf16 a[36:39], a[232:235], a[240:243], a[36:39]
    v_mfma_f32_16x16x32_bf16 a[40:43], a[216:219], a[244:247], a[40:43]
    s_waitcnt vmcnt(0)
    buffer_store_dwordx4 a[252:255], v234, s[84:87], s51 offen sc1
    v_mfma_f32_16x16x32_bf16 a[44:47], a[220:223], a[244:247], a[44:47]
    s_mov_b32 s49, 5
    s_mul_i32 s56, s49, 20480
    s_lshl_b32 s57, s49, 14
    v_mfma_f32_16x16x32_bf16 a[48:51], a[224:227], a[244:247], a[48:51]
    buffer_load_dwordx4 v[0:3], v243, s[20:23], s56 offen offset:0 sc1
    v_mfma_f32_16x16x32_bf16 a[52:55], a[228:231], a[244:247], a[52:55]
    buffer_load_dwordx4 v[4:7], v243, s[20:23], s56 offen offset:1024 sc1
    v_mfma_f32_16x16x32_bf16 a[56:59], a[232:235], a[244:247], a[56:59]
    buffer_load_dwordx4 v[20:23], v239, s[16:19], s57 offen sc1
    v_mfma_f32_16x16x32_bf16 a[60:63], a[216:219], a[248:251], a[60:63]
    buffer_load_dwordx4 v[8:11], v243, s[20:23], s56 offen offset:2048 sc1
    v_mfma_f32_16x16x32_bf16 a[64:67], a[220:223], a[248:251], a[64:67]
    buffer_load_dwordx4 v[24:27], v240, s[16:19], s57 offen sc1
    v_mfma_f32_16x16x32_bf16 a[68:71], a[224:227], a[248:251], a[68:71]
    v_mfma_f32_16x16x32_bf16 a[72:75], a[228:231], a[248:251], a[72:75]
    buffer_load_dwordx4 v[12:15], v243, s[20:23], s56 offen offset:3072 sc1
    v_mfma_f32_16x16x32_bf16 a[76:79], a[232:235], a[248:251], a[76:79]
    s_waitcnt lgkmcnt(0)
    buffer_load_dwordx4 v[28:31], v241, s[16:19], s57 offen sc1
    v_mfma_f32_16x16x32_bf16 a[0:3], a[180:183], a[200:203], a[0:3]
    s_waitcnt vmcnt(33)
    buffer_load_dwordx4 v[16:19], v244, s[20:23], s56 offen offset:0 sc1
    ds_read_b128 a[216:219], v235 offset:4096
    v_mfma_f32_16x16x32_bf16 a[4:7], a[184:187], a[200:203], a[4:7]
    buffer_load_dwordx4 v[32:35], v242, s[16:19], s57 offen sc1
    ds_read_b128 a[220:223], v235 offset:5120
    v_mfma_f32_16x16x32_bf16 a[8:11], a[188:191], a[200:203], a[8:11]
    ds_read_b128 a[236:239], v235 offset:6144
    v_mfma_f32_16x16x32_bf16 a[12:15], a[192:195], a[200:203], a[12:15]
    s_mov_b32 s49, 6
    s_mul_i32 s56, s49, 20480
    s_lshl_b32 s57, s49, 14
    ds_read_b128 a[224:227], v232 offset:32768
    v_mfma_f32_16x16x32_bf16 a[16:19], a[196:199], a[200:203], a[16:19]
    buffer_load_dwordx4 v[52:55], v243, s[20:23], s56 offen offset:0 sc1
    ds_read_b128 a[240:243], v232 offset:36864
    v_mfma_f32_16x16x32_bf16 a[20:23], a[180:183], a[204:207], a[20:23]
    buffer_load_dwordx4 v[56:59], v243, s[20:23], s56 offen offset:1024 sc1
    ds_read_b128 a[228:231], v232 offset:40960
    v_mfma_f32_16x16x32_bf16 a[24:27], a[184:187], a[204:207], a[24:27]
    buffer_load_dwordx4 v[216:219], v239, s[16:19], s57 offen sc1
    ds_read_b128 a[244:247], v232 offset:45056
    v_mfma_f32_16x16x32_bf16 a[28:31], a[188:191], a[204:207], a[28:31]
    buffer_load_dwordx4 v[60:63], v243, s[20:23], s56 offen offset:2048 sc1
    ds_read_b128 a[232:235], v232 offset:49152
    v_mfma_f32_16x16x32_bf16 a[32:35], a[192:195], a[204:207], a[32:35]
    buffer_load_dwordx4 v[220:223], v240, s[16:19], s57 offen sc1
    ds_read_b128 a[248:251], v232 offset:53248
    v_mfma_f32_16x16x32_bf16 a[36:39], a[196:199], a[204:207], a[36:39]
    v_mfma_f32_16x16x32_bf16 a[40:43], a[180:183], a[208:211], a[40:43]
    buffer_load_dwordx4 v[208:211], v243, s[20:23], s56 offen offset:3072 sc1
    v_mfma_f32_16x16x32_bf16 a[44:47], a[184:187], a[208:211], a[44:47]
    buffer_load_dwordx4 v[128:131], v241, s[16:19], s57 offen sc1
    v_mfma_f32_16x16x32_bf16 a[48:51], a[188:191], a[208:211], a[48:51]
    buffer_load_dwordx4 v[212:215], v244, s[20:23], s56 offen offset:0 sc1
    v_mfma_f32_16x16x32_bf16 a[52:55], a[192:195], a[208:211], a[52:55]
    buffer_load_dwordx4 v[132:135], v242, s[16:19], s57 offen sc1
    v_mfma_f32_16x16x32_bf16 a[56:59], a[196:199], a[208:211], a[56:59]
    v_mfma_f32_16x16x32_bf16 a[60:63], a[180:183], a[212:215], a[60:63]
    buffer_load_dwordx2 v[230:231], v229, s[84:87], s41 offen sc1
    v_mfma_f32_16x16x32_bf16 a[64:67], a[184:187], a[212:215], a[64:67]
    s_add_u32 s49, s50, 0
    s_mul_i32 s56, s49, 20480
    s_lshl_b32 s57, s49, 14
    v_mfma_f32_16x16x32_bf16 a[68:71], a[188:191], a[212:215], a[68:71]
    buffer_load_dwordx4 v[152:155], v243, s[24:27], s56 offen offset:0 sc1
    v_mfma_f32_16x16x32_bf16 a[72:75], a[192:195], a[212:215], a[72:75]
    buffer_load_dwordx4 v[156:159], v243, s[24:27], s56 offen offset:1024 sc1
    v_mfma_f32_16x16x32_bf16 a[76:79], a[196:199], a[212:215], a[76:79]
    s_waitcnt lgkmcnt(0)
    buffer_load_dwordx4 v[160:163], v243, s[24:27], s56 offen offset:2048 sc1
    v_mfma_f32_16x16x32_bf16 a[0:3], a[216:219], a[236:239], a[0:3]
    s_waitcnt vmcnt(39)
    buffer_load_dwordx4 v[164:167], v243, s[24:27], s56 offen offset:3072 sc1
    ds_read_b128 a[180:183], v232 offset:57344
    v_mfma_f32_16x16x32_bf16 a[4:7], a[220:223], a[236:239], a[4:7]
    buffer_load_dwordx4 v[168:171], v244, s[24:27], s56 offen offset:0 sc1
    ds_read_b128 a[184:187], v232 offset:61440
    v_mfma_f32_16x16x32_bf16 a[8:11], a[224:227], a[236:239], a[8:11]
    ds_read_b128 a[200:203], v233 offset:0
    v_mfma_f32_16x16x32_bf16 a[12:15], a[228:231], a[236:239], a[12:15]
    s_cmp_eq_u32 s50, 0
    s_cselect_b32 s49, 4, 0
    s_mul_i32 s56, s49, 20480
    s_lshl_b32 s57, s49, 14
    ds_read_b128 a[188:191], v233 offset:4096
    v_mfma_f32_16x16x32_bf16 a[16:19], a[232:235], a[236:239], a[16:19]
    buffer_load_dwordx4 v[76:79], v243, s[24:27], s56 offen offset:0 sc1
    ds_read_b128 a[204:207], v233 offset:8192
    v_mfma_f32_16x16x32_bf16 a[20:23], a[216:219], a[240:243], a[20:23]
    buffer_load_dwordx4 v[80:83], v243, s[24:27], s56 offen offset:1024 sc1
    ds_read_b128 a[192:195], v233 offset:12288
    v_mfma_f32_16x16x32_bf16 a[24:27], a[220:223], a[240:243], a[24:27]
    buffer_load_dwordx4 v[84:87], v243, s[24:27], s56 offen offset:2048 sc1
    ds_read_b128 a[208:211], v233 offset:16384
    v_mfma_f32_16x16x32_bf16 a[28:31], a[224:227], a[240:243], a[28:31]
    buffer_load_dwordx4 v[88:91], v243, s[24:27], s56 offen offset:3072 sc1
    ds_read_b128 a[196:199], v233 offset:20480
    v_mfma_f32_16x16x32_bf16 a[32:35], a[228:231], a[240:243], a[32:35]
    buffer_load_dwordx4 v[92:95], v244, s[24:27], s56 offen offset:0 sc1
    ds_read_b128 a[212:215], v233 offset:24576
    v_mfma_f32_16x16x32_bf16 a[36:39], a[232:235], a[240:243], a[36:39]
    v_mfma_f32_16x16x32_bf16 a[40:43], a[216:219], a[244:247], a[40:43]
    v_mfma_f32_16x16x32_bf16 a[44:47], a[220:223], a[244:247], a[44:47]
    s_waitcnt vmcnt(10)
    v_cmp_ne_u64 vcc, s[92:93], v[230:231]
    s_cbranch_vccnz L_s3
L_s3_back:
    v_mfma_f32_16x16x32_bf16 a[48:51], a[224:227], a[244:247], a[48:51]
    s_add_u32 s49, s50, 0
    s_mul_i32 s56, s49, 20480
    s_lshl_b32 s57, s49, 14
    v_mfma_f32_16x16x32_bf16 a[52:55], a[228:231], a[244:247], a[52:55]
    buffer_load_dwordx4 v[188:191], v239, s[8:11], s57 offen sc1
    v_mfma_f32_16x16x32_bf16 a[56:59], a[232:235], a[244:247], a[56:59]
    buffer_load_dwordx4 v[64:67], v240, s[8:11], s57 offen sc1
    v_mfma_f32_16x16x32_bf16 a[60:63], a[216:219], a[248:251], a[60:63]
    buffer_load_dwordx4 v[68:71], v241, s[8:11], s57 offen sc1
    v_mfma_f32_16x16x32_bf16 a[64:67], a[220:223], a[248:251], a[64:67]
    buffer_load_dwordx4 v[72:75], v242, s[8:11], s57 offen sc1
    v_mfma_f32_16x16x32_bf16 a[68:71], a[224:227], a[248:251], a[68:71]
    buffer_load_dwordx4 v[172:175], v239, s[28:31], s57 offen sc1
    v_mfma_f32_16x16x32_bf16 a[72:75], a[228:231], a[248:251], a[72:75]
    buffer_load_dwordx4 v[176:179], v240, s[28:31], s57 offen sc1
    v_mfma_f32_16x16x32_bf16 a[76:79], a[232:235], a[248:251], a[76:79]
    s_waitcnt lgkmcnt(0)
    buffer_load_dwordx4 v[180:183], v241, s[28:31], s57 offen sc1
    v_mfma_f32_16x16x32_bf16 a[0:3], a[180:183], a[200:203], a[0:3]
    buffer_load_dwordx4 v[184:187], v242, s[28:31], s57 offen sc1
    v_mfma_f32_16x16x32_bf16 a[4:7], a[184:187], a[200:203], a[4:7]
    v_mfma_f32_16x16x32_bf16 a[8:11], a[188:191], a[200:203], a[8:11]
    s_cmp_eq_u32 s50, 0
    s_cselect_b32 s49, 4, 0
    s_mul_i32 s56, s49, 20480
    s_lshl_b32 s57, s49, 14
    v_mfma_f32_16x16x32_bf16 a[12:15], a[192:195], a[200:203], a[12:15]
    buffer_load_dwordx4 v[112:115], v239, s[8:11], s57 offen sc1
    v_mfma_f32_16x16x32_bf16 a[16:19], a[196:199], a[200:203], a[16:19]
    buffer_load_dwordx4 v[116:119], v240, s[8:11], s57 offen sc1
    v_mfma_f32_16x16x32_bf16 a[20:23], a[180:183], a[204:207], a[20:23]
    buffer_load_dwordx4 v[120:123], v241, s[8:11], s57 offen sc1
    v_mfma_f32_16x16x32_bf16 a[24:27], a[184:187], a[204:207], a[24:27]
    buffer_load_dwordx4 v[124:127], v242, s[8:11], s57 offen sc1
    v_mfma_f32_16x16x32_bf16 a[28:31], a[188:191], a[204:207], a[28:31]
    buffer_load_dwordx4 v[96:99], v239, s[28:31], s57 offen sc1
    v_mfma_f32_16x16x32_bf16 a[32:35], a[192:195], a[204:207], a[32:35]
    buffer_load_dwordx4 v[100:103], v240, s[28:31], s57 offen sc1
    v_mfma_f32_16x16x32_bf16 a[36:39], a[196:199], a[204:207], a[36:39]
    buffer_load_dwordx4 v[104:107], v241, s[28:31], s57 offen sc1
    v_mfma_f32_16x16x32_bf16 a[40:43], a[180:183], a[208:211], a[40:43]
    buffer_load_dwordx4 v[108:111], v242, s[28:31], s57 offen sc1
    v_mfma_f32_16x16x32_bf16 a[44:47], a[184:187], a[208:211], a[44:47]
    v_mfma_f32_16x16x32_bf16 a[48:51], a[188:191], a[208:211], a[48:51]
    v_mfma_f32_16x16x32_bf16 a[52:55], a[192:195], a[208:211], a[52:55]
    v_mfma_f32_16x16x32_bf16 a[56:59], a[196:199], a[208:211], a[56:59]
    v_mfma_f32_16x16x32_bf16 a[60:63], a[180:183], a[212:215], a[60:63]
    v_mfma_f32_16x16x32_bf16 a[64:67], a[184:187], a[212:215], a[64:67]
    v_mfma_f32_16x16x32_bf16 a[68:71], a[188:191], a[212:215], a[68:71]
    v_mfma_f32_16x16x32_bf16 a[72:75], a[192:195], a[212:215], a[72:75]
    v_mfma_f32_16x16x32_bf16 a[76:79], a[196:199], a[212:215], a[76:79]
    s_waitcnt vmcnt(36)
    v_mfma_f32_16x16x32_bf16 a[0:3], v[0:3], v[20:23], a[0:3]
    v_mfma_f32_16x16x32_bf16 a[4:7], v[4:7], v[20:23], a[4:7]
    v_mfma_f32_16x16x32_bf16 a[8:11], v[8:11], v[20:23], a[8:11]
    v_mfma_f32_16x16x32_bf16 a[12:15], v[12:15], v[20:23], a[12:15]
    v_mfma_f32_16x16x32_bf16 a[16:19], v[16:19], v[20:23], a[16:19]
    v_mfma_f32_16x16x32_bf16 a[20:23], v[0:3], v[24:27], a[20:23]
    v_mfma_f32_16x16x32_bf16 a[24:27], v[4:7], v[24:27], a[24:27]
    v_mfma_f32_16x16x32_bf16 a[28:31], v[8:11], v[24:27], a[28:31]
    v_mfma_f32_16x16x32_bf16 a[32:35], v[12:15], v[24:27], a[32:35]
    v_mfma_f32_16x16x32_bf16 a[36:39], v[16:19], v[24:27], a[36:39]
    v_mfma_f32_16x16x32_bf16 a[40:43], v[0:3], v[28:31], a[40:43]
    v_mfma_f32_16x16x32_bf16 a[44:47], v[4:7], v[28:31], a[44:47]
    v_mfma_f32_16x16x32_bf16 a[48:51], v[8:11], v[28:31], a[48:51]
    v_mfma_f32_16x16x32_bf16 a[52:55], v[12:15], v[28:31], a[52:55]
    v_mfma_f32_16x16x32_bf16 a[56:59], v[16:19], v[28:31], a[56:59]
    v_mfma_f32_16x16x32_bf16 a[60:63], v[0:3], v[32:35], a[60:63]
    v_mfma_f32_16x16x32_bf16 a[64:67], v[4:7], v[32:35], a[64:67]
    v_mfma_f32_16x16x32_bf16 a[68:71], v[8:11], v[32:35], a[68:71]
    v_mfma_f32_16x16x32_bf16 a[72:75], v[12:15], v[32:35], a[72:75]
    v_mfma_f32_16x16x32_bf16 a[76:79], v[16:19], v[32:35], a[76:79]
    s_waitcnt vmcnt(27)
    v_mfma_f32_16x16x32_bf16 a[0:3], v[52:55], v[216:219], a[0:3]
    s_cmp_eq_u32 s50, 1
    s_cselect_b32 s49, 5, 1
    s_mul_i32 s56, s49, 20480
    s_lshl_b32 s57, s49, 14
    v_mfma_f32_16x16x32_bf16 a[4:7], v[56:59], v[216:219], a[4:7]
    buffer_load_dwordx4 v[0:3], v243, s[24:27], s56 offen offset:0 sc1
    v_mfma_f32_16x16x32_bf16 a[8:11], v[60:63], v[216:219], a[8:11]
    buffer_load_dwordx4 v[36:39], v239, s[8:11], s57 offen sc1
    v_mfma_f32_16x16x32_bf16 a[12:15], v[208:211], v[216:219], a[12:15]
    buffer_load_dwordx4 v[4:7], v243, s[24:27], s56 offen offset:1024 sc1
    v_mfma_f32_16x16x32_bf16 a[16:19], v[212:215], v[216:219], a[16:19]
    v_mfma_f32_16x16x32_bf16 a[20:23], v[52:55], v[220:223], a[20:23]
    buffer_load_dwordx4 v[40:43], v240, s[8:11], s57 offen sc1
    v_mfma_f32_16x16x32_bf16 a[24:27], v[56:59], v[220:223], a[24:27]
    buffer_load_dwordx4 v[20:23], v239, s[28:31], s57 offen sc1
    v_mfma_f32_16x16x32_bf16 a[28:31], v[60:63], v[220:223], a[28:31]
    buffer_load_dwordx4 v[8:11], v243, s[24:27], s56 offen offset:2048 sc1
    v_mfma_f32_16x16x32_bf16 a[32:35], v[208:211], v[220:223], a[32:35]
    v_mfma_f32_16x16x32_bf16 a[36:39], v[212:215], v[220:223], a[36:39]
    buffer_load_dwordx4 v[44:47], v241, s[8:11], s57 offen sc1
    v_mfma_f32_16x16x32_bf16 a[40:43], v[52:55], v[128:131], a[40:43]
    buffer_load_dwordx4 v[24:27], v240, s[28:31], s57 offen sc1
    v_mfma_f32_16x16x32_bf16 a[44:47], v[56:59], v[128:131], a[44:47]
    v_mfma_f32_16x16x32_bf16 a[48:51], v[60:63], v[128:131], a[48:51]
    buffer_load_dwordx4 v[12:15], v243, s[24:27], s56 offen offset:3072 sc1
    v_mfma_f32_16x16x32_bf16 a[52:55], v[208:211], v[128:131], a[52:55]
    buffer_load_dwordx4 v[48:51], v242, s[8:11], s57 offen sc1
    v_mfma_f32_16x16x32_bf16 a[56:59], v[212:215], v[128:131], a[56:59]
    buffer_load_dwordx4 v[28:31], v241, s[28:31], s57 offen sc1
    v_mfma_f32_16x16x32_bf16 a[60:63], v[52:55], v[132:135], a[60:63]
    v_mfma_f32_16x16x32_bf16 a[64:67], v[56:59], v[132:135], a[64:67]
    buffer_load_dwordx4 v[16:19], v244, s[24:27], s56 offen offset:0 sc1
    v_mfma_f32_16x16x32_bf16 a[68:71], v[60:63], v[132:135], a[68:71]
    buffer_load_dwordx4 v[32:35], v242, s[28:31], s57 offen sc1
    v_mfma_f32_16x16x32_bf16 a[72:75], v[208:211], v[132:135], a[72:75]
    v_mfma_f32_16x16x32_bf16 a[76:79], v[212:215], v[132:135], a[76:79]
    s_waitcnt vmcnt(21)
    v_mfma_f32_16x16x32_bf16 a[160:163], v[152:155], v[188:191], 0
    s_cmp_eq_u32 s50, 2
    s_cselect_b32 s49, 6, 2
    s_mul_i32 s56, s49, 20480
    s_lshl_b32 s57, s49, 14
    v_mfma_f32_16x16x32_bf16 a[164:167], v[156:159], v[188:191], 0
    buffer_load_dwordx4 v[52:55], v243, s[24:27], s56 offen offset:0 sc1
    v_mfma_f32_16x16x32_bf16 a[168:171], v[160:163], v[188:191], 0
    v_mfma_f32_16x16x32_bf16 a[172:175], v[164:167], v[188:191], 0
    buffer_load_dwordx4 v[136:139], v239, s[8:11], s57 offen sc1
    v_mfma_f32_16x16x32_bf16 a[176:179], v[168:171], v[188:191], 0
    v_mfma_f32_16x16x32_bf16 a[180:183], v[152:155], v[64:67], 0
    v_mfma_f32_16x16x32_bf16 a[184:187], v[156:159], v[64:67], 0
    buffer_load_dwordx4 v[56:59], v243, s[24:27], s56 offen offset:1024 sc1
    v_mfma_f32_16x16x32_bf16 a[188:191], v[160:163], v[64:67], 0
    v_mfma_f32_16x16x32_bf16 a[192:195], v[164:167], v[64:67], 0
    v_mfma_f32_16x16x32_bf16 a[196:199], v[168:171], v[64:67], 0
    buffer_load_dwordx4 v[140:143], v240, s[8:11], s57 offen sc1
    v_mfma_f32_16x16x32_bf16 a[200:203], v[152:155], v[68:71], 0
    v_mfma_f32_16x16x32_bf16 a[204:207], v[156:159], v[68:71], 0
    v_mfma_f32_16x16x32_bf16 a[208:211], v[160:163], v[68:71], 0
    buffer_load_dwordx4 v[216:219], v239, s[28:31], s57 offen sc1
    v_mfma_f32_16x16x32_bf16 a[212:215], v[164:167], v[68:71], 0
    v_mfma_f32_16x16x32_bf16 a[216:219], v[168:171], v[68:71], 0
    v_mfma_f32_16x16x32_bf16 a[220:223], v[152:155], v[72:75], 0
    buffer_load_dwordx4 v[60:63], v243, s[24:27], s56 offen offset:2048 sc1
    v_mfma_f32_16x16x32_bf16 a[224:227], v[156:159], v[72:75], 0
    v_mfma_f32_16x16x32_bf16 a[228:231], v[160:163], v[72:75], 0
    v_mfma_f32_16x16x32_bf16 a[232:235], v[164:167], v[72:75], 0
    buffer_load_dwordx4 v[144:147], v241, s[8:11], s57 offen sc1
    v_mfma_f32_16x16x32_bf16 a[236:239], v[168:171], v[72:75], 0
    v_mfma_f32_16x16x32_bf16 a[80:83], v[152:155], v[172:175], 0
    v_mfma_f32_16x16x32_bf16 a[84:87], v[156:159], v[172:175], 0
    buffer_load_dwordx4 v[220:223], v240, s[28:31], s57 offen sc1
    v_mfma_f32_16x16x32_bf16 a[88:91], v[160:163], v[172:175], 0
    v_mfma_f32_16x16x32_bf16 a[92:95], v[164:167], v[172:175], 0
    v_mfma_f32_16x16x32_bf16 a[96:99], v[168:171], v[172:175], 0
    buffer_load_dwordx4 v[208:211], v243, s[24:27], s56 offen offset:3072 sc1
    v_mfma_f32_16x16x32_bf16 a[100:103], v[152:155], v[176:179], 0
    v_mfma_f32_16x16x32_bf16 a[104:107], v[156:159], v[176:179], 0
    v_mfma_f32_16x16x32_bf16 a[108:111], v[160:163], v[176:179], 0
    buffer_load_dwordx4 v[148:151], v242, s[8:11], s57 offen sc1
    v_mfma_f32_16x16x32_bf16 a[112:115], v[164:167], v[176:179], 0
    v_mfma_f32_16x16x32_bf16 a[116:119], v[168:171], v[176:179], 0
    v_mfma_f32_16x16x32_bf16 a[120:123], v[152:155], v[180:183], 0
    buffer_load_dwordx4 v[128:131], v241, s[28:31], s57 offen sc1
    v_mfma_f32_16x16x32_bf16 a[124:127], v[156:159], v[180:183], 0
    v_mfma_f32_16x16x32_bf16 a[128:131], v[160:163], v[180:183], 0
    v_mfma_f32_16x16x32_bf16 a[132:135], v[164:167], v[180:183], 0
    buffer_load_dwordx4 v[212:215], v244, s[24:27], s56 offen offset:0 sc1
    v_mfma_f32_16x16x32_bf16 a[136:139], v[168:171], v[180:183], 0
    v_mfma_f32_16x16x32_bf16 a[140:143], v[152:155], v[184:187], 0
    v_mfma_f32_16x16x32_bf16 a[144:147], v[156:159], v[184:187], 0
    buffer_load_dwordx4 v[132:135], v242, s[28:31], s57 offen sc1
    v_mfma_f32_16x16x32_bf16 a[148:151], v[160:163], v[184:187], 0
    v_mfma_f32_16x16x32_bf16 a[152:155], v[164:167], v[184:187], 0
    v_mfma_f32_16x16x32_bf16 a[156:159], v[168:171], v[184:187], 0
    s_waitcnt vmcnt(26)
    v_mfma_f32_16x16x32_bf16 a[160:163], v[76:79], v[112:115], a[160:163]
    s_cmp_eq_u32 s50, 3
    s_cselect_b32 s49, 7, 3
    s_mul_i32 s56, s49, 20480
    s_lshl_b32 s57, s49, 14
    v_mfma_f32_16x16x32_bf16 a[164:167], v[80:83], v[112:115], a[164:167]
    s_barrier
    buffer_load_dwordx4 v[152:155], v243, s[24:27], s56 offen offset:0 sc1
    v_mfma_f32_16x16x32_bf16 a[168:171], v[84:87], v[112:115], a[168:171]
    v_mfma_f32_16x16x32_bf16 a[172:175], v[88:91], v[112:115], a[172:175]
    buffer_load_dwordx4 v[188:191], v239, s[8:11], s57 offen sc1
    v_mfma_f32_16x16x32_bf16 a[176:179], v[92:95], v[112:115], a[176:179]
    v_mfma_f32_16x16x32_bf16 a[180:183], v[76:79], v[116:119], a[180:183]
    v_mfma_f32_16x16x32_bf16 a[184:187], v[80:83], v[116:119], a[184:187]
    buffer_load_dwordx4 v[156:159], v243, s[24:27], s56 offen offset:1024 sc1
    v_mfma_f32_16x16x32_bf16 a[188:191], v[84:87], v[116:119], a[188:191]
    v_mfma_f32_16x16x32_bf16 a[192:195], v[88:91], v[116:119], a[192:195]
    v_mfma_f32_16x16x32_bf16 a[196:199], v[92:95], v[116:119], a[196:199]
    buffer_load_dwordx4 v[64:67], v240, s[8:11], s57 offen sc1
    v_mfma_f32_16x16x32_bf16 a[200:203], v[76:79], v[120:123], a[200:203]
    v_mfma_f32_16x16x32_bf16 a[204:207], v[80:83], v[120:123], a[204:207]
    v_mfma_f32_16x16x32_bf16 a[208:211], v[84:87], v[120:123], a[208:211]
    buffer_load_dwordx4 v[172:175], v239, s[28:31], s57 offen sc1
    v_mfma_f32_16x16x32_bf16 a[212:215], v[88:91], v[120:123], a[212:215]
    v_mfma_f32_16x16x32_bf16 a[216:219], v[92:95], v[120:123], a[216:219]
    v_mfma_f32_16x16x32_bf16 a[220:223], v[76:79], v[124:127], a[220:223]
    buffer_load_dwordx4 v[160:163], v243, s[24:27], s56 offen offset:2048 sc1
    v_mfma_f32_16x16x32_bf16 a[224:227], v[80:83], v[124:127], a[224:227]
    v_mfma_f32_16x16x32_bf16 a[228:231], v[84:87], v[124:127], a[228:231]
    v_mfma_f32_16x16x32_bf16 a[232:235], v[88:91], v[124:127], a[232:235]
    buffer_load_dwordx4 v[68:71], v241, s[8:11], s57 offen sc1
    v_mfma_f32_16x16x32_bf16 a[236:239], v[92:95], v[124:127], a[236:239]
    v_mfma_f32_16x16x32_bf16 a[80:83], v[76:79], v[96:99], a[80:83]
    v_mfma_f32_16x16x32_bf16 a[84:87], v[80:83], v[96:99], a[84:87]
    buffer_load_dwordx4 v[176:179], v240, s[28:31], s57 offen sc1
    v_mfma_f32_16x16x32_bf16 a[88:91], v[84:87], v[96:99], a[88:91]
    v_mfma_f32_16x16x32_bf16 a[92:95], v[88:91], v[96:99], a[92:95]
    v_mfma_f32_16x16x32_bf16 a[96:99], v[92:95], v[96:99], a[96:99]
    buffer_load_dwordx4 v[164:167], v243, s[24:27], s56 offen offset:3072 sc1
    v_mfma_f32_16x16x32_bf16 a[100:103], v[76:79], v[100:103], a[100:103]
    v_mfma_f32_16x16x32_bf16 a[104:107], v[80:83], v[100:103], a[104:107]
    v_mfma_f32_16x16x32_bf16 a[108:111], v[84:87], v[100:103], a[108:111]
    buffer_load_dwordx4 v[72:75], v242, s[8:11], s57 offen sc1
    v_mfma_f32_16x16x32_bf16 a[112:115], v[88:91], v[100:103], a[112:115]
    v_mfma_f32_16x16x32_bf16 a[116:119], v[92:95], v[100:103], a[116:119]
    v_mfma_f32_16x16x32_bf16 a[120:123], v[76:79], v[104:107], a[120:123]
    buffer_load_dwordx4 v[180:183], v241, s[28:31], s57 offen sc1
    v_mfma_f32_16x16x32_bf16 a[124:127], v[80:83], v[104:107], a[124:127]
    v_mfma_f32_16x16x32_bf16 a[128:131], v[84:87], v[104:107], a[128:131]
    v_mfma_f32_16x16x32_bf16 a[132:135], v[88:91], v[104:107], a[132:135]
    buffer_load_dwordx4 v[168:171], v244, s[24:27], s56 offen offset:0 sc1
    v_mfma_f32_16x16x32_bf16 a[136:139], v[92:95], v[104:107], a[136:139]
    v_mfma_f32_16x16x32_bf16 a[140:143], v[76:79], v[108:111], a[140:143]
    v_mfma_f32_16x16x32_bf16 a[144:147], v[80:83], v[108:111], a[144:147]
    buffer_load_dwordx4 v[184:187], v242, s[28:31], s57 offen sc1
    v_mfma_f32_16x16x32_bf16 a[148:151], v[84:87], v[108:111], a[148:151]
    v_mfma_f32_16x16x32_bf16 a[152:155], v[88:91], v[108:111], a[152:155]
    v_mfma_f32_16x16x32_bf16 a[156:159], v[92:95], v[108:111], a[156:159]
    s_waitcnt vmcnt(26)
    v_mfma_f32_16x16x32_bf16 a[160:163], v[0:3], v[36:39], a[160:163]
    s_cmp_eq_u32 s50, 0
    s_cselect_b32 s49, 8, 4
    s_mul_i32 s56, s49, 20480
    s_lshl_b32 s57, s49, 14
    v_mfma_f32_16x16x32_bf16 a[164:167], v[4:7], v[36:39], a[164:167]
    buffer_load_dwordx4 v[76:79], v243, s[24:27], s56 offen offset:0 sc1
    v_mfma_f32_16x16x32_bf16 a[168:171], v[8:11], v[36:39], a[168:171]
    s_or_b32 s3, s4, s44
    v_mfma_f32_16x16x32_bf16 a[172:175], v[12:15], v[36:39], a[172:175]
    buffer_load_dwordx4 v[112:115], v239, s[8:11], s57 offen sc1
    v_mfma_f32_16x16x32_bf16 a[176:179], v[16:19], v[36:39], a[176:179]
    s_lshl_b32 s3, s3, 20
    v_mfma_f32_16x16x32_bf16 a[180:183], v[0:3], v[40:43], a[180:183]
    s_lshl_b32 s7, s6, 7
    v_mfma_f32_16x16x32_bf16 a[184:187], v[4:7], v[40:43], a[184:187]
    buffer_load_dwordx4 v[80:83], v243, s[24:27], s56 offen offset:1024 sc1
    v_mfma_f32_16x16x32_bf16 a[188:191], v[8:11], v[40:43], a[188:191]
    s_add_u32 s3, s3, s7
    v_mfma_f32_16x16x32_bf16 a[192:195], v[12:15], v[40:43], a[192:195]
    buffer_store_dwordx4 a[252:255], v234, s[84:87], s3 offen sc1
    v_mfma_f32_16x16x32_bf16 a[196:199], v[16:19], v[40:43], a[196:199]
    buffer_load_dwordx4 v[116:119], v240, s[8:11], s57 offen sc1
    v_mfma_f32_16x16x32_bf16 a[200:203], v[0:3], v[44:47], a[200:203]
    v_mfma_f32_16x16x32_bf16 a[204:207], v[4:7], v[44:47], a[204:207]
    v_mfma_f32_16x16x32_bf16 a[208:211], v[8:11], v[44:47], a[208:211]
    buffer_load_dwordx4 v[96:99], v239, s[28:31], s57 offen sc1
    v_mfma_f32_16x16x32_bf16 a[212:215], v[12:15], v[44:47], a[212:215]
    v_mfma_f32_16x16x32_bf16 a[216:219], v[16:19], v[44:47], a[216:219]
    v_mfma_f32_16x16x32_bf16 a[220:223], v[0:3], v[48:51], a[220:223]
    buffer_load_dwordx4 v[84:87], v243, s[24:27], s56 offen offset:2048 sc1
    v_mfma_f32_16x16x32_bf16 a[224:227], v[4:7], v[48:51], a[224:227]
    v_mfma_f32_16x16x32_bf16 a[228:231], v[8:11], v[48:51], a[228:231]
    v_mfma_f32_16x16x32_bf16 a[232:235], v[12:15], v[48:51], a[232:235]
    buffer_load_dwordx4 v[120:123], v241, s[8:11], s57 offen sc1
    v_mfma_f32_16x16x32_bf16 a[236:239], v[16:19], v[48:51], a[236:239]
    v_mfma_f32_16x16x32_bf16 a[80:83], v[0:3], v[20:23], a[80:83]
    v_mfma_f32_16x16x32_bf16 a[84:87], v[4:7], v[20:23], a[84:87]
    buffer_load_dwordx4 v[100:103], v240, s[28:31], s57 offen sc1
    v_mfma_f32_16x16x32_bf16 a[88:91], v[8:11], v[20:23], a[88:91]
    v_mfma_f32_16x16x32_bf16 a[92:95], v[12:15], v[20:23], a[92:95]
    v_mfma_f32_16x16x32_bf16 a[96:99], v[16:19], v[20:23], a[96:99]
    buffer_load_dwordx4 v[88:91], v243, s[24:27], s56 offen offset:3072 sc1
    v_mfma_f32_16x16x32_bf16 a[100:103], v[0:3], v[24:27], a[100:103]
    v_mfma_f32_16x16x32_bf16 a[104:107], v[4:7], v[24:27], a[104:107]
    v_mfma_f32_16x16x32_bf16 a[108:111], v[8:11], v[24:27], a[108:111]
    buffer_load_dwordx4 v[124:127], v242, s[8:11], s57 offen sc1
    v_mfma_f32_16x16x32_bf16 a[112:115], v[12:15], v[24:27], a[112:115]
    v_mfma_f32_16x16x32_bf16 a[116:119], v[16:19], v[24:27], a[116:119]
    v_mfma_f32_16x16x32_bf16 a[120:123], v[0:3], v[28:31], a[120:123]
    buffer_load_dwordx4 v[104:107], v241, s[28:31], s57 offen sc1
    v_mfma_f32_16x16x32_bf16 a[124:127], v[4:7], v[28:31], a[124:127]
    v_mfma_f32_16x16x32_bf16 a[128:131], v[8:11], v[28:31], a[128:131]
    v_mfma_f32_16x16x32_bf16 a[132:135], v[12:15], v[28:31], a[132:135]
    buffer_load_dwordx4 v[92:95], v244, s[24:27], s56 offen offset:0 sc1
    v_mfma_f32_16x16x32_bf16 a[136:139], v[16:19], v[28:31], a[136:139]
    v_mfma_f32_16x16x32_bf16 a[140:143], v[0:3], v[32:35], a[140:143]
    v_mfma_f32_16x16x32_bf16 a[144:147], v[4:7], v[32:35], a[144:147]
    buffer_load_dwordx4 v[108:111], v242, s[28:31], s57 offen sc1
    v_mfma_f32_16x16x32_bf16 a[148:151], v[8:11], v[32:35], a[148:151]
    v_mfma_f32_16x16x32_bf16 a[152:155], v[12:15], v[32:35], a[152:155]
    v_mfma_f32_16x16x32_bf16 a[156:159], v[16:19], v[32:35], a[156:159]
    s_waitcnt vmcnt(27)
    v_mfma_f32_16x16x32_bf16 a[160:163], v[52:55], v[136:139], a[160:163]
    s_cmp_eq_u32 s50, 1
    s_cselect_b32 s49, 9, 5
    s_mul_i32 s56, s49, 20480
    s_lshl_b32 s57, s49, 14
    v_mfma_f32_16x16x32_bf16 a[164:167], v[56:59], v[136:139], a[164:167]
    buffer_load_dwordx4 v[0:3], v243, s[24:27], s56 offen offset:0 sc1
    v_mfma_f32_16x16x32_bf16 a[168:171], v[60:63], v[136:139], a[168:171]
    s_add_u32 s12, s82, 0x2800000
    s_addc_u32 s13, s83, 0
    v_mfma_f32_16x16x32_bf16 a[172:175], v[208:211], v[136:139], a[172:175]
    s_mov_b32 s14, 0x500000
    v_mfma_f32_16x16x32_bf16 a[176:179], v[212:215], v[136:139], a[176:179]
    s_mov_b32 s15, 0x20000
    v_mfma_f32_16x16x32_bf16 a[180:183], v[52:55], v[140:143], a[180:183]
    buffer_load_dwordx4 v[36:39], v239, s[8:11], s57 offen sc1
    v_mfma_f32_16x16x32_bf16 a[184:187], v[56:59], v[140:143], a[184:187]
    s_mul_i32 s42, s2, 20480
    v_mfma_f32_16x16x32_bf16 a[188:191], v[60:63], v[140:143], a[188:191]
    s_xor_b32 s3, s2, 2
    v_mfma_f32_16x16x32_bf16 a[192:195], v[208:211], v[140:143], a[192:195]
    s_mul_i32 s43, s3, 20480
    v_mfma_f32_16x16x32_bf16 a[196:199], v[212:215], v[140:143], a[196:199]
    buffer_load_dwordx4 v[4:7], v243, s[24:27], s56 offen offset:1024 sc1
    v_mfma_f32_16x16x32_bf16 a[200:203], v[52:55], v[144:147], a[200:203]
L_padD_0:
    s_cbranch_execz L_padD_1
    s_lshl_b32 s3, s2, 2
    v_mfma_f32_16x16x32_bf16 a[204:207], v[56:59], v[144:147], a[204:207]
    s_add_u32 s3, s3, s4
    v_mfma_f32_16x16x32_bf16 a[208:211], v[60:63], v[144:147], a[208:211]
    s_lshl_b32 s3, s3, 7
    v_mfma_f32_16x16x32_bf16 a[212:215], v[208:211], v[144:147], a[212:215]
    s_add_u32 s52, s3, 262144
    v_mfma_f32_16x16x32_bf16 a[216:219], v[212:215], v[144:147], a[216:219]
    buffer_load_dwordx4 v[40:43], v240, s[8:11], s57 offen sc1
    v_mfma_f32_16x16x32_bf16 a[220:223], v[52:55], v[148:151], a[220:223]
    s_xor_b32 s55, s52, 1024
    v_mfma_f32_16x16x32_bf16 a[224:227], v[56:59], v[148:151], a[224:227]
    v_mfma_f32_16x16x32_bf16 a[228:231], v[60:63], v[148:151], a[228:231]
    v_mfma_f32_16x16x32_bf16 a[232:235], v[208:211], v[148:151], a[232:235]
    buffer_load_dwordx4 v[20:23], v239, s[28:31], s57 offen sc1
    v_mfma_f32_16x16x32_bf16 a[236:239], v[212:215], v[148:151], a[236:239]
    v_mfma_f32_16x16x32_bf16 a[80:83], v[52:55], v[216:219], a[80:83]
    v_mfma_f32_16x16x32_bf16 a[84:87], v[56:59], v[216:219], a[84:87]
    v_mfma_f32_16x16x32_bf16 a[88:91], v[60:63], v[216:219], a[88:91]
    v_mfma_f32_16x16x32_bf16 a[92:95], v[208:211], v[216:219], a[92:95]
    buffer_load_dwordx4 v[8:11], v243, s[24:27], s56 offen offset:2048 sc1
    v_mfma_f32_16x16x32_bf16 a[96:99], v[212:215], v[216:219], a[96:99]
    v_mfma_f32_16x16x32_bf16 a[100:103], v[52:55], v[220:223], a[100:103]
    v_mfma_f32_16x16x32_bf16 a[104:107], v[56:59], v[220:223], a[104:107]
    v_mfma_f32_16x16x32_bf16 a[108:111], v[60:63], v[220:223], a[108:111]
    buffer_load_dwordx4 v[44:47], v241, s[8:11], s57 offen sc1
    v_mfma_f32_16x16x32_bf16 a[112:115], v[208:211], v[220:223], a[112:115]
    v_mfma_f32_16x16x32_bf16 a[116:119], v[212:215], v[220:223], a[116:119]
    v_mfma_f32_16x16x32_bf16 a[120:123], v[52:55], v[128:131], a[120:123]
    v_mfma_f32_16x16x32_bf16 a[124:127], v[56:59], v[128:131], a[124:127]
    v_mfma_f32_16x16x32_bf16 a[128:131], v[60:63], v[128:131], a[128:131]
    buffer_load_dwordx4 v[24:27], v240, s[28:31], s57 offen sc1
    v_mfma_f32_16x16x32_bf16 a[132:135], v[208:211], v[128:131], a[132:135]
    v_mfma_f32_16x16x32_bf16 a[136:139], v[212:215], v[128:131], a[136:139]
    v_mfma_f32_16x16x32_bf16 a[140:143], v[52:55], v[132:135], a[140:143]
    v_mfma_f32_16x16x32_bf16 a[144:147], v[56:59], v[132:135], a[144:147]
    buffer_load_dwordx4 v[12:15], v243, s[24:27], s56 offen offset:3072 sc1
    v_mfma_f32_16x16x32_bf16 a[148:151], v[60:63], v[132:135], a[148:151]
    v_mfma_f32_16x16x32_bf16 a[152:155], v[208:211], v[132:135], a[152:155]
    v_mfma_f32_16x16x32_bf16 a[156:159], v[212:215], v[132:135], a[156:159]
    s_waitcnt vmcnt(23)
    v_mfma_f32_16x16x32_bf16 a[160:163], v[152:155], v[188:191], a[160:163]
    v_mfma_f32_16x16x32_bf16 a[164:167], v[156:159], v[188:191], a[164:167]
    buffer_load_dwordx4 v[48:51], v242, s[8:11], s57 offen sc1
    v_mfma_f32_16x16x32_bf16 a[168:171], v[160:163], v[188:191], a[168:171]
    s_mul_i32 s7, s53, 81920
    v_bfe_u32 v192, v238, 4, 4
    v_lshrrev_b32 v193, 8, v238
    v_mfma_f32_16x16x32_bf16 a[172:175], v[164:167], v[188:191], a[172:175]
    s_mul_i32 s3, s54, 160
    v_mul_u32_u24 v224, 160, v192
    v_lshl_add_u32 v224, v193, 3, v224
    v_mfma_f32_16x16x32_bf16 a[176:179], v[168:171], v[188:191], a[176:179]
    s_add_u32 s7, s7, s3
    v_add_u32 v224, s66, v224
    v_lshrrev_b32 v192, 4, v238
    v_mfma_f32_16x16x32_bf16 a[180:183], v[152:155], v[64:67], a[180:183]
    buffer_load_dwordx4 v[28:31], v241, s[28:31], s57 offen sc1
    v_mfma_f32_16x16x32_bf16 a[184:187], v[156:159], v[64:67], a[184:187]
    s_mul_i32 s3, s4, 20480
    v_mul_u32_u24 v193, 6554, v192
    v_lshrrev_b32 v193, 16, v193
    v_mfma_f32_16x16x32_bf16 a[188:191], v[160:163], v[64:67], a[188:191]
    s_add_u32 s7, s7, s3
    v_mul_u32_u24 v193, 1120, v193
    v_lshl_add_u32 v248, v192, 4, v193
    v_mfma_f32_16x16x32_bf16 a[192:195], v[164:167], v[64:67], a[192:195]
    s_add_u32 s60, s96, s7
    s_addc_u32 s61, s97, 0
    v_add_u32 v192, 64, v192
    v_mfma_f32_16x16x32_bf16 a[196:199], v[168:171], v[64:67], a[196:199]
    s_mov_b32 s62, 0x4ba0
    v_mul_u32_u24 v193, 6554, v192
    v_lshrrev_b32 v193, 16, v193
    v_mfma_f32_16x16x32_bf16 a[200:203], v[152:155], v[68:71], a[200:203]
    buffer_load_dwordx4 v[16:19], v244, s[24:27], s56 offen offset:0 sc1
    v_mfma_f32_16x16x32_bf16 a[204:207], v[156:159], v[68:71], a[204:207]
    s_mov_b32 s63, 0x20000
    v_mul_u32_u24 v193, 1120, v193
    v_lshl_add_u32 v249, v192, 4, v193
    v_mfma_f32_16x16x32_bf16 a[208:211], v[160:163], v[68:71], a[208:211]
    v_add_u32 v192, 64, v192
    v_mul_u32_u24 v193, 6554, v192
    v_mfma_f32_16x16x32_bf16 a[212:215], v[164:167], v[68:71], a[212:215]
    v_lshrrev_b32 v193, 16, v193
    v_mul_u32_u24 v193, 1120, v193
    v_mfma_f32_16x16x32_bf16 a[216:219], v[168:171], v[68:71], a[216:219]
    buffer_load_dwordx4 v[32:35], v242, s[28:31], s57 offen sc1
    v_mfma_f32_16x16x32_bf16 a[220:223], v[152:155], v[72:75], a[220:223]
    v_lshl_add_u32 v250, v192, 4, v193
    v_and_b32 v192, 0x200, v238
    v_mfma_f32_16x16x32_bf16 a[224:227], v[156:159], v[72:75], a[224:227]
    v_lshl_add_u32 v250, v192, 20, v250
    v_mfma_f32_16x16x32_bf16 a[228:231], v[160:163], v[72:75], a[228:231]
    v_mfma_f32_16x16x32_bf16 a[232:235], v[164:167], v[72:75], a[232:235]
    v_mfma_f32_16x16x32_bf16 a[236:239], v[168:171], v[72:75], a[236:239]
    v_mfma_f32_16x16x32_bf16 a[80:83], v[152:155], v[172:175], a[80:83]
    s_cmp_eq_u32 s50, 2
    s_cselect_b32 s49, 10, 6
    s_mul_i32 s56, s49, 20480
    s_lshl_b32 s57, s49, 14
    v_mfma_f32_16x16x32_bf16 a[84:87], v[156:159], v[172:175], a[84:87]
    buffer_load_dwordx4 v[52:55], v243, s[24:27], s56 offen offset:0 sc1
    v_mfma_f32_16x16x32_bf16 a[88:91], v[160:163], v[172:175], a[88:91]
    v_mfma_f32_16x16x32_bf16 a[92:95], v[164:167], v[172:175], a[92:95]
    v_mfma_f32_16x16x32_bf16 a[96:99], v[168:171], v[172:175], a[96:99]
    v_mfma_f32_16x16x32_bf16 a[100:103], v[152:155], v[176:179], a[100:103]
    buffer_load_dwordx4 v[136:139], v239, s[8:11], s57 offen sc1
    v_mfma_f32_16x16x32_bf16 a[104:107], v[156:159], v[176:179], a[104:107]
    v_mfma_f32_16x16x32_bf16 a[108:111], v[160:163], v[176:179], a[108:111]
    v_mfma_f32_16x16x32_bf16 a[112:115], v[164:167], v[176:179], a[112:115]
    v_mfma_f32_16x16x32_bf16 a[116:119], v[168:171], v[176:179], a[116:119]
    buffer_load_dwordx4 v[56:59], v243, s[24:27], s56 offen offset:1024 sc1
    v_mfma_f32_16x16x32_bf16 a[120:123], v[152:155], v[180:183], a[120:123]
    v_mfma_f32_16x16x32_bf16 a[124:127], v[156:159], v[180:183], a[124:127]
    v_mfma_f32_16x16x32_bf16 a[128:131], v[160:163], v[180:183], a[128:131]
    v_mfma_f32_16x16x32_bf16 a[132:135], v[164:167], v[180:183], a[132:135]
    v_mfma_f32_16x16x32_bf16 a[136:139], v[168:171], v[180:183], a[136:139]
    buffer_load_dwordx4 v[140:143], v240, s[8:11], s57 offen sc1
    v_mfma_f32_16x16x32_bf16 a[140:143], v[152:155], v[184:187], a[140:143]
    v_mfma_f32_16x16x32_bf16 a[144:147], v[156:159], v[184:187], a[144:147]
    v_mfma_f32_16x16x32_bf16 a[148:151], v[160:163], v[184:187], a[148:151]
    v_mfma_f32_16x16x32_bf16 a[152:155], v[164:167], v[184:187], a[152:155]
    buffer_load_dwordx4 v[216:219], v239, s[28:31], s57 offen sc1
    v_mfma_f32_16x16x32_bf16 a[156:159], v[168:171], v[184:187], a[156:159]
    s_waitcnt vmcnt(18)
    v_mfma_f32_16x16x32_bf16 a[160:163], v[76:79], v[112:115], a[160:163]
    v_mfma_f32_16x16x32_bf16 a[164:167], v[80:83], v[112:115], a[164:167]
    s_mul_i32 s3, s4, 30720
    v_add_u32 v228, s3, v238
    v_mfma_f32_16x16x32_bf16 a[168:171], v[84:87], v[112:115], a[168:171]
    s_add_u32 s3, s4, 1
    v_mfma_f32_16x16x32_bf16 a[172:175], v[88:91], v[112:115], a[172:175]
    buffer_load_dwordx4 v[60:63], v243, s[24:27], s56 offen offset:2048 sc1
    v_mfma_f32_16x16x32_bf16 a[176:179], v[92:95], v[112:115], a[176:179]
    s_and_b32 s3, s3, 3
    v_mfma_f32_16x16x32_bf16 a[180:183], v[76:79], v[116:119], a[180:183]
    s_mul_i32 s3, s3, 30720
    v_mfma_f32_16x16x32_bf16 a[184:187], v[80:83], v[116:119], a[184:187]
    s_add_u32 s3, s3, 0
    v_add_u32 v225, s3, v238
    v_mfma_f32_16x16x32_bf16 a[188:191], v[84:87], v[116:119], a[188:191]
    buffer_load_dwordx4 v[144:147], v241, s[8:11], s57 offen sc1
    v_mfma_f32_16x16x32_bf16 a[192:195], v[88:91], v[116:119], a[192:195]
    s_add_u32 s3, s4, 2
    v_mfma_f32_16x16x32_bf16 a[196:199], v[92:95], v[116:119], a[196:199]
    s_and_b32 s3, s3, 3
    v_mfma_f32_16x16x32_bf16 a[200:203], v[76:79], v[120:123], a[200:203]
    s_mul_i32 s3, s3, 30720
    v_mfma_f32_16x16x32_bf16 a[204:207], v[80:83], v[120:123], a[204:207]
    s_add_u32 s3, s3, 5120
    v_add_u32 v226, s3, v238
    v_mfma_f32_16x16x32_bf16 a[208:211], v[84:87], v[120:123], a[208:211]
    buffer_load_dwordx4 v[220:223], v240, s[28:31], s57 offen sc1
    v_mfma_f32_16x16x32_bf16 a[212:215], v[88:91], v[120:123], a[212:215]
    s_add_u32 s3, s4, 3
    v_mfma_f32_16x16x32_bf16 a[216:219], v[92:95], v[120:123], a[216:219]
    s_and_b32 s3, s3, 3
    v_mfma_f32_16x16x32_bf16 a[220:223], v[76:79], v[124:127], a[220:223]
    s_mul_i32 s3, s3, 30720
    v_mfma_f32_16x16x32_bf16 a[224:227], v[80:83], v[124:127], a[224:227]
    buffer_load_dwordx4 v[208:211], v243, s[24:27], s56 offen offset:3072 sc1
    v_mfma_f32_16x16x32_bf16 a[228:231], v[84:87], v[124:127], a[228:231]
    s_add_u32 s3, s3, 10240
    v_add_u32 v227, s3, v238
    v_mfma_f32_16x16x32_bf16 a[232:235], v[88:91], v[124:127], a[232:235]
    v_mfma_f32_16x16x32_bf16 a[236:239], v[92:95], v[124:127], a[236:239]
    v_mfma_f32_16x16x32_bf16 a[80:83], v[76:79], v[96:99], a[80:83]
    v_mfma_f32_16x16x32_bf16 a[84:87], v[80:83], v[96:99], a[84:87]
    buffer_load_dwordx4 v[148:151], v242, s[8:11], s57 offen sc1
    v_mfma_f32_16x16x32_bf16 a[88:91], v[84:87], v[96:99], a[88:91]
    v_mfma_f32_16x16x32_bf16 a[92:95], v[88:91], v[96:99], a[92:95]
    v_mfma_f32_16x16x32_bf16 a[96:99], v[92:95], v[96:99], a[96:99]
    v_mfma_f32_16x16x32_bf16 a[100:103], v[76:79], v[100:103], a[100:103]
    buffer_load_dwordx4 v[128:131], v241, s[28:31], s57 offen sc1
    v_mfma_f32_16x16x32_bf16 a[104:107], v[80:83], v[100:103], a[104:107]
    v_mfma_f32_16x16x32_bf16 a[108:111], v[84:87], v[100:103], a[108:111]
    v_mfma_f32_16x16x32_bf16 a[112:115], v[88:91], v[100:103], a[112:115]
    v_mfma_f32_16x16x32_bf16 a[116:119], v[92:95], v[100:103], a[116:119]
    v_mfma_f32_16x16x32_bf16 a[120:123], v[76:79], v[104:107], a[120:123]
    buffer_load_dwordx4 v[212:215], v244, s[24:27], s56 offen offset:0 sc1
    v_mfma_f32_16x16x32_bf16 a[124:127], v[80:83], v[104:107], a[124:127]
    v_mfma_f32_16x16x32_bf16 a[128:131], v[84:87], v[104:107], a[128:131]
    v_mfma_f32_16x16x32_bf16 a[132:135], v[88:91], v[104:107], a[132:135]
    v_mfma_f32_16x16x32_bf16 a[136:139], v[92:95], v[104:107], a[136:139]
    buffer_load_dwordx4 v[132:135], v242, s[28:31], s57 offen sc1
    v_mfma_f32_16x16x32_bf16 a[140:143], v[76:79], v[108:111], a[140:143]
    v_mfma_f32_16x16x32_bf16 a[144:147], v[80:83], v[108:111], a[144:147]
    v_mfma_f32_16x16x32_bf16 a[148:151], v[84:87], v[108:111], a[148:151]
    v_mfma_f32_16x16x32_bf16 a[152:155], v[88:91], v[108:111], a[152:155]
    v_mfma_f32_16x16x32_bf16 a[156:159], v[92:95], v[108:111], a[156:159]
    s_waitcnt vmcnt(13)
    v_mfma_f32_16x16x32_bf16 a[160:163], v[0:3], v[36:39], a[160:163]
    s_cmp_eq_u32 s50, 3
    s_cselect_b32 s49, 11, 7
    s_mul_i32 s56, s49, 20480
    s_lshl_b32 s57, s49, 14
    v_mfma_f32_16x16x32_bf16 a[164:167], v[4:7], v[36:39], a[164:167]
    buffer_load_dwordx4 v[152:155], v243, s[24:27], s56 offen offset:0 sc1
    v_mfma_f32_16x16x32_bf16 a[168:171], v[8:11], v[36:39], a[168:171]
    v_mfma_f32_16x16x32_bf16 a[172:175], v[12:15], v[36:39], a[172:175]
    buffer_load_dwordx4 v[188:191], v239, s[8:11], s57 offen sc1
    v_mfma_f32_16x16x32_bf16 a[176:179], v[16:19], v[36:39], a[176:179]
    v_mfma_f32_16x16x32_bf16 a[180:183], v[0:3], v[40:43], a[180:183]
    v_mfma_f32_16x16x32_bf16 a[184:187], v[4:7], v[40:43], a[184:187]
    buffer_load_dwordx4 v[156:159], v243, s[24:27], s56 offen offset:1024 sc1
    v_mfma_f32_16x16x32_bf16 a[188:191], v[8:11], v[40:43], a[188:191]
    v_mfma_f32_16x16x32_bf16 a[192:195], v[12:15], v[40:43], a[192:195]
    v_mfma_f32_16x16x32_bf16 a[196:199], v[16:19], v[40:43], a[196:199]
    buffer_load_dwordx4 v[64:67], v240, s[8:11], s57 offen sc1
    v_mfma_f32_16x16x32_bf16 a[200:203], v[0:3], v[44:47], a[200:203]
    v_mfma_f32_16x16x32_bf16 a[204:207], v[4:7], v[44:47], a[204:207]
    v_mfma_f32_16x16x32_bf16 a[208:211], v[8:11], v[44:47], a[208:211]
    buffer_load_dwordx4 v[172:175], v239, s[28:31], s57 offen sc1
    v_mfma_f32_16x16x32_bf16 a[212:215], v[12:15], v[44:47], a[212:215]
    v_mfma_f32_16x16x32_bf16 a[216:219], v[16:19], v[44:47], a[216:219]
    v_mfma_f32_16x16x32_bf16 a[220:223], v[0:3], v[48:51], a[220:223]
    buffer_load_dwordx4 v[160:163], v243, s[24:27], s56 offen offset:2048 sc1
    v_mfma_f32_16x16x32_bf16 a[224:227], v[4:7], v[48:51], a[224:227]
    v_mfma_f32_16x16x32_bf16 a[228:231], v[8:11], v[48:51], a[228:231]
    v_mfma_f32_16x16x32_bf16 a[232:235], v[12:15], v[48:51], a[232:235]
    buffer_load_dwordx4 v[68:71], v241, s[8:11], s57 offen sc1
    v_mfma_f32_16x16x32_bf16 a[236:239], v[16:19], v[48:51], a[236:239]
    v_mfma_f32_16x16x32_bf16 a[80:83], v[0:3], v[20:23], a[80:83]
    v_mfma_f32_16x16x32_bf16 a[84:87], v[4:7], v[20:23], a[84:87]
    buffer_load_dwordx4 v[176:179], v240, s[28:31], s57 offen sc1
    v_mfma_f32_16x16x32_bf16 a[88:91], v[8:11], v[20:23], a[88:91]
    v_mfma_f32_16x16x32_bf16 a[92:95], v[12:15], v[20:23], a[92:95]
    v_mfma_f32_16x16x32_bf16 a[96:99], v[16:19], v[20:23], a[96:99]
    buffer_load_dwordx4 v[164:167], v243, s[24:27], s56 offen offset:3072 sc1
    v_mfma_f32_16x16x32_bf16 a[100:103], v[0:3], v[24:27], a[100:103]
    v_mfma_f32_16x16x32_bf16 a[104:107], v[4:7], v[24:27], a[104:107]
    v_mfma_f32_16x16x32_bf16 a[108:111], v[8:11], v[24:27], a[108:111]
    buffer_load_dwordx4 v[72:75], v242, s[8:11], s57 offen sc1
    v_mfma_f32_16x16x32_bf16 a[112:115], v[12:15], v[24:27], a[112:115]
    v_mfma_f32_16x16x32_bf16 a[116:119], v[16:19], v[24:27], a[116:119]
    v_mfma_f32_16x16x32_bf16 a[120:123], v[0:3], v[28:31], a[120:123]
    buffer_load_dwordx4 v[180:183], v241, s[28:31], s57 offen sc1
    v_mfma_f32_16x16x32_bf16 a[124:127], v[4:7], v[28:31], a[124:127]
    v_mfma_f32_16x16x32_bf16 a[128:131], v[8:11], v[28:31], a[128:131]
    v_mfma_f32_16x16x32_bf16 a[132:135], v[12:15], v[28:31], a[132:135]
    buffer_load_dwordx4 v[168:171], v244, s[24:27], s56 offen offset:0 sc1
    v_mfma_f32_16x16x32_bf16 a[136:139], v[16:19], v[28:31], a[136:139]
    v_mfma_f32_16x16x32_bf16 a[140:143], v[0:3], v[32:35], a[140:143]
    v_mfma_f32_16x16x32_bf16 a[144:147], v[4:7], v[32:35], a[144:147]
    buffer_load_dwordx4 v[184:187], v242, s[28:31], s57 offen sc1
    v_mfma_f32_16x16x32_bf16 a[148:151], v[8:11], v[32:35], a[148:151]
    v_mfma_f32_16x16x32_bf16 a[152:155], v[12:15], v[32:35], a[152:155]
    v_mfma_f32_16x16x32_bf16 a[156:159], v[16:19], v[32:35], a[156:159]
    s_waitcnt vmcnt(13)
    v_mfma_f32_16x16x32_bf16 a[160:163], v[52:55], v[136:139], a[160:163]
    s_cmp_eq_u32 s50, 0
    s_cselect_b32 s49, 12, 8
    s_mul_i32 s56, s49, 20480
    s_lshl_b32 s57, s49, 14
    v_mfma_f32_16x16x32_bf16 a[164:167], v[56:59], v[136:139], a[164:167]
    buffer_load_dwordx4 v[76:79], v243, s[24:27], s56 offen offset:0 sc1
    v_mfma_f32_16x16x32_bf16 a[168:171], v[60:63], v[136:139], a[168:171]
    v_mfma_f32_16x16x32_bf16 a[172:175], v[208:211], v[136:139], a[172:175]
    buffer_load_dwordx4 v[112:115], v239, s[8:11], s57 offen sc1
    v_mfma_f32_16x16x32_bf16 a[176:179], v[212:215], v[136:139], a[176:179]
    v_mfma_f32_16x16x32_bf16 a[180:183], v[52:55], v[140:143], a[180:183]
    v_mfma_f32_16x16x32_bf16 a[184:187], v[56:59], v[140:143], a[184:187]
    buffer_load_dwordx4 v[80:83], v243, s[24:27], s56 offen offset:1024 sc1
    v_mfma_f32_16x16x32_bf16 a[188:191], v[60:63], v[140:143], a[188:191]
    v_mfma_f32_16x16x32_bf16 a[192:195], v[208:211], v[140:143], a[192:195]
    v_mfma_f32_16x16x32_bf16 a[196:199], v[212:215], v[140:143], a[196:199]
    buffer_load_dwordx4 v[116:119], v240, s[8:11], s57 offen sc1
    v_mfma_f32_16x16x32_bf16 a[200:203], v[52:55], v[144:147], a[200:203]
    v_mfma_f32_16x16x32_bf16 a[204:207], v[56:59], v[144:147], a[204:207]
    v_mfma_f32_16x16x32_bf16 a[208:211], v[60:63], v[144:147], a[208:211]
    buffer_load_dwordx4 v[96:99], v239, s[28:31], s57 offen sc1
    v_mfma_f32_16x16x32_bf16 a[212:215], v[208:211], v[144:147], a[212:215]
    v_mfma_f32_16x16x32_bf16 a[216:219], v[212:215], v[144:147], a[216:219]
    v_mfma_f32_16x16x32_bf16 a[220:223], v[52:55], v[148:151], a[220:223]
    buffer_load_dwordx4 v[84:87], v243, s[24:27], s56 offen offset:2048 sc1
    v_mfma_f32_16x16x32_bf16 a[224:227], v[56:59], v[148:151], a[224:227]
    v_mfma_f32_16x16x32_bf16 a[228:231], v[60:63], v[148:151], a[228:231]
    v_mfma_f32_16x16x32_bf16 a[232:235], v[208:211], v[148:151], a[232:235]
    buffer_load_dwordx4 v[120:123], v241, s[8:11], s57 offen sc1
    v_mfma_f32_16x16x32_bf16 a[236:239], v[212:215], v[148:151], a[236:239]
    v_mfma_f32_16x16x32_bf16 a[80:83], v[52:55], v[216:219], a[80:83]
    v_mfma_f32_16x16x32_bf16 a[84:87], v[56:59], v[216:219], a[84:87]
    buffer_load_dwordx4 v[100:103], v240, s[28:31], s57 offen sc1
    v_mfma_f32_16x16x32_bf16 a[88:91], v[60:63], v[216:219], a[88:91]
    v_mfma_f32_16x16x32_bf16 a[92:95], v[208:211], v[216:219], a[92:95]
    v_mfma_f32_16x16x32_bf16 a[96:99], v[212:215], v[216:219], a[96:99]
    buffer_load_dwordx4 v[88:91], v243, s[24:27], s56 offen offset:3072 sc1
    v_mfma_f32_16x16x32_bf16 a[100:103], v[52:55], v[220:223], a[100:103]
    v_mfma_f32_16x16x32_bf16 a[104:107], v[56:59], v[220:223], a[104:107]
    v_mfma_f32_16x16x32_bf16 a[108:111], v[60:63], v[220:223], a[108:111]
    buffer_load_dwordx4 v[124:127], v242, s[8:11], s57 offen sc1
    v_mfma_f32_16x16x32_bf16 a[112:115], v[208:211], v[220:223], a[112:115]
    v_mfma_f32_16x16x32_bf16 a[116:119], v[212:215], v[220:223], a[116:119]
    v_mfma_f32_16x16x32_bf16 a[120:123], v[52:55], v[128:131], a[120:123]
    buffer_load_dwordx4 v[104:107], v241, s[28:31], s57 offen sc1
    v_mfma_f32_16x16x32_bf16 a[124:127], v[56:59], v[128:131], a[124:127]
    v_mfma_f32_16x16x32_bf16 a[128:131], v[60:63], v[128:131], a[128:131]
    v_mfma_f32_16x16x32_bf16 a[132:135], v[208:211], v[128:131], a[132:135]
    buffer_load_dwordx4 v[92:95], v244, s[24:27], s56 offen offset:0 sc1
    v_mfma_f32_16x16x32_bf16 a[136:139], v[212:215], v[128:131], a[136:139]
    v_mfma_f32_16x16x32_bf16 a[140:143], v[52:55], v[132:135], a[140:143]
    v_mfma_f32_16x16x32_bf16 a[144:147], v[56:59], v[132:135], a[144:147]
    buffer_load_dwordx4 v[108:111], v242, s[28:31], s57 offen sc1
    v_mfma_f32_16x16x32_bf16 a[148:151], v[60:63], v[132:135], a[148:151]
    v_mfma_f32_16x16x32_bf16 a[152:155], v[208:211], v[132:135], a[152:155]
    v_mfma_f32_16x16x32_bf16 a[156:159], v[212:215], v[132:135], a[156:159]
    s_waitcnt vmcnt(13)
    v_mfma_f32_16x16x32_bf16 a[160:163], v[152:155], v[188:191], a[160:163]
    s_cmp_eq_u32 s50, 1
    s_cselect_b32 s49, 13, 9
    s_mul_i32 s56, s49, 20480
    s_lshl_b32 s57, s49, 14
    v_mfma_f32_16x16x32_bf16 a[164:167], v[156:159], v[188:191], a[164:167]
    buffer_load_dwordx4 v[0:3], v243, s[24:27], s56 offen offset:0 sc1
    v_mfma_f32_16x16x32_bf16 a[168:171], v[160:163], v[188:191], a[168:171]
    v_mfma_f32_16x16x32_bf16 a[172:175], v[164:167], v[188:191], a[172:175]
    buffer_load_dwordx4 v[36:39], v239, s[8:11], s57 offen sc1
    v_mfma_f32_16x16x32_bf16 a[176:179], v[168:171], v[188:191], a[176:179]
    v_mfma_f32_16x16x32_bf16 a[180:183], v[152:155], v[64:67], a[180:183]
    v_mfma_f32_16x16x32_bf16 a[184:187], v[156:159], v[64:67], a[184:187]
    buffer_load_dwordx4 v[4:7], v243, s[24:27], s56 offen offset:1024 sc1
    v_mfma_f32_16x16x32_bf16 a[188:191], v[160:163], v[64:67], a[188:191]
    v_mfma_f32_16x16x32_bf16 a[192:195], v[164:167], v[64:67], a[192:195]
    v_mfma_f32_16x16x32_bf16 a[196:199], v[168:171], v[64:67], a[196:199]
    buffer_load_dwordx4 v[40:43], v240, s[8:11], s57 offen sc1
    v_mfma_f32_16x16x32_bf16 a[200:203], v[152:155], v[68:71], a[200:203]
    v_mfma_f32_16x16x32_bf16 a[204:207], v[156:159], v[68:71], a[204:207]
    v_mfma_f32_16x16x32_bf16 a[208:211], v[160:163], v[68:71], a[208:211]
    buffer_load_dwordx4 v[20:23], v239, s[28:31], s57 offen sc1
    v_mfma_f32_16x16x32_bf16 a[212:215], v[164:167], v[68:71], a[212:215]
    v_mfma_f32_16x16x32_bf16 a[216:219], v[168:171], v[68:71], a[216:219]
    v_mfma_f32_16x16x32_bf16 a[220:223], v[152:155], v[72:75], a[220:223]
    buffer_load_dwordx4 v[8:11], v243, s[24:27], s56 offen offset:2048 sc1
    v_mfma_f32_16x16x32_bf16 a[224:227], v[156:159], v[72:75], a[224:227]
    v_mfma_f32_16x16x32_bf16 a[228:231], v[160:163], v[72:75], a[228:231]
    v_mfma_f32_16x16x32_bf16 a[232:235], v[164:167], v[72:75], a[232:235]
    buffer_load_dwordx4 v[44:47], v241, s[8:11], s57 offen sc1
    v_mfma_f32_16x16x32_bf16 a[236:239], v[168:171], v[72:75], a[236:239]
    v_mfma_f32_16x16x32_bf16 a[80:83], v[152:155], v[172:175], a[80:83]
    v_mfma_f32_16x16x32_bf16 a[84:87], v[156:159], v[172:175], a[84:87]
    buffer_load_dwordx4 v[24:27], v240, s[28:31], s57 offen sc1
    v_mfma_f32_16x16x32_bf16 a[88:91], v[160:163], v[172:175], a[88:91]
    v_mfma_f32_16x16x32_bf16 a[92:95], v[164:167], v[172:175], a[92:95]
    v_mfma_f32_16x16x32_bf16 a[96:99], v[168:171], v[172:175], a[96:99]
    buffer_load_dwordx4 v[12:15], v243, s[24:27], s56 offen offset:3072 sc1
    v_mfma_f32_16x16x32_bf16 a[100:103], v[152:155], v[176:179], a[100:103]
    v_mfma_f32_16x16x32_bf16 a[104:107], v[156:159], v[176:179], a[104:107]
    v_mfma_f32_16x16x32_bf16 a[108:111], v[160:163], v[176:179], a[108:111]
    buffer_load_dwordx4 v[48:51], v242, s[8:11], s57 offen sc1
    v_mfma_f32_16x16x32_bf16 a[112:115], v[164:167], v[176:179], a[112:115]
    v_mfma_f32_16x16x32_bf16 a[116:119], v[168:171], v[176:179], a[116:119]
    v_mfma_f32_16x16x32_bf16 a[120:123], v[152:155], v[180:183], a[120:123]
    buffer_load_dwordx4 v[28:31], v241, s[28:31], s57 offen sc1
    v_mfma_f32_16x16x32_bf16 a[124:127], v[156:159], v[180:183], a[124:127]
    v_mfma_f32_16x16x32_bf16 a[128:131], v[160:163], v[180:183], a[128:131]
    v_mfma_f32_16x16x32_bf16 a[132:135], v[164:167], v[180:183], a[132:135]
    buffer_load_dwordx4 v[16:19], v244, s[24:27], s56 offen offset:0 sc1
    v_mfma_f32_16x16x32_bf16 a[136:139], v[168:171], v[180:183], a[136:139]
    v_mfma_f32_16x16x32_bf16 a[140:143], v[152:155], v[184:187], a[140:143]
    v_mfma_f32_16x16x32_bf16 a[144:147], v[156:159], v[184:187], a[144:147]
    buffer_load_dwordx4 v[32:35], v242, s[28:31], s57 offen sc1
    v_mfma_f32_16x16x32_bf16 a[148:151], v[160:163], v[184:187], a[148:151]
    v_mfma_f32_16x16x32_bf16 a[152:155], v[164:167], v[184:187], a[152:155]
    v_mfma_f32_16x16x32_bf16 a[156:159], v[168:171], v[184:187], a[156:159]
    s_waitcnt vmcnt(13)
    v_mfma_f32_16x16x32_bf16 a[160:163], v[76:79], v[112:115], a[160:163]
    s_cmp_eq_u32 s50, 2
    s_cselect_b32 s49, 14, 10
    s_mul_i32 s56, s49, 20480
    s_lshl_b32 s57, s49, 14
    v_mfma_f32_16x16x32_bf16 a[164:167], v[80:83], v[112:115], a[164:167]
    buffer_load_dwordx4 v[52:55], v243, s[24:27], s56 offen offset:0 sc1
    v_mfma_f32_16x16x32_bf16 a[168:171], v[84:87], v[112:115], a[168:171]
    v_mfma_f32_16x16x32_bf16 a[172:175], v[88:91], v[112:115], a[172:175]
    buffer_load_dwordx4 v[136:139], v239, s[8:11], s57 offen sc1
    v_mfma_f32_16x16x32_bf16 a[176:179], v[92:95], v[112:115], a[176:179]
    v_mfma_f32_16x16x32_bf16 a[180:183], v[76:79], v[116:119], a[180:183]
    v_mfma_f32_16x16x32_bf16 a[184:187], v[80:83], v[116:119], a[184:187]
    buffer_load_dwordx4 v[56:59], v243, s[24:27], s56 offen offset:1024 sc1
    v_mfma_f32_16x16x32_bf16 a[188:191], v[84:87], v[116:119], a[188:191]
    v_mfma_f32_16x16x32_bf16 a[192:195], v[88:91], v[116:119], a[192:195]
    v_mfma_f32_16x16x32_bf16 a[196:199], v[92:95], v[116:119], a[196:199]
    buffer_load_dwordx4 v[140:143], v240, s[8:11], s57 offen sc1
    v_mfma_f32_16x16x32_bf16 a[200:203], v[76:79], v[120:123], a[200:203]
    v_mfma_f32_16x16x32_bf16 a[204:207], v[80:83], v[120:123], a[204:207]
    v_mfma_f32_16x16x32_bf16 a[208:211], v[84:87], v[120:123], a[208:211]
    buffer_load_dwordx4 v[216:219], v239, s[28:31], s57 offen sc1
    v_mfma_f32_16x16x32_bf16 a[212:215], v[88:91], v[120:123], a[212:215]
    v_mfma_f32_16x16x32_bf16 a[216:219], v[92:95], v[120:123], a[216:219]
    v_mfma_f32_16x16x32_bf16 a[220:223], v[76:79], v[124:127], a[220:223]
    buffer_load_dwordx4 v[60:63], v243, s[24:27], s56 offen offset:2048 sc1
    v_mfma_f32_16x16x32_bf16 a[224:227], v[80:83], v[124:127], a[224:227]
    v_mfma_f32_16x16x32_bf16 a[228:231], v[84:87], v[124:127], a[228:231]
    v_mfma_f32_16x16x32_bf16 a[232:235], v[88:91], v[124:127], a[232:235]
    buffer_load_dwordx4 v[144:147], v241, s[8:11], s57 offen sc1
    v_mfma_f32_16x16x32_bf16 a[236:239], v[92:95], v[124:127], a[236:239]
    v_mfma_f32_16x16x32_bf16 a[80:83], v[76:79], v[96:99], a[80:83]
    v_mfma_f32_16x16x32_bf16 a[84:87], v[80:83], v[96:99], a[84:87]
    buffer_load_dwordx4 v[220:223], v240, s[28:31], s57 offen sc1
    v_mfma_f32_16x16x32_bf16 a[88:91], v[84:87], v[96:99], a[88:91]
    v_mfma_f32_16x16x32_bf16 a[92:95], v[88:91], v[96:99], a[92:95]
    v_mfma_f32_16x16x32_bf16 a[96:99], v[92:95], v[96:99], a[96:99]
    buffer_load_dwordx4 v[208:211], v243, s[24:27], s56 offen offset:3072 sc1
    v_mfma_f32_16x16x32_bf16 a[100:103], v[76:79], v[100:103], a[100:103]
    v_mfma_f32_16x16x32_bf16 a[104:107], v[80:83], v[100:103], a[104:107]
    v_mfma_f32_16x16x32_bf16 a[108:111], v[84:87], v[100:103], a[108:111]
    buffer_load_dwordx4 v[148:151], v242, s[8:11], s57 offen sc1
    v_mfma_f32_16x16x32_bf16 a[112:115], v[88:91], v[100:103], a[112:115]
    v_mfma_f32_16x16x32_bf16 a[116:119], v[92:95], v[100:103], a[116:119]
    v_mfma_f32_16x16x32_bf16 a[120:123], v[76:79], v[104:107], a[120:123]
    buffer_load_dwordx4 v[128:131], v241, s[28:31], s57 offen sc1
    v_mfma_f32_16x16x32_bf16 a[124:127], v[80:83], v[104:107], a[124:127]
    v_mfma_f32_16x16x32_bf16 a[128:131], v[84:87], v[104:107], a[128:131]
    v_mfma_f32_16x16x32_bf16 a[132:135], v[88:91], v[104:107], a[132:135]
    buffer_load_dwordx4 v[212:215], v244, s[24:27], s56 offen offset:0 sc1
    v_mfma_f32_16x16x32_bf16 a[136:139], v[92:95], v[104:107], a[136:139]
    v_mfma_f32_16x16x32_bf16 a[140:143], v[76:79], v[108:111], a[140:143]
    v_mfma_f32_16x16x32_bf16 a[144:147], v[80:83], v[108:111], a[144:147]
    buffer_load_dwordx4 v[132:135], v242, s[28:31], s57 offen sc1
    v_mfma_f32_16x16x32_bf16 a[148:151], v[84:87], v[108:111], a[148:151]
    v_mfma_f32_16x16x32_bf16 a[152:155], v[88:91], v[108:111], a[152:155]
    v_mfma_f32_16x16x32_bf16 a[156:159], v[92:95], v[108:111], a[156:159]
    s_waitcnt vmcnt(13)
    v_mfma_f32_16x16x32_bf16 a[160:163], v[0:3], v[36:39], a[160:163]
    s_cmp_eq_u32 s50, 3
    s_cselect_b32 s49, 15, 11
    s_mul_i32 s56, s49, 20480
    s_lshl_b32 s57, s49, 14
    v_mfma_f32_16x16x32_bf16 a[164:167], v[4:7], v[36:39], a[164:167]
    buffer_load_dwordx4 v[152:155], v243, s[24:27], s56 offen offset:0 sc1
    v_mfma_f32_16x16x32_bf16 a[168:171], v[8:11], v[36:39], a[168:171]
    v_mfma_f32_16x16x32_bf16 a[172:175], v[12:15], v[36:39], a[172:175]
    buffer_load_dwordx4 v[188:191], v239, s[8:11], s57 offen sc1
    v_mfma_f32_16x16x32_bf16 a[176:179], v[16:19], v[36:39], a[176:179]
    v_mfma_f32_16x16x32_bf16 a[180:183], v[0:3], v[40:43], a[180:183]
    v_mfma_f32_16x16x32_bf16 a[184:187], v[4:7], v[40:43], a[184:187]
    buffer_load_dwordx4 v[156:159], v243, s[24:27], s56 offen offset:1024 sc1
    v_mfma_f32_16x16x32_bf16 a[188:191], v[8:11], v[40:43], a[188:191]
    v_mfma_f32_16x16x32_bf16 a[192:195], v[12:15], v[40:43], a[192:195]
    v_mfma_f32_16x16x32_bf16 a[196:199], v[16:19], v[40:43], a[196:199]
    buffer_load_dwordx4 v[64:67], v240, s[8:11], s57 offen sc1
    v_mfma_f32_16x16x32_bf16 a[200:203], v[0:3], v[44:47], a[200:203]
    v_mfma_f32_16x16x32_bf16 a[204:207], v[4:7], v[44:47], a[204:207]
    v_mfma_f32_16x16x32_bf16 a[208:211], v[8:11], v[44:47], a[208:211]
    buffer_load_dwordx4 v[172:175], v239, s[28:31], s57 offen sc1
    v_mfma_f32_16x16x32_bf16 a[212:215], v[12:15], v[44:47], a[212:215]
    v_mfma_f32_16x16x32_bf16 a[216:219], v[16:19], v[44:47], a[216:219]
    v_mfma_f32_16x16x32_bf16 a[220:223], v[0:3], v[48:51], a[220:223]
    buffer_load_dwordx4 v[160:163], v243, s[24:27], s56 offen offset:2048 sc1
    v_mfma_f32_16x16x32_bf16 a[224:227], v[4:7], v[48:51], a[224:227]
    v_mfma_f32_16x16x32_bf16 a[228:231], v[8:11], v[48:51], a[228:231]
    v_mfma_f32_16x16x32_bf16 a[232:235], v[12:15], v[48:51], a[232:235]
    buffer_load_dwordx4 v[68:71], v241, s[8:11], s57 offen sc1
    v_mfma_f32_16x16x32_bf16 a[236:239], v[16:19], v[48:51], a[236:239]
    v_mfma_f32_16x16x32_bf16 a[80:83], v[0:3], v[20:23], a[80:83]
    v_mfma_f32_16x16x32_bf16 a[84:87], v[4:7], v[20:23], a[84:87]
    buffer_load_dwordx4 v[176:179], v240, s[28:31], s57 offen sc1
    v_mfma_f32_16x16x32_bf16 a[88:91], v[8:11], v[20:23], a[88:91]
    v_mfma_f32_16x16x32_bf16 a[92:95], v[12:15], v[20:23], a[92:95]
    v_mfma_f32_16x16x32_bf16 a[96:99], v[16:19], v[20:23], a[96:99]
    buffer_load_dwordx4 v[164:167], v243, s[24:27], s56 offen offset:3072 sc1
    v_mfma_f32_16x16x32_bf16 a[100:103], v[0:3], v[24:27], a[100:103]
    v_mfma_f32_16x16x32_bf16 a[104:107], v[4:7], v[24:27], a[104:107]
    v_mfma_f32_16x16x32_bf16 a[108:111], v[8:11], v[24:27], a[108:111]
    buffer_load_dwordx4 v[72:75], v242, s[8:11], s57 offen sc1
    v_mfma_f32_16x16x32_bf16 a[112:115], v[12:15], v[24:27], a[112:115]
    v_mfma_f32_16x16x32_bf16 a[116:119], v[16:19], v[24:27], a[116:119]
    v_mfma_f32_16x16x32_bf16 a[120:123], v[0:3], v[28:31], a[120:123]
    buffer_load_dwordx4 v[180:183], v241, s[28:31], s57 offen sc1
    v_mfma_f32_16x16x32_bf16 a[124:127], v[4:7], v[28:31], a[124:127]
    v_mfma_f32_16x16x32_bf16 a[128:131], v[8:11], v[28:31], a[128:131]
    v_mfma_f32_16x16x32_bf16 a[132:135], v[12:15], v[28:31], a[132:135]
    buffer_load_dwordx4 v[168:171], v244, s[24:27], s56 offen offset:0 sc1
    v_mfma_f32_16x16x32_bf16 a[136:139], v[16:19], v[28:31], a[136:139]
    v_mfma_f32_16x16x32_bf16 a[140:143], v[0:3], v[32:35], a[140:143]
    v_mfma_f32_16x16x32_bf16 a[144:147], v[4:7], v[32:35], a[144:147]
    buffer_load_dwordx4 v[184:187], v242, s[28:31], s57 offen sc1
    v_mfma_f32_16x16x32_bf16 a[148:151], v[8:11], v[32:35], a[148:151]
    v_mfma_f32_16x16x32_bf16 a[152:155], v[12:15], v[32:35], a[152:155]
    v_mfma_f32_16x16x32_bf16 a[156:159], v[16:19], v[32:35], a[156:159]
    s_waitcnt vmcnt(13)
    v_mfma_f32_16x16x32_bf16 a[160:163], v[52:55], v[136:139], a[160:163]
    s_cmp_le_u32 s50, 0
    s_cselect_b32 s49, 13, 12
    s_mul_i32 s56, s49, 20480
    s_lshl_b32 s57, s49, 14
    v_mfma_f32_16x16x32_bf16 a[164:167], v[56:59], v[136:139], a[164:167]
    buffer_load_dwordx4 v[76:79], v243, s[24:27], s56 offen offset:0 sc1
    v_mfma_f32_16x16x32_bf16 a[168:171], v[60:63], v[136:139], a[168:171]
    v_mfma_f32_16x16x32_bf16 a[172:175], v[208:211], v[136:139], a[172:175]
    buffer_load_dwordx4 v[112:115], v239, s[8:11], s57 offen sc1
    v_mfma_f32_16x16x32_bf16 a[176:179], v[212:215], v[136:139], a[176:179]
    v_mfma_f32_16x16x32_bf16 a[180:183], v[52:55], v[140:143], a[180:183]
    v_mfma_f32_16x16x32_bf16 a[184:187], v[56:59], v[140:143], a[184:187]
    buffer_load_dwordx4 v[80:83], v243, s[24:27], s56 offen offset:1024 sc1
    v_mfma_f32_16x16x32_bf16 a[188:191], v[60:63], v[140:143], a[188:191]
    v_mfma_f32_16x16x32_bf16 a[192:195], v[208:211], v[140:143], a[192:195]
    v_mfma_f32_16x16x32_bf16 a[196:199], v[212:215], v[140:143], a[196:199]
    buffer_load_dwordx4 v[116:119], v240, s[8:11], s57 offen sc1
    v_mfma_f32_16x16x32_bf16 a[200:203], v[52:55], v[144:147], a[200:203]
    v_mfma_f32_16x16x32_bf16 a[204:207], v[56:59], v[144:147], a[204:207]
    v_mfma_f32_16x16x32_bf16 a[208:211], v[60:63], v[144:147], a[208:211]
    buffer_load_dwordx4 v[96:99], v239, s[28:31], s57 offen sc1
    v_mfma_f32_16x16x32_bf16 a[212:215], v[208:211], v[144:147], a[212:215]
    v_mfma_f32_16x16x32_bf16 a[216:219], v[212:215], v[144:147], a[216:219]
    v_mfma_f32_16x16x32_bf16 a[220:223], v[52:55], v[148:151], a[220:223]
    buffer_load_dwordx4 v[84:87], v243, s[24:27], s56 offen offset:2048 sc1
    v_mfma_f32_16x16x32_bf16 a[224:227], v[56:59], v[148:151], a[224:227]
    v_mfma_f32_16x16x32_bf16 a[228:231], v[60:63], v[148:151], a[228:231]
    v_mfma_f32_16x16x32_bf16 a[232:235], v[208:211], v[148:151], a[232:235]
    buffer_load_dwordx4 v[120:123], v241, s[8:11], s57 offen sc1
    v_mfma_f32_16x16x32_bf16 a[236:239], v[212:215], v[148:151], a[236:239]
    v_mfma_f32_16x16x32_bf16 a[80:83], v[52:55], v[216:219], a[80:83]
    v_mfma_f32_16x16x32_bf16 a[84:87], v[56:59], v[216:219], a[84:87]
    buffer_load_dwordx4 v[100:103], v240, s[28:31], s57 offen sc1
    v_mfma_f32_16x16x32_bf16 a[88:91], v[60:63], v[216:219], a[88:91]
    v_mfma_f32_16x16x32_bf16 a[92:95], v[208:211], v[216:219], a[92:95]
    v_mfma_f32_16x16x32_bf16 a[96:99], v[212:215], v[216:219], a[96:99]
    buffer_load_dwordx4 v[88:91], v243, s[24:27], s56 offen offset:3072 sc1
    v_mfma_f32_16x16x32_bf16 a[100:103], v[52:55], v[220:223], a[100:103]
    v_mfma_f32_16x16x32_bf16 a[104:107], v[56:59], v[220:223], a[104:107]
    v_mfma_f32_16x16x32_bf16 a[108:111], v[60:63], v[220:223], a[108:111]
    buffer_load_dwordx4 v[124:127], v242, s[8:11], s57 offen sc1
    v_mfma_f32_16x16x32_bf16 a[112:115], v[208:211], v[220:223], a[112:115]
    v_mfma_f32_16x16x32_bf16 a[116:119], v[212:215], v[220:223], a[116:119]
    v_mfma_f32_16x16x32_bf16 a[120:123], v[52:55], v[128:131], a[120:123]
    buffer_load_dwordx4 v[104:107], v241, s[28:31], s57 offen sc1
    v_mfma_f32_16x16x32_bf16 a[124:127], v[56:59], v[128:131], a[124:127]
    v_mfma_f32_16x16x32_bf16 a[128:131], v[60:63], v[128:131], a[128:131]
    v_mfma_f32_16x16x32_bf16 a[132:135], v[208:211], v[128:131], a[132:135]
    buffer_load_dwordx4 v[92:95], v244, s[24:27], s56 offen offset:0 sc1
    v_mfma_f32_16x16x32_bf16 a[136:139], v[212:215], v[128:131], a[136:139]
L_padD_1:
    s_cbranch_execz L_padD_2
    v_mfma_f32_16x16x32_bf16 a[140:143], v[52:55], v[132:135], a[140:143]
    v_mfma_f32_16x16x32_bf16 a[144:147], v[56:59], v[132:135], a[144:147]
    buffer_load_dwordx4 v[108:111], v242, s[28:31], s57 offen sc1
    v_mfma_f32_16x16x32_bf16 a[148:151], v[60:63], v[132:135], a[148:151]
    v_mfma_f32_16x16x32_bf16 a[152:155], v[208:211], v[132:135], a[152:155]
    v_mfma_f32_16x16x32_bf16 a[156:159], v[212:215], v[132:135], a[156:159]
    s_waitcnt vmcnt(13)
    v_mfma_f32_16x16x32_bf16 a[160:163], v[152:155], v[188:191], a[160:163]
    s_cmp_le_u32 s50, 1
    s_cselect_b32 s49, 14, 13
    s_mul_i32 s56, s49, 20480
    s_lshl_b32 s57, s49, 14
    v_mfma_f32_16x16x32_bf16 a[164:167], v[156:159], v[188:191], a[164:167]
    buffer_load_dwordx4 v[0:3], v243, s[24:27], s56 offen offset:0 sc1
    v_mfma_f32_16x16x32_bf16 a[168:171], v[160:163], v[188:191], a[168:171]
    v_mfma_f32_16x16x32_bf16 a[172:175], v[164:167], v[188:191], a[172:175]
    buffer_load_dwordx4 v[36:39], v239, s[8:11], s57 offen sc1
    v_mfma_f32_16x16x32_bf16 a[176:179], v[168:171], v[188:191], a[176:179]
    v_mfma_f32_16x16x32_bf16 a[180:183], v[152:155], v[64:67], a[180:183]
    v_mfma_f32_16x16x32_bf16 a[184:187], v[156:159], v[64:67], a[184:187]
    buffer_load_dwordx4 v[4:7], v243, s[24:27], s56 offen offset:1024 sc1
    v_mfma_f32_16x16x32_bf16 a[188:191], v[160:163], v[64:67], a[188:191]
    v_mfma_f32_16x16x32_bf16 a[192:195], v[164:167], v[64:67], a[192:195]
    v_mfma_f32_16x16x32_bf16 a[196:199], v[168:171], v[64:67], a[196:199]
    buffer_load_dwordx4 v[40:43], v240, s[8:11], s57 offen sc1
    v_mfma_f32_16x16x32_bf16 a[200:203], v[152:155], v[68:71], a[200:203]
    v_mfma_f32_16x16x32_bf16 a[204:207], v[156:159], v[68:71], a[204:207]
    v_mfma_f32_16x16x32_bf16 a[208:211], v[160:163], v[68:71], a[208:211]
    buffer_load_dwordx4 v[20:23], v239, s[28:31], s57 offen sc1
    v_mfma_f32_16x16x32_bf16 a[212:215], v[164:167], v[68:71], a[212:215]
    v_mfma_f32_16x16x32_bf16 a[216:219], v[168:171], v[68:71], a[216:219]
    v_mfma_f32_16x16x32_bf16 a[220:223], v[152:155], v[72:75], a[220:223]
    buffer_load_dwordx4 v[8:11], v243, s[24:27], s56 offen offset:2048 sc1
    v_mfma_f32_16x16x32_bf16 a[224:227], v[156:159], v[72:75], a[224:227]
    v_mfma_f32_16x16x32_bf16 a[228:231], v[160:163], v[72:75], a[228:231]
    v_mfma_f32_16x16x32_bf16 a[232:235], v[164:167], v[72:75], a[232:235]
    buffer_load_dwordx4 v[44:47], v241, s[8:11], s57 offen sc1
    v_mfma_f32_16x16x32_bf16 a[236:239], v[168:171], v[72:75], a[236:239]
    v_mfma_f32_16x16x32_bf16 a[80:83], v[152:155], v[172:175], a[80:83]
    v_mfma_f32_16x16x32_bf16 a[84:87], v[156:159], v[172:175], a[84:87]
    buffer_load_dwordx4 v[24:27], v240, s[28:31], s57 offen sc1
    v_mfma_f32_16x16x32_bf16 a[88:91], v[160:163], v[172:175], a[88:91]
    v_mfma_f32_16x16x32_bf16 a[92:95], v[164:167], v[172:175], a[92:95]
    v_mfma_f32_16x16x32_bf16 a[96:99], v[168:171], v[172:175], a[96:99]
    buffer_load_dwordx4 v[12:15], v243, s[24:27], s56 offen offset:3072 sc1
    v_mfma_f32_16x16x32_bf16 a[100:103], v[152:155], v[176:179], a[100:103]
    v_mfma_f32_16x16x32_bf16 a[104:107], v[156:159], v[176:179], a[104:107]
    v_mfma_f32_16x16x32_bf16 a[108:111], v[160:163], v[176:179], a[108:111]
    buffer_load_dwordx4 v[48:51], v242, s[8:11], s57 offen sc1
    v_mfma_f32_16x16x32_bf16 a[112:115], v[164:167], v[176:179], a[112:115]
    v_mfma_f32_16x16x32_bf16 a[116:119], v[168:171], v[176:179], a[116:119]
    v_mfma_f32_16x16x32_bf16 a[120:123], v[152:155], v[180:183], a[120:123]
    buffer_load_dwordx4 v[28:31], v241, s[28:31], s57 offen sc1
    v_mfma_f32_16x16x32_bf16 a[124:127], v[156:159], v[180:183], a[124:127]
    v_mfma_f32_16x16x32_bf16 a[128:131], v[160:163], v[180:183], a[128:131]
    v_mfma_f32_16x16x32_bf16 a[132:135], v[164:167], v[180:183], a[132:135]
    buffer_load_dwordx4 v[16:19], v244, s[24:27], s56 offen offset:0 sc1
    v_mfma_f32_16x16x32_bf16 a[136:139], v[168:171], v[180:183], a[136:139]
    v_mfma_f32_16x16x32_bf16 a[140:143], v[152:155], v[184:187], a[140:143]
    v_mfma_f32_16x16x32_bf16 a[144:147], v[156:159], v[184:187], a[144:147]
    buffer_load_dwordx4 v[32:35], v242, s[28:31], s57 offen sc1
    v_mfma_f32_16x16x32_bf16 a[148:151], v[160:163], v[184:187], a[148:151]
    v_mfma_f32_16x16x32_bf16 a[152:155], v[164:167], v[184:187], a[152:155]
    v_mfma_f32_16x16x32_bf16 a[156:159], v[168:171], v[184:187], a[156:159]
    s_waitcnt vmcnt(13)
    v_mfma_f32_16x16x32_bf16 a[160:163], v[76:79], v[112:115], a[160:163]
    s_cmp_le_u32 s50, 2
    s_cselect_b32 s49, 15, 14
    s_mul_i32 s56, s49, 20480
    s_lshl_b32 s57, s49, 14
    v_mfma_f32_16x16x32_bf16 a[164:167], v[80:83], v[112:115], a[164:167]
    buffer_load_dwordx4 v[52:55], v243, s[24:27], s56 offen offset:0 sc1
    v_mfma_f32_16x16x32_bf16 a[168:171], v[84:87], v[112:115], a[168:171]
    v_mfma_f32_16x16x32_bf16 a[172:175], v[88:91], v[112:115], a[172:175]
    buffer_load_dwordx4 v[136:139], v239, s[8:11], s57 offen sc1
    v_mfma_f32_16x16x32_bf16 a[176:179], v[92:95], v[112:115], a[176:179]
    v_mfma_f32_16x16x32_bf16 a[180:183], v[76:79], v[116:119], a[180:183]
    v_mfma_f32_16x16x32_bf16 a[184:187], v[80:83], v[116:119], a[184:187]
    buffer_load_dwordx4 v[56:59], v243, s[24:27], s56 offen offset:1024 sc1
    v_mfma_f32_16x16x32_bf16 a[188:191], v[84:87], v[116:119], a[188:191]
    v_mfma_f32_16x16x32_bf16 a[192:195], v[88:91], v[116:119], a[192:195]
    v_mfma_f32_16x16x32_bf16 a[196:199], v[92:95], v[116:119], a[196:199]
    buffer_load_dwordx4 v[140:143], v240, s[8:11], s57 offen sc1
    v_mfma_f32_16x16x32_bf16 a[200:203], v[76:79], v[120:123], a[200:203]
    v_mfma_f32_16x16x32_bf16 a[204:207], v[80:83], v[120:123], a[204:207]
    v_mfma_f32_16x16x32_bf16 a[208:211], v[84:87], v[120:123], a[208:211]
    buffer_load_dwordx4 v[216:219], v239, s[28:31], s57 offen sc1
    v_mfma_f32_16x16x32_bf16 a[212:215], v[88:91], v[120:123], a[212:215]
    v_mfma_f32_16x16x32_bf16 a[216:219], v[92:95], v[120:123], a[216:219]
    v_mfma_f32_16x16x32_bf16 a[220:223], v[76:79], v[124:127], a[220:223]
    buffer_load_dwordx4 v[60:63], v243, s[24:27], s56 offen offset:2048 sc1
    v_mfma_f32_16x16x32_bf16 a[224:227], v[80:83], v[124:127], a[224:227]
    v_mfma_f32_16x16x32_bf16 a[228:231], v[84:87], v[124:127], a[228:231]
    v_mfma_f32_16x16x32_bf16 a[232:235], v[88:91], v[124:127], a[232:235]
    buffer_load_dwordx4 v[144:147], v241, s[8:11], s57 offen sc1
    v_mfma_f32_16x16x32_bf16 a[236:239], v[92:95], v[124:127], a[236:239]
    v_mfma_f32_16x16x32_bf16 a[80:83], v[76:79], v[96:99], a[80:83]
    v_mfma_f32_16x16x32_bf16 a[84:87], v[80:83], v[96:99], a[84:87]
    buffer_load_dwordx4 v[220:223], v240, s[28:31], s57 offen sc1
    v_mfma_f32_16x16x32_bf16 a[88:91], v[84:87], v[96:99], a[88:91]
    v_mfma_f32_16x16x32_bf16 a[92:95], v[88:91], v[96:99], a[92:95]
    v_mfma_f32_16x16x32_bf16 a[96:99], v[92:95], v[96:99], a[96:99]
    buffer_load_dwordx4 v[208:211], v243, s[24:27], s56 offen offset:3072 sc1
    v_mfma_f32_16x16x32_bf16 a[100:103], v[76:79], v[100:103], a[100:103]
    v_mfma_f32_16x16x32_bf16 a[104:107], v[80:83], v[100:103], a[104:107]
    v_mfma_f32_16x16x32_bf16 a[108:111], v[84:87], v[100:103], a[108:111]
    buffer_load_dwordx4 v[148:151], v242, s[8:11], s57 offen sc1
    v_mfma_f32_16x16x32_bf16 a[112:115], v[88:91], v[100:103], a[112:115]
    v_mfma_f32_16x16x32_bf16 a[116:119], v[92:95], v[100:103], a[116:119]
    v_mfma_f32_16x16x32_bf16 a[120:123], v[76:79], v[104:107], a[120:123]
    buffer_load_dwordx4 v[128:131], v241, s[28:31], s57 offen sc1
    v_mfma_f32_16x16x32_bf16 a[124:127], v[80:83], v[104:107], a[124:127]
    v_mfma_f32_16x16x32_bf16 a[128:131], v[84:87], v[104:107], a[128:131]
    v_mfma_f32_16x16x32_bf16 a[132:135], v[88:91], v[104:107], a[132:135]
    buffer_load_dwordx4 v[212:215], v244, s[24:27], s56 offen offset:0 sc1
    v_mfma_f32_16x16x32_bf16 a[136:139], v[92:95], v[104:107], a[136:139]
    v_mfma_f32_16x16x32_bf16 a[140:143], v[76:79], v[108:111], a[140:143]
    v_mfma_f32_16x16x32_bf16 a[144:147], v[80:83], v[108:111], a[144:147]
    buffer_load_dwordx4 v[132:135], v242, s[28:31], s57 offen sc1
    v_mfma_f32_16x16x32_bf16 a[148:151], v[84:87], v[108:111], a[148:151]
    v_mfma_f32_16x16x32_bf16 a[152:155], v[88:91], v[108:111], a[152:155]
    v_mfma_f32_16x16x32_bf16 a[156:159], v[92:95], v[108:111], a[156:159]
    s_waitcnt vmcnt(13)
    v_mfma_f32_16x16x32_bf16 a[160:163], v[0:3], v[36:39], a[160:163]
    s_mov_b32 s49, 7
    s_mul_i32 s56, s49, 20480
    s_lshl_b32 s57, s49, 14
    v_mfma_f32_16x16x32_bf16 a[164:167], v[4:7], v[36:39], a[164:167]
    buffer_load_dwordx4 v[152:155], v243, s[20:23], s56 offen offset:0 sc1
    v_mfma_f32_16x16x32_bf16 a[168:171], v[8:11], v[36:39], a[168:171]
    v_mfma_f32_16x16x32_bf16 a[172:175], v[12:15], v[36:39], a[172:175]
    v_mfma_f32_16x16x32_bf16 a[176:179], v[16:19], v[36:39], a[176:179]
    v_mfma_f32_16x16x32_bf16 a[180:183], v[0:3], v[40:43], a[180:183]
    buffer_load_dwordx4 v[156:159], v243, s[20:23], s56 offen offset:1024 sc1
    v_mfma_f32_16x16x32_bf16 a[184:187], v[4:7], v[40:43], a[184:187]
    v_mfma_f32_16x16x32_bf16 a[188:191], v[8:11], v[40:43], a[188:191]
    v_mfma_f32_16x16x32_bf16 a[192:195], v[12:15], v[40:43], a[192:195]
    v_mfma_f32_16x16x32_bf16 a[196:199], v[16:19], v[40:43], a[196:199]
    buffer_load_dwordx4 v[172:175], v239, s[16:19], s57 offen sc1
    v_mfma_f32_16x16x32_bf16 a[200:203], v[0:3], v[44:47], a[200:203]
    v_mfma_f32_16x16x32_bf16 a[204:207], v[4:7], v[44:47], a[204:207]
    v_mfma_f32_16x16x32_bf16 a[208:211], v[8:11], v[44:47], a[208:211]
    v_mfma_f32_16x16x32_bf16 a[212:215], v[12:15], v[44:47], a[212:215]
    buffer_load_dwordx4 v[160:163], v243, s[20:23], s56 offen offset:2048 sc1
    v_mfma_f32_16x16x32_bf16 a[216:219], v[16:19], v[44:47], a[216:219]
    v_mfma_f32_16x16x32_bf16 a[220:223], v[0:3], v[48:51], a[220:223]
    v_mfma_f32_16x16x32_bf16 a[224:227], v[4:7], v[48:51], a[224:227]
    v_mfma_f32_16x16x32_bf16 a[228:231], v[8:11], v[48:51], a[228:231]
    buffer_load_dwordx4 v[176:179], v240, s[16:19], s57 offen sc1
    v_mfma_f32_16x16x32_bf16 a[232:235], v[12:15], v[48:51], a[232:235]
    v_mfma_f32_16x16x32_bf16 a[236:239], v[16:19], v[48:51], a[236:239]
    v_mfma_f32_16x16x32_bf16 a[80:83], v[0:3], v[20:23], a[80:83]
    v_mfma_f32_16x16x32_bf16 a[84:87], v[4:7], v[20:23], a[84:87]
    v_mfma_f32_16x16x32_bf16 a[88:91], v[8:11], v[20:23], a[88:91]
    buffer_load_dwordx4 v[164:167], v243, s[20:23], s56 offen offset:3072 sc1
    v_mfma_f32_16x16x32_bf16 a[92:95], v[12:15], v[20:23], a[92:95]
    v_mfma_f32_16x16x32_bf16 a[96:99], v[16:19], v[20:23], a[96:99]
    v_mfma_f32_16x16x32_bf16 a[100:103], v[0:3], v[24:27], a[100:103]
    v_mfma_f32_16x16x32_bf16 a[104:107], v[4:7], v[24:27], a[104:107]
    buffer_load_dwordx4 v[180:183], v241, s[16:19], s57 offen sc1
    v_mfma_f32_16x16x32_bf16 a[108:111], v[8:11], v[24:27], a[108:111]
    v_mfma_f32_16x16x32_bf16 a[112:115], v[12:15], v[24:27], a[112:115]
    v_mfma_f32_16x16x32_bf16 a[116:119], v[16:19], v[24:27], a[116:119]
    v_mfma_f32_16x16x32_bf16 a[120:123], v[0:3], v[28:31], a[120:123]
    buffer_load_dwordx4 v[168:171], v244, s[20:23], s56 offen offset:0 sc1
    v_mfma_f32_16x16x32_bf16 a[124:127], v[4:7], v[28:31], a[124:127]
    v_mfma_f32_16x16x32_bf16 a[128:131], v[8:11], v[28:31], a[128:131]
    v_mfma_f32_16x16x32_bf16 a[132:135], v[12:15], v[28:31], a[132:135]
    v_mfma_f32_16x16x32_bf16 a[136:139], v[16:19], v[28:31], a[136:139]
    buffer_load_dwordx4 v[184:187], v242, s[16:19], s57 offen sc1
    v_mfma_f32_16x16x32_bf16 a[140:143], v[0:3], v[32:35], a[140:143]
    v_mfma_f32_16x16x32_bf16 a[144:147], v[4:7], v[32:35], a[144:147]
    v_mfma_f32_16x16x32_bf16 a[148:151], v[8:11], v[32:35], a[148:151]
    v_mfma_f32_16x16x32_bf16 a[152:155], v[12:15], v[32:35], a[152:155]
    v_mfma_f32_16x16x32_bf16 a[156:159], v[16:19], v[32:35], a[156:159]
    s_waitcnt vmcnt(9)
    v_mfma_f32_16x16x32_bf16 a[180:183], v[52:55], v[140:143], a[180:183]
    s_mov_b32 s49, 8
    s_mul_i32 s56, s49, 20480
    s_lshl_b32 s57, s49, 14
    v_mfma_f32_16x16x32_bf16 a[184:187], v[56:59], v[140:143], a[184:187]
    buffer_load_dwordx4 v[76:79], v243, s[20:23], s56 offen offset:0 sc1
    v_mfma_f32_16x16x32_bf16 a[188:191], v[60:63], v[140:143], a[188:191]
    v_mfma_f32_16x16x32_bf16 a[192:195], v[208:211], v[140:143], a[192:195]
    v_mfma_f32_16x16x32_bf16 a[196:199], v[212:215], v[140:143], a[196:199]
    v_mfma_f32_16x16x32_bf16 a[200:203], v[52:55], v[144:147], a[200:203]
    buffer_load_dwordx4 v[80:83], v243, s[20:23], s56 offen offset:1024 sc1
    v_mfma_f32_16x16x32_bf16 a[204:207], v[56:59], v[144:147], a[204:207]
    v_mfma_f32_16x16x32_bf16 a[208:211], v[60:63], v[144:147], a[208:211]
    v_mfma_f32_16x16x32_bf16 a[212:215], v[208:211], v[144:147], a[212:215]
    v_mfma_f32_16x16x32_bf16 a[216:219], v[212:215], v[144:147], a[216:219]
    buffer_load_dwordx4 v[96:99], v239, s[16:19], s57 offen sc1
    v_mfma_f32_16x16x32_bf16 a[220:223], v[52:55], v[148:151], a[220:223]
    v_mfma_f32_16x16x32_bf16 a[224:227], v[56:59], v[148:151], a[224:227]
    v_mfma_f32_16x16x32_bf16 a[228:231], v[60:63], v[148:151], a[228:231]
    v_mfma_f32_16x16x32_bf16 a[232:235], v[208:211], v[148:151], a[232:235]
    buffer_load_dwordx4 v[84:87], v243, s[20:23], s56 offen offset:2048 sc1
    v_mfma_f32_16x16x32_bf16 a[236:239], v[212:215], v[148:151], a[236:239]
    v_mfma_f32_16x16x32_bf16 a[160:163], v[52:55], v[136:139], a[160:163]
    v_mfma_f32_16x16x32_bf16 a[164:167], v[56:59], v[136:139], a[164:167]
    v_mfma_f32_16x16x32_bf16 a[168:171], v[60:63], v[136:139], a[168:171]
    buffer_load_dwordx4 v[100:103], v240, s[16:19], s57 offen sc1
    v_mfma_f32_16x16x32_bf16 a[172:175], v[208:211], v[136:139], a[172:175]
    v_mfma_f32_16x16x32_bf16 a[176:179], v[212:215], v[136:139], a[176:179]
    v_mfma_f32_16x16x32_bf16 a[100:103], v[52:55], v[220:223], a[100:103]
    v_mfma_f32_16x16x32_bf16 a[104:107], v[56:59], v[220:223], a[104:107]
    ds_write_b128 v225, a[180:183] offset:0
    v_mfma_f32_16x16x32_bf16 a[108:111], v[60:63], v[220:223], a[108:111]
    buffer_load_dwordx4 v[88:91], v243, s[20:23], s56 offen offset:3072 sc1
    ds_write_b128 v225, a[184:187] offset:1024
    v_mfma_f32_16x16x32_bf16 a[112:115], v[208:211], v[220:223], a[112:115]
    ds_write_b128 v225, a[188:191] offset:2048
    v_mfma_f32_16x16x32_bf16 a[116:119], v[212:215], v[220:223], a[116:119]
    ds_write_b128 v225, a[192:195] offset:3072
    v_mfma_f32_16x16x32_bf16 a[120:123], v[52:55], v[128:131], a[120:123]
    ds_write_b128 v225, a[196:199] offset:4096
    v_mfma_f32_16x16x32_bf16 a[124:127], v[56:59], v[128:131], a[124:127]
    buffer_load_dwordx4 v[104:107], v241, s[16:19], s57 offen sc1
    ds_write_b128 v226, a[200:203] offset:0
    v_mfma_f32_16x16x32_bf16 a[128:131], v[60:63], v[128:131], a[128:131]
    ds_write_b128 v226, a[204:207] offset:1024
    v_mfma_f32_16x16x32_bf16 a[132:135], v[208:211], v[128:131], a[132:135]
    ds_write_b128 v226, a[208:211] offset:2048
    v_mfma_f32_16x16x32_bf16 a[136:139], v[212:215], v[128:131], a[136:139]
    ds_write_b128 v226, a[212:215] offset:3072
    v_mfma_f32_16x16x32_bf16 a[140:143], v[52:55], v[132:135], a[140:143]
    buffer_load_dwordx4 v[92:95], v244, s[20:23], s56 offen offset:0 sc1
    ds_write_b128 v226, a[216:219] offset:4096
    v_mfma_f32_16x16x32_bf16 a[144:147], v[56:59], v[132:135], a[144:147]
    ds_write_b128 v227, a[220:223] offset:0
    v_mfma_f32_16x16x32_bf16 a[148:151], v[60:63], v[132:135], a[148:151]
    ds_write_b128 v227, a[224:227] offset:1024
    v_mfma_f32_16x16x32_bf16 a[152:155], v[208:211], v[132:135], a[152:155]
    ds_write_b128 v227, a[228:231] offset:2048
    v_mfma_f32_16x16x32_bf16 a[156:159], v[212:215], v[132:135], a[156:159]
    buffer_load_dwordx4 v[108:111], v242, s[16:19], s57 offen sc1
    ds_write_b128 v227, a[232:235] offset:3072
    v_mfma_f32_16x16x32_bf16 a[80:83], v[52:55], v[216:219], a[80:83]
    ds_write_b128 v227, a[236:239] offset:4096
    v_mfma_f32_16x16x32_bf16 a[84:87], v[56:59], v[216:219], a[84:87]
    v_mfma_f32_16x16x32_bf16 a[88:91], v[60:63], v[216:219], a[88:91]
    v_mfma_f32_16x16x32_bf16 a[92:95], v[208:211], v[216:219], a[92:95]
    v_mfma_f32_16x16x32_bf16 a[96:99], v[212:215], v[216:219], a[96:99]
    s_waitcnt vmcnt(9)
    v_mfma_f32_16x16x32_bf16 a[0:3], v[152:155], v[172:175], a[0:3]
    s_mov_b32 s49, 9
    s_mul_i32 s56, s49, 20480
    s_lshl_b32 s57, s49, 14
    s_waitcnt lgkmcnt(0)
    s_barrier
    v_mfma_f32_16x16x32_bf16 a[4:7], v[156:159], v[172:175], a[4:7]
    buffer_load_dwordx4 v[0:3], v243, s[20:23], s56 offen offset:0 sc1
    ds_read_b128 v[36:39], v228 offset:0
    ds_read_b128 v[40:43], v228 offset:5120
    v_mfma_f32_16x16x32_bf16 a[8:11], v[160:163], v[172:175], a[8:11]
    ds_read_b128 v[44:47], v228 offset:10240
    ds_read_b128 v[48:51], v228 offset:1024
    v_mfma_f32_16x16x32_bf16 a[12:15], v[164:167], v[172:175], a[12:15]
    buffer_load_dwordx4 v[4:7], v243, s[20:23], s56 offen offset:1024 sc1
    ds_read_b128 v[136:139], v228 offset:6144
    ds_read_b128 v[140:143], v228 offset:11264
    v_mfma_f32_16x16x32_bf16 a[16:19], v[168:171], v[172:175], a[16:19]
    ds_read_b128 v[144:147], v228 offset:2048
    ds_read_b128 v[148:151], v228 offset:7168
    v_mfma_f32_16x16x32_bf16 a[20:23], v[152:155], v[176:179], a[20:23]
    buffer_load_dwordx4 v[20:23], v239, s[16:19], s57 offen sc1
    ds_read_b128 v[188:191], v228 offset:12288
    ds_read_b128 v[64:67], v228 offset:3072
    v_mfma_f32_16x16x32_bf16 a[24:27], v[156:159], v[176:179], a[24:27]
    ds_read_b128 v[68:71], v228 offset:8192
    ds_read_b128 v[72:75], v228 offset:13312
    v_mfma_f32_16x16x32_bf16 a[28:31], v[160:163], v[176:179], a[28:31]
    buffer_load_dwordx4 v[8:11], v243, s[20:23], s56 offen offset:2048 sc1
    ds_read_b128 v[112:115], v228 offset:4096
    ds_read_b128 v[116:119], v228 offset:9216
    v_mfma_f32_16x16x32_bf16 a[32:35], v[164:167], v[176:179], a[32:35]
    ds_read_b128 v[120:123], v228 offset:14336
    v_mfma_f32_16x16x32_bf16 a[36:39], v[168:171], v[176:179], a[36:39]
    buffer_load_dwordx4 v[24:27], v240, s[16:19], s57 offen sc1
    v_mfma_f32_16x16x32_bf16 a[40:43], v[152:155], v[180:183], a[40:43]
    v_mfma_f32_16x16x32_bf16 a[44:47], v[156:159], v[180:183], a[44:47]
    buffer_load_dwordx4 v[12:15], v243, s[20:23], s56 offen offset:3072 sc1
    v_mfma_f32_16x16x32_bf16 a[48:51], v[160:163], v[180:183], a[48:51]
    s_waitcnt lgkmcnt(0)
    v_accvgpr_read_b32 v192, a160
    v_accvgpr_read_b32 v193, a161
    v_accvgpr_read_b32 v194, a162
    v_accvgpr_read_b32 v195, a163
    v_add_f32 v36, v36, v40
    v_add_f32 v37, v37, v41
    v_add_f32 v38, v38, v42
    v_add_f32 v39, v39, v43
    v_add_f32 v192, v192, v44
    v_add_f32 v193, v193, v45
    v_add_f32 v194, v194, v46
    v_mfma_f32_16x16x32_bf16 a[52:55], v[164:167], v[180:183], a[52:55]
    buffer_load_dwordx4 v[28:31], v241, s[16:19], s57 offen sc1
    v_add_f32 v195, v195, v47
    v_add_f32 v36, v36, v192
    v_add_f32 v37, v37, v193
    v_add_f32 v38, v38, v194
    v_add_f32 v39, v39, v195
    buffer_store_dwordx4 v[36:39], v243, s[12:15], s42 offen offset:0 sc1
    v_accvgpr_read_b32 v192, a164
    v_accvgpr_read_b32 v193, a165
    v_accvgpr_read_b32 v194, a166
    v_mfma_f32_16x16x32_bf16 a[56:59], v[168:171], v[180:183], a[56:59]
    v_accvgpr_read_b32 v195, a167
    v_add_f32 v48, v48, v136
    v_add_f32 v49, v49, v137
    v_add_f32 v50, v50, v138
    v_add_f32 v51, v51, v139
    v_add_f32 v192, v192, v140
    v_add_f32 v193, v193, v141
    v_add_f32 v194, v194, v142
    v_add_f32 v195, v195, v143
    v_add_f32 v48, v48, v192
    v_add_f32 v49, v49, v193
    v_add_f32 v50, v50, v194
    v_mfma_f32_16x16x32_bf16 a[60:63], v[152:155], v[184:187], a[60:63]
    buffer_load_dwordx4 v[16:19], v244, s[20:23], s56 offen offset:0 sc1
    v_add_f32 v51, v51, v195
    buffer_store_dwordx4 v[48:51], v243, s[12:15], s42 offen offset:1024 sc1
    v_accvgpr_read_b32 v192, a168
    v_accvgpr_read_b32 v193, a169
    v_accvgpr_read_b32 v194, a170
    v_accvgpr_read_b32 v195, a171
    v_add_f32 v144, v144, v148
    v_add_f32 v145, v145, v149
    v_add_f32 v146, v146, v150
    v_mfma_f32_16x16x32_bf16 a[64:67], v[156:159], v[184:187], a[64:67]
    v_add_f32 v147, v147, v151
    v_add_f32 v192, v192, v188
    v_add_f32 v193, v193, v189
    v_add_f32 v194, v194, v190
    v_add_f32 v195, v195, v191
    v_add_f32 v144, v144, v192
    v_add_f32 v145, v145, v193
    v_add_f32 v146, v146, v194
    v_add_f32 v147, v147, v195
    buffer_store_dwordx4 v[144:147], v243, s[12:15], s42 offen offset:2048 sc1
    v_accvgpr_read_b32 v192, a172
    v_mfma_f32_16x16x32_bf16 a[68:71], v[160:163], v[184:187], a[68:71]
    buffer_load_dwordx4 v[32:35], v242, s[16:19], s57 offen sc1
    v_accvgpr_read_b32 v193, a173
    v_accvgpr_read_b32 v194, a174
    v_accvgpr_read_b32 v195, a175
    v_add_f32 v64, v64, v68
    v_add_f32 v65, v65, v69
    v_add_f32 v66, v66, v70
    v_add_f32 v67, v67, v71
    v_add_f32 v192, v192, v72
    v_add_f32 v193, v193, v73
    v_add_f32 v194, v194, v74
    v_mfma_f32_16x16x32_bf16 a[72:75], v[164:167], v[184:187], a[72:75]
    v_add_f32 v195, v195, v75
    v_add_f32 v64, v64, v192
    v_add_f32 v65, v65, v193
    v_add_f32 v66, v66, v194
    v_add_f32 v67, v67, v195
    buffer_store_dwordx4 v[64:67], v243, s[12:15], s42 offen offset:3072 sc1
    v_accvgpr_read_b32 v192, a176
    v_accvgpr_read_b32 v193, a177
    v_accvgpr_read_b32 v194, a178
    v_accvgpr_read_b32 v195, a179
    v_add_f32 v112, v112, v116
    v_mfma_f32_16x16x32_bf16 a[76:79], v[168:171], v[184:187], a[76:79]
    s_waitcnt vmcnt(13)
    v_add_f32 v113, v113, v117
    v_add_f32 v114, v114, v118
    v_add_f32 v115, v115, v119
    v_add_f32 v192, v192, v120
    v_add_f32 v193, v193, v121
    v_add_f32 v194, v194, v122
    v_add_f32 v195, v195, v123
    v_add_f32 v112, v112, v192
    v_add_f32 v113, v113, v193
    v_add_f32 v114, v114, v194
    v_add_f32 v115, v115, v195
    buffer_store_dwordx4 v[112:115], v244, s[12:15], s42 offen offset:0 sc1
    v_mfma_f32_16x16x32_bf16 a[0:3], v[76:79], v[96:99], a[0:3]
    s_mov_b32 s49, 10
    s_mul_i32 s56, s49, 20480
    s_lshl_b32 s57, s49, 14
    v_mfma_f32_16x16x32_bf16 a[4:7], v[80:83], v[96:99], a[4:7]
    buffer_load_dwordx4 v[52:55], v243, s[20:23], s56 offen offset:0 sc1
    ds_write_b128 v225, a[100:103] offset:15360
    v_mfma_f32_16x16x32_bf16 a[8:11], v[84:87], v[96:99], a[8:11]
    ds_write_b128 v225, a[104:107] offset:16384
    v_mfma_f32_16x16x32_bf16 a[12:15], v[88:91], v[96:99], a[12:15]
    buffer_load_dwordx4 v[56:59], v243, s[20:23], s56 offen offset:1024 sc1
    ds_write_b128 v225, a[108:111] offset:17408
    v_mfma_f32_16x16x32_bf16 a[16:19], v[92:95], v[96:99], a[16:19]
    ds_write_b128 v225, a[112:115] offset:18432
    v_mfma_f32_16x16x32_bf16 a[20:23], v[76:79], v[100:103], a[20:23]
    buffer_load_dwordx4 v[216:219], v239, s[16:19], s57 offen sc1
    ds_write_b128 v225, a[116:119] offset:19456
    v_mfma_f32_16x16x32_bf16 a[24:27], v[80:83], v[100:103], a[24:27]
    ds_write_b128 v226, a[120:123] offset:15360
    v_mfma_f32_16x16x32_bf16 a[28:31], v[84:87], v[100:103], a[28:31]
    buffer_load_dwordx4 v[60:63], v243, s[20:23], s56 offen offset:2048 sc1
    ds_write_b128 v226, a[124:127] offset:16384
    v_mfma_f32_16x16x32_bf16 a[32:35], v[88:91], v[100:103], a[32:35]
    ds_write_b128 v226, a[128:131] offset:17408
    v_mfma_f32_16x16x32_bf16 a[36:39], v[92:95], v[100:103], a[36:39]
    buffer_load_dwordx4 v[220:223], v240, s[16:19], s57 offen sc1
    ds_write_b128 v226, a[132:135] offset:18432
    v_mfma_f32_16x16x32_bf16 a[40:43], v[76:79], v[104:107], a[40:43]
    ds_write_b128 v226, a[136:139] offset:19456
    v_mfma_f32_16x16x32_bf16 a[44:47], v[80:83], v[104:107], a[44:47]
    buffer_load_dwordx4 v[208:211], v243, s[20:23], s56 offen offset:3072 sc1
    ds_write_b128 v227, a[140:143] offset:15360
    v_mfma_f32_16x16x32_bf16 a[48:51], v[84:87], v[104:107], a[48:51]
    ds_write_b128 v227, a[144:147] offset:16384
    v_mfma_f32_16x16x32_bf16 a[52:55], v[88:91], v[104:107], a[52:55]
    buffer_load_dwordx4 v[128:131], v241, s[16:19], s57 offen sc1
    ds_write_b128 v227, a[148:151] offset:17408
    v_mfma_f32_16x16x32_bf16 a[56:59], v[92:95], v[104:107], a[56:59]
    ds_write_b128 v227, a[152:155] offset:18432
    v_mfma_f32_16x16x32_bf16 a[60:63], v[76:79], v[108:111], a[60:63]
    buffer_load_dwordx4 v[212:215], v244, s[20:23], s56 offen offset:0 sc1
    ds_write_b128 v227, a[156:159] offset:19456
    v_mfma_f32_16x16x32_bf16 a[64:67], v[80:83], v[108:111], a[64:67]
    v_mfma_f32_16x16x32_bf16 a[68:71], v[84:87], v[108:111], a[68:71]
    buffer_load_dwordx4 v[132:135], v242, s[16:19], s57 offen sc1
    v_mfma_f32_16x16x32_bf16 a[72:75], v[88:91], v[108:111], a[72:75]
    s_waitcnt vmcnt(9)
    buffer_store_dwordx4 a[252:255], v234, s[84:87], s52 offen sc1
    v_mfma_f32_16x16x32_bf16 a[76:79], v[92:95], v[108:111], a[76:79]
    s_waitcnt vmcnt(12)
    v_mfma_f32_16x16x32_bf16 a[0:3], v[0:3], v[20:23], a[0:3]
    s_mov_b32 s49, 11
    s_mul_i32 s56, s49, 20480
    s_lshl_b32 s57, s49, 14
    s_waitcnt lgkmcnt(0)
    s_barrier
    v_mfma_f32_16x16x32_bf16 a[4:7], v[4:7], v[20:23], a[4:7]
    buffer_load_dwordx4 v[152:155], v243, s[20:23], s56 offen offset:0 sc1
    ds_read_b128 v[36:39], v228 offset:15360
    ds_read_b128 v[40:43], v228 offset:20480
    v_mfma_f32_16x16x32_bf16 a[8:11], v[8:11], v[20:23], a[8:11]
    ds_read_b128 v[44:47], v228 offset:25600
    ds_read_b128 v[48:51], v228 offset:16384
    v_mfma_f32_16x16x32_bf16 a[12:15], v[12:15], v[20:23], a[12:15]
    buffer_load_dwordx4 v[156:159], v243, s[20:23], s56 offen offset:1024 sc1
    ds_read_b128 v[136:139], v228 offset:21504
    ds_read_b128 v[140:143], v228 offset:26624
    v_mfma_f32_16x16x32_bf16 a[16:19], v[16:19], v[20:23], a[16:19]
    ds_read_b128 v[144:147], v228 offset:17408
    ds_read_b128 v[148:151], v228 offset:22528
    v_mfma_f32_16x16x32_bf16 a[20:23], v[0:3], v[24:27], a[20:23]
    buffer_load_dwordx4 v[172:175], v239, s[16:19], s57 offen sc1
    ds_read_b128 v[188:191], v228 offset:27648
    ds_read_b128 v[64:67], v228 offset:18432
    v_mfma_f32_16x16x32_bf16 a[24:27], v[4:7], v[24:27], a[24:27]
    ds_read_b128 v[68:71], v228 offset:23552
    ds_read_b128 v[72:75], v228 offset:28672
    v_mfma_f32_16x16x32_bf16 a[28:31], v[8:11], v[24:27], a[28:31]
    buffer_load_dwordx4 v[160:163], v243, s[20:23], s56 offen offset:2048 sc1
    ds_read_b128 v[112:115], v228 offset:19456
    ds_read_b128 v[116:119], v228 offset:24576
    v_mfma_f32_16x16x32_bf16 a[32:35], v[12:15], v[24:27], a[32:35]
    ds_read_b128 v[120:123], v228 offset:29696
    v_mfma_f32_16x16x32_bf16 a[36:39], v[16:19], v[24:27], a[36:39]
    buffer_load_dwordx4 v[176:179], v240, s[16:19], s57 offen sc1
    v_mfma_f32_16x16x32_bf16 a[40:43], v[0:3], v[28:31], a[40:43]
    v_mfma_f32_16x16x32_bf16 a[44:47], v[4:7], v[28:31], a[44:47]
    buffer_load_dwordx4 v[164:167], v243, s[20:23], s56 offen offset:3072 sc1
    v_mfma_f32_16x16x32_bf16 a[48:51], v[8:11], v[28:31], a[48:51]
    s_waitcnt lgkmcnt(0)
    v_accvgpr_read_b32 v192, a80
    v_accvgpr_read_b32 v193, a81
    v_accvgpr_read_b32 v194, a82
    v_accvgpr_read_b32 v195, a83
    v_add_f32 v36, v36, v40
    v_add_f32 v37, v37, v41
    v_add_f32 v38, v38, v42
    v_add_f32 v39, v39, v43
    v_add_f32 v192, v192, v44
    v_add_f32 v193, v193, v45
    v_mfma_f32_16x16x32_bf16 a[52:55], v[12:15], v[28:31], a[52:55]
    buffer_load_dwordx4 v[180:183], v241, s[16:19], s57 offen sc1
    v_add_f32 v194, v194, v46
    v_add_f32 v195, v195, v47
    v_add_f32 v36, v36, v192
    v_add_f32 v37, v37, v193
    v_add_f32 v38, v38, v194
    v_add_f32 v39, v39, v195
    v_accvgpr_read_b32 v192, a84
    v_accvgpr_read_b32 v193, a85
    v_accvgpr_read_b32 v194, a86
    v_mfma_f32_16x16x32_bf16 a[56:59], v[16:19], v[28:31], a[56:59]
    v_accvgpr_read_b32 v195, a87
    v_add_f32 v48, v48, v136
    v_add_f32 v49, v49, v137
    v_add_f32 v50, v50, v138
    v_add_f32 v51, v51, v139
    v_add_f32 v192, v192, v140
    v_add_f32 v193, v193, v141
    v_add_f32 v194, v194, v142
    v_add_f32 v195, v195, v143
    v_add_f32 v48, v48, v192
    v_add_f32 v49, v49, v193
    v_mfma_f32_16x16x32_bf16 a[60:63], v[0:3], v[32:35], a[60:63]
    buffer_load_dwordx4 v[168:171], v244, s[20:23], s56 offen offset:0 sc1
    v_add_f32 v50, v50, v194
    v_add_f32 v51, v51, v195
    v_accvgpr_read_b32 v192, a88
    v_accvgpr_read_b32 v193, a89
    v_accvgpr_read_b32 v194, a90
    v_accvgpr_read_b32 v195, a91
    v_add_f32 v144, v144, v148
    v_add_f32 v145, v145, v149
    v_add_f32 v146, v146, v150
    v_mfma_f32_16x16x32_bf16 a[64:67], v[4:7], v[32:35], a[64:67]
    v_add_f32 v147, v147, v151
    v_add_f32 v192, v192, v188
    v_add_f32 v193, v193, v189
    v_add_f32 v194, v194, v190
    v_add_f32 v195, v195, v191
    v_add_f32 v144, v144, v192
    v_add_f32 v145, v145, v193
    v_add_f32 v146, v146, v194
    v_add_f32 v147, v147, v195
    v_accvgpr_read_b32 v192, a92
    v_mfma_f32_16x16x32_bf16 a[68:71], v[8:11], v[32:35], a[68:71]
    buffer_load_dwordx4 v[184:187], v242, s[16:19], s57 offen sc1
    v_accvgpr_read_b32 v193, a93
    v_accvgpr_read_b32 v194, a94
    v_accvgpr_read_b32 v195, a95
    v_add_f32 v64, v64, v68
    v_add_f32 v65, v65, v69
    v_add_f32 v66, v66, v70
    v_add_f32 v67, v67, v71
    v_add_f32 v192, v192, v72
    v_add_f32 v193, v193, v73
    v_mfma_f32_16x16x32_bf16 a[72:75], v[12:15], v[32:35], a[72:75]
    v_add_f32 v194, v194, v74
    v_add_f32 v195, v195, v75
    v_add_f32 v64, v64, v192
    v_add_f32 v65, v65, v193
    v_add_f32 v66, v66, v194
    v_add_f32 v67, v67, v195
    v_accvgpr_read_b32 v192, a96
    v_accvgpr_read_b32 v193, a97
    v_accvgpr_read_b32 v194, a98
    v_accvgpr_read_b32 v195, a99
    v_add_f32 v112, v112, v116
    v_mfma_f32_16x16x32_bf16 a[76:79], v[16:19], v[32:35], a[76:79]
    s_waitcnt vmcnt(10)
    v_add_f32 v113, v113, v117
    v_add_f32 v114, v114, v118
    v_add_f32 v115, v115, v119
    v_add_f32 v192, v192, v120
    v_add_f32 v193, v193, v121
    v_add_f32 v194, v194, v122
    v_add_f32 v195, v195, v123
    v_add_f32 v112, v112, v192
    v_add_f32 v113, v113, v193
    v_add_f32 v114, v114, v194
    v_add_f32 v115, v115, v195
    v_mfma_f32_16x16x32_bf16 a[0:3], v[52:55], v[216:219], a[0:3]
    s_mov_b32 s49, 12
    s_mul_i32 s56, s49, 20480
    s_lshl_b32 s57, s49, 14
    ds_read_b64 v[192:193], v224 offset:0
    v_mfma_f32_16x16x32_bf16 a[4:7], v[56:59], v[216:219], a[4:7]
    buffer_load_dwordx4 v[76:79], v243, s[20:23], s56 offen offset:0 sc1
    ds_read_b64 v[194:195], v224 offset:32
    v_mfma_f32_16x16x32_bf16 a[8:11], v[60:63], v[216:219], a[8:11]
    ds_read_b64 v[196:197], v224 offset:64
    v_mfma_f32_16x16x32_bf16 a[12:15], v[208:211], v[216:219], a[12:15]
    buffer_load_dwordx4 v[80:83], v243, s[20:23], s56 offen offset:1024 sc1
    ds_read_b64 v[198:199], v224 offset:96
    v_mfma_f32_16x16x32_bf16 a[16:19], v[212:215], v[216:219], a[16:19]
    ds_read_b64 v[200:201], v224 offset:128
    v_mfma_f32_16x16x32_bf16 a[20:23], v[52:55], v[220:223], a[20:23]
    buffer_load_dwordx4 v[96:99], v239, s[16:19], s57 offen sc1
    v_mfma_f32_16x16x32_bf16 a[24:27], v[56:59], v[220:223], a[24:27]
    v_mfma_f32_16x16x32_bf16 a[28:31], v[60:63], v[220:223], a[28:31]
    buffer_load_dwordx4 v[84:87], v243, s[20:23], s56 offen offset:2048 sc1
    v_mfma_f32_16x16x32_bf16 a[32:35], v[208:211], v[220:223], a[32:35]
    s_waitcnt lgkmcnt(0)
    s_mov_b32 s3, 0xffff0000
    v_lshlrev_b32 v44, 16, v192
    v_mfma_f32_16x16x32_bf16 a[36:39], v[212:215], v[220:223], a[36:39]
    buffer_load_dwordx4 v[100:103], v240, s[16:19], s57 offen sc1
    v_and_b32 v45, s3, v192
    v_mfma_f32_16x16x32_bf16 a[40:43], v[52:55], v[128:131], a[40:43]
L_padD_2:
    s_cbranch_execz L_padD_3
    v_lshlrev_b32 v46, 16, v193
    v_and_b32 v47, s3, v193
    v_lshlrev_b32 v140, 16, v194
    v_mfma_f32_16x16x32_bf16 a[44:47], v[56:59], v[128:131], a[44:47]
    buffer_load_dwordx4 v[88:91], v243, s[20:23], s56 offen offset:3072 sc1
    v_and_b32 v141, s3, v194
    v_mfma_f32_16x16x32_bf16 a[48:51], v[60:63], v[128:131], a[48:51]
    v_lshlrev_b32 v142, 16, v195
    v_and_b32 v143, s3, v195
    v_lshlrev_b32 v188, 16, v196
    v_mfma_f32_16x16x32_bf16 a[52:55], v[208:211], v[128:131], a[52:55]
    buffer_load_dwordx4 v[104:107], v241, s[16:19], s57 offen sc1
    v_and_b32 v189, s3, v196
    v_mfma_f32_16x16x32_bf16 a[56:59], v[212:215], v[128:131], a[56:59]
    v_lshlrev_b32 v190, 16, v197
    v_and_b32 v191, s3, v197
    v_lshlrev_b32 v72, 16, v198
    v_mfma_f32_16x16x32_bf16 a[60:63], v[52:55], v[132:135], a[60:63]
    buffer_load_dwordx4 v[92:95], v244, s[20:23], s56 offen offset:0 sc1
    v_and_b32 v73, s3, v198
    v_mfma_f32_16x16x32_bf16 a[64:67], v[56:59], v[132:135], a[64:67]
    v_lshlrev_b32 v74, 16, v199
    v_and_b32 v75, s3, v199
    v_lshlrev_b32 v120, 16, v200
    v_mfma_f32_16x16x32_bf16 a[68:71], v[60:63], v[132:135], a[68:71]
    buffer_load_dwordx4 v[108:111], v242, s[16:19], s57 offen sc1
    v_and_b32 v121, s3, v200
    v_mfma_f32_16x16x32_bf16 a[72:75], v[208:211], v[132:135], a[72:75]
    v_lshlrev_b32 v122, 16, v201
    v_and_b32 v123, s3, v201
    v_mov_b32 v124, s58
    v_mfma_f32_16x16x32_bf16 a[76:79], v[212:215], v[132:135], a[76:79]
    s_waitcnt vmcnt(9)
    v_mov_b32 v125, s58
    v_mov_b32 v126, 1.0
    v_mov_b32 v127, 1.0
    v_mfma_f32_16x16x32_bf16 a[0:3], v[152:155], v[172:175], a[0:3]
    s_mov_b32 s49, 13
    s_mul_i32 s56, s49, 20480
    s_lshl_b32 s57, s49, 14
    v_mfma_f32_16x16x32_bf16 a[4:7], v[156:159], v[172:175], a[4:7]
    buffer_load_dwordx4 v[0:3], v243, s[20:23], s56 offen offset:0 sc1
    v_mfma_f32_16x16x32_bf16 a[8:11], v[160:163], v[172:175], a[8:11]
    v_mfma_f32_16x16x32_bf16 a[12:15], v[164:167], v[172:175], a[12:15]
    buffer_load_dwordx4 v[4:7], v243, s[20:23], s56 offen offset:1024 sc1
    v_mfma_f32_16x16x32_bf16 a[16:19], v[168:171], v[172:175], a[16:19]
    v_mfma_f32_16x16x32_bf16 a[20:23], v[152:155], v[176:179], a[20:23]
    buffer_load_dwordx4 v[24:27], v240, s[16:19], s57 offen sc1
    v_mfma_f32_16x16x32_bf16 a[24:27], v[156:159], v[176:179], a[24:27]
    v_mfma_f32_16x16x32_bf16 a[28:31], v[160:163], v[176:179], a[28:31]
    buffer_load_dwordx4 v[8:11], v243, s[20:23], s56 offen offset:2048 sc1
    v_mfma_f32_16x16x32_bf16 a[32:35], v[164:167], v[176:179], a[32:35]
    v_mfma_f32_16x16x32_bf16 a[36:39], v[168:171], v[176:179], a[36:39]
    buffer_load_dwordx4 v[12:15], v243, s[20:23], s56 offen offset:3072 sc1
    v_mfma_f32_16x16x32_bf16 a[40:43], v[152:155], v[180:183], a[40:43]
    v_mfma_f32_16x16x32_bf16 a[44:47], v[156:159], v[180:183], a[44:47]
    buffer_load_dwordx4 v[16:19], v244, s[20:23], s56 offen offset:0 sc1
    v_mfma_f32_16x16x32_bf16 a[48:51], v[160:163], v[180:183], a[48:51]
    v_mfma_f32_16x16x32_bf16 a[52:55], v[164:167], v[180:183], a[52:55]
    buffer_load_dwordx4 v[28:31], v241, s[16:19], s57 offen sc1
    v_mfma_f32_16x16x32_bf16 a[56:59], v[168:171], v[180:183], a[56:59]
    v_mfma_f32_16x16x32_bf16 a[60:63], v[152:155], v[184:187], a[60:63]
    buffer_load_dwordx4 v[32:35], v242, s[16:19], s57 offen sc1
    v_mfma_f32_16x16x32_bf16 a[64:67], v[156:159], v[184:187], a[64:67]
    v_mfma_f32_16x16x32_bf16 a[68:71], v[160:163], v[184:187], a[68:71]
    buffer_load_dwordx4 v[20:23], v239, s[16:19], s57 offen sc1
    v_mfma_f32_16x16x32_bf16 a[72:75], v[164:167], v[184:187], a[72:75]
    buffer_load_dwordx2 v[230:231], off, s[84:87], s55 sc1
    v_mfma_f32_16x16x32_bf16 a[76:79], v[168:171], v[184:187], a[76:79]
    s_waitcnt vmcnt(10)
    v_mfma_f32_16x16x32_bf16 a[0:3], v[76:79], v[96:99], a[0:3]
    v_mfma_f32_16x16x32_bf16 a[4:7], v[80:83], v[96:99], a[4:7]
    v_mfma_f32_16x16x32_bf16 a[8:11], v[84:87], v[96:99], a[8:11]
    v_mfma_f32_16x16x32_bf16 a[12:15], v[88:91], v[96:99], a[12:15]
    v_mfma_f32_16x16x32_bf16 a[16:19], v[92:95], v[96:99], a[16:19]
    v_mfma_f32_16x16x32_bf16 a[20:23], v[76:79], v[100:103], a[20:23]
    v_mfma_f32_16x16x32_bf16 a[24:27], v[80:83], v[100:103], a[24:27]
    v_mfma_f32_16x16x32_bf16 a[28:31], v[84:87], v[100:103], a[28:31]
    v_mfma_f32_16x16x32_bf16 a[32:35], v[88:91], v[100:103], a[32:35]
    v_mfma_f32_16x16x32_bf16 a[36:39], v[92:95], v[100:103], a[36:39]
    v_mfma_f32_16x16x32_bf16 a[40:43], v[76:79], v[104:107], a[40:43]
    v_mfma_f32_16x16x32_bf16 a[44:47], v[80:83], v[104:107], a[44:47]
    v_mfma_f32_16x16x32_bf16 a[48:51], v[84:87], v[104:107], a[48:51]
    s_waitcnt vmcnt(0)
    v_cmp_ne_u64 vcc, s[92:93], v[230:231]
    s_cbranch_vccnz L_s4
L_s4_back:
    v_mfma_f32_16x16x32_bf16 a[52:55], v[88:91], v[104:107], a[52:55]
    buffer_load_dwordx4 v[40:43], v243, s[12:15], s43 offen offset:0 sc1
    v_mfma_f32_16x16x32_bf16 a[56:59], v[92:95], v[104:107], a[56:59]
    buffer_load_dwordx4 v[136:139], v243, s[12:15], s43 offen offset:1024 sc1
    v_mfma_f32_16x16x32_bf16 a[60:63], v[76:79], v[108:111], a[60:63]
    buffer_load_dwordx4 v[148:151], v243, s[12:15], s43 offen offset:2048 sc1
    v_mfma_f32_16x16x32_bf16 a[64:67], v[80:83], v[108:111], a[64:67]
    buffer_load_dwordx4 v[68:71], v243, s[12:15], s43 offen offset:3072 sc1
    v_mfma_f32_16x16x32_bf16 a[68:71], v[84:87], v[108:111], a[68:71]
    buffer_load_dwordx4 v[116:119], v244, s[12:15], s43 offen offset:0 sc1
    v_mfma_f32_16x16x32_bf16 a[72:75], v[88:91], v[108:111], a[72:75]
    v_mfma_f32_16x16x32_bf16 a[76:79], v[92:95], v[108:111], a[76:79]
    s_waitcnt vmcnt(9)
    v_mfma_f32_16x16x32_bf16 a[20:23], v[0:3], v[24:27], a[20:23]
    v_mfma_f32_16x16x32_bf16 a[24:27], v[4:7], v[24:27], a[24:27]
    v_mfma_f32_16x16x32_bf16 a[28:31], v[8:11], v[24:27], a[28:31]
    v_mfma_f32_16x16x32_bf16 a[32:35], v[12:15], v[24:27], a[32:35]
    v_mfma_f32_16x16x32_bf16 a[36:39], v[16:19], v[24:27], a[36:39]
    s_waitcnt vmcnt(8)
    v_mfma_f32_16x16x32_bf16 a[40:43], v[0:3], v[28:31], a[40:43]
    v_mfma_f32_16x16x32_bf16 a[44:47], v[4:7], v[28:31], a[44:47]
    v_mfma_f32_16x16x32_bf16 a[48:51], v[8:11], v[28:31], a[48:51]
    v_mfma_f32_16x16x32_bf16 a[52:55], v[12:15], v[28:31], a[52:55]
    v_mfma_f32_16x16x32_bf16 a[56:59], v[16:19], v[28:31], a[56:59]
    s_waitcnt vmcnt(7)
    v_mfma_f32_16x16x32_bf16 a[60:63], v[0:3], v[32:35], a[60:63]
    v_mfma_f32_16x16x32_bf16 a[64:67], v[4:7], v[32:35], a[64:67]
    ds_write_b128 v225, a[20:23] offset:0
    v_mfma_f32_16x16x32_bf16 a[68:71], v[8:11], v[32:35], a[68:71]
    ds_write_b128 v225, a[24:27] offset:1024
    v_mfma_f32_16x16x32_bf16 a[72:75], v[12:15], v[32:35], a[72:75]
    ds_write_b128 v225, a[28:31] offset:2048
    v_mfma_f32_16x16x32_bf16 a[76:79], v[16:19], v[32:35], a[76:79]
    s_waitcnt vmcnt(6)
    ds_write_b128 v225, a[32:35] offset:3072
    v_mfma_f32_16x16x32_bf16 a[0:3], v[0:3], v[20:23], a[0:3]
    ds_write_b128 v225, a[36:39] offset:4096
    v_mfma_f32_16x16x32_bf16 a[4:7], v[4:7], v[20:23], a[4:7]
    ds_write_b128 v226, a[40:43] offset:0
    v_mfma_f32_16x16x32_bf16 a[8:11], v[8:11], v[20:23], a[8:11]
    ds_write_b128 v226, a[44:47] offset:1024
    v_mfma_f32_16x16x32_bf16 a[12:15], v[12:15], v[20:23], a[12:15]
    ds_write_b128 v226, a[48:51] offset:2048
    v_mfma_f32_16x16x32_bf16 a[16:19], v[16:19], v[20:23], a[16:19]
    ds_write_b128 v226, a[52:55] offset:3072
    ds_write_b128 v226, a[56:59] offset:4096
    ds_write_b128 v227, a[60:63] offset:0
    ds_write_b128 v227, a[64:67] offset:1024
    ds_write_b128 v227, a[68:71] offset:2048
    ds_write_b128 v227, a[72:75] offset:3072
    ds_write_b128 v227, a[76:79] offset:4096
    s_waitcnt lgkmcnt(0)
    s_barrier
    ds_read_b128 v[0:3], v228 offset:0
    ds_read_b128 v[4:7], v228 offset:5120
    ds_read_b128 v[8:11], v228 offset:10240
    ds_read_b128 v[12:15], v228 offset:1024
    ds_read_b128 v[16:19], v228 offset:6144
    ds_read_b128 v[20:23], v228 offset:11264
    ds_read_b128 v[24:27], v228 offset:2048
    ds_read_b128 v[28:31], v228 offset:7168
    ds_read_b128 v[32:35], v228 offset:12288
    ds_read_b128 v[52:55], v228 offset:3072
    ds_read_b128 v[56:59], v228 offset:8192
    ds_read_b128 v[60:63], v228 offset:13312
    ds_read_b128 v[208:211], v228 offset:4096
    ds_read_b128 v[212:215], v228 offset:9216
    ds_read_b128 v[216:219], v228 offset:14336
    v_accvgpr_read_b32 v220, a0
    v_accvgpr_read_b32 v221, a1
    v_accvgpr_read_b32 v222, a2
    v_accvgpr_read_b32 v223, a3
    v_accvgpr_read_b32 v128, a4
    v_accvgpr_read_b32 v129, a5
    v_accvgpr_read_b32 v130, a6
    v_accvgpr_read_b32 v131, a7
    v_accvgpr_read_b32 v132, a8
    v_accvgpr_read_b32 v133, a9
    v_accvgpr_read_b32 v134, a10
    v_accvgpr_read_b32 v135, a11
    v_accvgpr_read_b32 v152, a12
    v_accvgpr_read_b32 v153, a13
    v_accvgpr_read_b32 v154, a14
    v_accvgpr_read_b32 v155, a15
    v_accvgpr_read_b32 v156, a16
    v_accvgpr_read_b32 v157, a17
    v_accvgpr_read_b32 v158, a18
    v_accvgpr_read_b32 v159, a19
    s_waitcnt lgkmcnt(12)
    v_pk_add_f32 v[220:221], v[220:221], v[0:1]
    v_pk_add_f32 v[222:223], v[222:223], v[2:3]
    v_pk_add_f32 v[220:221], v[220:221], v[4:5]
    v_pk_add_f32 v[222:223], v[222:223], v[6:7]
    v_pk_add_f32 v[220:221], v[220:221], v[8:9]
    v_pk_add_f32 v[222:223], v[222:223], v[10:11]
    v_pk_mul_f32 v[160:161], v[220:221], v[124:125]
    v_pk_mul_f32 v[162:163], v[222:223], v[124:125]
    v_exp_f32 v160, v160
    v_exp_f32 v161, v161
    v_exp_f32 v162, v162
    v_exp_f32 v163, v163
    s_waitcnt lgkmcnt(9)
    v_pk_add_f32 v[128:129], v[128:129], v[12:13]
    v_pk_add_f32 v[130:131], v[130:131], v[14:15]
    v_pk_add_f32 v[128:129], v[128:129], v[16:17]
    v_pk_add_f32 v[130:131], v[130:131], v[18:19]
    v_pk_add_f32 v[128:129], v[128:129], v[20:21]
    v_pk_add_f32 v[130:131], v[130:131], v[22:23]
    v_pk_mul_f32 v[164:165], v[128:129], v[124:125]
    v_pk_mul_f32 v[166:167], v[130:131], v[124:125]
    v_exp_f32 v164, v164
    v_exp_f32 v165, v165
    v_exp_f32 v166, v166
    v_exp_f32 v167, v167
    s_waitcnt lgkmcnt(6)
    v_pk_add_f32 v[132:133], v[132:133], v[24:25]
    v_pk_add_f32 v[134:135], v[134:135], v[26:27]
    v_pk_add_f32 v[132:133], v[132:133], v[28:29]
    v_pk_add_f32 v[134:135], v[134:135], v[30:31]
    v_pk_add_f32 v[132:133], v[132:133], v[32:33]
    v_pk_add_f32 v[134:135], v[134:135], v[34:35]
    v_pk_mul_f32 v[168:169], v[132:133], v[124:125]
    v_pk_mul_f32 v[170:171], v[134:135], v[124:125]
    v_exp_f32 v168, v168
    v_exp_f32 v169, v169
    v_exp_f32 v170, v170
    v_exp_f32 v171, v171
    s_waitcnt lgkmcnt(3)
    v_pk_add_f32 v[152:153], v[152:153], v[52:53]
    v_pk_add_f32 v[154:155], v[154:155], v[54:55]
    v_pk_add_f32 v[152:153], v[152:153], v[56:57]
    v_pk_add_f32 v[154:155], v[154:155], v[58:59]
    v_pk_add_f32 v[152:153], v[152:153], v[60:61]
    v_pk_add_f32 v[154:155], v[154:155], v[62:63]
    v_pk_mul_f32 v[172:173], v[152:153], v[124:125]
    v_pk_mul_f32 v[174:175], v[154:155], v[124:125]
    v_exp_f32 v172, v172
    v_exp_f32 v173, v173
    v_exp_f32 v174, v174
    v_exp_f32 v175, v175
    s_waitcnt lgkmcnt(0)
    v_pk_add_f32 v[156:157], v[156:157], v[208:209]
    v_pk_add_f32 v[158:159], v[158:159], v[210:211]
    v_pk_add_f32 v[156:157], v[156:157], v[212:213]
    v_pk_add_f32 v[158:159], v[158:159], v[214:215]
    v_pk_add_f32 v[156:157], v[156:157], v[216:217]
    v_pk_add_f32 v[158:159], v[158:159], v[218:219]
    v_pk_mul_f32 v[176:177], v[156:157], v[124:125]
    v_pk_mul_f32 v[178:179], v[158:159], v[124:125]
    v_exp_f32 v176, v176
    v_exp_f32 v177, v177
    v_exp_f32 v178, v178
    v_exp_f32 v179, v179
    s_waitcnt vmcnt(0)
    v_pk_add_f32 v[160:161], v[160:161], v[126:127]
    v_pk_add_f32 v[162:163], v[162:163], v[126:127]
    v_rcp_f32 v160, v160
    v_rcp_f32 v161, v161
    v_rcp_f32 v162, v162
    v_rcp_f32 v163, v163
    v_pk_add_f32 v[36:37], v[36:37], v[40:41]
    v_pk_add_f32 v[38:39], v[38:39], v[42:43]
    v_pk_mul_f32 v[220:221], v[220:221], v[160:161]
    v_pk_mul_f32 v[222:223], v[222:223], v[162:163]
    v_pk_fma_f32 v[220:221], v[220:221], v[36:37], v[44:45]
    v_pk_fma_f32 v[222:223], v[222:223], v[38:39], v[46:47]
    v_cvt_pk_bf16_f32 v192, v220, v221
    v_cvt_pk_bf16_f32 v193, v222, v223
    ds_write_b64 v224, v[192:193] offset:0
    v_pk_add_f32 v[164:165], v[164:165], v[126:127]
    v_pk_add_f32 v[166:167], v[166:167], v[126:127]
    v_rcp_f32 v164, v164
    v_rcp_f32 v165, v165
    v_rcp_f32 v166, v166
    v_rcp_f32 v167, v167
    v_pk_add_f32 v[48:49], v[48:49], v[136:137]
    v_pk_add_f32 v[50:51], v[50:51], v[138:139]
    v_pk_mul_f32 v[128:129], v[128:129], v[164:165]
    v_pk_mul_f32 v[130:131], v[130:131], v[166:167]
    v_pk_fma_f32 v[128:129], v[128:129], v[48:49], v[140:141]
    v_pk_fma_f32 v[130:131], v[130:131], v[50:51], v[142:143]
    v_cvt_pk_bf16_f32 v194, v128, v129
    v_cvt_pk_bf16_f32 v195, v130, v131
    ds_write_b64 v224, v[194:195] offset:32
    v_pk_add_f32 v[168:169], v[168:169], v[126:127]
    v_pk_add_f32 v[170:171], v[170:171], v[126:127]
    v_rcp_f32 v168, v168
    v_rcp_f32 v169, v169
    v_rcp_f32 v170, v170
    v_rcp_f32 v171, v171
    v_pk_add_f32 v[144:145], v[144:145], v[148:149]
    v_pk_add_f32 v[146:147], v[146:147], v[150:151]
    v_pk_mul_f32 v[132:133], v[132:133], v[168:169]
    v_pk_mul_f32 v[134:135], v[134:135], v[170:171]
    v_pk_fma_f32 v[132:133], v[132:133], v[144:145], v[188:189]
    v_pk_fma_f32 v[134:135], v[134:135], v[146:147], v[190:191]
    v_cvt_pk_bf16_f32 v196, v132, v133
    v_cvt_pk_bf16_f32 v197, v134, v135
    ds_write_b64 v224, v[196:197] offset:64
    v_pk_add_f32 v[172:173], v[172:173], v[126:127]
    v_pk_add_f32 v[174:175], v[174:175], v[126:127]
    v_rcp_f32 v172, v172
    v_rcp_f32 v173, v173
    v_rcp_f32 v174, v174
    v_rcp_f32 v175, v175
    v_pk_add_f32 v[64:65], v[64:65], v[68:69]
    v_pk_add_f32 v[66:67], v[66:67], v[70:71]
    v_pk_mul_f32 v[152:153], v[152:153], v[172:173]
    v_pk_mul_f32 v[154:155], v[154:155], v[174:175]
    v_pk_fma_f32 v[152:153], v[152:153], v[64:65], v[72:73]
    v_pk_fma_f32 v[154:155], v[154:155], v[66:67], v[74:75]
    v_cvt_pk_bf16_f32 v198, v152, v153
    v_cvt_pk_bf16_f32 v199, v154, v155
    ds_write_b64 v224, v[198:199] offset:96
    v_pk_add_f32 v[176:177], v[176:177], v[126:127]
    v_pk_add_f32 v[178:179], v[178:179], v[126:127]
    v_rcp_f32 v176, v176
    v_rcp_f32 v177, v177
    v_rcp_f32 v178, v178
    v_rcp_f32 v179, v179
    v_pk_add_f32 v[112:113], v[112:113], v[116:117]
    v_pk_add_f32 v[114:115], v[114:115], v[118:119]
    v_pk_mul_f32 v[156:157], v[156:157], v[176:177]
    v_pk_mul_f32 v[158:159], v[158:159], v[178:179]
    v_pk_fma_f32 v[156:157], v[156:157], v[112:113], v[120:121]
    v_pk_fma_f32 v[158:159], v[158:159], v[114:115], v[122:123]
    v_cvt_pk_bf16_f32 v200, v156, v157
    v_cvt_pk_bf16_f32 v201, v158, v159
    ds_write_b64 v224, v[200:201] offset:128
    ds_read_b128 v[180:183], v235 offset:0
    ds_read_b128 v[184:187], v235 offset:1024
    ds_read_b128 v[76:79], v235 offset:2048
    s_waitcnt lgkmcnt(2)
    buffer_store_dwordx4 v[180:183], v248, s[60:63], 0 offen
    s_waitcnt lgkmcnt(1)
    buffer_store_dwordx4 v[184:187], v249, s[60:63], 0 offen
    s_waitcnt lgkmcnt(0)
    buffer_store_dwordx4 v[76:79], v250, s[60:63], 0 offen
L_a_end:
    s_endpgm
L_s3:
    s_mov_b32 s59, 262144
L_s3l:
    buffer_load_dwordx2 v[230:231], v229, s[84:87], s41 offen sc1
    s_waitcnt vmcnt(0)
    v_cmp_ne_u64 vcc, s[92:93], v[230:231]
    s_cbranch_vccz L_s3l_ok
L_padD_3:
    s_cbranch_execz L_vis_ret
    s_sleep 4
    s_sub_u32 s59, s59, 1
    s_cmp_lg_u32 s59, 0
    s_cbranch_scc1 L_s3l
L_s3l_ok:
    s_branch L_s3_back
L_s4:
    s_mov_b32 s59, 262144
L_s4l:
    buffer_load_dwordx2 v[230:231], off, s[84:87], s55 sc1
    s_waitcnt vmcnt(0)
    v_cmp_ne_u64 vcc, s[92:93], v[230:231]
    s_cbranch_vccz L_s4l_ok
    s_sleep 1
    s_sub_u32 s59, s59, 1
    s_cmp_lg_u32 s59, 0
    s_cbranch_scc1 L_s4l
L_s4l_ok:
    s_branch L_s4_back
L_a_noffn:
    s_lshr_b32 s7, s50, 1
L_padC_0:
    s_cbranch_execz L_padC_1
    s_mul_i32 s7, s7, 3
    s_add_u32 s7, s7, 32
    s_and_b32 s3, s50, 1
    s_lshl_b32 s3, s3, 1
    s_add_u32 s49, s7, s3
    s_cmp_lt_u32 s49, 54
    s_cselect_b32 s49, s49, 0x40000
    s_lshl_b32 s49, s49, 12
    s_add_u32 s7, s7, 1
    s_cmp_lt_u32 s7, 54
    s_cselect_b32 s7, s7, 0x40000
    s_lshl_b32 s7, s7, 12
    s_lshl_b32 s3, s3, 2
    s_add_u32 s50, s7, s3
    s_cmp_lg_u32 s3, 0
    s_cselect_b64 vcc, -1, 0
    v_cndmask_b32 v112, v242, v244, vcc
    v_cndmask_b32 v113, v243, v245, vcc
    v_cndmask_b32 v114, v244, v243, vcc
    s_waitcnt vmcnt(12) lgkmcnt(0)
    v_mfma_f32_16x16x32_bf16 a[0:3], v[192:195], a[64:67], 0
    v_mfma_f32_16x16x32_bf16 a[0:3], v[196:199], a[68:71], a[0:3]
    ds_read_b64_tr_b16 v[208:209], v243 offset:0
    ds_read_b64_tr_b16 v[210:211], v243 offset:512
    v_mfma_f32_16x16x32_bf16 a[0:3], v[200:203], a[72:75], a[0:3]
    s_mul_i32 s65, s60, 442368
    v_mfma_f32_16x16x32_bf16 a[0:3], v[204:207], a[76:79], a[0:3]
    s_waitcnt vmcnt(8)
    ds_read_b64_tr_b16 v[212:213], v243 offset:4096
    ds_read_b64_tr_b16 v[214:215], v243 offset:4608
    v_mfma_f32_16x16x32_bf16 a[4:7], v[192:195], a[80:83], 0
    s_add_u32 m0, s40, 131072
    v_mfma_f32_16x16x32_bf16 a[4:7], v[196:199], a[84:87], a[4:7]
    s_add_u32 s41, s65, 0
    ds_read_b64_tr_b16 v[216:217], v243 offset:8192
    ds_read_b64_tr_b16 v[218:219], v243 offset:8704
    v_mfma_f32_16x16x32_bf16 a[4:7], v[200:203], a[88:91], a[4:7]
    buffer_load_dwordx4 v241, s[20:23], s41 offen lds
    v_mfma_f32_16x16x32_bf16 a[4:7], v[204:207], a[92:95], a[4:7]
    s_waitcnt vmcnt(5)
    ds_read_b64_tr_b16 v[220:221], v243 offset:12288
    ds_read_b64_tr_b16 v[222:223], v243 offset:12800
    v_mfma_f32_16x16x32_bf16 a[8:11], v[192:195], a[96:99], 0
    s_add_u32 m0, s40, 135168
    v_mfma_f32_16x16x32_bf16 a[8:11], v[196:199], a[100:103], a[8:11]
    s_add_u32 s41, s65, 110592
    v_mfma_f32_16x16x32_bf16 a[8:11], v[200:203], a[104:107], a[8:11]
    buffer_load_dwordx4 v241, s[20:23], s41 offen lds
    v_mfma_f32_16x16x32_bf16 a[8:11], v[204:207], a[108:111], a[8:11]
    s_waitcnt vmcnt(2)
    v_mfma_f32_16x16x32_bf16 a[12:15], v[192:195], a[112:115], 0
    v_mfma_f32_16x16x32_bf16 a[12:15], v[196:199], a[116:119], a[12:15]
    s_add_u32 m0, s40, 139264
    v_mfma_f32_16x16x32_bf16 a[12:15], v[200:203], a[120:123], a[12:15]
    s_add_u32 s41, s65, 221184
    v_mfma_f32_16x16x32_bf16 a[12:15], v[204:207], a[124:127], a[12:15]
    s_waitcnt lgkmcnt(0)
    v_mfma_f32_16x16x32_bf16 a[16:19], v[208:211], a[64:67], 0
    buffer_load_dwordx4 v241, s[20:23], s41 offen lds
    v_mfma_f32_16x16x32_bf16 a[16:19], v[212:215], a[68:71], a[16:19]
    ds_read_b64_tr_b16 v[192:193], v244 offset:0
    ds_read_b64_tr_b16 v[194:195], v244 offset:512
    v_mfma_f32_16x16x32_bf16 a[16:19], v[216:219], a[72:75], a[16:19]
    s_add_u32 m0, s40, 143360
    v_mfma_f32_16x16x32_bf16 a[16:19], v[220:223], a[76:79], a[16:19]
    s_add_u32 s41, s65, 331776
    ds_read_b64_tr_b16 v[196:197], v244 offset:4096
    ds_read_b64_tr_b16 v[198:199], v244 offset:4608
    v_mfma_f32_16x16x32_bf16 a[20:23], v[208:211], a[80:83], 0
    buffer_load_dwordx4 v241, s[20:23], s41 offen lds
    v_mfma_f32_16x16x32_bf16 a[20:23], v[212:215], a[84:87], a[20:23]
    ds_read_b64_tr_b16 v[200:201], v244 offset:8192
    ds_read_b64_tr_b16 v[202:203], v244 offset:8704
    v_mfma_f32_16x16x32_bf16 a[20:23], v[216:219], a[88:91], a[20:23]
    s_mul_i32 s65, s60, 442368
    v_mfma_f32_16x16x32_bf16 a[20:23], v[220:223], a[92:95], a[20:23]
    s_add_u32 m0, s40, 147456
    ds_read_b64_tr_b16 v[204:205], v244 offset:12288
    ds_read_b64_tr_b16 v[206:207], v244 offset:12800
    v_mfma_f32_16x16x32_bf16 a[24:27], v[208:211], a[96:99], 0
    s_add_u32 s41, s65, 0
    v_mfma_f32_16x16x32_bf16 a[24:27], v[212:215], a[100:103], a[24:27]
    buffer_load_dwordx4 v241, s[24:27], s41 offen lds
    v_mfma_f32_16x16x32_bf16 a[24:27], v[216:219], a[104:107], a[24:27]
    v_mfma_f32_16x16x32_bf16 a[24:27], v[220:223], a[108:111], a[24:27]
    v_mfma_f32_16x16x32_bf16 a[28:31], v[208:211], a[112:115], 0
    s_add_u32 m0, s40, 151552
    v_mfma_f32_16x16x32_bf16 a[28:31], v[212:215], a[116:119], a[28:31]
    s_add_u32 s41, s65, 110592
    v_mfma_f32_16x16x32_bf16 a[28:31], v[216:219], a[120:123], a[28:31]
    buffer_load_dwordx4 v241, s[24:27], s41 offen lds
    v_mfma_f32_16x16x32_bf16 a[28:31], v[220:223], a[124:127], a[28:31]
    s_waitcnt lgkmcnt(0)
    v_mfma_f32_16x16x32_bf16 a[32:35], v[192:195], a[64:67], 0
    v_mfma_f32_16x16x32_bf16 a[32:35], v[196:199], a[68:71], a[32:35]
    ds_read_b64_tr_b16 v[208:209], v245 offset:0
    ds_read_b64_tr_b16 v[210:211], v245 offset:512
    v_mfma_f32_16x16x32_bf16 a[32:35], v[200:203], a[72:75], a[32:35]
    s_add_u32 m0, s40, 155648
    v_mfma_f32_16x16x32_bf16 a[32:35], v[204:207], a[76:79], a[32:35]
    s_add_u32 s41, s65, 221184
    ds_read_b64_tr_b16 v[212:213], v245 offset:4096
    ds_read_b64_tr_b16 v[214:215], v245 offset:4608
    v_mfma_f32_16x16x32_bf16 a[36:39], v[192:195], a[80:83], 0
    buffer_load_dwordx4 v241, s[24:27], s41 offen lds
    v_mfma_f32_16x16x32_bf16 a[36:39], v[196:199], a[84:87], a[36:39]
    ds_read_b64_tr_b16 v[216:217], v245 offset:8192
    ds_read_b64_tr_b16 v[218:219], v245 offset:8704
    v_mfma_f32_16x16x32_bf16 a[36:39], v[200:203], a[88:91], a[36:39]
    s_add_u32 m0, s40, 159744
    v_mfma_f32_16x16x32_bf16 a[36:39], v[204:207], a[92:95], a[36:39]
    s_add_u32 s41, s65, 331776
    ds_read_b64_tr_b16 v[220:221], v245 offset:12288
    ds_read_b64_tr_b16 v[222:223], v245 offset:12800
    v_mfma_f32_16x16x32_bf16 a[40:43], v[192:195], a[96:99], 0
    buffer_load_dwordx4 v241, s[24:27], s41 offen lds
    v_mfma_f32_16x16x32_bf16 a[40:43], v[196:199], a[100:103], a[40:43]
    v_mfma_f32_16x16x32_bf16 a[40:43], v[200:203], a[104:107], a[40:43]
    v_mfma_f32_16x16x32_bf16 a[40:43], v[204:207], a[108:111], a[40:43]
    v_mfma_f32_16x16x32_bf16 a[44:47], v[192:195], a[112:115], 0
    v_mfma_f32_16x16x32_bf16 a[44:47], v[196:199], a[116:119], a[44:47]
    v_mfma_f32_16x16x32_bf16 a[44:47], v[200:203], a[120:123], a[44:47]
    v_mfma_f32_16x16x32_bf16 a[44:47], v[204:207], a[124:127], a[44:47]
    s_waitcnt lgkmcnt(0)
    v_mfma_f32_16x16x32_bf16 a[48:51], v[208:211], a[64:67], 0
    s_waitcnt vmcnt(25)
    s_barrier
    v_mfma_f32_16x16x32_bf16 a[48:51], v[212:215], a[68:71], a[48:51]
    s_mul_i32 s65, s61, 1048576
    ds_read_b64_tr_b16 v[192:193], v242 offset:16384
    ds_read_b64_tr_b16 v[194:195], v242 offset:16896
    v_mfma_f32_16x16x32_bf16 a[48:51], v[216:219], a[72:75], a[48:51]
    s_add_u32 m0, s40, 98304
    v_mfma_f32_16x16x32_bf16 a[48:51], v[220:223], a[76:79], a[48:51]
    s_add_u32 s41, s65, 0
    ds_read_b64_tr_b16 v[196:197], v242 offset:20480
    ds_read_b64_tr_b16 v[198:199], v242 offset:20992
    v_mfma_f32_16x16x32_bf16 a[52:55], v[208:211], a[80:83], 0
    buffer_load_dwordx4 v240, s[16:19], s41 offen lds
    v_mfma_f32_16x16x32_bf16 a[52:55], v[212:215], a[84:87], a[52:55]
    ds_read_b64_tr_b16 v[200:201], v242 offset:24576
    ds_read_b64_tr_b16 v[202:203], v242 offset:25088
    v_mfma_f32_16x16x32_bf16 a[52:55], v[216:219], a[88:91], a[52:55]
    s_add_u32 m0, s40, 102400
    v_mfma_f32_16x16x32_bf16 a[52:55], v[220:223], a[92:95], a[52:55]
    s_add_u32 s41, s65, 262144
    ds_read_b64_tr_b16 v[204:205], v242 offset:28672
    ds_read_b64_tr_b16 v[206:207], v242 offset:29184
    v_mfma_f32_16x16x32_bf16 a[56:59], v[208:211], a[96:99], 0
    buffer_load_dwordx4 v240, s[16:19], s41 offen lds
    v_mfma_f32_16x16x32_bf16 a[56:59], v[212:215], a[100:103], a[56:59]
    v_mfma_f32_16x16x32_bf16 a[56:59], v[216:219], a[104:107], a[56:59]
    s_add_u32 m0, s40, 106496
    v_mfma_f32_16x16x32_bf16 a[56:59], v[220:223], a[108:111], a[56:59]
    s_add_u32 s41, s65, 524288
    v_mfma_f32_16x16x32_bf16 a[60:63], v[208:211], a[112:115], 0
    buffer_load_dwordx4 v240, s[16:19], s41 offen lds
    v_mfma_f32_16x16x32_bf16 a[60:63], v[212:215], a[116:119], a[60:63]
    s_add_u32 m0, s40, 110592
    v_mfma_f32_16x16x32_bf16 a[60:63], v[216:219], a[120:123], a[60:63]
    s_add_u32 s41, s65, 786432
    v_mfma_f32_16x16x32_bf16 a[60:63], v[220:223], a[124:127], a[60:63]
    s_waitcnt lgkmcnt(0)
    v_mfma_f32_16x16x32_bf16 v[128:131], v[192:195], a[64:67], 0
    buffer_load_dwordx4 v240, s[16:19], s41 offen lds
    v_mfma_f32_16x16x32_bf16 v[128:131], v[196:199], a[68:71], v[128:131]
    ds_read_b64_tr_b16 v[208:209], v243 offset:16384
    ds_read_b64_tr_b16 v[210:211], v243 offset:16896
    v_mfma_f32_16x16x32_bf16 v[128:131], v[200:203], a[72:75], v[128:131]
    s_lshl_b32 s59, s61, 11
    v_mfma_f32_16x16x32_bf16 v[128:131], v[204:207], a[76:79], v[128:131]
    s_add_u32 s55, s59, 0
    ds_read_b64_tr_b16 v[212:213], v243 offset:20480
    ds_read_b64_tr_b16 v[214:215], v243 offset:20992
    v_mfma_f32_16x16x32_bf16 v[132:135], v[192:195], a[80:83], 0
    buffer_load_dwordx4 a[128:131], v239, s[28:31], s55 offen offset:0 sc1
    v_mfma_f32_16x16x32_bf16 v[132:135], v[196:199], a[84:87], v[132:135]
    ds_read_b64_tr_b16 v[216:217], v243 offset:24576
    ds_read_b64_tr_b16 v[218:219], v243 offset:25088
    v_mfma_f32_16x16x32_bf16 v[132:135], v[200:203], a[88:91], v[132:135]
    v_mfma_f32_16x16x32_bf16 v[132:135], v[204:207], a[92:95], v[132:135]
    ds_read_b64_tr_b16 v[220:221], v243 offset:28672
    ds_read_b64_tr_b16 v[222:223], v243 offset:29184
    v_mfma_f32_16x16x32_bf16 v[136:139], v[192:195], a[96:99], 0
    buffer_load_dwordx4 a[132:135], v239, s[28:31], s55 offen offset:512 sc1
    v_mfma_f32_16x16x32_bf16 v[136:139], v[196:199], a[100:103], v[136:139]
    v_mfma_f32_16x16x32_bf16 v[136:139], v[200:203], a[104:107], v[136:139]
    v_mfma_f32_16x16x32_bf16 v[136:139], v[204:207], a[108:111], v[136:139]
    v_mfma_f32_16x16x32_bf16 v[140:143], v[192:195], a[112:115], 0
    buffer_load_dwordx4 a[136:139], v239, s[28:31], s55 offen offset:1024 sc1
    v_mfma_f32_16x16x32_bf16 v[140:143], v[196:199], a[116:119], v[140:143]
    v_mfma_f32_16x16x32_bf16 v[140:143], v[200:203], a[120:123], v[140:143]
    v_mfma_f32_16x16x32_bf16 v[140:143], v[204:207], a[124:127], v[140:143]
    s_waitcnt lgkmcnt(0)
    v_mfma_f32_16x16x32_bf16 v[144:147], v[208:211], a[64:67], 0
    buffer_load_dwordx4 a[140:143], v239, s[28:31], s55 offen offset:1536 sc1
    v_mfma_f32_16x16x32_bf16 v[144:147], v[212:215], a[68:71], v[144:147]
    ds_read_b64_tr_b16 v[192:193], v244 offset:16384
    ds_read_b64_tr_b16 v[194:195], v244 offset:16896
    v_mfma_f32_16x16x32_bf16 v[144:147], v[216:219], a[72:75], v[144:147]
    v_mfma_f32_16x16x32_bf16 v[144:147], v[220:223], a[76:79], v[144:147]
    s_add_u32 s55, s59, 20480
    ds_read_b64_tr_b16 v[196:197], v244 offset:20480
    ds_read_b64_tr_b16 v[198:199], v244 offset:20992
    v_mfma_f32_16x16x32_bf16 v[148:151], v[208:211], a[80:83], 0
    buffer_load_dwordx4 a[144:147], v239, s[28:31], s55 offen offset:0 sc1
    v_mfma_f32_16x16x32_bf16 v[148:151], v[212:215], a[84:87], v[148:151]
    ds_read_b64_tr_b16 v[200:201], v244 offset:24576
    ds_read_b64_tr_b16 v[202:203], v244 offset:25088
    v_mfma_f32_16x16x32_bf16 v[148:151], v[216:219], a[88:91], v[148:151]
    v_mfma_f32_16x16x32_bf16 v[148:151], v[220:223], a[92:95], v[148:151]
    ds_read_b64_tr_b16 v[204:205], v244 offset:28672
    ds_read_b64_tr_b16 v[206:207], v244 offset:29184
    v_mfma_f32_16x16x32_bf16 v[152:155], v[208:211], a[96:99], 0
    buffer_load_dwordx4 a[148:151], v239, s[28:31], s55 offen offset:512 sc1
    v_mfma_f32_16x16x32_bf16 v[152:155], v[212:215], a[100:103], v[152:155]
    v_mfma_f32_16x16x32_bf16 v[152:155], v[216:219], a[104:107], v[152:155]
    v_mfma_f32_16x16x32_bf16 v[152:155], v[220:223], a[108:111], v[152:155]
    v_mfma_f32_16x16x32_bf16 v[156:159], v[208:211], a[112:115], 0
    buffer_load_dwordx4 a[152:155], v239, s[28:31], s55 offen offset:1024 sc1
    v_mfma_f32_16x16x32_bf16 v[156:159], v[212:215], a[116:119], v[156:159]
    v_mfma_f32_16x16x32_bf16 v[156:159], v[216:219], a[120:123], v[156:159]
    v_mfma_f32_16x16x32_bf16 v[156:159], v[220:223], a[124:127], v[156:159]
    s_waitcnt lgkmcnt(0)
    v_mfma_f32_16x16x32_bf16 v[160:163], v[192:195], a[64:67], 0
    buffer_load_dwordx4 a[156:159], v239, s[28:31], s55 offen offset:1536 sc1
    v_mfma_f32_16x16x32_bf16 v[160:163], v[196:199], a[68:71], v[160:163]
    ds_read_b64_tr_b16 v[208:209], v245 offset:16384
    ds_read_b64_tr_b16 v[210:211], v245 offset:16896
    v_mfma_f32_16x16x32_bf16 v[160:163], v[200:203], a[72:75], v[160:163]
    v_mfma_f32_16x16x32_bf16 v[160:163], v[204:207], a[76:79], v[160:163]
    s_add_u32 s55, s59, 40960
    ds_read_b64_tr_b16 v[212:213], v245 offset:20480
    ds_read_b64_tr_b16 v[214:215], v245 offset:20992
    v_mfma_f32_16x16x32_bf16 v[164:167], v[192:195], a[80:83], 0
    buffer_load_dwordx4 a[160:163], v239, s[28:31], s55 offen offset:0 sc1
    v_mfma_f32_16x16x32_bf16 v[164:167], v[196:199], a[84:87], v[164:167]
L_padC_1:
    s_cbranch_execz L_padC_2
    ds_read_b64_tr_b16 v[216:217], v245 offset:24576
    ds_read_b64_tr_b16 v[218:219], v245 offset:25088
    v_mfma_f32_16x16x32_bf16 v[164:167], v[200:203], a[88:91], v[164:167]
    v_mfma_f32_16x16x32_bf16 v[164:167], v[204:207], a[92:95], v[164:167]
    ds_read_b64_tr_b16 v[220:221], v245 offset:28672
    ds_read_b64_tr_b16 v[222:223], v245 offset:29184
    v_mfma_f32_16x16x32_bf16 v[168:171], v[192:195], a[96:99], 0
    buffer_load_dwordx4 a[164:167], v239, s[28:31], s55 offen offset:512 sc1
    v_mfma_f32_16x16x32_bf16 v[168:171], v[196:199], a[100:103], v[168:171]
    v_mfma_f32_16x16x32_bf16 v[168:171], v[200:203], a[104:107], v[168:171]
    v_mfma_f32_16x16x32_bf16 v[168:171], v[204:207], a[108:111], v[168:171]
    v_mfma_f32_16x16x32_bf16 v[172:175], v[192:195], a[112:115], 0
    v_mfma_f32_16x16x32_bf16 v[172:175], v[196:199], a[116:119], v[172:175]
    v_mfma_f32_16x16x32_bf16 v[172:175], v[200:203], a[120:123], v[172:175]
    v_mfma_f32_16x16x32_bf16 v[172:175], v[204:207], a[124:127], v[172:175]
    s_waitcnt lgkmcnt(0)
    v_mfma_f32_16x16x32_bf16 v[176:179], v[208:211], a[64:67], 0
    s_waitcnt vmcnt(18)
    s_barrier
    v_mfma_f32_16x16x32_bf16 v[176:179], v[212:215], a[68:71], v[176:179]
    s_mul_i32 s65, s61, 442368
    ds_read_b64_tr_b16 v[192:193], v112 offset:32768
    ds_read_b64_tr_b16 v[194:195], v112 offset:33280
    v_mfma_f32_16x16x32_bf16 v[176:179], v[216:219], a[72:75], v[176:179]
    s_add_u32 m0, s40, 114688
    v_mfma_f32_16x16x32_bf16 v[176:179], v[220:223], a[76:79], v[176:179]
    s_add_u32 s41, s65, 0
    ds_read_b64_tr_b16 v[196:197], v112 offset:36864
    ds_read_b64_tr_b16 v[198:199], v112 offset:37376
    v_mfma_f32_16x16x32_bf16 v[180:183], v[208:211], a[80:83], 0
    buffer_load_dwordx4 v241, s[20:23], s41 offen lds
    v_mfma_f32_16x16x32_bf16 v[180:183], v[212:215], a[84:87], v[180:183]
    ds_read_b64_tr_b16 v[200:201], v112 offset:40960
    ds_read_b64_tr_b16 v[202:203], v112 offset:41472
    v_mfma_f32_16x16x32_bf16 v[180:183], v[216:219], a[88:91], v[180:183]
    s_add_u32 m0, s40, 118784
    v_mfma_f32_16x16x32_bf16 v[180:183], v[220:223], a[92:95], v[180:183]
    s_add_u32 s41, s65, 110592
    ds_read_b64_tr_b16 v[204:205], v112 offset:45056
    ds_read_b64_tr_b16 v[206:207], v112 offset:45568
    v_mfma_f32_16x16x32_bf16 v[184:187], v[208:211], a[96:99], 0
    buffer_load_dwordx4 v241, s[20:23], s41 offen lds
    v_mfma_f32_16x16x32_bf16 v[184:187], v[212:215], a[100:103], v[184:187]
    v_mfma_f32_16x16x32_bf16 v[184:187], v[216:219], a[104:107], v[184:187]
    s_add_u32 m0, s40, 122880
    v_mfma_f32_16x16x32_bf16 v[184:187], v[220:223], a[108:111], v[184:187]
    s_add_u32 s41, s65, 221184
    v_mfma_f32_16x16x32_bf16 v[188:191], v[208:211], a[112:115], 0
    buffer_load_dwordx4 v241, s[20:23], s41 offen lds
    v_mfma_f32_16x16x32_bf16 v[188:191], v[212:215], a[116:119], v[188:191]
    s_add_u32 m0, s40, 126976
    v_mfma_f32_16x16x32_bf16 v[188:191], v[216:219], a[120:123], v[188:191]
    s_add_u32 s41, s65, 331776
    v_mfma_f32_16x16x32_bf16 v[188:191], v[220:223], a[124:127], v[188:191]
    s_waitcnt lgkmcnt(0)
    v_mfma_f32_16x16x32_bf16 v[0:3], v[192:195], a[64:67], 0
    buffer_load_dwordx4 v241, s[20:23], s41 offen lds
    v_mfma_f32_16x16x32_bf16 v[0:3], v[196:199], a[68:71], v[0:3]
    ds_read_b64_tr_b16 v[208:209], v113 offset:32768
    ds_read_b64_tr_b16 v[210:211], v113 offset:33280
    v_mfma_f32_16x16x32_bf16 v[0:3], v[200:203], a[72:75], v[0:3]
    v_mfma_f32_16x16x32_bf16 v[0:3], v[204:207], a[76:79], v[0:3]
    ds_read_b64_tr_b16 v[212:213], v113 offset:36864
    ds_read_b64_tr_b16 v[214:215], v113 offset:37376
    v_mfma_f32_16x16x32_bf16 v[4:7], v[192:195], a[80:83], 0
    buffer_load_dwordx4 a[168:171], v239, s[28:31], s55 offen offset:1024 sc1
    v_mfma_f32_16x16x32_bf16 v[4:7], v[196:199], a[84:87], v[4:7]
    ds_read_b64_tr_b16 v[216:217], v113 offset:40960
    ds_read_b64_tr_b16 v[218:219], v113 offset:41472
    v_mfma_f32_16x16x32_bf16 v[4:7], v[200:203], a[88:91], v[4:7]
    v_mfma_f32_16x16x32_bf16 v[4:7], v[204:207], a[92:95], v[4:7]
    ds_read_b64_tr_b16 v[220:221], v113 offset:45056
    ds_read_b64_tr_b16 v[222:223], v113 offset:45568
    v_mfma_f32_16x16x32_bf16 v[8:11], v[192:195], a[96:99], 0
    buffer_load_dwordx4 a[172:175], v239, s[28:31], s55 offen offset:1536 sc1
    v_mfma_f32_16x16x32_bf16 v[8:11], v[196:199], a[100:103], v[8:11]
    v_mfma_f32_16x16x32_bf16 v[8:11], v[200:203], a[104:107], v[8:11]
    v_mfma_f32_16x16x32_bf16 v[8:11], v[204:207], a[108:111], v[8:11]
    s_add_u32 s55, s59, 61440
    v_mfma_f32_16x16x32_bf16 v[12:15], v[192:195], a[112:115], 0
    buffer_load_dwordx4 a[176:179], v239, s[28:31], s55 offen offset:0 sc1
    v_mfma_f32_16x16x32_bf16 v[12:15], v[196:199], a[116:119], v[12:15]
    v_mfma_f32_16x16x32_bf16 v[12:15], v[200:203], a[120:123], v[12:15]
    v_mfma_f32_16x16x32_bf16 v[12:15], v[204:207], a[124:127], v[12:15]
    s_waitcnt lgkmcnt(0)
    v_mfma_f32_16x16x32_bf16 v[16:19], v[208:211], a[64:67], 0
    buffer_load_dwordx4 a[180:183], v239, s[28:31], s55 offen offset:512 sc1
    v_mfma_f32_16x16x32_bf16 v[16:19], v[212:215], a[68:71], v[16:19]
    ds_read_b64_tr_b16 v[192:193], v114 offset:32768
    ds_read_b64_tr_b16 v[194:195], v114 offset:33280
    v_mfma_f32_16x16x32_bf16 v[16:19], v[216:219], a[72:75], v[16:19]
    v_mfma_f32_16x16x32_bf16 v[16:19], v[220:223], a[76:79], v[16:19]
    ds_read_b64_tr_b16 v[196:197], v114 offset:36864
    ds_read_b64_tr_b16 v[198:199], v114 offset:37376
    v_mfma_f32_16x16x32_bf16 v[20:23], v[208:211], a[80:83], 0
    buffer_load_dwordx4 a[184:187], v239, s[28:31], s55 offen offset:1024 sc1
    v_mfma_f32_16x16x32_bf16 v[20:23], v[212:215], a[84:87], v[20:23]
    ds_read_b64_tr_b16 v[200:201], v114 offset:40960
    ds_read_b64_tr_b16 v[202:203], v114 offset:41472
    v_mfma_f32_16x16x32_bf16 v[20:23], v[216:219], a[88:91], v[20:23]
    v_mfma_f32_16x16x32_bf16 v[20:23], v[220:223], a[92:95], v[20:23]
    ds_read_b64_tr_b16 v[204:205], v114 offset:45056
    ds_read_b64_tr_b16 v[206:207], v114 offset:45568
    v_mfma_f32_16x16x32_bf16 v[24:27], v[208:211], a[96:99], 0
    buffer_load_dwordx4 a[188:191], v239, s[28:31], s55 offen offset:1536 sc1
    v_mfma_f32_16x16x32_bf16 v[24:27], v[212:215], a[100:103], v[24:27]
    v_mfma_f32_16x16x32_bf16 v[24:27], v[216:219], a[104:107], v[24:27]
    v_mfma_f32_16x16x32_bf16 v[24:27], v[220:223], a[108:111], v[24:27]
    v_mfma_f32_16x16x32_bf16 v[28:31], v[208:211], a[112:115], 0
    v_mfma_f32_16x16x32_bf16 v[28:31], v[212:215], a[116:119], v[28:31]
    v_mfma_f32_16x16x32_bf16 v[28:31], v[216:219], a[120:123], v[28:31]
    v_mfma_f32_16x16x32_bf16 v[28:31], v[220:223], a[124:127], v[28:31]
    s_waitcnt lgkmcnt(0)
    v_mfma_f32_16x16x32_bf16 v[32:35], v[192:195], a[64:67], 0
    s_waitcnt vmcnt(24)
    s_barrier
    v_mfma_f32_16x16x32_bf16 v[32:35], v[196:199], a[68:71], v[32:35]
    s_mul_i32 s65, s61, 442368
    ds_read_b64_tr_b16 v[208:209], v112 offset:49152
    ds_read_b64_tr_b16 v[210:211], v112 offset:49664
    v_mfma_f32_16x16x32_bf16 v[32:35], v[200:203], a[72:75], v[32:35]
    s_add_u32 m0, s40, 131072
    v_mfma_f32_16x16x32_bf16 v[32:35], v[204:207], a[76:79], v[32:35]
    s_add_u32 s41, s65, 0
    ds_read_b64_tr_b16 v[212:213], v112 offset:53248
    ds_read_b64_tr_b16 v[214:215], v112 offset:53760
    v_mfma_f32_16x16x32_bf16 v[36:39], v[192:195], a[80:83], 0
    buffer_load_dwordx4 v241, s[24:27], s41 offen lds
    v_mfma_f32_16x16x32_bf16 v[36:39], v[196:199], a[84:87], v[36:39]
    ds_read_b64_tr_b16 v[216:217], v112 offset:57344
    ds_read_b64_tr_b16 v[218:219], v112 offset:57856
    v_mfma_f32_16x16x32_bf16 v[36:39], v[200:203], a[88:91], v[36:39]
    v_mfma_f32_16x16x32_bf16 v[36:39], v[204:207], a[92:95], v[36:39]
    s_add_u32 m0, s40, 135168
    ds_read_b64_tr_b16 v[220:221], v112 offset:61440
    ds_read_b64_tr_b16 v[222:223], v112 offset:61952
    v_mfma_f32_16x16x32_bf16 v[40:43], v[192:195], a[96:99], 0
    s_add_u32 s41, s65, 110592
    v_mfma_f32_16x16x32_bf16 v[40:43], v[196:199], a[100:103], v[40:43]
    buffer_load_dwordx4 v241, s[24:27], s41 offen lds
    v_mfma_f32_16x16x32_bf16 v[40:43], v[200:203], a[104:107], v[40:43]
    v_mfma_f32_16x16x32_bf16 v[40:43], v[204:207], a[108:111], v[40:43]
    v_mfma_f32_16x16x32_bf16 v[44:47], v[192:195], a[112:115], 0
    v_mfma_f32_16x16x32_bf16 v[44:47], v[196:199], a[116:119], v[44:47]
    s_add_u32 m0, s40, 139264
    v_mfma_f32_16x16x32_bf16 v[44:47], v[200:203], a[120:123], v[44:47]
    s_add_u32 s41, s65, 221184
    v_mfma_f32_16x16x32_bf16 v[44:47], v[204:207], a[124:127], v[44:47]
    s_waitcnt lgkmcnt(0)
    v_mfma_f32_16x16x32_bf16 v[64:67], v[208:211], a[64:67], 0
    buffer_load_dwordx4 v241, s[24:27], s41 offen lds
    v_mfma_f32_16x16x32_bf16 v[64:67], v[212:215], a[68:71], v[64:67]
    ds_read_b64_tr_b16 v[192:193], v113 offset:49152
    ds_read_b64_tr_b16 v[194:195], v113 offset:49664
    v_mfma_f32_16x16x32_bf16 v[64:67], v[216:219], a[72:75], v[64:67]
    v_mfma_f32_16x16x32_bf16 v[64:67], v[220:223], a[76:79], v[64:67]
    ds_read_b64_tr_b16 v[196:197], v113 offset:53248
    ds_read_b64_tr_b16 v[198:199], v113 offset:53760
    v_mfma_f32_16x16x32_bf16 v[68:71], v[208:211], a[80:83], 0
    s_add_u32 m0, s40, 143360
    v_mfma_f32_16x16x32_bf16 v[68:71], v[212:215], a[84:87], v[68:71]
    s_add_u32 s41, s65, 331776
    ds_read_b64_tr_b16 v[200:201], v113 offset:57344
    ds_read_b64_tr_b16 v[202:203], v113 offset:57856
    v_mfma_f32_16x16x32_bf16 v[68:71], v[216:219], a[88:91], v[68:71]
    buffer_load_dwordx4 v241, s[24:27], s41 offen lds
    v_mfma_f32_16x16x32_bf16 v[68:71], v[220:223], a[92:95], v[68:71]
    ds_read_b64_tr_b16 v[204:205], v113 offset:61440
    ds_read_b64_tr_b16 v[206:207], v113 offset:61952
    v_mfma_f32_16x16x32_bf16 v[72:75], v[208:211], a[96:99], 0
    v_mfma_f32_16x16x32_bf16 v[72:75], v[212:215], a[100:103], v[72:75]
    s_lshl_b32 s59, s62, 11
    v_mfma_f32_16x16x32_bf16 v[72:75], v[216:219], a[104:107], v[72:75]
    s_add_u32 s55, s59, 0
    v_mfma_f32_16x16x32_bf16 v[72:75], v[220:223], a[108:111], v[72:75]
    buffer_load_dwordx4 a[192:195], v239, s[28:31], s55 offen offset:0 sc1
    v_mfma_f32_16x16x32_bf16 v[76:79], v[208:211], a[112:115], 0
    v_mfma_f32_16x16x32_bf16 v[76:79], v[212:215], a[116:119], v[76:79]
    v_mfma_f32_16x16x32_bf16 v[76:79], v[216:219], a[120:123], v[76:79]
    v_mfma_f32_16x16x32_bf16 v[76:79], v[220:223], a[124:127], v[76:79]
    s_waitcnt lgkmcnt(0)
    v_mfma_f32_16x16x32_bf16 v[80:83], v[192:195], a[64:67], 0
    v_mfma_f32_16x16x32_bf16 v[80:83], v[196:199], a[68:71], v[80:83]
    ds_read_b64_tr_b16 v[208:209], v114 offset:49152
    ds_read_b64_tr_b16 v[210:211], v114 offset:49664
    v_mfma_f32_16x16x32_bf16 v[80:83], v[200:203], a[72:75], v[80:83]
    buffer_load_dwordx4 a[196:199], v239, s[28:31], s55 offen offset:512 sc1
    v_mfma_f32_16x16x32_bf16 v[80:83], v[204:207], a[76:79], v[80:83]
    ds_read_b64_tr_b16 v[212:213], v114 offset:53248
    ds_read_b64_tr_b16 v[214:215], v114 offset:53760
    v_mfma_f32_16x16x32_bf16 v[84:87], v[192:195], a[80:83], 0
    v_mfma_f32_16x16x32_bf16 v[84:87], v[196:199], a[84:87], v[84:87]
    ds_read_b64_tr_b16 v[216:217], v114 offset:57344
    ds_read_b64_tr_b16 v[218:219], v114 offset:57856
    v_mfma_f32_16x16x32_bf16 v[84:87], v[200:203], a[88:91], v[84:87]
    v_mfma_f32_16x16x32_bf16 v[84:87], v[204:207], a[92:95], v[84:87]
    ds_read_b64_tr_b16 v[220:221], v114 offset:61440
    ds_read_b64_tr_b16 v[222:223], v114 offset:61952
    v_mfma_f32_16x16x32_bf16 v[88:91], v[192:195], a[96:99], 0
    buffer_load_dwordx4 a[200:203], v239, s[28:31], s55 offen offset:1024 sc1
    v_mfma_f32_16x16x32_bf16 v[88:91], v[196:199], a[100:103], v[88:91]
    v_mfma_f32_16x16x32_bf16 v[88:91], v[200:203], a[104:107], v[88:91]
    v_mfma_f32_16x16x32_bf16 v[88:91], v[204:207], a[108:111], v[88:91]
    v_mfma_f32_16x16x32_bf16 v[92:95], v[192:195], a[112:115], 0
    v_mfma_f32_16x16x32_bf16 v[92:95], v[196:199], a[116:119], v[92:95]
    v_mfma_f32_16x16x32_bf16 v[92:95], v[200:203], a[120:123], v[92:95]
    v_mfma_f32_16x16x32_bf16 v[92:95], v[204:207], a[124:127], v[92:95]
    s_waitcnt lgkmcnt(0)
    v_mfma_f32_16x16x32_bf16 v[96:99], v[208:211], a[64:67], 0
    s_waitcnt vmcnt(27)
    s_barrier
    v_mfma_f32_16x16x32_bf16 v[96:99], v[212:215], a[68:71], v[96:99]
    s_mul_i32 s65, s61, 1048576
    ds_read_b64_tr_b16 v[192:193], v242 offset:0
    ds_read_b64_tr_b16 v[194:195], v242 offset:512
    v_mfma_f32_16x16x32_bf16 v[96:99], v[216:219], a[72:75], v[96:99]
    s_add_u32 m0, s40, 147456
    v_mfma_f32_16x16x32_bf16 v[96:99], v[220:223], a[76:79], v[96:99]
    s_add_u32 s41, s65, 128
    ds_read_b64_tr_b16 v[196:197], v242 offset:4096
    ds_read_b64_tr_b16 v[198:199], v242 offset:4608
    v_mfma_f32_16x16x32_bf16 v[100:103], v[208:211], a[80:83], 0
    buffer_load_dwordx4 v240, s[16:19], s41 offen lds
    v_mfma_f32_16x16x32_bf16 v[100:103], v[212:215], a[84:87], v[100:103]
    ds_read_b64_tr_b16 v[200:201], v242 offset:8192
    ds_read_b64_tr_b16 v[202:203], v242 offset:8704
    v_mfma_f32_16x16x32_bf16 v[100:103], v[216:219], a[88:91], v[100:103]
    s_add_u32 m0, s40, 151552
    v_mfma_f32_16x16x32_bf16 v[100:103], v[220:223], a[92:95], v[100:103]
    s_add_u32 s41, s65, 262272
    ds_read_b64_tr_b16 v[204:205], v242 offset:12288
    ds_read_b64_tr_b16 v[206:207], v242 offset:12800
    v_mfma_f32_16x16x32_bf16 v[104:107], v[208:211], a[96:99], 0
    buffer_load_dwordx4 v240, s[16:19], s41 offen lds
    v_mfma_f32_16x16x32_bf16 v[104:107], v[212:215], a[100:103], v[104:107]
    v_mfma_f32_16x16x32_bf16 v[104:107], v[216:219], a[104:107], v[104:107]
    s_add_u32 m0, s40, 155648
    v_mfma_f32_16x16x32_bf16 v[104:107], v[220:223], a[108:111], v[104:107]
    s_add_u32 s41, s65, 524416
    v_mfma_f32_16x16x32_bf16 v[108:111], v[208:211], a[112:115], 0
    buffer_load_dwordx4 v240, s[16:19], s41 offen lds
    v_mfma_f32_16x16x32_bf16 v[108:111], v[212:215], a[116:119], v[108:111]
    v_mfma_f32_16x16x32_bf16 v[108:111], v[216:219], a[120:123], v[108:111]
    v_mfma_f32_16x16x32_bf16 v[108:111], v[220:223], a[124:127], v[108:111]
    s_waitcnt lgkmcnt(0) vmcnt(10)
    v_mfma_f32_16x16x32_bf16 a[0:3], v[192:195], a[128:131], a[0:3]
    s_add_u32 m0, s40, 159744
    v_mfma_f32_16x16x32_bf16 a[0:3], v[196:199], a[132:135], a[0:3]
    s_add_u32 s41, s65, 786560
    ds_read_b64_tr_b16 v[208:209], v243 offset:0
    ds_read_b64_tr_b16 v[210:211], v243 offset:512
    v_mfma_f32_16x16x32_bf16 a[0:3], v[200:203], a[136:139], a[0:3]
    buffer_load_dwordx4 v240, s[16:19], s41 offen lds
    v_mfma_f32_16x16x32_bf16 a[0:3], v[204:207], a[140:143], a[0:3]
    ds_read_b64_tr_b16 v[212:213], v243 offset:4096
    ds_read_b64_tr_b16 v[214:215], v243 offset:4608
    v_mfma_f32_16x16x32_bf16 a[4:7], v[192:195], a[144:147], a[4:7]
    v_mfma_f32_16x16x32_bf16 a[4:7], v[196:199], a[148:151], a[4:7]
    ds_read_b64_tr_b16 v[216:217], v243 offset:8192
    ds_read_b64_tr_b16 v[218:219], v243 offset:8704
    v_mfma_f32_16x16x32_bf16 a[4:7], v[200:203], a[152:155], a[4:7]
    buffer_load_dwordx4 a[204:207], v239, s[28:31], s55 offen offset:1536 sc1
    v_mfma_f32_16x16x32_bf16 a[4:7], v[204:207], a[156:159], a[4:7]
    ds_read_b64_tr_b16 v[220:221], v243 offset:12288
    ds_read_b64_tr_b16 v[222:223], v243 offset:12800
    v_mfma_f32_16x16x32_bf16 a[8:11], v[192:195], a[160:163], a[8:11]
    s_add_u32 s55, s59, 20480
    v_mfma_f32_16x16x32_bf16 a[8:11], v[196:199], a[164:167], a[8:11]
    buffer_load_dwordx4 a[208:211], v239, s[28:31], s55 offen offset:0 sc1
    v_mfma_f32_16x16x32_bf16 a[8:11], v[200:203], a[168:171], a[8:11]
    v_mfma_f32_16x16x32_bf16 a[8:11], v[204:207], a[172:175], a[8:11]
    v_mfma_f32_16x16x32_bf16 a[12:15], v[192:195], a[176:179], a[12:15]
    v_mfma_f32_16x16x32_bf16 a[12:15], v[196:199], a[180:183], a[12:15]
    v_mfma_f32_16x16x32_bf16 a[12:15], v[200:203], a[184:187], a[12:15]
    buffer_load_dwordx4 a[212:215], v239, s[28:31], s55 offen offset:512 sc1
    v_mfma_f32_16x16x32_bf16 a[12:15], v[204:207], a[188:191], a[12:15]
    s_waitcnt lgkmcnt(0)
    v_mfma_f32_16x16x32_bf16 a[16:19], v[208:211], a[128:131], a[16:19]
    v_mfma_f32_16x16x32_bf16 a[16:19], v[212:215], a[132:135], a[16:19]
    ds_read_b64_tr_b16 v[192:193], v244 offset:0
    ds_read_b64_tr_b16 v[194:195], v244 offset:512
    v_mfma_f32_16x16x32_bf16 a[16:19], v[216:219], a[136:139], a[16:19]
    buffer_load_dwordx4 a[216:219], v239, s[28:31], s55 offen offset:1024 sc1
    v_mfma_f32_16x16x32_bf16 a[16:19], v[220:223], a[140:143], a[16:19]
    ds_read_b64_tr_b16 v[196:197], v244 offset:4096
    ds_read_b64_tr_b16 v[198:199], v244 offset:4608
    v_mfma_f32_16x16x32_bf16 a[20:23], v[208:211], a[144:147], a[20:23]
    v_mfma_f32_16x16x32_bf16 a[20:23], v[212:215], a[148:151], a[20:23]
    ds_read_b64_tr_b16 v[200:201], v244 offset:8192
    ds_read_b64_tr_b16 v[202:203], v244 offset:8704
    v_mfma_f32_16x16x32_bf16 a[20:23], v[216:219], a[152:155], a[20:23]
    v_mfma_f32_16x16x32_bf16 a[20:23], v[220:223], a[156:159], a[20:23]
    ds_read_b64_tr_b16 v[204:205], v244 offset:12288
    ds_read_b64_tr_b16 v[206:207], v244 offset:12800
    v_mfma_f32_16x16x32_bf16 a[24:27], v[208:211], a[160:163], a[24:27]
    buffer_load_dwordx4 a[220:223], v239, s[28:31], s55 offen offset:1536 sc1
    v_mfma_f32_16x16x32_bf16 a[24:27], v[212:215], a[164:167], a[24:27]
    v_mfma_f32_16x16x32_bf16 a[24:27], v[216:219], a[168:171], a[24:27]
    s_add_u32 s55, s59, 40960
    v_mfma_f32_16x16x32_bf16 a[24:27], v[220:223], a[172:175], a[24:27]
    buffer_load_dwordx4 a[224:227], v239, s[28:31], s55 offen offset:0 sc1
    v_mfma_f32_16x16x32_bf16 a[28:31], v[208:211], a[176:179], a[28:31]
    v_mfma_f32_16x16x32_bf16 a[28:31], v[212:215], a[180:183], a[28:31]
    v_mfma_f32_16x16x32_bf16 a[28:31], v[216:219], a[184:187], a[28:31]
    v_mfma_f32_16x16x32_bf16 a[28:31], v[220:223], a[188:191], a[28:31]
    s_waitcnt lgkmcnt(0)
    v_mfma_f32_16x16x32_bf16 a[32:35], v[192:195], a[128:131], a[32:35]
    buffer_load_dwordx4 a[228:231], v239, s[28:31], s55 offen offset:512 sc1
    v_mfma_f32_16x16x32_bf16 a[32:35], v[196:199], a[132:135], a[32:35]
    ds_read_b64_tr_b16 v[208:209], v245 offset:0
    ds_read_b64_tr_b16 v[210:211], v245 offset:512
    v_mfma_f32_16x16x32_bf16 a[32:35], v[200:203], a[136:139], a[32:35]
    v_mfma_f32_16x16x32_bf16 a[32:35], v[204:207], a[140:143], a[32:35]
    ds_read_b64_tr_b16 v[212:213], v245 offset:4096
    ds_read_b64_tr_b16 v[214:215], v245 offset:4608
    v_mfma_f32_16x16x32_bf16 a[36:39], v[192:195], a[144:147], a[36:39]
    buffer_load_dwordx4 a[232:235], v239, s[28:31], s55 offen offset:1024 sc1
    v_mfma_f32_16x16x32_bf16 a[36:39], v[196:199], a[148:151], a[36:39]
    ds_read_b64_tr_b16 v[216:217], v245 offset:8192
    ds_read_b64_tr_b16 v[218:219], v245 offset:8704
    v_mfma_f32_16x16x32_bf16 a[36:39], v[200:203], a[152:155], a[36:39]
    v_mfma_f32_16x16x32_bf16 a[36:39], v[204:207], a[156:159], a[36:39]
    ds_read_b64_tr_b16 v[220:221], v245 offset:12288
    ds_read_b64_tr_b16 v[222:223], v245 offset:12800
    v_mfma_f32_16x16x32_bf16 a[40:43], v[192:195], a[160:163], a[40:43]
    buffer_load_dwordx4 a[236:239], v239, s[28:31], s55 offen offset:1536 sc1
    v_mfma_f32_16x16x32_bf16 a[40:43], v[196:199], a[164:167], a[40:43]
    v_mfma_f32_16x16x32_bf16 a[40:43], v[200:203], a[168:171], a[40:43]
    v_mfma_f32_16x16x32_bf16 a[40:43], v[204:207], a[172:175], a[40:43]
    v_mfma_f32_16x16x32_bf16 a[44:47], v[192:195], a[176:179], a[44:47]
    v_mfma_f32_16x16x32_bf16 a[44:47], v[196:199], a[180:183], a[44:47]
    v_mfma_f32_16x16x32_bf16 a[44:47], v[200:203], a[184:187], a[44:47]
    v_mfma_f32_16x16x32_bf16 a[44:47], v[204:207], a[188:191], a[44:47]
    s_waitcnt lgkmcnt(0)
    v_mfma_f32_16x16x32_bf16 a[48:51], v[208:211], a[128:131], a[48:51]
    s_waitcnt vmcnt(26)
    s_barrier
    v_mfma_f32_16x16x32_bf16 a[48:51], v[212:215], a[132:135], a[48:51]
    s_mul_i32 s65, s62, 442368
    ds_read_b64_tr_b16 v[192:193], v112 offset:16384
    ds_read_b64_tr_b16 v[194:195], v112 offset:16896
    v_mfma_f32_16x16x32_bf16 a[48:51], v[216:219], a[136:139], a[48:51]
    s_add_u32 m0, s40, 98304
    v_mfma_f32_16x16x32_bf16 a[48:51], v[220:223], a[140:143], a[48:51]
    s_add_u32 s41, s65, 0
    ds_read_b64_tr_b16 v[196:197], v112 offset:20480
    ds_read_b64_tr_b16 v[198:199], v112 offset:20992
    v_mfma_f32_16x16x32_bf16 a[52:55], v[208:211], a[144:147], a[52:55]
    buffer_load_dwordx4 v241, s[20:23], s41 offen lds
    v_mfma_f32_16x16x32_bf16 a[52:55], v[212:215], a[148:151], a[52:55]
    ds_read_b64_tr_b16 v[200:201], v112 offset:24576
    ds_read_b64_tr_b16 v[202:203], v112 offset:25088
    v_mfma_f32_16x16x32_bf16 a[52:55], v[216:219], a[152:155], a[52:55]
    v_mfma_f32_16x16x32_bf16 a[52:55], v[220:223], a[156:159], a[52:55]
    s_add_u32 m0, s40, 102400
    ds_read_b64_tr_b16 v[204:205], v112 offset:28672
    ds_read_b64_tr_b16 v[206:207], v112 offset:29184
    v_mfma_f32_16x16x32_bf16 a[56:59], v[208:211], a[160:163], a[56:59]
    s_add_u32 s41, s65, 110592
    v_mfma_f32_16x16x32_bf16 a[56:59], v[212:215], a[164:167], a[56:59]
    buffer_load_dwordx4 v241, s[20:23], s41 offen lds
    v_mfma_f32_16x16x32_bf16 a[56:59], v[216:219], a[168:171], a[56:59]
    v_mfma_f32_16x16x32_bf16 a[56:59], v[220:223], a[172:175], a[56:59]
    v_mfma_f32_16x16x32_bf16 a[60:63], v[208:211], a[176:179], a[60:63]
    s_add_u32 m0, s40, 106496
    v_mfma_f32_16x16x32_bf16 a[60:63], v[212:215], a[180:183], a[60:63]
    s_add_u32 s41, s65, 221184
    v_mfma_f32_16x16x32_bf16 a[60:63], v[216:219], a[184:187], a[60:63]
    buffer_load_dwordx4 v241, s[20:23], s41 offen lds
    v_mfma_f32_16x16x32_bf16 a[60:63], v[220:223], a[188:191], a[60:63]
    s_waitcnt lgkmcnt(0)
    v_mfma_f32_16x16x32_bf16 v[0:3], v[192:195], a[128:131], v[0:3]
    v_mfma_f32_16x16x32_bf16 v[0:3], v[196:199], a[132:135], v[0:3]
    ds_read_b64_tr_b16 v[208:209], v113 offset:16384
    ds_read_b64_tr_b16 v[210:211], v113 offset:16896
    v_mfma_f32_16x16x32_bf16 v[0:3], v[200:203], a[136:139], v[0:3]
    s_add_u32 m0, s40, 110592
    v_mfma_f32_16x16x32_bf16 v[0:3], v[204:207], a[140:143], v[0:3]
    s_add_u32 s41, s65, 331776
    ds_read_b64_tr_b16 v[212:213], v113 offset:20480
    ds_read_b64_tr_b16 v[214:215], v113 offset:20992
    v_mfma_f32_16x16x32_bf16 v[4:7], v[192:195], a[144:147], v[4:7]
    buffer_load_dwordx4 v241, s[20:23], s41 offen lds
    v_mfma_f32_16x16x32_bf16 v[4:7], v[196:199], a[148:151], v[4:7]
    ds_read_b64_tr_b16 v[216:217], v113 offset:24576
    ds_read_b64_tr_b16 v[218:219], v113 offset:25088
    v_mfma_f32_16x16x32_bf16 v[4:7], v[200:203], a[152:155], v[4:7]
    v_mfma_f32_16x16x32_bf16 v[4:7], v[204:207], a[156:159], v[4:7]
    s_add_u32 s55, s59, 61440
    ds_read_b64_tr_b16 v[220:221], v113 offset:28672
    ds_read_b64_tr_b16 v[222:223], v113 offset:29184
    v_mfma_f32_16x16x32_bf16 v[8:11], v[192:195], a[160:163], v[8:11]
    buffer_load_dwordx4 a[240:243], v239, s[28:31], s55 offen offset:0 sc1
    v_mfma_f32_16x16x32_bf16 v[8:11], v[196:199], a[164:167], v[8:11]
    v_mfma_f32_16x16x32_bf16 v[8:11], v[200:203], a[168:171], v[8:11]
    v_mfma_f32_16x16x32_bf16 v[8:11], v[204:207], a[172:175], v[8:11]
    v_mfma_f32_16x16x32_bf16 v[12:15], v[192:195], a[176:179], v[12:15]
    v_mfma_f32_16x16x32_bf16 v[12:15], v[196:199], a[180:183], v[12:15]
    buffer_load_dwordx4 a[244:247], v239, s[28:31], s55 offen offset:512 sc1
    v_mfma_f32_16x16x32_bf16 v[12:15], v[200:203], a[184:187], v[12:15]
    v_mfma_f32_16x16x32_bf16 v[12:15], v[204:207], a[188:191], v[12:15]
    s_waitcnt lgkmcnt(0)
    v_mfma_f32_16x16x32_bf16 v[16:19], v[208:211], a[128:131], v[16:19]
    v_mfma_f32_16x16x32_bf16 v[16:19], v[212:215], a[132:135], v[16:19]
    ds_read_b64_tr_b16 v[192:193], v114 offset:16384
    ds_read_b64_tr_b16 v[194:195], v114 offset:16896
    v_mfma_f32_16x16x32_bf16 v[16:19], v[216:219], a[136:139], v[16:19]
    buffer_load_dwordx4 a[248:251], v239, s[28:31], s55 offen offset:1024 sc1
    v_mfma_f32_16x16x32_bf16 v[16:19], v[220:223], a[140:143], v[16:19]
    ds_read_b64_tr_b16 v[196:197], v114 offset:20480
    ds_read_b64_tr_b16 v[198:199], v114 offset:20992
    v_mfma_f32_16x16x32_bf16 v[20:23], v[208:211], a[144:147], v[20:23]
    v_mfma_f32_16x16x32_bf16 v[20:23], v[212:215], a[148:151], v[20:23]
    ds_read_b64_tr_b16 v[200:201], v114 offset:24576
    ds_read_b64_tr_b16 v[202:203], v114 offset:25088
    v_mfma_f32_16x16x32_bf16 v[20:23], v[216:219], a[152:155], v[20:23]
    v_mfma_f32_16x16x32_bf16 v[20:23], v[220:223], a[156:159], v[20:23]
    ds_read_b64_tr_b16 v[204:205], v114 offset:28672
    ds_read_b64_tr_b16 v[206:207], v114 offset:29184
    v_mfma_f32_16x16x32_bf16 v[24:27], v[208:211], a[160:163], v[24:27]
    buffer_load_dwordx4 a[252:255], v239, s[28:31], s55 offen offset:1536 sc1
    v_mfma_f32_16x16x32_bf16 v[24:27], v[212:215], a[164:167], v[24:27]
    v_mfma_f32_16x16x32_bf16 v[24:27], v[216:219], a[168:171], v[24:27]
    v_mfma_f32_16x16x32_bf16 v[24:27], v[220:223], a[172:175], v[24:27]
    v_mfma_f32_16x16x32_bf16 v[28:31], v[208:211], a[176:179], v[28:31]
    v_mfma_f32_16x16x32_bf16 v[28:31], v[212:215], a[180:183], v[28:31]
    v_mfma_f32_16x16x32_bf16 v[28:31], v[216:219], a[184:187], v[28:31]
    v_mfma_f32_16x16x32_bf16 v[28:31], v[220:223], a[188:191], v[28:31]
    s_waitcnt lgkmcnt(0)
    v_mfma_f32_16x16x32_bf16 v[32:35], v[192:195], a[128:131], v[32:35]
    s_waitcnt vmcnt(24)
    s_barrier
    v_mfma_f32_16x16x32_bf16 v[32:35], v[196:199], a[132:135], v[32:35]
    s_mul_i32 s65, s62, 1048576
    ds_read_b64_tr_b16 v[208:209], v112 offset:32768
    ds_read_b64_tr_b16 v[210:211], v112 offset:33280
    v_mfma_f32_16x16x32_bf16 v[32:35], v[200:203], a[136:139], v[32:35]
    s_add_u32 m0, s40, 114688
    v_mfma_f32_16x16x32_bf16 v[32:35], v[204:207], a[140:143], v[32:35]
    s_add_u32 s41, s65, 0
    ds_read_b64_tr_b16 v[212:213], v112 offset:36864
    ds_read_b64_tr_b16 v[214:215], v112 offset:37376
    v_mfma_f32_16x16x32_bf16 v[36:39], v[192:195], a[144:147], v[36:39]
    buffer_load_dwordx4 v240, s[16:19], s41 offen lds
    v_mfma_f32_16x16x32_bf16 v[36:39], v[196:199], a[148:151], v[36:39]
    ds_read_b64_tr_b16 v[216:217], v112 offset:40960
    ds_read_b64_tr_b16 v[218:219], v112 offset:41472
    v_mfma_f32_16x16x32_bf16 v[36:39], v[200:203], a[152:155], v[36:39]
    s_add_u32 m0, s40, 118784
    v_mfma_f32_16x16x32_bf16 v[36:39], v[204:207], a[156:159], v[36:39]
    s_add_u32 s41, s65, 262144
    ds_read_b64_tr_b16 v[220:221], v112 offset:45056
    ds_read_b64_tr_b16 v[222:223], v112 offset:45568
    v_mfma_f32_16x16x32_bf16 v[40:43], v[192:195], a[160:163], v[40:43]
    buffer_load_dwordx4 v240, s[16:19], s41 offen lds
    v_mfma_f32_16x16x32_bf16 v[40:43], v[196:199], a[164:167], v[40:43]
    v_mfma_f32_16x16x32_bf16 v[40:43], v[200:203], a[168:171], v[40:43]
    s_add_u32 m0, s40, 122880
    v_mfma_f32_16x16x32_bf16 v[40:43], v[204:207], a[172:175], v[40:43]
    s_add_u32 s41, s65, 524288
    v_mfma_f32_16x16x32_bf16 v[44:47], v[192:195], a[176:179], v[44:47]
    buffer_load_dwordx4 v240, s[16:19], s41 offen lds
    v_mfma_f32_16x16x32_bf16 v[44:47], v[196:199], a[180:183], v[44:47]
    s_add_u32 m0, s40, 126976
    v_mfma_f32_16x16x32_bf16 v[44:47], v[200:203], a[184:187], v[44:47]
    s_add_u32 s41, s65, 786432
    v_mfma_f32_16x16x32_bf16 v[44:47], v[204:207], a[188:191], v[44:47]
    s_waitcnt lgkmcnt(0)
    v_mfma_f32_16x16x32_bf16 v[64:67], v[208:211], a[128:131], v[64:67]
    buffer_load_dwordx4 v240, s[16:19], s41 offen lds
    v_mfma_f32_16x16x32_bf16 v[64:67], v[212:215], a[132:135], v[64:67]
    ds_read_b64_tr_b16 v[192:193], v113 offset:32768
    ds_read_b64_tr_b16 v[194:195], v113 offset:33280
    v_mfma_f32_16x16x32_bf16 v[64:67], v[216:219], a[136:139], v[64:67]
    s_lshl_b32 s59, s63, 11
    v_mfma_f32_16x16x32_bf16 v[64:67], v[220:223], a[140:143], v[64:67]
    s_add_u32 s55, s59, 0
    ds_read_b64_tr_b16 v[196:197], v113 offset:36864
    ds_read_b64_tr_b16 v[198:199], v113 offset:37376
    v_mfma_f32_16x16x32_bf16 v[68:71], v[208:211], a[144:147], v[68:71]
    buffer_load_dwordx4 a[64:67], v239, s[28:31], s55 offen offset:0 sc1
    v_mfma_f32_16x16x32_bf16 v[68:71], v[212:215], a[148:151], v[68:71]
    ds_read_b64_tr_b16 v[200:201], v113 offset:40960
    ds_read_b64_tr_b16 v[202:203], v113 offset:41472
    v_mfma_f32_16x16x32_bf16 v[68:71], v[216:219], a[152:155], v[68:71]
    v_mfma_f32_16x16x32_bf16 v[68:71], v[220:223], a[156:159], v[68:71]
    ds_read_b64_tr_b16 v[204:205], v113 offset:45056
    ds_read_b64_tr_b16 v[206:207], v113 offset:45568
    v_mfma_f32_16x16x32_bf16 v[72:75], v[208:211], a[160:163], v[72:75]
    buffer_load_dwordx4 a[68:71], v239, s[28:31], s55 offen offset:512 sc1
    v_mfma_f32_16x16x32_bf16 v[72:75], v[212:215], a[164:167], v[72:75]
    v_mfma_f32_16x16x32_bf16 v[72:75], v[216:219], a[168:171], v[72:75]
    v_mfma_f32_16x16x32_bf16 v[72:75], v[220:223], a[172:175], v[72:75]
    v_mfma_f32_16x16x32_bf16 v[76:79], v[208:211], a[176:179], v[76:79]
    buffer_load_dwordx4 a[72:75], v239, s[28:31], s55 offen offset:1024 sc1
    v_mfma_f32_16x16x32_bf16 v[76:79], v[212:215], a[180:183], v[76:79]
    v_mfma_f32_16x16x32_bf16 v[76:79], v[216:219], a[184:187], v[76:79]
    v_mfma_f32_16x16x32_bf16 v[76:79], v[220:223], a[188:191], v[76:79]
    s_waitcnt lgkmcnt(0)
    v_mfma_f32_16x16x32_bf16 v[80:83], v[192:195], a[128:131], v[80:83]
    buffer_load_dwordx4 a[76:79], v239, s[28:31], s55 offen offset:1536 sc1
    v_mfma_f32_16x16x32_bf16 v[80:83], v[196:199], a[132:135], v[80:83]
    ds_read_b64_tr_b16 v[208:209], v114 offset:32768
    ds_read_b64_tr_b16 v[210:211], v114 offset:33280
    v_mfma_f32_16x16x32_bf16 v[80:83], v[200:203], a[136:139], v[80:83]
    v_mfma_f32_16x16x32_bf16 v[80:83], v[204:207], a[140:143], v[80:83]
    s_add_u32 s55, s59, 20480
    ds_read_b64_tr_b16 v[212:213], v114 offset:36864
    ds_read_b64_tr_b16 v[214:215], v114 offset:37376
    v_mfma_f32_16x16x32_bf16 v[84:87], v[192:195], a[144:147], v[84:87]
    buffer_load_dwordx4 a[80:83], v239, s[28:31], s55 offen offset:0 sc1
    v_mfma_f32_16x16x32_bf16 v[84:87], v[196:199], a[148:151], v[84:87]
    ds_read_b64_tr_b16 v[216:217], v114 offset:40960
    ds_read_b64_tr_b16 v[218:219], v114 offset:41472
    v_mfma_f32_16x16x32_bf16 v[84:87], v[200:203], a[152:155], v[84:87]
    v_mfma_f32_16x16x32_bf16 v[84:87], v[204:207], a[156:159], v[84:87]
    ds_read_b64_tr_b16 v[220:221], v114 offset:45056
    ds_read_b64_tr_b16 v[222:223], v114 offset:45568
    v_mfma_f32_16x16x32_bf16 v[88:91], v[192:195], a[160:163], v[88:91]
    buffer_load_dwordx4 a[84:87], v239, s[28:31], s55 offen offset:512 sc1
    v_mfma_f32_16x16x32_bf16 v[88:91], v[196:199], a[164:167], v[88:91]
    v_mfma_f32_16x16x32_bf16 v[88:91], v[200:203], a[168:171], v[88:91]
    v_mfma_f32_16x16x32_bf16 v[88:91], v[204:207], a[172:175], v[88:91]
    v_mfma_f32_16x16x32_bf16 v[92:95], v[192:195], a[176:179], v[92:95]
L_padC_2:
    s_cbranch_execz L_padC_3
    v_mfma_f32_16x16x32_bf16 v[92:95], v[196:199], a[180:183], v[92:95]
    v_mfma_f32_16x16x32_bf16 v[92:95], v[200:203], a[184:187], v[92:95]
    v_mfma_f32_16x16x32_bf16 v[92:95], v[204:207], a[188:191], v[92:95]
    s_waitcnt lgkmcnt(0)
    v_mfma_f32_16x16x32_bf16 v[96:99], v[208:211], a[128:131], v[96:99]
    s_waitcnt vmcnt(27)
    s_barrier
    v_mfma_f32_16x16x32_bf16 v[96:99], v[212:215], a[132:135], v[96:99]
    s_mul_i32 s65, s63, 442368
    ds_read_b64_tr_b16 v[192:193], v242 offset:49152
    ds_read_b64_tr_b16 v[194:195], v242 offset:49664
    v_mfma_f32_16x16x32_bf16 v[96:99], v[216:219], a[136:139], v[96:99]
    s_add_u32 m0, s40, 131072
    v_mfma_f32_16x16x32_bf16 v[96:99], v[220:223], a[140:143], v[96:99]
    s_add_u32 s41, s65, 0
    ds_read_b64_tr_b16 v[196:197], v242 offset:53248
    ds_read_b64_tr_b16 v[198:199], v242 offset:53760
    v_mfma_f32_16x16x32_bf16 v[100:103], v[208:211], a[144:147], v[100:103]
    buffer_load_dwordx4 v241, s[20:23], s41 offen lds
    v_mfma_f32_16x16x32_bf16 v[100:103], v[212:215], a[148:151], v[100:103]
    ds_read_b64_tr_b16 v[200:201], v242 offset:57344
    ds_read_b64_tr_b16 v[202:203], v242 offset:57856
    v_mfma_f32_16x16x32_bf16 v[100:103], v[216:219], a[152:155], v[100:103]
    v_mfma_f32_16x16x32_bf16 v[100:103], v[220:223], a[156:159], v[100:103]
    s_add_u32 m0, s40, 135168
    ds_read_b64_tr_b16 v[204:205], v242 offset:61440
    ds_read_b64_tr_b16 v[206:207], v242 offset:61952
    v_mfma_f32_16x16x32_bf16 v[104:107], v[208:211], a[160:163], v[104:107]
    s_add_u32 s41, s65, 110592
    v_mfma_f32_16x16x32_bf16 v[104:107], v[212:215], a[164:167], v[104:107]
    buffer_load_dwordx4 v241, s[20:23], s41 offen lds
    v_mfma_f32_16x16x32_bf16 v[104:107], v[216:219], a[168:171], v[104:107]
    v_mfma_f32_16x16x32_bf16 v[104:107], v[220:223], a[172:175], v[104:107]
    v_mfma_f32_16x16x32_bf16 v[108:111], v[208:211], a[176:179], v[108:111]
    s_add_u32 m0, s40, 139264
    v_mfma_f32_16x16x32_bf16 v[108:111], v[212:215], a[180:183], v[108:111]
    s_add_u32 s41, s65, 221184
    v_mfma_f32_16x16x32_bf16 v[108:111], v[216:219], a[184:187], v[108:111]
    buffer_load_dwordx4 v241, s[20:23], s41 offen lds
    v_mfma_f32_16x16x32_bf16 v[108:111], v[220:223], a[188:191], v[108:111]
    s_waitcnt lgkmcnt(0)
    v_mfma_f32_16x16x32_bf16 v[128:131], v[192:195], a[128:131], v[128:131]
    v_mfma_f32_16x16x32_bf16 v[128:131], v[196:199], a[132:135], v[128:131]
    ds_read_b64_tr_b16 v[208:209], v243 offset:49152
    ds_read_b64_tr_b16 v[210:211], v243 offset:49664
    v_mfma_f32_16x16x32_bf16 v[128:131], v[200:203], a[136:139], v[128:131]
    s_add_u32 m0, s40, 143360
    v_mfma_f32_16x16x32_bf16 v[128:131], v[204:207], a[140:143], v[128:131]
    s_add_u32 s41, s65, 331776
    ds_read_b64_tr_b16 v[212:213], v243 offset:53248
    ds_read_b64_tr_b16 v[214:215], v243 offset:53760
    v_mfma_f32_16x16x32_bf16 v[132:135], v[192:195], a[144:147], v[132:135]
    buffer_load_dwordx4 v241, s[20:23], s41 offen lds
    v_mfma_f32_16x16x32_bf16 v[132:135], v[196:199], a[148:151], v[132:135]
    ds_read_b64_tr_b16 v[216:217], v243 offset:57344
    ds_read_b64_tr_b16 v[218:219], v243 offset:57856
    v_mfma_f32_16x16x32_bf16 v[132:135], v[200:203], a[152:155], v[132:135]
    v_mfma_f32_16x16x32_bf16 v[132:135], v[204:207], a[156:159], v[132:135]
    ds_read_b64_tr_b16 v[220:221], v243 offset:61440
    ds_read_b64_tr_b16 v[222:223], v243 offset:61952
    v_mfma_f32_16x16x32_bf16 v[136:139], v[192:195], a[160:163], v[136:139]
    buffer_load_dwordx4 a[88:91], v239, s[28:31], s55 offen offset:1024 sc1
    v_mfma_f32_16x16x32_bf16 v[136:139], v[196:199], a[164:167], v[136:139]
    v_mfma_f32_16x16x32_bf16 v[136:139], v[200:203], a[168:171], v[136:139]
    v_mfma_f32_16x16x32_bf16 v[136:139], v[204:207], a[172:175], v[136:139]
    v_mfma_f32_16x16x32_bf16 v[140:143], v[192:195], a[176:179], v[140:143]
    v_mfma_f32_16x16x32_bf16 v[140:143], v[196:199], a[180:183], v[140:143]
    buffer_load_dwordx4 a[92:95], v239, s[28:31], s55 offen offset:1536 sc1
    v_mfma_f32_16x16x32_bf16 v[140:143], v[200:203], a[184:187], v[140:143]
    v_mfma_f32_16x16x32_bf16 v[140:143], v[204:207], a[188:191], v[140:143]
    s_waitcnt lgkmcnt(0)
    v_mfma_f32_16x16x32_bf16 v[144:147], v[208:211], a[128:131], v[144:147]
    v_mfma_f32_16x16x32_bf16 v[144:147], v[212:215], a[132:135], v[144:147]
    ds_read_b64_tr_b16 v[192:193], v244 offset:49152
    ds_read_b64_tr_b16 v[194:195], v244 offset:49664
    v_mfma_f32_16x16x32_bf16 v[144:147], v[216:219], a[136:139], v[144:147]
    v_mfma_f32_16x16x32_bf16 v[144:147], v[220:223], a[140:143], v[144:147]
    s_add_u32 s55, s59, 40960
    ds_read_b64_tr_b16 v[196:197], v244 offset:53248
    ds_read_b64_tr_b16 v[198:199], v244 offset:53760
    v_mfma_f32_16x16x32_bf16 v[148:151], v[208:211], a[144:147], v[148:151]
    buffer_load_dwordx4 a[96:99], v239, s[28:31], s55 offen offset:0 sc1
    v_mfma_f32_16x16x32_bf16 v[148:151], v[212:215], a[148:151], v[148:151]
    ds_read_b64_tr_b16 v[200:201], v244 offset:57344
    ds_read_b64_tr_b16 v[202:203], v244 offset:57856
    v_mfma_f32_16x16x32_bf16 v[148:151], v[216:219], a[152:155], v[148:151]
    v_mfma_f32_16x16x32_bf16 v[148:151], v[220:223], a[156:159], v[148:151]
    ds_read_b64_tr_b16 v[204:205], v244 offset:61440
    ds_read_b64_tr_b16 v[206:207], v244 offset:61952
    v_mfma_f32_16x16x32_bf16 v[152:155], v[208:211], a[160:163], v[152:155]
    buffer_load_dwordx4 a[100:103], v239, s[28:31], s55 offen offset:512 sc1
    v_mfma_f32_16x16x32_bf16 v[152:155], v[212:215], a[164:167], v[152:155]
    v_mfma_f32_16x16x32_bf16 v[152:155], v[216:219], a[168:171], v[152:155]
    v_mfma_f32_16x16x32_bf16 v[152:155], v[220:223], a[172:175], v[152:155]
    v_mfma_f32_16x16x32_bf16 v[156:159], v[208:211], a[176:179], v[156:159]
    v_mfma_f32_16x16x32_bf16 v[156:159], v[212:215], a[180:183], v[156:159]
    buffer_load_dwordx4 a[104:107], v239, s[28:31], s55 offen offset:1024 sc1
    v_mfma_f32_16x16x32_bf16 v[156:159], v[216:219], a[184:187], v[156:159]
    v_mfma_f32_16x16x32_bf16 v[156:159], v[220:223], a[188:191], v[156:159]
    s_waitcnt lgkmcnt(0)
    v_mfma_f32_16x16x32_bf16 v[160:163], v[192:195], a[128:131], v[160:163]
    v_mfma_f32_16x16x32_bf16 v[160:163], v[196:199], a[132:135], v[160:163]
    ds_read_b64_tr_b16 v[208:209], v245 offset:49152
    ds_read_b64_tr_b16 v[210:211], v245 offset:49664
    v_mfma_f32_16x16x32_bf16 v[160:163], v[200:203], a[136:139], v[160:163]
    buffer_load_dwordx4 a[108:111], v239, s[28:31], s55 offen offset:1536 sc1
    v_mfma_f32_16x16x32_bf16 v[160:163], v[204:207], a[140:143], v[160:163]
    ds_read_b64_tr_b16 v[212:213], v245 offset:53248
    ds_read_b64_tr_b16 v[214:215], v245 offset:53760
    v_mfma_f32_16x16x32_bf16 v[164:167], v[192:195], a[144:147], v[164:167]
    v_mfma_f32_16x16x32_bf16 v[164:167], v[196:199], a[148:151], v[164:167]
    ds_read_b64_tr_b16 v[216:217], v245 offset:57344
    ds_read_b64_tr_b16 v[218:219], v245 offset:57856
    v_mfma_f32_16x16x32_bf16 v[164:167], v[200:203], a[152:155], v[164:167]
    v_mfma_f32_16x16x32_bf16 v[164:167], v[204:207], a[156:159], v[164:167]
    s_add_u32 s55, s59, 61440
    ds_read_b64_tr_b16 v[220:221], v245 offset:61440
    ds_read_b64_tr_b16 v[222:223], v245 offset:61952
    v_mfma_f32_16x16x32_bf16 v[168:171], v[192:195], a[160:163], v[168:171]
    buffer_load_dwordx4 a[112:115], v239, s[28:31], s55 offen offset:0 sc1
    v_mfma_f32_16x16x32_bf16 v[168:171], v[196:199], a[164:167], v[168:171]
    v_mfma_f32_16x16x32_bf16 v[168:171], v[200:203], a[168:171], v[168:171]
    v_mfma_f32_16x16x32_bf16 v[168:171], v[204:207], a[172:175], v[168:171]
    v_mfma_f32_16x16x32_bf16 v[172:175], v[192:195], a[176:179], v[172:175]
    v_mfma_f32_16x16x32_bf16 v[172:175], v[196:199], a[180:183], v[172:175]
    v_mfma_f32_16x16x32_bf16 v[172:175], v[200:203], a[184:187], v[172:175]
    v_mfma_f32_16x16x32_bf16 v[172:175], v[204:207], a[188:191], v[172:175]
    s_waitcnt lgkmcnt(0)
    v_mfma_f32_16x16x32_bf16 v[176:179], v[208:211], a[128:131], v[176:179]
    s_waitcnt vmcnt(25)
    s_barrier
    v_mfma_f32_16x16x32_bf16 v[176:179], v[212:215], a[132:135], v[176:179]
    s_mul_i32 s65, s62, 442368
    ds_read_b64_tr_b16 v[192:193], v112 offset:0
    ds_read_b64_tr_b16 v[194:195], v112 offset:512
    v_mfma_f32_16x16x32_bf16 v[176:179], v[216:219], a[136:139], v[176:179]
    s_add_u32 m0, s40, 147456
    v_mfma_f32_16x16x32_bf16 v[176:179], v[220:223], a[140:143], v[176:179]
    s_add_u32 s41, s65, 0
    ds_read_b64_tr_b16 v[196:197], v112 offset:4096
    ds_read_b64_tr_b16 v[198:199], v112 offset:4608
    v_mfma_f32_16x16x32_bf16 v[180:183], v[208:211], a[144:147], v[180:183]
    buffer_load_dwordx4 v241, s[24:27], s41 offen lds
    v_mfma_f32_16x16x32_bf16 v[180:183], v[212:215], a[148:151], v[180:183]
    ds_read_b64_tr_b16 v[200:201], v112 offset:8192
    ds_read_b64_tr_b16 v[202:203], v112 offset:8704
    v_mfma_f32_16x16x32_bf16 v[180:183], v[216:219], a[152:155], v[180:183]
    s_add_u32 m0, s40, 151552
    v_mfma_f32_16x16x32_bf16 v[180:183], v[220:223], a[156:159], v[180:183]
    s_add_u32 s41, s65, 110592
    ds_read_b64_tr_b16 v[204:205], v112 offset:12288
    ds_read_b64_tr_b16 v[206:207], v112 offset:12800
    v_mfma_f32_16x16x32_bf16 v[184:187], v[208:211], a[160:163], v[184:187]
    buffer_load_dwordx4 v241, s[24:27], s41 offen lds
    v_mfma_f32_16x16x32_bf16 v[184:187], v[212:215], a[164:167], v[184:187]
    v_mfma_f32_16x16x32_bf16 v[184:187], v[216:219], a[168:171], v[184:187]
    v_mfma_f32_16x16x32_bf16 v[184:187], v[220:223], a[172:175], v[184:187]
    s_add_u32 m0, s40, 155648
    v_mfma_f32_16x16x32_bf16 v[188:191], v[208:211], a[176:179], v[188:191]
    s_add_u32 s41, s65, 221184
    v_mfma_f32_16x16x32_bf16 v[188:191], v[212:215], a[180:183], v[188:191]
    buffer_load_dwordx4 v241, s[24:27], s41 offen lds
    v_mfma_f32_16x16x32_bf16 v[188:191], v[216:219], a[184:187], v[188:191]
    v_mfma_f32_16x16x32_bf16 v[188:191], v[220:223], a[188:191], v[188:191]
    s_waitcnt lgkmcnt(0) vmcnt(24)
    v_mfma_f32_16x16x32_bf16 v[0:3], v[192:195], a[192:195], v[0:3]
    s_add_u32 m0, s40, 159744
    v_mfma_f32_16x16x32_bf16 v[0:3], v[196:199], a[196:199], v[0:3]
    s_add_u32 s41, s65, 331776
    ds_read_b64_tr_b16 v[208:209], v113 offset:0
    ds_read_b64_tr_b16 v[210:211], v113 offset:512
    v_mfma_f32_16x16x32_bf16 v[0:3], v[200:203], a[200:203], v[0:3]
    buffer_load_dwordx4 v241, s[24:27], s41 offen lds
    v_mfma_f32_16x16x32_bf16 v[0:3], v[204:207], a[204:207], v[0:3]
    ds_read_b64_tr_b16 v[212:213], v113 offset:4096
    ds_read_b64_tr_b16 v[214:215], v113 offset:4608
    v_mfma_f32_16x16x32_bf16 v[4:7], v[192:195], a[208:211], v[4:7]
    v_mfma_f32_16x16x32_bf16 v[4:7], v[196:199], a[212:215], v[4:7]
    ds_read_b64_tr_b16 v[216:217], v113 offset:8192
    ds_read_b64_tr_b16 v[218:219], v113 offset:8704
    v_mfma_f32_16x16x32_bf16 v[4:7], v[200:203], a[216:219], v[4:7]
    buffer_load_dwordx4 a[116:119], v239, s[28:31], s55 offen offset:512 sc1
    v_mfma_f32_16x16x32_bf16 v[4:7], v[204:207], a[220:223], v[4:7]
    ds_read_b64_tr_b16 v[220:221], v113 offset:12288
    ds_read_b64_tr_b16 v[222:223], v113 offset:12800
    v_mfma_f32_16x16x32_bf16 v[8:11], v[192:195], a[224:227], v[8:11]
    v_mfma_f32_16x16x32_bf16 v[8:11], v[196:199], a[228:231], v[8:11]
    v_mfma_f32_16x16x32_bf16 v[8:11], v[200:203], a[232:235], v[8:11]
    buffer_load_dwordx4 a[120:123], v239, s[28:31], s55 offen offset:1024 sc1
    v_mfma_f32_16x16x32_bf16 v[8:11], v[204:207], a[236:239], v[8:11]
    v_mfma_f32_16x16x32_bf16 v[12:15], v[192:195], a[240:243], v[12:15]
    v_mfma_f32_16x16x32_bf16 v[12:15], v[196:199], a[244:247], v[12:15]
    v_mfma_f32_16x16x32_bf16 v[12:15], v[200:203], a[248:251], v[12:15]
    v_mfma_f32_16x16x32_bf16 v[12:15], v[204:207], a[252:255], v[12:15]
    s_waitcnt lgkmcnt(0)
    v_mfma_f32_16x16x32_bf16 v[16:19], v[208:211], a[192:195], v[16:19]
    buffer_load_dwordx4 a[124:127], v239, s[28:31], s55 offen offset:1536 sc1
    v_mfma_f32_16x16x32_bf16 v[16:19], v[212:215], a[196:199], v[16:19]
    ds_read_b64_tr_b16 v[192:193], v114 offset:0
    ds_read_b64_tr_b16 v[194:195], v114 offset:512
    v_mfma_f32_16x16x32_bf16 v[16:19], v[216:219], a[200:203], v[16:19]
    s_lshl_b32 s59, s64, 11
    v_mfma_f32_16x16x32_bf16 v[16:19], v[220:223], a[204:207], v[16:19]
    s_add_u32 s55, s59, 0
    ds_read_b64_tr_b16 v[196:197], v114 offset:4096
    ds_read_b64_tr_b16 v[198:199], v114 offset:4608
    v_mfma_f32_16x16x32_bf16 v[20:23], v[208:211], a[208:211], v[20:23]
    buffer_load_dwordx4 a[128:131], v239, s[28:31], s55 offen offset:0 sc1
    v_mfma_f32_16x16x32_bf16 v[20:23], v[212:215], a[212:215], v[20:23]
    ds_read_b64_tr_b16 v[200:201], v114 offset:8192
    ds_read_b64_tr_b16 v[202:203], v114 offset:8704
    v_mfma_f32_16x16x32_bf16 v[20:23], v[216:219], a[216:219], v[20:23]
    v_mfma_f32_16x16x32_bf16 v[20:23], v[220:223], a[220:223], v[20:23]
    ds_read_b64_tr_b16 v[204:205], v114 offset:12288
    ds_read_b64_tr_b16 v[206:207], v114 offset:12800
    v_mfma_f32_16x16x32_bf16 v[24:27], v[208:211], a[224:227], v[24:27]
    buffer_load_dwordx4 a[132:135], v239, s[28:31], s55 offen offset:512 sc1
    v_mfma_f32_16x16x32_bf16 v[24:27], v[212:215], a[228:231], v[24:27]
    v_mfma_f32_16x16x32_bf16 v[24:27], v[216:219], a[232:235], v[24:27]
    v_mfma_f32_16x16x32_bf16 v[24:27], v[220:223], a[236:239], v[24:27]
    v_mfma_f32_16x16x32_bf16 v[28:31], v[208:211], a[240:243], v[28:31]
    v_mfma_f32_16x16x32_bf16 v[28:31], v[212:215], a[244:247], v[28:31]
    v_mfma_f32_16x16x32_bf16 v[28:31], v[216:219], a[248:251], v[28:31]
    v_mfma_f32_16x16x32_bf16 v[28:31], v[220:223], a[252:255], v[28:31]
    s_waitcnt lgkmcnt(0)
    v_mfma_f32_16x16x32_bf16 v[32:35], v[192:195], a[192:195], v[32:35]
    s_waitcnt vmcnt(26)
    s_barrier
    v_mfma_f32_16x16x32_bf16 v[32:35], v[196:199], a[196:199], v[32:35]
    s_mul_i32 s65, s64, 442368
    ds_read_b64_tr_b16 v[208:209], v242 offset:16384
    ds_read_b64_tr_b16 v[210:211], v242 offset:16896
    v_mfma_f32_16x16x32_bf16 v[32:35], v[200:203], a[200:203], v[32:35]
    s_add_u32 m0, s40, 98304
    v_mfma_f32_16x16x32_bf16 v[32:35], v[204:207], a[204:207], v[32:35]
    s_add_u32 s41, s65, 0
    ds_read_b64_tr_b16 v[212:213], v242 offset:20480
    ds_read_b64_tr_b16 v[214:215], v242 offset:20992
    v_mfma_f32_16x16x32_bf16 v[36:39], v[192:195], a[208:211], v[36:39]
    buffer_load_dwordx4 v241, s[20:23], s41 offen lds
    v_mfma_f32_16x16x32_bf16 v[36:39], v[196:199], a[212:215], v[36:39]
    ds_read_b64_tr_b16 v[216:217], v242 offset:24576
    ds_read_b64_tr_b16 v[218:219], v242 offset:25088
    v_mfma_f32_16x16x32_bf16 v[36:39], v[200:203], a[216:219], v[36:39]
    s_add_u32 m0, s40, 102400
    v_mfma_f32_16x16x32_bf16 v[36:39], v[204:207], a[220:223], v[36:39]
    s_add_u32 s41, s65, 110592
    ds_read_b64_tr_b16 v[220:221], v242 offset:28672
    ds_read_b64_tr_b16 v[222:223], v242 offset:29184
    v_mfma_f32_16x16x32_bf16 v[40:43], v[192:195], a[224:227], v[40:43]
    buffer_load_dwordx4 v241, s[20:23], s41 offen lds
    v_mfma_f32_16x16x32_bf16 v[40:43], v[196:199], a[228:231], v[40:43]
    v_mfma_f32_16x16x32_bf16 v[40:43], v[200:203], a[232:235], v[40:43]
    v_mfma_f32_16x16x32_bf16 v[40:43], v[204:207], a[236:239], v[40:43]
    s_add_u32 m0, s40, 106496
    v_mfma_f32_16x16x32_bf16 v[44:47], v[192:195], a[240:243], v[44:47]
    s_add_u32 s41, s65, 221184
    v_mfma_f32_16x16x32_bf16 v[44:47], v[196:199], a[244:247], v[44:47]
    buffer_load_dwordx4 v241, s[20:23], s41 offen lds
    v_mfma_f32_16x16x32_bf16 v[44:47], v[200:203], a[248:251], v[44:47]
    v_mfma_f32_16x16x32_bf16 v[44:47], v[204:207], a[252:255], v[44:47]
    s_waitcnt lgkmcnt(0)
    v_mfma_f32_16x16x32_bf16 a[0:3], v[208:211], a[192:195], a[0:3]
    s_add_u32 m0, s40, 110592
    v_mfma_f32_16x16x32_bf16 a[0:3], v[212:215], a[196:199], a[0:3]
    s_add_u32 s41, s65, 331776
    ds_read_b64_tr_b16 v[192:193], v243 offset:16384
    ds_read_b64_tr_b16 v[194:195], v243 offset:16896
    v_mfma_f32_16x16x32_bf16 a[0:3], v[216:219], a[200:203], a[0:3]
    buffer_load_dwordx4 v241, s[20:23], s41 offen lds
    v_mfma_f32_16x16x32_bf16 a[0:3], v[220:223], a[204:207], a[0:3]
    ds_read_b64_tr_b16 v[196:197], v243 offset:20480
    ds_read_b64_tr_b16 v[198:199], v243 offset:20992
    v_mfma_f32_16x16x32_bf16 a[4:7], v[208:211], a[208:211], a[4:7]
    v_mfma_f32_16x16x32_bf16 a[4:7], v[212:215], a[212:215], a[4:7]
    ds_read_b64_tr_b16 v[200:201], v243 offset:24576
    ds_read_b64_tr_b16 v[202:203], v243 offset:25088
    v_mfma_f32_16x16x32_bf16 a[4:7], v[216:219], a[216:219], a[4:7]
    v_mfma_f32_16x16x32_bf16 a[4:7], v[220:223], a[220:223], a[4:7]
    ds_read_b64_tr_b16 v[204:205], v243 offset:28672
    ds_read_b64_tr_b16 v[206:207], v243 offset:29184
    v_mfma_f32_16x16x32_bf16 a[8:11], v[208:211], a[224:227], a[8:11]
    buffer_load_dwordx4 a[136:139], v239, s[28:31], s55 offen offset:1024 sc1
    v_mfma_f32_16x16x32_bf16 a[8:11], v[212:215], a[228:231], a[8:11]
    v_mfma_f32_16x16x32_bf16 a[8:11], v[216:219], a[232:235], a[8:11]
    v_mfma_f32_16x16x32_bf16 a[8:11], v[220:223], a[236:239], a[8:11]
    buffer_load_dwordx4 a[140:143], v239, s[28:31], s55 offen offset:1536 sc1
    v_mfma_f32_16x16x32_bf16 a[12:15], v[208:211], a[240:243], a[12:15]
    v_mfma_f32_16x16x32_bf16 a[12:15], v[212:215], a[244:247], a[12:15]
    v_mfma_f32_16x16x32_bf16 a[12:15], v[216:219], a[248:251], a[12:15]
    s_add_u32 s55, s59, 20480
    v_mfma_f32_16x16x32_bf16 a[12:15], v[220:223], a[252:255], a[12:15]
    s_waitcnt lgkmcnt(0)
    v_mfma_f32_16x16x32_bf16 a[16:19], v[192:195], a[192:195], a[16:19]
    buffer_load_dwordx4 a[144:147], v239, s[28:31], s55 offen offset:0 sc1
    v_mfma_f32_16x16x32_bf16 a[16:19], v[196:199], a[196:199], a[16:19]
    ds_read_b64_tr_b16 v[208:209], v244 offset:16384
    ds_read_b64_tr_b16 v[210:211], v244 offset:16896
    v_mfma_f32_16x16x32_bf16 a[16:19], v[200:203], a[200:203], a[16:19]
    v_mfma_f32_16x16x32_bf16 a[16:19], v[204:207], a[204:207], a[16:19]
    ds_read_b64_tr_b16 v[212:213], v244 offset:20480
    ds_read_b64_tr_b16 v[214:215], v244 offset:20992
    v_mfma_f32_16x16x32_bf16 a[20:23], v[192:195], a[208:211], a[20:23]
    v_mfma_f32_16x16x32_bf16 a[20:23], v[196:199], a[212:215], a[20:23]
    ds_read_b64_tr_b16 v[216:217], v244 offset:24576
    ds_read_b64_tr_b16 v[218:219], v244 offset:25088
    v_mfma_f32_16x16x32_bf16 a[20:23], v[200:203], a[216:219], a[20:23]
    buffer_load_dwordx4 a[148:151], v239, s[28:31], s55 offen offset:512 sc1
    v_mfma_f32_16x16x32_bf16 a[20:23], v[204:207], a[220:223], a[20:23]
    ds_read_b64_tr_b16 v[220:221], v244 offset:28672
    ds_read_b64_tr_b16 v[222:223], v244 offset:29184
    v_mfma_f32_16x16x32_bf16 a[24:27], v[192:195], a[224:227], a[24:27]
    v_mfma_f32_16x16x32_bf16 a[24:27], v[196:199], a[228:231], a[24:27]
    v_mfma_f32_16x16x32_bf16 a[24:27], v[200:203], a[232:235], a[24:27]
    buffer_load_dwordx4 a[152:155], v239, s[28:31], s55 offen offset:1024 sc1
    v_mfma_f32_16x16x32_bf16 a[24:27], v[204:207], a[236:239], a[24:27]
    v_mfma_f32_16x16x32_bf16 a[28:31], v[192:195], a[240:243], a[28:31]
    v_mfma_f32_16x16x32_bf16 a[28:31], v[196:199], a[244:247], a[28:31]
    v_mfma_f32_16x16x32_bf16 a[28:31], v[200:203], a[248:251], a[28:31]
    buffer_load_dwordx4 a[156:159], v239, s[28:31], s55 offen offset:1536 sc1
    v_mfma_f32_16x16x32_bf16 a[28:31], v[204:207], a[252:255], a[28:31]
    s_waitcnt lgkmcnt(0)
    v_mfma_f32_16x16x32_bf16 a[32:35], v[208:211], a[192:195], a[32:35]
    v_mfma_f32_16x16x32_bf16 a[32:35], v[212:215], a[196:199], a[32:35]
    ds_read_b64_tr_b16 v[192:193], v245 offset:16384
    ds_read_b64_tr_b16 v[194:195], v245 offset:16896
    v_mfma_f32_16x16x32_bf16 a[32:35], v[216:219], a[200:203], a[32:35]
    v_mfma_f32_16x16x32_bf16 a[32:35], v[220:223], a[204:207], a[32:35]
    s_add_u32 s55, s59, 40960
    ds_read_b64_tr_b16 v[196:197], v245 offset:20480
    ds_read_b64_tr_b16 v[198:199], v245 offset:20992
    v_mfma_f32_16x16x32_bf16 a[36:39], v[208:211], a[208:211], a[36:39]
    buffer_load_dwordx4 a[160:163], v239, s[28:31], s55 offen offset:0 sc1
    v_mfma_f32_16x16x32_bf16 a[36:39], v[212:215], a[212:215], a[36:39]
    ds_read_b64_tr_b16 v[200:201], v245 offset:24576
    ds_read_b64_tr_b16 v[202:203], v245 offset:25088
    v_mfma_f32_16x16x32_bf16 a[36:39], v[216:219], a[216:219], a[36:39]
    v_mfma_f32_16x16x32_bf16 a[36:39], v[220:223], a[220:223], a[36:39]
    ds_read_b64_tr_b16 v[204:205], v245 offset:28672
    ds_read_b64_tr_b16 v[206:207], v245 offset:29184
    v_mfma_f32_16x16x32_bf16 a[40:43], v[208:211], a[224:227], a[40:43]
    buffer_load_dwordx4 a[164:167], v239, s[28:31], s55 offen offset:512 sc1
    v_mfma_f32_16x16x32_bf16 a[40:43], v[212:215], a[228:231], a[40:43]
    v_mfma_f32_16x16x32_bf16 a[40:43], v[216:219], a[232:235], a[40:43]
    v_mfma_f32_16x16x32_bf16 a[40:43], v[220:223], a[236:239], a[40:43]
    v_mfma_f32_16x16x32_bf16 a[44:47], v[208:211], a[240:243], a[44:47]
    v_mfma_f32_16x16x32_bf16 a[44:47], v[212:215], a[244:247], a[44:47]
    v_mfma_f32_16x16x32_bf16 a[44:47], v[216:219], a[248:251], a[44:47]
    v_mfma_f32_16x16x32_bf16 a[44:47], v[220:223], a[252:255], a[44:47]
    s_waitcnt lgkmcnt(0)
    v_mfma_f32_16x16x32_bf16 a[48:51], v[192:195], a[192:195], a[48:51]
    s_waitcnt vmcnt(28)
    s_barrier
    v_mfma_f32_16x16x32_bf16 a[48:51], v[196:199], a[196:199], a[48:51]
    s_mul_i32 s65, s63, 442368
    ds_read_b64_tr_b16 v[208:209], v112 offset:32768
    ds_read_b64_tr_b16 v[210:211], v112 offset:33280
    v_mfma_f32_16x16x32_bf16 a[48:51], v[200:203], a[200:203], a[48:51]
    s_add_u32 m0, s40, 114688
    v_mfma_f32_16x16x32_bf16 a[48:51], v[204:207], a[204:207], a[48:51]
    s_add_u32 s41, s65, 0
    ds_read_b64_tr_b16 v[212:213], v112 offset:36864
    ds_read_b64_tr_b16 v[214:215], v112 offset:37376
    v_mfma_f32_16x16x32_bf16 a[52:55], v[192:195], a[208:211], a[52:55]
    buffer_load_dwordx4 v241, s[24:27], s41 offen lds
    v_mfma_f32_16x16x32_bf16 a[52:55], v[196:199], a[212:215], a[52:55]
    ds_read_b64_tr_b16 v[216:217], v112 offset:40960
    ds_read_b64_tr_b16 v[218:219], v112 offset:41472
    v_mfma_f32_16x16x32_bf16 a[52:55], v[200:203], a[216:219], a[52:55]
    s_add_u32 m0, s40, 118784
    v_mfma_f32_16x16x32_bf16 a[52:55], v[204:207], a[220:223], a[52:55]
    s_add_u32 s41, s65, 110592
    ds_read_b64_tr_b16 v[220:221], v112 offset:45056
    ds_read_b64_tr_b16 v[222:223], v112 offset:45568
    v_mfma_f32_16x16x32_bf16 a[56:59], v[192:195], a[224:227], a[56:59]
    buffer_load_dwordx4 v241, s[24:27], s41 offen lds
    v_mfma_f32_16x16x32_bf16 a[56:59], v[196:199], a[228:231], a[56:59]
    v_mfma_f32_16x16x32_bf16 a[56:59], v[200:203], a[232:235], a[56:59]
    s_add_u32 m0, s40, 122880
    v_mfma_f32_16x16x32_bf16 a[56:59], v[204:207], a[236:239], a[56:59]
    s_add_u32 s41, s65, 221184
    v_mfma_f32_16x16x32_bf16 a[60:63], v[192:195], a[240:243], a[60:63]
    buffer_load_dwordx4 v241, s[24:27], s41 offen lds
    v_mfma_f32_16x16x32_bf16 a[60:63], v[196:199], a[244:247], a[60:63]
    s_add_u32 m0, s40, 126976
    v_mfma_f32_16x16x32_bf16 a[60:63], v[200:203], a[248:251], a[60:63]
    s_add_u32 s41, s65, 331776
    v_mfma_f32_16x16x32_bf16 a[60:63], v[204:207], a[252:255], a[60:63]
    s_waitcnt lgkmcnt(0) vmcnt(17)
    v_mfma_f32_16x16x32_bf16 v[0:3], v[208:211], a[64:67], v[0:3]
    buffer_load_dwordx4 v241, s[24:27], s41 offen lds
    v_mfma_f32_16x16x32_bf16 v[0:3], v[212:215], a[68:71], v[0:3]
    ds_read_b64_tr_b16 v[192:193], v113 offset:32768
    ds_read_b64_tr_b16 v[194:195], v113 offset:33280
    v_mfma_f32_16x16x32_bf16 v[0:3], v[216:219], a[72:75], v[0:3]
    v_mfma_f32_16x16x32_bf16 v[0:3], v[220:223], a[76:79], v[0:3]
    ds_read_b64_tr_b16 v[196:197], v113 offset:36864
    ds_read_b64_tr_b16 v[198:199], v113 offset:37376
    v_mfma_f32_16x16x32_bf16 v[4:7], v[208:211], a[80:83], v[4:7]
    buffer_load_dwordx4 a[168:171], v239, s[28:31], s55 offen offset:1024 sc1
    v_mfma_f32_16x16x32_bf16 v[4:7], v[212:215], a[84:87], v[4:7]
    ds_read_b64_tr_b16 v[200:201], v113 offset:40960
    ds_read_b64_tr_b16 v[202:203], v113 offset:41472
    v_mfma_f32_16x16x32_bf16 v[4:7], v[216:219], a[88:91], v[4:7]
    v_mfma_f32_16x16x32_bf16 v[4:7], v[220:223], a[92:95], v[4:7]
    ds_read_b64_tr_b16 v[204:205], v113 offset:45056
    ds_read_b64_tr_b16 v[206:207], v113 offset:45568
    v_mfma_f32_16x16x32_bf16 v[8:11], v[208:211], a[96:99], v[8:11]
    buffer_load_dwordx4 a[172:175], v239, s[28:31], s55 offen offset:1536 sc1
    v_mfma_f32_16x16x32_bf16 v[8:11], v[212:215], a[100:103], v[8:11]
    v_mfma_f32_16x16x32_bf16 v[8:11], v[216:219], a[104:107], v[8:11]
    v_mfma_f32_16x16x32_bf16 v[8:11], v[220:223], a[108:111], v[8:11]
    s_add_u32 s55, s59, 61440
    v_mfma_f32_16x16x32_bf16 v[12:15], v[208:211], a[112:115], v[12:15]
    buffer_load_dwordx4 a[176:179], v239, s[28:31], s55 offen offset:0 sc1
    v_mfma_f32_16x16x32_bf16 v[12:15], v[212:215], a[116:119], v[12:15]
    v_mfma_f32_16x16x32_bf16 v[12:15], v[216:219], a[120:123], v[12:15]
    v_mfma_f32_16x16x32_bf16 v[12:15], v[220:223], a[124:127], v[12:15]
    s_waitcnt lgkmcnt(0)
    v_mfma_f32_16x16x32_bf16 v[16:19], v[192:195], a[64:67], v[16:19]
    buffer_load_dwordx4 a[180:183], v239, s[28:31], s55 offen offset:512 sc1
    v_mfma_f32_16x16x32_bf16 v[16:19], v[196:199], a[68:71], v[16:19]
    ds_read_b64_tr_b16 v[208:209], v114 offset:32768
    ds_read_b64_tr_b16 v[210:211], v114 offset:33280
    v_mfma_f32_16x16x32_bf16 v[16:19], v[200:203], a[72:75], v[16:19]
    v_mfma_f32_16x16x32_bf16 v[16:19], v[204:207], a[76:79], v[16:19]
    ds_read_b64_tr_b16 v[212:213], v114 offset:36864
    ds_read_b64_tr_b16 v[214:215], v114 offset:37376
    v_mfma_f32_16x16x32_bf16 v[20:23], v[192:195], a[80:83], v[20:23]
    buffer_load_dwordx4 a[184:187], v239, s[28:31], s55 offen offset:1024 sc1
    v_mfma_f32_16x16x32_bf16 v[20:23], v[196:199], a[84:87], v[20:23]
    ds_read_b64_tr_b16 v[216:217], v114 offset:40960
    ds_read_b64_tr_b16 v[218:219], v114 offset:41472
    v_mfma_f32_16x16x32_bf16 v[20:23], v[200:203], a[88:91], v[20:23]
    v_mfma_f32_16x16x32_bf16 v[20:23], v[204:207], a[92:95], v[20:23]
    ds_read_b64_tr_b16 v[220:221], v114 offset:45056
    ds_read_b64_tr_b16 v[222:223], v114 offset:45568
    v_mfma_f32_16x16x32_bf16 v[24:27], v[192:195], a[96:99], v[24:27]
    buffer_load_dwordx4 a[188:191], v239, s[28:31], s55 offen offset:1536 sc1
    v_mfma_f32_16x16x32_bf16 v[24:27], v[196:199], a[100:103], v[24:27]
    v_mfma_f32_16x16x32_bf16 v[24:27], v[200:203], a[104:107], v[24:27]
    v_mfma_f32_16x16x32_bf16 v[24:27], v[204:207], a[108:111], v[24:27]
    v_mfma_f32_16x16x32_bf16 v[28:31], v[192:195], a[112:115], v[28:31]
    v_mfma_f32_16x16x32_bf16 v[28:31], v[196:199], a[116:119], v[28:31]
    v_mfma_f32_16x16x32_bf16 v[28:31], v[200:203], a[120:123], v[28:31]
    v_mfma_f32_16x16x32_bf16 v[28:31], v[204:207], a[124:127], v[28:31]
    s_waitcnt lgkmcnt(0)
    v_mfma_f32_16x16x32_bf16 v[32:35], v[208:211], a[64:67], v[32:35]
    s_waitcnt vmcnt(27)
    s_barrier
    v_mfma_f32_16x16x32_bf16 v[32:35], v[212:215], a[68:71], v[32:35]
    s_mul_i32 s65, s64, 442368
    ds_read_b64_tr_b16 v[192:193], v112 offset:49152
    ds_read_b64_tr_b16 v[194:195], v112 offset:49664
    v_mfma_f32_16x16x32_bf16 v[32:35], v[216:219], a[72:75], v[32:35]
    s_add_u32 m0, s40, 131072
    v_mfma_f32_16x16x32_bf16 v[32:35], v[220:223], a[76:79], v[32:35]
    s_add_u32 s41, s65, 0
    ds_read_b64_tr_b16 v[196:197], v112 offset:53248
    ds_read_b64_tr_b16 v[198:199], v112 offset:53760
    v_mfma_f32_16x16x32_bf16 v[36:39], v[208:211], a[80:83], v[36:39]
    buffer_load_dwordx4 v241, s[24:27], s41 offen lds
    v_mfma_f32_16x16x32_bf16 v[36:39], v[212:215], a[84:87], v[36:39]
    ds_read_b64_tr_b16 v[200:201], v112 offset:57344
    ds_read_b64_tr_b16 v[202:203], v112 offset:57856
    v_mfma_f32_16x16x32_bf16 v[36:39], v[216:219], a[88:91], v[36:39]
    s_add_u32 m0, s40, 135168
    v_mfma_f32_16x16x32_bf16 v[36:39], v[220:223], a[92:95], v[36:39]
    s_add_u32 s41, s65, 110592
    ds_read_b64_tr_b16 v[204:205], v112 offset:61440
    ds_read_b64_tr_b16 v[206:207], v112 offset:61952
    v_mfma_f32_16x16x32_bf16 v[40:43], v[208:211], a[96:99], v[40:43]
    buffer_load_dwordx4 v241, s[24:27], s41 offen lds
    v_mfma_f32_16x16x32_bf16 v[40:43], v[212:215], a[100:103], v[40:43]
    v_mfma_f32_16x16x32_bf16 v[40:43], v[216:219], a[104:107], v[40:43]
    v_mfma_f32_16x16x32_bf16 v[40:43], v[220:223], a[108:111], v[40:43]
    s_add_u32 m0, s40, 139264
    v_mfma_f32_16x16x32_bf16 v[44:47], v[208:211], a[112:115], v[44:47]
    s_add_u32 s41, s65, 221184
    v_mfma_f32_16x16x32_bf16 v[44:47], v[212:215], a[116:119], v[44:47]
    buffer_load_dwordx4 v241, s[24:27], s41 offen lds
    v_mfma_f32_16x16x32_bf16 v[44:47], v[216:219], a[120:123], v[44:47]
    v_mfma_f32_16x16x32_bf16 v[44:47], v[220:223], a[124:127], v[44:47]
    s_waitcnt lgkmcnt(0)
    v_mfma_f32_16x16x32_bf16 v[64:67], v[192:195], a[192:195], v[64:67]
    s_add_u32 m0, s40, 143360
    v_mfma_f32_16x16x32_bf16 v[64:67], v[196:199], a[196:199], v[64:67]
    s_add_u32 s41, s65, 331776
    ds_read_b64_tr_b16 v[208:209], v113 offset:49152
    ds_read_b64_tr_b16 v[210:211], v113 offset:49664
    v_mfma_f32_16x16x32_bf16 v[64:67], v[200:203], a[200:203], v[64:67]
    buffer_load_dwordx4 v241, s[24:27], s41 offen lds
    v_mfma_f32_16x16x32_bf16 v[64:67], v[204:207], a[204:207], v[64:67]
    ds_read_b64_tr_b16 v[212:213], v113 offset:53248
    ds_read_b64_tr_b16 v[214:215], v113 offset:53760
    v_mfma_f32_16x16x32_bf16 v[68:71], v[192:195], a[208:211], v[68:71]
    v_mfma_f32_16x16x32_bf16 v[68:71], v[196:199], a[212:215], v[68:71]
    s_mov_b32 s41, 0
    ds_read_b64_tr_b16 v[216:217], v113 offset:57344
    ds_read_b64_tr_b16 v[218:219], v113 offset:57856
    v_mfma_f32_16x16x32_bf16 v[68:71], v[200:203], a[216:219], v[68:71]
    buffer_load_dword v254, v252, s[8:11], s41 offen
    v_mfma_f32_16x16x32_bf16 v[68:71], v[204:207], a[220:223], v[68:71]
    ds_read_b64_tr_b16 v[220:221], v113 offset:61440
    ds_read_b64_tr_b16 v[222:223], v113 offset:61952
    v_mfma_f32_16x16x32_bf16 v[72:75], v[192:195], a[224:227], v[72:75]
    v_mfma_f32_16x16x32_bf16 v[72:75], v[196:199], a[228:231], v[72:75]
    s_mov_b32 s41, 32768
    v_mfma_f32_16x16x32_bf16 v[72:75], v[200:203], a[232:235], v[72:75]
    buffer_load_dword v254, v252, s[8:11], s41 offen
    v_mfma_f32_16x16x32_bf16 v[72:75], v[204:207], a[236:239], v[72:75]
    v_mfma_f32_16x16x32_bf16 v[76:79], v[192:195], a[240:243], v[76:79]
    v_mfma_f32_16x16x32_bf16 v[76:79], v[196:199], a[244:247], v[76:79]
    v_mfma_f32_16x16x32_bf16 v[76:79], v[200:203], a[248:251], v[76:79]
    s_mov_b32 s41, 0
    v_mfma_f32_16x16x32_bf16 v[76:79], v[204:207], a[252:255], v[76:79]
    s_waitcnt lgkmcnt(0)
    v_mfma_f32_16x16x32_bf16 v[80:83], v[208:211], a[192:195], v[80:83]
    buffer_load_dword v254, v252, s[12:15], s41 offen
    v_mfma_f32_16x16x32_bf16 v[80:83], v[212:215], a[196:199], v[80:83]
    ds_read_b64_tr_b16 v[192:193], v114 offset:49152
    ds_read_b64_tr_b16 v[194:195], v114 offset:49664
    v_mfma_f32_16x16x32_bf16 v[80:83], v[216:219], a[200:203], v[80:83]
    v_mfma_f32_16x16x32_bf16 v[80:83], v[220:223], a[204:207], v[80:83]
    s_mov_b32 s41, 65536
    ds_read_b64_tr_b16 v[196:197], v114 offset:53248
    ds_read_b64_tr_b16 v[198:199], v114 offset:53760
    v_mfma_f32_16x16x32_bf16 v[84:87], v[208:211], a[208:211], v[84:87]
    buffer_load_dword v254, v252, s[8:11], s41 offen
    v_mfma_f32_16x16x32_bf16 v[84:87], v[212:215], a[212:215], v[84:87]
L_padC_3:
    s_cbranch_execz L_padC_4
    ds_read_b64_tr_b16 v[200:201], v114 offset:57344
    ds_read_b64_tr_b16 v[202:203], v114 offset:57856
    v_mfma_f32_16x16x32_bf16 v[84:87], v[216:219], a[216:219], v[84:87]
    v_mfma_f32_16x16x32_bf16 v[84:87], v[220:223], a[220:223], v[84:87]
    s_mov_b32 s41, 32768
    ds_read_b64_tr_b16 v[204:205], v114 offset:61440
    ds_read_b64_tr_b16 v[206:207], v114 offset:61952
    v_mfma_f32_16x16x32_bf16 v[88:91], v[208:211], a[224:227], v[88:91]
    buffer_load_dword v254, v252, s[12:15], s41 offen
    v_mfma_f32_16x16x32_bf16 v[88:91], v[212:215], a[228:231], v[88:91]
    v_mfma_f32_16x16x32_bf16 v[88:91], v[216:219], a[232:235], v[88:91]
    v_mfma_f32_16x16x32_bf16 v[88:91], v[220:223], a[236:239], v[88:91]
    v_mfma_f32_16x16x32_bf16 v[92:95], v[208:211], a[240:243], v[92:95]
    v_mfma_f32_16x16x32_bf16 v[92:95], v[212:215], a[244:247], v[92:95]
    v_mfma_f32_16x16x32_bf16 v[92:95], v[216:219], a[248:251], v[92:95]
    v_mfma_f32_16x16x32_bf16 v[92:95], v[220:223], a[252:255], v[92:95]
    s_waitcnt lgkmcnt(0)
    v_mfma_f32_16x16x32_bf16 v[96:99], v[192:195], a[192:195], v[96:99]
    s_waitcnt vmcnt(27)
    s_barrier
    v_lshrrev_b32 v248, 4, v238
    v_mfma_f32_16x16x32_bf16 v[96:99], v[196:199], a[196:199], v[96:99]
    ds_read_b64_tr_b16 v[208:209], v112 offset:0
    ds_read_b64_tr_b16 v[210:211], v112 offset:512
    v_mfma_f32_16x16x32_bf16 v[96:99], v[200:203], a[200:203], v[96:99]
    v_mul_u32_u24 v249, 6554, v248
    v_lshrrev_b32 v249, 16, v249
    v_mfma_f32_16x16x32_bf16 v[96:99], v[204:207], a[204:207], v[96:99]
    ds_read_b64_tr_b16 v[212:213], v112 offset:4096
    ds_read_b64_tr_b16 v[214:215], v112 offset:4608
    v_mfma_f32_16x16x32_bf16 v[100:103], v[192:195], a[208:211], v[100:103]
    v_mul_u32_u24 v249, 1120, v249
    v_lshl_add_u32 v239, v248, 4, v249
    v_mfma_f32_16x16x32_bf16 v[100:103], v[196:199], a[212:215], v[100:103]
    ds_read_b64_tr_b16 v[216:217], v112 offset:8192
    ds_read_b64_tr_b16 v[218:219], v112 offset:8704
    v_mfma_f32_16x16x32_bf16 v[100:103], v[200:203], a[216:219], v[100:103]
    v_add_u32 v248, 64, v248
    v_mul_u32_u24 v249, 6554, v248
    v_mfma_f32_16x16x32_bf16 v[100:103], v[204:207], a[220:223], v[100:103]
    ds_read_b64_tr_b16 v[220:221], v112 offset:12288
    ds_read_b64_tr_b16 v[222:223], v112 offset:12800
    v_mfma_f32_16x16x32_bf16 v[104:107], v[192:195], a[224:227], v[104:107]
    v_lshrrev_b32 v249, 16, v249
    v_mul_u32_u24 v249, 1120, v249
    v_mfma_f32_16x16x32_bf16 v[104:107], v[196:199], a[228:231], v[104:107]
    v_lshl_add_u32 v241, v248, 4, v249
    v_add_u32 v248, 64, v248
    v_mfma_f32_16x16x32_bf16 v[104:107], v[200:203], a[232:235], v[104:107]
    v_mul_u32_u24 v249, 6554, v248
    v_lshrrev_b32 v249, 16, v249
    v_mfma_f32_16x16x32_bf16 v[104:107], v[204:207], a[236:239], v[104:107]
    v_mul_u32_u24 v249, 1120, v249
    v_lshl_add_u32 v253, v248, 4, v249
    v_mfma_f32_16x16x32_bf16 v[108:111], v[192:195], a[240:243], v[108:111]
    v_and_b32 v248, 0x200, v238
    v_lshl_add_u32 v253, v248, 20, v253
    v_mfma_f32_16x16x32_bf16 v[108:111], v[196:199], a[244:247], v[108:111]
    v_mfma_f32_16x16x32_bf16 v[108:111], v[200:203], a[248:251], v[108:111]
    v_mfma_f32_16x16x32_bf16 v[108:111], v[204:207], a[252:255], v[108:111]
    s_waitcnt lgkmcnt(0) vmcnt(9)
    v_mfma_f32_16x16x32_bf16 v[0:3], v[208:211], a[128:131], v[0:3]
    v_mfma_f32_16x16x32_bf16 v[0:3], v[212:215], a[132:135], v[0:3]
    ds_read_b64_tr_b16 v[192:193], v113 offset:0
    ds_read_b64_tr_b16 v[194:195], v113 offset:512
    v_mfma_f32_16x16x32_bf16 v[0:3], v[216:219], a[136:139], v[0:3]
    v_mfma_f32_16x16x32_bf16 v[0:3], v[220:223], a[140:143], v[0:3]
    ds_read_b64_tr_b16 v[196:197], v113 offset:4096
    ds_read_b64_tr_b16 v[198:199], v113 offset:4608
    v_mfma_f32_16x16x32_bf16 v[4:7], v[208:211], a[144:147], v[4:7]
    v_mfma_f32_16x16x32_bf16 v[4:7], v[212:215], a[148:151], v[4:7]
    ds_read_b64_tr_b16 v[200:201], v113 offset:8192
    ds_read_b64_tr_b16 v[202:203], v113 offset:8704
    v_mfma_f32_16x16x32_bf16 v[4:7], v[216:219], a[152:155], v[4:7]
    v_mfma_f32_16x16x32_bf16 v[4:7], v[220:223], a[156:159], v[4:7]
    ds_read_b64_tr_b16 v[204:205], v113 offset:12288
    ds_read_b64_tr_b16 v[206:207], v113 offset:12800
    v_mfma_f32_16x16x32_bf16 v[8:11], v[208:211], a[160:163], v[8:11]
    v_mfma_f32_16x16x32_bf16 v[8:11], v[212:215], a[164:167], v[8:11]
    v_mfma_f32_16x16x32_bf16 v[8:11], v[216:219], a[168:171], v[8:11]
    v_mfma_f32_16x16x32_bf16 v[8:11], v[220:223], a[172:175], v[8:11]
    v_mfma_f32_16x16x32_bf16 v[12:15], v[208:211], a[176:179], v[12:15]
    v_mfma_f32_16x16x32_bf16 v[12:15], v[212:215], a[180:183], v[12:15]
    v_mfma_f32_16x16x32_bf16 v[12:15], v[216:219], a[184:187], v[12:15]
    v_mfma_f32_16x16x32_bf16 v[12:15], v[220:223], a[188:191], v[12:15]
    s_waitcnt lgkmcnt(0)
    v_mfma_f32_16x16x32_bf16 v[16:19], v[192:195], a[128:131], v[16:19]
    v_mfma_f32_16x16x32_bf16 v[16:19], v[196:199], a[132:135], v[16:19]
    ds_read_b64_tr_b16 v[208:209], v114 offset:0
    ds_read_b64_tr_b16 v[210:211], v114 offset:512
    v_mfma_f32_16x16x32_bf16 v[16:19], v[200:203], a[136:139], v[16:19]
    v_mfma_f32_16x16x32_bf16 v[16:19], v[204:207], a[140:143], v[16:19]
    ds_read_b64_tr_b16 v[212:213], v114 offset:4096
    ds_read_b64_tr_b16 v[214:215], v114 offset:4608
    v_mfma_f32_16x16x32_bf16 v[20:23], v[192:195], a[144:147], v[20:23]
    v_mfma_f32_16x16x32_bf16 v[20:23], v[196:199], a[148:151], v[20:23]
    ds_read_b64_tr_b16 v[216:217], v114 offset:8192
    ds_read_b64_tr_b16 v[218:219], v114 offset:8704
    v_mfma_f32_16x16x32_bf16 v[20:23], v[200:203], a[152:155], v[20:23]
    v_mfma_f32_16x16x32_bf16 v[20:23], v[204:207], a[156:159], v[20:23]
    ds_read_b64_tr_b16 v[220:221], v114 offset:12288
    ds_read_b64_tr_b16 v[222:223], v114 offset:12800
    v_mfma_f32_16x16x32_bf16 v[24:27], v[192:195], a[160:163], v[24:27]
    v_mfma_f32_16x16x32_bf16 v[24:27], v[196:199], a[164:167], v[24:27]
    v_mfma_f32_16x16x32_bf16 v[24:27], v[200:203], a[168:171], v[24:27]
    v_mfma_f32_16x16x32_bf16 v[24:27], v[204:207], a[172:175], v[24:27]
    v_mfma_f32_16x16x32_bf16 v[28:31], v[192:195], a[176:179], v[28:31]
    v_mfma_f32_16x16x32_bf16 v[28:31], v[196:199], a[180:183], v[28:31]
    v_mfma_f32_16x16x32_bf16 v[28:31], v[200:203], a[184:187], v[28:31]
    v_mfma_f32_16x16x32_bf16 v[28:31], v[204:207], a[188:191], v[28:31]
    s_waitcnt lgkmcnt(0)
    v_mfma_f32_16x16x32_bf16 v[32:35], v[208:211], a[128:131], v[32:35]
    s_waitcnt vmcnt(15)
    s_barrier
    v_mfma_f32_16x16x32_bf16 v[32:35], v[212:215], a[132:135], v[32:35]
    s_mul_i32 s65, s63, 1048576
    ds_read_b64_tr_b16 v[192:193], v112 offset:16384
    ds_read_b64_tr_b16 v[194:195], v112 offset:16896
    v_mfma_f32_16x16x32_bf16 v[32:35], v[216:219], a[136:139], v[32:35]
    s_add_u32 m0, s40, 147456
    v_mfma_f32_16x16x32_bf16 v[32:35], v[220:223], a[140:143], v[32:35]
    s_add_u32 s41, s65, 0
    ds_read_b64_tr_b16 v[196:197], v112 offset:20480
    ds_read_b64_tr_b16 v[198:199], v112 offset:20992
    v_mfma_f32_16x16x32_bf16 v[36:39], v[208:211], a[144:147], v[36:39]
    buffer_load_dwordx4 v240, s[16:19], s41 offen lds
    v_mfma_f32_16x16x32_bf16 v[36:39], v[212:215], a[148:151], v[36:39]
    ds_read_b64_tr_b16 v[200:201], v112 offset:24576
    ds_read_b64_tr_b16 v[202:203], v112 offset:25088
    v_mfma_f32_16x16x32_bf16 v[36:39], v[216:219], a[152:155], v[36:39]
    v_mul_f32 v248, s52, v0
    v_mul_f32 v249, s52, v1
    v_mfma_f32_16x16x32_bf16 v[36:39], v[220:223], a[156:159], v[36:39]
    s_add_u32 m0, s40, 151552
    ds_read_b64_tr_b16 v[204:205], v112 offset:28672
    ds_read_b64_tr_b16 v[206:207], v112 offset:29184
    v_mfma_f32_16x16x32_bf16 v[40:43], v[208:211], a[160:163], v[40:43]
    s_add_u32 s41, s65, 262144
    v_mul_f32 v250, s52, v2
    v_mul_f32 v251, s52, v3
    v_mfma_f32_16x16x32_bf16 v[40:43], v[212:215], a[164:167], v[40:43]
    buffer_load_dwordx4 v240, s[16:19], s41 offen lds
    v_mfma_f32_16x16x32_bf16 v[40:43], v[216:219], a[168:171], v[40:43]
    v_exp_f32 v248, v248
    v_mfma_f32_16x16x32_bf16 v[40:43], v[220:223], a[172:175], v[40:43]
    v_exp_f32 v249, v249
    v_mfma_f32_16x16x32_bf16 v[44:47], v[208:211], a[176:179], v[44:47]
    s_add_u32 m0, s40, 155648
    v_exp_f32 v250, v250
    v_mfma_f32_16x16x32_bf16 v[44:47], v[212:215], a[180:183], v[44:47]
    s_add_u32 s41, s65, 524288
    v_exp_f32 v251, v251
    v_mfma_f32_16x16x32_bf16 v[44:47], v[216:219], a[184:187], v[44:47]
    buffer_load_dwordx4 v240, s[16:19], s41 offen lds
    v_mfma_f32_16x16x32_bf16 v[44:47], v[220:223], a[188:191], v[44:47]
    s_waitcnt lgkmcnt(0)
    v_fma_f32 v248, v248, s51, s51
    v_fma_f32 v249, v249, s51, s51
    v_mfma_f32_16x16x32_bf16 v[64:67], v[192:195], a[64:67], v[64:67]
    v_fma_f32 v250, v250, s51, s51
    v_fma_f32 v251, v251, s51, s51
    v_mfma_f32_16x16x32_bf16 v[64:67], v[196:199], a[68:71], v[64:67]
    ds_read_b64_tr_b16 v[208:209], v113 offset:16384
    ds_read_b64_tr_b16 v[210:211], v113 offset:16896
    v_mfma_f32_16x16x32_bf16 v[64:67], v[200:203], a[72:75], v[64:67]
    s_add_u32 m0, s40, 159744
    v_rcp_f32 v248, v248
    v_mfma_f32_16x16x32_bf16 v[64:67], v[204:207], a[76:79], v[64:67]
    s_add_u32 s41, s65, 786432
    ds_read_b64_tr_b16 v[212:213], v113 offset:20480
    ds_read_b64_tr_b16 v[214:215], v113 offset:20992
    v_mfma_f32_16x16x32_bf16 v[68:71], v[192:195], a[80:83], v[68:71]
    buffer_load_dwordx4 v240, s[16:19], s41 offen lds
    v_mfma_f32_16x16x32_bf16 v[68:71], v[196:199], a[84:87], v[68:71]
    s_mul_i32 s65, s64, 1048576
    ds_read_b64_tr_b16 v[216:217], v113 offset:24576
    ds_read_b64_tr_b16 v[218:219], v113 offset:25088
    v_mfma_f32_16x16x32_bf16 v[68:71], v[200:203], a[88:91], v[68:71]
    s_add_u32 m0, s40, 98304
    v_rcp_f32 v249, v249
    v_mfma_f32_16x16x32_bf16 v[68:71], v[204:207], a[92:95], v[68:71]
    s_add_u32 s41, s65, 0
    ds_read_b64_tr_b16 v[220:221], v113 offset:28672
    ds_read_b64_tr_b16 v[222:223], v113 offset:29184
    v_mfma_f32_16x16x32_bf16 v[72:75], v[192:195], a[96:99], v[72:75]
    buffer_load_dwordx4 v240, s[16:19], s41 offen lds
    v_mfma_f32_16x16x32_bf16 v[72:75], v[196:199], a[100:103], v[72:75]
    v_rcp_f32 v250, v250
    v_mfma_f32_16x16x32_bf16 v[72:75], v[200:203], a[104:107], v[72:75]
    v_rcp_f32 v251, v251
    v_mfma_f32_16x16x32_bf16 v[72:75], v[204:207], a[108:111], v[72:75]
    s_add_u32 m0, s40, 102400
    v_mul_f32 v0, v0, v248
    v_mul_f32 v1, v1, v249
    v_mfma_f32_16x16x32_bf16 v[76:79], v[192:195], a[112:115], v[76:79]
    s_add_u32 s41, s65, 262144
    v_mul_f32 v2, v2, v250
    v_mul_f32 v3, v3, v251
    v_mfma_f32_16x16x32_bf16 v[76:79], v[196:199], a[116:119], v[76:79]
    buffer_load_dwordx4 v240, s[16:19], s41 offen lds
    v_mfma_f32_16x16x32_bf16 v[76:79], v[200:203], a[120:123], v[76:79]
    v_mul_f32 v248, s52, v16
    v_mul_f32 v249, s52, v17
    v_mfma_f32_16x16x32_bf16 v[76:79], v[204:207], a[124:127], v[76:79]
    s_waitcnt lgkmcnt(0)
    v_mul_f32 v250, s52, v18
    v_mul_f32 v251, s52, v19
    v_mfma_f32_16x16x32_bf16 v[80:83], v[208:211], a[64:67], v[80:83]
    s_add_u32 m0, s40, 106496
    v_exp_f32 v248, v248
    v_mfma_f32_16x16x32_bf16 v[80:83], v[212:215], a[68:71], v[80:83]
    s_add_u32 s41, s65, 524288
    ds_read_b64_tr_b16 v[192:193], v114 offset:16384
    ds_read_b64_tr_b16 v[194:195], v114 offset:16896
    v_mfma_f32_16x16x32_bf16 v[80:83], v[216:219], a[72:75], v[80:83]
    buffer_load_dwordx4 v240, s[16:19], s41 offen lds
    v_mfma_f32_16x16x32_bf16 v[80:83], v[220:223], a[76:79], v[80:83]
    ds_read_b64_tr_b16 v[196:197], v114 offset:20480
    ds_read_b64_tr_b16 v[198:199], v114 offset:20992
    v_mfma_f32_16x16x32_bf16 v[84:87], v[208:211], a[80:83], v[84:87]
    v_exp_f32 v249, v249
    v_mfma_f32_16x16x32_bf16 v[84:87], v[212:215], a[84:87], v[84:87]
    ds_read_b64_tr_b16 v[200:201], v114 offset:24576
    ds_read_b64_tr_b16 v[202:203], v114 offset:25088
    v_mfma_f32_16x16x32_bf16 v[84:87], v[216:219], a[88:91], v[84:87]
    s_add_u32 m0, s40, 110592
    v_exp_f32 v250, v250
    v_mfma_f32_16x16x32_bf16 v[84:87], v[220:223], a[92:95], v[84:87]
    s_add_u32 s41, s65, 786432
    ds_read_b64_tr_b16 v[204:205], v114 offset:28672
    ds_read_b64_tr_b16 v[206:207], v114 offset:29184
    v_mfma_f32_16x16x32_bf16 v[88:91], v[208:211], a[96:99], v[88:91]
    buffer_load_dwordx4 v240, s[16:19], s41 offen lds
    v_mfma_f32_16x16x32_bf16 v[88:91], v[212:215], a[100:103], v[88:91]
    v_exp_f32 v251, v251
    v_mfma_f32_16x16x32_bf16 v[88:91], v[216:219], a[104:107], v[88:91]
    v_fma_f32 v248, v248, s51, s51
    v_fma_f32 v249, v249, s51, s51
    v_mfma_f32_16x16x32_bf16 v[88:91], v[220:223], a[108:111], v[88:91]
    v_fma_f32 v250, v250, s51, s51
    v_fma_f32 v251, v251, s51, s51
    v_mfma_f32_16x16x32_bf16 v[92:95], v[208:211], a[112:115], v[92:95]
    v_rcp_f32 v248, v248
    v_mfma_f32_16x16x32_bf16 v[92:95], v[212:215], a[116:119], v[92:95]
    v_rcp_f32 v249, v249
    v_mfma_f32_16x16x32_bf16 v[92:95], v[216:219], a[120:123], v[92:95]
    v_rcp_f32 v250, v250
    v_mfma_f32_16x16x32_bf16 v[92:95], v[220:223], a[124:127], v[92:95]
    s_waitcnt lgkmcnt(0)
    v_rcp_f32 v251, v251
    v_mfma_f32_16x16x32_bf16 v[96:99], v[192:195], a[64:67], v[96:99]
    s_waitcnt vmcnt(13)
    s_barrier
    v_mul_f32 v16, v16, v248
    v_mfma_f32_16x16x32_bf16 v[96:99], v[196:199], a[68:71], v[96:99]
    s_mul_i32 s65, s62, 1048576
    ds_read_b64_tr_b16 v[208:209], v112 offset:32768
    ds_read_b64_tr_b16 v[210:211], v112 offset:33280
    v_mfma_f32_16x16x32_bf16 v[96:99], v[200:203], a[72:75], v[96:99]
    s_add_u32 m0, s40, 114688
    v_mul_f32 v17, v17, v249
    v_mul_f32 v18, v18, v250
    v_mfma_f32_16x16x32_bf16 v[96:99], v[204:207], a[76:79], v[96:99]
    s_add_u32 s41, s65, 128
    ds_read_b64_tr_b16 v[212:213], v112 offset:36864
    ds_read_b64_tr_b16 v[214:215], v112 offset:37376
    v_mfma_f32_16x16x32_bf16 v[100:103], v[192:195], a[80:83], v[100:103]
    buffer_load_dwordx4 v240, s[16:19], s41 offen lds
    v_mfma_f32_16x16x32_bf16 v[100:103], v[196:199], a[84:87], v[100:103]
    ds_read_b64_tr_b16 v[216:217], v112 offset:40960
    ds_read_b64_tr_b16 v[218:219], v112 offset:41472
    v_mfma_f32_16x16x32_bf16 v[100:103], v[200:203], a[88:91], v[100:103]
    v_mul_f32 v19, v19, v251
    v_mul_f32 v248, s52, v4
    v_mfma_f32_16x16x32_bf16 v[100:103], v[204:207], a[92:95], v[100:103]
    ds_read_b64_tr_b16 v[220:221], v112 offset:45056
    ds_read_b64_tr_b16 v[222:223], v112 offset:45568
    v_mfma_f32_16x16x32_bf16 v[104:107], v[192:195], a[96:99], v[104:107]
    s_add_u32 m0, s40, 118784
    v_mul_f32 v249, s52, v5
    v_mul_f32 v250, s52, v6
    v_mfma_f32_16x16x32_bf16 v[104:107], v[196:199], a[100:103], v[104:107]
    s_add_u32 s41, s65, 262272
    v_mul_f32 v251, s52, v7
    v_mfma_f32_16x16x32_bf16 v[104:107], v[200:203], a[104:107], v[104:107]
    buffer_load_dwordx4 v240, s[16:19], s41 offen lds
    v_mfma_f32_16x16x32_bf16 v[104:107], v[204:207], a[108:111], v[104:107]
    v_exp_f32 v248, v248
    v_mfma_f32_16x16x32_bf16 v[108:111], v[192:195], a[112:115], v[108:111]
    v_exp_f32 v249, v249
    v_mfma_f32_16x16x32_bf16 v[108:111], v[196:199], a[116:119], v[108:111]
    s_add_u32 m0, s40, 122880
    v_exp_f32 v250, v250
    v_mfma_f32_16x16x32_bf16 v[108:111], v[200:203], a[120:123], v[108:111]
    s_add_u32 s41, s65, 524416
    v_exp_f32 v251, v251
    v_mfma_f32_16x16x32_bf16 v[108:111], v[204:207], a[124:127], v[108:111]
    s_waitcnt lgkmcnt(0)
    v_fma_f32 v248, v248, s51, s51
    v_fma_f32 v249, v249, s51, s51
    v_mfma_f32_16x16x32_bf16 v[64:67], v[208:211], a[128:131], v[64:67]
    buffer_load_dwordx4 v240, s[16:19], s41 offen lds
    v_mfma_f32_16x16x32_bf16 v[64:67], v[212:215], a[132:135], v[64:67]
    ds_read_b64_tr_b16 v[192:193], v113 offset:32768
    ds_read_b64_tr_b16 v[194:195], v113 offset:33280
    v_mfma_f32_16x16x32_bf16 v[64:67], v[216:219], a[136:139], v[64:67]
    v_fma_f32 v250, v250, s51, s51
    v_fma_f32 v251, v251, s51, s51
    v_mfma_f32_16x16x32_bf16 v[64:67], v[220:223], a[140:143], v[64:67]
    ds_read_b64_tr_b16 v[196:197], v113 offset:36864
    ds_read_b64_tr_b16 v[198:199], v113 offset:37376
    v_mfma_f32_16x16x32_bf16 v[68:71], v[208:211], a[144:147], v[68:71]
    s_add_u32 m0, s40, 126976
    v_rcp_f32 v248, v248
    v_mfma_f32_16x16x32_bf16 v[68:71], v[212:215], a[148:151], v[68:71]
    s_add_u32 s41, s65, 786560
    ds_read_b64_tr_b16 v[200:201], v113 offset:40960
    ds_read_b64_tr_b16 v[202:203], v113 offset:41472
    v_mfma_f32_16x16x32_bf16 v[68:71], v[216:219], a[152:155], v[68:71]
    buffer_load_dwordx4 v240, s[16:19], s41 offen lds
    v_mfma_f32_16x16x32_bf16 v[68:71], v[220:223], a[156:159], v[68:71]
    ds_read_b64_tr_b16 v[204:205], v113 offset:45056
    ds_read_b64_tr_b16 v[206:207], v113 offset:45568
    v_mfma_f32_16x16x32_bf16 v[72:75], v[208:211], a[160:163], v[72:75]
    v_rcp_f32 v249, v249
    v_mfma_f32_16x16x32_bf16 v[72:75], v[212:215], a[164:167], v[72:75]
    v_rcp_f32 v250, v250
    v_mfma_f32_16x16x32_bf16 v[72:75], v[216:219], a[168:171], v[72:75]
    s_add_u32 m0, s40, 0
    v_rcp_f32 v251, v251
    v_mfma_f32_16x16x32_bf16 v[72:75], v[220:223], a[172:175], v[72:75]
    s_mov_b32 s41, 0
    v_mul_f32 v4, v4, v248
    v_mul_f32 v5, v5, v249
    v_mfma_f32_16x16x32_bf16 v[76:79], v[208:211], a[176:179], v[76:79]
    buffer_load_dwordx4 v236, s[8:11], s41 offen lds
    v_mfma_f32_16x16x32_bf16 v[76:79], v[212:215], a[180:183], v[76:79]
    v_mul_f32 v6, v6, v250
    v_mul_f32 v7, v7, v251
    v_mfma_f32_16x16x32_bf16 v[76:79], v[216:219], a[184:187], v[76:79]
    v_mul_f32 v248, s52, v20
    v_mul_f32 v249, s52, v21
    v_mfma_f32_16x16x32_bf16 v[76:79], v[220:223], a[188:191], v[76:79]
    s_waitcnt lgkmcnt(0)
    v_mul_f32 v250, s52, v22
    v_mul_f32 v251, s52, v23
    v_mfma_f32_16x16x32_bf16 v[80:83], v[192:195], a[128:131], v[80:83]
    s_add_u32 m0, s40, 4096
    v_exp_f32 v248, v248
    v_mfma_f32_16x16x32_bf16 v[80:83], v[196:199], a[132:135], v[80:83]
    s_mov_b32 s41, 4096
    ds_read_b64_tr_b16 v[208:209], v114 offset:32768
    ds_read_b64_tr_b16 v[210:211], v114 offset:33280
    v_mfma_f32_16x16x32_bf16 v[80:83], v[200:203], a[136:139], v[80:83]
    buffer_load_dwordx4 v236, s[8:11], s41 offen lds
    v_mfma_f32_16x16x32_bf16 v[80:83], v[204:207], a[140:143], v[80:83]
    ds_read_b64_tr_b16 v[212:213], v114 offset:36864
    ds_read_b64_tr_b16 v[214:215], v114 offset:37376
    v_mfma_f32_16x16x32_bf16 v[84:87], v[192:195], a[144:147], v[84:87]
    v_exp_f32 v249, v249
    v_mfma_f32_16x16x32_bf16 v[84:87], v[196:199], a[148:151], v[84:87]
    ds_read_b64_tr_b16 v[216:217], v114 offset:40960
    ds_read_b64_tr_b16 v[218:219], v114 offset:41472
    v_mfma_f32_16x16x32_bf16 v[84:87], v[200:203], a[152:155], v[84:87]
    v_exp_f32 v250, v250
    v_mfma_f32_16x16x32_bf16 v[84:87], v[204:207], a[156:159], v[84:87]
    ds_read_b64_tr_b16 v[220:221], v114 offset:45056
    ds_read_b64_tr_b16 v[222:223], v114 offset:45568
    v_mfma_f32_16x16x32_bf16 v[88:91], v[192:195], a[160:163], v[88:91]
    v_exp_f32 v251, v251
    v_mfma_f32_16x16x32_bf16 v[88:91], v[196:199], a[164:167], v[88:91]
    v_fma_f32 v248, v248, s51, s51
    v_fma_f32 v249, v249, s51, s51
    v_mfma_f32_16x16x32_bf16 v[88:91], v[200:203], a[168:171], v[88:91]
    v_fma_f32 v250, v250, s51, s51
    v_fma_f32 v251, v251, s51, s51
    v_mfma_f32_16x16x32_bf16 v[88:91], v[204:207], a[172:175], v[88:91]
    v_rcp_f32 v248, v248
    v_mfma_f32_16x16x32_bf16 v[92:95], v[192:195], a[176:179], v[92:95]
    v_rcp_f32 v249, v249
    v_mfma_f32_16x16x32_bf16 v[92:95], v[196:199], a[180:183], v[92:95]
    v_rcp_f32 v250, v250
    v_mfma_f32_16x16x32_bf16 v[92:95], v[200:203], a[184:187], v[92:95]
    v_rcp_f32 v251, v251
    v_mfma_f32_16x16x32_bf16 v[92:95], v[204:207], a[188:191], v[92:95]
    s_waitcnt lgkmcnt(0)
    v_mul_f32 v20, v20, v248
    v_mul_f32 v21, v21, v249
    v_mfma_f32_16x16x32_bf16 v[96:99], v[208:211], a[128:131], v[96:99]
    s_waitcnt vmcnt(10)
    s_barrier
    v_mul_f32 v22, v22, v250
    v_mfma_f32_16x16x32_bf16 v[96:99], v[212:215], a[132:135], v[96:99]
    s_mul_i32 s65, s63, 1048576
    ds_read_b64_tr_b16 v[192:193], v242 offset:49152
    ds_read_b64_tr_b16 v[194:195], v242 offset:49664
    v_mfma_f32_16x16x32_bf16 v[96:99], v[216:219], a[136:139], v[96:99]
    s_add_u32 m0, s40, 131072
    v_mul_f32 v23, v23, v251
    v_mul_f32 v248, s52, v8
    v_mfma_f32_16x16x32_bf16 v[96:99], v[220:223], a[140:143], v[96:99]
    s_add_u32 s41, s65, 128
    ds_read_b64_tr_b16 v[196:197], v242 offset:53248
    ds_read_b64_tr_b16 v[198:199], v242 offset:53760
    v_mfma_f32_16x16x32_bf16 v[100:103], v[208:211], a[144:147], v[100:103]
    buffer_load_dwordx4 v240, s[16:19], s41 offen lds
    v_mfma_f32_16x16x32_bf16 v[100:103], v[212:215], a[148:151], v[100:103]
    ds_read_b64_tr_b16 v[200:201], v242 offset:57344
    ds_read_b64_tr_b16 v[202:203], v242 offset:57856
    v_mfma_f32_16x16x32_bf16 v[100:103], v[216:219], a[152:155], v[100:103]
    v_mul_f32 v249, s52, v9
    v_mul_f32 v250, s52, v10
    v_mfma_f32_16x16x32_bf16 v[100:103], v[220:223], a[156:159], v[100:103]
    ds_read_b64_tr_b16 v[204:205], v242 offset:61440
    ds_read_b64_tr_b16 v[206:207], v242 offset:61952
    v_mfma_f32_16x16x32_bf16 v[104:107], v[208:211], a[160:163], v[104:107]
    s_add_u32 m0, s40, 135168
    v_mul_f32 v251, s52, v11
    v_mfma_f32_16x16x32_bf16 v[104:107], v[212:215], a[164:167], v[104:107]
    s_add_u32 s41, s65, 262272
    v_exp_f32 v248, v248
    v_mfma_f32_16x16x32_bf16 v[104:107], v[216:219], a[168:171], v[104:107]
    buffer_load_dwordx4 v240, s[16:19], s41 offen lds
    v_mfma_f32_16x16x32_bf16 v[104:107], v[220:223], a[172:175], v[104:107]
    v_exp_f32 v249, v249
    v_mfma_f32_16x16x32_bf16 v[108:111], v[208:211], a[176:179], v[108:111]
    v_exp_f32 v250, v250
    v_mfma_f32_16x16x32_bf16 v[108:111], v[212:215], a[180:183], v[108:111]
    s_add_u32 m0, s40, 139264
    v_exp_f32 v251, v251
    v_mfma_f32_16x16x32_bf16 v[108:111], v[216:219], a[184:187], v[108:111]
    s_add_u32 s41, s65, 524416
    v_fma_f32 v248, v248, s51, s51
    v_fma_f32 v249, v249, s51, s51
    v_mfma_f32_16x16x32_bf16 v[108:111], v[220:223], a[188:191], v[108:111]
    s_waitcnt lgkmcnt(0)
    v_fma_f32 v250, v250, s51, s51
    v_fma_f32 v251, v251, s51, s51
    v_mfma_f32_16x16x32_bf16 a[0:3], v[192:195], a[64:67], a[0:3]
    buffer_load_dwordx4 v240, s[16:19], s41 offen lds
    v_mfma_f32_16x16x32_bf16 a[0:3], v[196:199], a[68:71], a[0:3]
    ds_read_b64_tr_b16 v[208:209], v243 offset:49152
    ds_read_b64_tr_b16 v[210:211], v243 offset:49664
    v_mfma_f32_16x16x32_bf16 a[0:3], v[200:203], a[72:75], a[0:3]
    v_rcp_f32 v248, v248
    v_mfma_f32_16x16x32_bf16 a[0:3], v[204:207], a[76:79], a[0:3]
    ds_read_b64_tr_b16 v[212:213], v243 offset:53248
    ds_read_b64_tr_b16 v[214:215], v243 offset:53760
    v_mfma_f32_16x16x32_bf16 a[4:7], v[192:195], a[80:83], a[4:7]
    s_add_u32 m0, s40, 143360
    v_rcp_f32 v249, v249
    v_mfma_f32_16x16x32_bf16 a[4:7], v[196:199], a[84:87], a[4:7]
    s_add_u32 s41, s65, 786560
    ds_read_b64_tr_b16 v[216:217], v243 offset:57344
    ds_read_b64_tr_b16 v[218:219], v243 offset:57856
    v_mfma_f32_16x16x32_bf16 a[4:7], v[200:203], a[88:91], a[4:7]
    buffer_load_dwordx4 v240, s[16:19], s41 offen lds
    v_mfma_f32_16x16x32_bf16 a[4:7], v[204:207], a[92:95], a[4:7]
    ds_read_b64_tr_b16 v[220:221], v243 offset:61440
    ds_read_b64_tr_b16 v[222:223], v243 offset:61952
    v_mfma_f32_16x16x32_bf16 a[8:11], v[192:195], a[96:99], a[8:11]
    v_rcp_f32 v250, v250
    v_mfma_f32_16x16x32_bf16 a[8:11], v[196:199], a[100:103], a[8:11]
    v_rcp_f32 v251, v251
    v_mfma_f32_16x16x32_bf16 a[8:11], v[200:203], a[104:107], a[8:11]
    s_add_u32 m0, s40, 8192
    v_mul_f32 v8, v8, v248
    v_mul_f32 v9, v9, v249
    v_mfma_f32_16x16x32_bf16 a[8:11], v[204:207], a[108:111], a[8:11]
    s_mov_b32 s41, 8192
    v_mul_f32 v10, v10, v250
    v_mul_f32 v11, v11, v251
    v_mfma_f32_16x16x32_bf16 a[12:15], v[192:195], a[112:115], a[12:15]
    buffer_load_dwordx4 v236, s[8:11], s41 offen lds
    v_mfma_f32_16x16x32_bf16 a[12:15], v[196:199], a[116:119], a[12:15]
    v_mul_f32 v248, s52, v24
    v_mul_f32 v249, s52, v25
    v_mfma_f32_16x16x32_bf16 a[12:15], v[200:203], a[120:123], a[12:15]
    v_mul_f32 v250, s52, v26
    v_mul_f32 v251, s52, v27
    v_mfma_f32_16x16x32_bf16 a[12:15], v[204:207], a[124:127], a[12:15]
    s_waitcnt lgkmcnt(0)
    v_exp_f32 v248, v248
    v_mfma_f32_16x16x32_bf16 a[16:19], v[208:211], a[64:67], a[16:19]
    s_add_u32 m0, s40, 12288
    v_exp_f32 v249, v249
    v_mfma_f32_16x16x32_bf16 a[16:19], v[212:215], a[68:71], a[16:19]
    s_mov_b32 s41, 12288
    ds_read_b64_tr_b16 v[192:193], v244 offset:49152
    ds_read_b64_tr_b16 v[194:195], v244 offset:49664
    v_mfma_f32_16x16x32_bf16 a[16:19], v[216:219], a[72:75], a[16:19]
    buffer_load_dwordx4 v236, s[8:11], s41 offen lds
    v_mfma_f32_16x16x32_bf16 a[16:19], v[220:223], a[76:79], a[16:19]
    ds_read_b64_tr_b16 v[196:197], v244 offset:53248
    ds_read_b64_tr_b16 v[198:199], v244 offset:53760
    v_mfma_f32_16x16x32_bf16 a[20:23], v[208:211], a[80:83], a[20:23]
    v_exp_f32 v250, v250
    v_mfma_f32_16x16x32_bf16 a[20:23], v[212:215], a[84:87], a[20:23]
    ds_read_b64_tr_b16 v[200:201], v244 offset:57344
    ds_read_b64_tr_b16 v[202:203], v244 offset:57856
    v_mfma_f32_16x16x32_bf16 a[20:23], v[216:219], a[88:91], a[20:23]
    s_add_u32 m0, s40, 16384
    v_exp_f32 v251, v251
    v_mfma_f32_16x16x32_bf16 a[20:23], v[220:223], a[92:95], a[20:23]
    s_mov_b32 s41, 16384
    ds_read_b64_tr_b16 v[204:205], v244 offset:61440
    ds_read_b64_tr_b16 v[206:207], v244 offset:61952
    v_mfma_f32_16x16x32_bf16 a[24:27], v[208:211], a[96:99], a[24:27]
    buffer_load_dwordx4 v236, s[8:11], s41 offen lds
    v_mfma_f32_16x16x32_bf16 a[24:27], v[212:215], a[100:103], a[24:27]
    v_fma_f32 v248, v248, s51, s51
    v_fma_f32 v249, v249, s51, s51
    v_mfma_f32_16x16x32_bf16 a[24:27], v[216:219], a[104:107], a[24:27]
    v_fma_f32 v250, v250, s51, s51
    v_fma_f32 v251, v251, s51, s51
    v_mfma_f32_16x16x32_bf16 a[24:27], v[220:223], a[108:111], a[24:27]
    v_rcp_f32 v248, v248
    v_mfma_f32_16x16x32_bf16 a[28:31], v[208:211], a[112:115], a[28:31]
    s_add_u32 m0, s40, 20480
    v_rcp_f32 v249, v249
    v_mfma_f32_16x16x32_bf16 a[28:31], v[212:215], a[116:119], a[28:31]
    s_mov_b32 s41, 20480
    v_rcp_f32 v250, v250
    v_mfma_f32_16x16x32_bf16 a[28:31], v[216:219], a[120:123], a[28:31]
    buffer_load_dwordx4 v236, s[8:11], s41 offen lds
    v_mfma_f32_16x16x32_bf16 a[28:31], v[220:223], a[124:127], a[28:31]
    s_waitcnt lgkmcnt(0)
    v_rcp_f32 v251, v251
    v_mfma_f32_16x16x32_bf16 a[32:35], v[192:195], a[64:67], a[32:35]
    v_mul_f32 v24, v24, v248
    v_mul_f32 v25, v25, v249
    v_mfma_f32_16x16x32_bf16 a[32:35], v[196:199], a[68:71], a[32:35]
    ds_read_b64_tr_b16 v[208:209], v245 offset:49152
    ds_read_b64_tr_b16 v[210:211], v245 offset:49664
    v_mfma_f32_16x16x32_bf16 a[32:35], v[200:203], a[72:75], a[32:35]
    s_add_u32 m0, s40, 24576
    v_mul_f32 v26, v26, v250
    v_mul_f32 v27, v27, v251
    v_mfma_f32_16x16x32_bf16 a[32:35], v[204:207], a[76:79], a[32:35]
    s_mov_b32 s41, 24576
    ds_read_b64_tr_b16 v[212:213], v245 offset:53248
    ds_read_b64_tr_b16 v[214:215], v245 offset:53760
    v_mfma_f32_16x16x32_bf16 a[36:39], v[192:195], a[80:83], a[36:39]
    buffer_load_dwordx4 v236, s[8:11], s41 offen lds
    v_mfma_f32_16x16x32_bf16 a[36:39], v[196:199], a[84:87], a[36:39]
    ds_read_b64_tr_b16 v[216:217], v245 offset:57344
    ds_read_b64_tr_b16 v[218:219], v245 offset:57856
    v_mfma_f32_16x16x32_bf16 a[36:39], v[200:203], a[88:91], a[36:39]
    v_mul_f32 v248, s52, v12
    v_mul_f32 v249, s52, v13
    v_mfma_f32_16x16x32_bf16 a[36:39], v[204:207], a[92:95], a[36:39]
    ds_read_b64_tr_b16 v[220:221], v245 offset:61440
    ds_read_b64_tr_b16 v[222:223], v245 offset:61952
    v_mfma_f32_16x16x32_bf16 a[40:43], v[192:195], a[96:99], a[40:43]
    v_mul_f32 v250, s52, v14
    v_mul_f32 v251, s52, v15
    v_mfma_f32_16x16x32_bf16 a[40:43], v[196:199], a[100:103], a[40:43]
    v_exp_f32 v248, v248
    v_mfma_f32_16x16x32_bf16 a[40:43], v[200:203], a[104:107], a[40:43]
    v_exp_f32 v249, v249
    v_mfma_f32_16x16x32_bf16 a[40:43], v[204:207], a[108:111], a[40:43]
    v_exp_f32 v250, v250
    v_mfma_f32_16x16x32_bf16 a[44:47], v[192:195], a[112:115], a[44:47]
    v_exp_f32 v251, v251
    v_mfma_f32_16x16x32_bf16 a[44:47], v[196:199], a[116:119], a[44:47]
    v_fma_f32 v248, v248, s51, s51
    v_fma_f32 v249, v249, s51, s51
    v_mfma_f32_16x16x32_bf16 a[44:47], v[200:203], a[120:123], a[44:47]
    v_fma_f32 v250, v250, s51, s51
    v_fma_f32 v251, v251, s51, s51
    v_mfma_f32_16x16x32_bf16 a[44:47], v[204:207], a[124:127], a[44:47]
    s_waitcnt lgkmcnt(0)
    v_rcp_f32 v248, v248
    v_mfma_f32_16x16x32_bf16 a[48:51], v[208:211], a[64:67], a[48:51]
    s_waitcnt vmcnt(15)
    s_barrier
    v_mfma_f32_16x16x32_bf16 a[48:51], v[212:215], a[68:71], a[48:51]
    s_mul_i32 s65, s64, 1048576
    ds_read_b64_tr_b16 v[192:193], v242 offset:0
    ds_read_b64_tr_b16 v[194:195], v242 offset:512
    v_mfma_f32_16x16x32_bf16 a[48:51], v[216:219], a[72:75], a[48:51]
    s_add_u32 m0, s40, 147456
    v_rcp_f32 v249, v249
    v_mfma_f32_16x16x32_bf16 a[48:51], v[220:223], a[76:79], a[48:51]
    s_add_u32 s41, s65, 128
    ds_read_b64_tr_b16 v[196:197], v242 offset:4096
    ds_read_b64_tr_b16 v[198:199], v242 offset:4608
    v_mfma_f32_16x16x32_bf16 a[52:55], v[208:211], a[80:83], a[52:55]
L_padC_4:
    s_cbranch_execz L_padC_5
    buffer_load_dwordx4 v240, s[16:19], s41 offen lds
    v_mfma_f32_16x16x32_bf16 a[52:55], v[212:215], a[84:87], a[52:55]
    ds_read_b64_tr_b16 v[200:201], v242 offset:8192
    ds_read_b64_tr_b16 v[202:203], v242 offset:8704
    v_mfma_f32_16x16x32_bf16 a[52:55], v[216:219], a[88:91], a[52:55]
    v_rcp_f32 v250, v250
    v_mfma_f32_16x16x32_bf16 a[52:55], v[220:223], a[92:95], a[52:55]
    ds_read_b64_tr_b16 v[204:205], v242 offset:12288
    ds_read_b64_tr_b16 v[206:207], v242 offset:12800
    v_mfma_f32_16x16x32_bf16 a[56:59], v[208:211], a[96:99], a[56:59]
    s_add_u32 m0, s40, 151552
    v_rcp_f32 v251, v251
    v_mfma_f32_16x16x32_bf16 a[56:59], v[212:215], a[100:103], a[56:59]
    s_add_u32 s41, s65, 262272
    v_mul_f32 v12, v12, v248
    v_mul_f32 v13, v13, v249
    v_mfma_f32_16x16x32_bf16 a[56:59], v[216:219], a[104:107], a[56:59]
    buffer_load_dwordx4 v240, s[16:19], s41 offen lds
    v_mfma_f32_16x16x32_bf16 a[56:59], v[220:223], a[108:111], a[56:59]
    v_mul_f32 v14, v14, v250
    v_mul_f32 v15, v15, v251
    v_mfma_f32_16x16x32_bf16 a[60:63], v[208:211], a[112:115], a[60:63]
    v_mul_f32 v248, s52, v28
    v_mul_f32 v249, s52, v29
    v_mfma_f32_16x16x32_bf16 a[60:63], v[212:215], a[116:119], a[60:63]
    s_add_u32 m0, s40, 155648
    v_mul_f32 v250, s52, v30
    v_mul_f32 v251, s52, v31
    v_mfma_f32_16x16x32_bf16 a[60:63], v[216:219], a[120:123], a[60:63]
    s_add_u32 s41, s65, 524416
    v_exp_f32 v248, v248
    v_mfma_f32_16x16x32_bf16 a[60:63], v[220:223], a[124:127], a[60:63]
    s_waitcnt lgkmcnt(0)
    v_exp_f32 v249, v249
    v_mfma_f32_16x16x32_bf16 a[0:3], v[192:195], a[128:131], a[0:3]
    buffer_load_dwordx4 v240, s[16:19], s41 offen lds
    v_mfma_f32_16x16x32_bf16 a[0:3], v[196:199], a[132:135], a[0:3]
    ds_read_b64_tr_b16 v[208:209], v243 offset:0
    ds_read_b64_tr_b16 v[210:211], v243 offset:512
    v_mfma_f32_16x16x32_bf16 a[0:3], v[200:203], a[136:139], a[0:3]
    v_exp_f32 v250, v250
    v_mfma_f32_16x16x32_bf16 a[0:3], v[204:207], a[140:143], a[0:3]
    ds_read_b64_tr_b16 v[212:213], v243 offset:4096
    ds_read_b64_tr_b16 v[214:215], v243 offset:4608
    v_mfma_f32_16x16x32_bf16 a[4:7], v[192:195], a[144:147], a[4:7]
    s_add_u32 m0, s40, 159744
    v_exp_f32 v251, v251
    v_mfma_f32_16x16x32_bf16 a[4:7], v[196:199], a[148:151], a[4:7]
    s_add_u32 s41, s65, 786560
    ds_read_b64_tr_b16 v[216:217], v243 offset:8192
    ds_read_b64_tr_b16 v[218:219], v243 offset:8704
    v_mfma_f32_16x16x32_bf16 a[4:7], v[200:203], a[152:155], a[4:7]
    buffer_load_dwordx4 v240, s[16:19], s41 offen lds
    v_mfma_f32_16x16x32_bf16 a[4:7], v[204:207], a[156:159], a[4:7]
    ds_read_b64_tr_b16 v[220:221], v243 offset:12288
    ds_read_b64_tr_b16 v[222:223], v243 offset:12800
    v_mfma_f32_16x16x32_bf16 a[8:11], v[192:195], a[160:163], a[8:11]
    v_fma_f32 v248, v248, s51, s51
    v_fma_f32 v249, v249, s51, s51
    v_mfma_f32_16x16x32_bf16 a[8:11], v[196:199], a[164:167], a[8:11]
    v_fma_f32 v250, v250, s51, s51
    v_fma_f32 v251, v251, s51, s51
    v_mfma_f32_16x16x32_bf16 a[8:11], v[200:203], a[168:171], a[8:11]
    s_add_u32 m0, s40, 28672
    v_rcp_f32 v248, v248
    v_mfma_f32_16x16x32_bf16 a[8:11], v[204:207], a[172:175], a[8:11]
    s_mov_b32 s41, 28672
    v_rcp_f32 v249, v249
    v_mfma_f32_16x16x32_bf16 a[12:15], v[192:195], a[176:179], a[12:15]
    buffer_load_dwordx4 v236, s[8:11], s41 offen lds
    v_mfma_f32_16x16x32_bf16 a[12:15], v[196:199], a[180:183], a[12:15]
    v_rcp_f32 v250, v250
    v_mfma_f32_16x16x32_bf16 a[12:15], v[200:203], a[184:187], a[12:15]
    v_rcp_f32 v251, v251
    v_mfma_f32_16x16x32_bf16 a[12:15], v[204:207], a[188:191], a[12:15]
    s_waitcnt lgkmcnt(0)
    v_mul_f32 v28, v28, v248
    v_mul_f32 v29, v29, v249
    v_mfma_f32_16x16x32_bf16 a[16:19], v[208:211], a[128:131], a[16:19]
    s_add_u32 m0, s40, 32768
    v_mul_f32 v30, v30, v250
    v_mul_f32 v31, v31, v251
    v_mfma_f32_16x16x32_bf16 a[16:19], v[212:215], a[132:135], a[16:19]
    s_mov_b32 s41, 32768
    ds_read_b64_tr_b16 v[192:193], v244 offset:0
    ds_read_b64_tr_b16 v[194:195], v244 offset:512
    v_mfma_f32_16x16x32_bf16 a[16:19], v[216:219], a[136:139], a[16:19]
    buffer_load_dwordx4 v236, s[8:11], s41 offen lds
    v_mfma_f32_16x16x32_bf16 a[16:19], v[220:223], a[140:143], a[16:19]
    ds_read_b64_tr_b16 v[196:197], v244 offset:4096
    ds_read_b64_tr_b16 v[198:199], v244 offset:4608
    v_mfma_f32_16x16x32_bf16 a[20:23], v[208:211], a[144:147], a[20:23]
    v_mul_f32 v0, v0, v64
    v_mul_f32 v1, v1, v65
    v_mfma_f32_16x16x32_bf16 a[20:23], v[212:215], a[148:151], a[20:23]
    ds_read_b64_tr_b16 v[200:201], v244 offset:8192
    ds_read_b64_tr_b16 v[202:203], v244 offset:8704
    v_mfma_f32_16x16x32_bf16 a[20:23], v[216:219], a[152:155], a[20:23]
    s_add_u32 m0, s40, 36864
    v_mul_f32 v2, v2, v66
    v_mul_f32 v3, v3, v67
    v_mfma_f32_16x16x32_bf16 a[20:23], v[220:223], a[156:159], a[20:23]
    s_mov_b32 s41, 36864
    ds_read_b64_tr_b16 v[204:205], v244 offset:12288
    ds_read_b64_tr_b16 v[206:207], v244 offset:12800
    v_mfma_f32_16x16x32_bf16 a[24:27], v[208:211], a[160:163], a[24:27]
    buffer_load_dwordx4 v236, s[8:11], s41 offen lds
    v_mfma_f32_16x16x32_bf16 a[24:27], v[212:215], a[164:167], a[24:27]
    v_mul_f32 v16, v16, v80
    v_mul_f32 v17, v17, v81
    v_mfma_f32_16x16x32_bf16 a[24:27], v[216:219], a[168:171], a[24:27]
    v_mul_f32 v18, v18, v82
    v_mul_f32 v19, v19, v83
    v_mfma_f32_16x16x32_bf16 a[24:27], v[220:223], a[172:175], a[24:27]
    v_cvt_pk_bf16_f32 v64, v0, v1
    v_cvt_pk_bf16_f32 v65, v2, v3
    v_mfma_f32_16x16x32_bf16 a[28:31], v[208:211], a[176:179], a[28:31]
    s_add_u32 m0, s40, 40960
    v_cvt_pk_bf16_f32 v66, v16, v17
    v_cvt_pk_bf16_f32 v67, v18, v19
    v_mfma_f32_16x16x32_bf16 a[28:31], v[212:215], a[180:183], a[28:31]
    s_mov_b32 s41, 40960
    v_mul_f32 v4, v4, v68
    v_mul_f32 v5, v5, v69
    v_mfma_f32_16x16x32_bf16 a[28:31], v[216:219], a[184:187], a[28:31]
    buffer_load_dwordx4 v236, s[8:11], s41 offen lds
    v_mfma_f32_16x16x32_bf16 a[28:31], v[220:223], a[188:191], a[28:31]
    s_waitcnt lgkmcnt(0)
    v_mul_f32 v6, v6, v70
    v_mul_f32 v7, v7, v71
    v_mfma_f32_16x16x32_bf16 a[32:35], v[192:195], a[128:131], a[32:35]
    v_mul_f32 v20, v20, v84
    v_mul_f32 v21, v21, v85
    v_mfma_f32_16x16x32_bf16 a[32:35], v[196:199], a[132:135], a[32:35]
    ds_read_b64_tr_b16 v[208:209], v245 offset:0
    ds_read_b64_tr_b16 v[210:211], v245 offset:512
    v_mfma_f32_16x16x32_bf16 a[32:35], v[200:203], a[136:139], a[32:35]
    s_add_u32 m0, s40, 45056
    v_mul_f32 v22, v22, v86
    v_mul_f32 v23, v23, v87
    v_mfma_f32_16x16x32_bf16 a[32:35], v[204:207], a[140:143], a[32:35]
    s_mov_b32 s41, 45056
    ds_read_b64_tr_b16 v[212:213], v245 offset:4096
    ds_read_b64_tr_b16 v[214:215], v245 offset:4608
    v_mfma_f32_16x16x32_bf16 a[36:39], v[192:195], a[144:147], a[36:39]
    buffer_load_dwordx4 v236, s[8:11], s41 offen lds
    v_mfma_f32_16x16x32_bf16 a[36:39], v[196:199], a[148:151], a[36:39]
    ds_read_b64_tr_b16 v[216:217], v245 offset:8192
    ds_read_b64_tr_b16 v[218:219], v245 offset:8704
    v_mfma_f32_16x16x32_bf16 a[36:39], v[200:203], a[152:155], a[36:39]
    v_cvt_pk_bf16_f32 v68, v4, v5
    v_cvt_pk_bf16_f32 v69, v6, v7
    v_mfma_f32_16x16x32_bf16 a[36:39], v[204:207], a[156:159], a[36:39]
    ds_read_b64_tr_b16 v[220:221], v245 offset:12288
    ds_read_b64_tr_b16 v[222:223], v245 offset:12800
    v_mfma_f32_16x16x32_bf16 a[40:43], v[192:195], a[160:163], a[40:43]
    v_cvt_pk_bf16_f32 v70, v20, v21
    v_cvt_pk_bf16_f32 v71, v22, v23
    v_mfma_f32_16x16x32_bf16 a[40:43], v[196:199], a[164:167], a[40:43]
    v_mul_f32 v8, v8, v72
    v_mul_f32 v9, v9, v73
    v_mfma_f32_16x16x32_bf16 a[40:43], v[200:203], a[168:171], a[40:43]
    v_mul_f32 v10, v10, v74
    v_mul_f32 v11, v11, v75
    v_mfma_f32_16x16x32_bf16 a[40:43], v[204:207], a[172:175], a[40:43]
    v_mul_f32 v24, v24, v88
    v_mul_f32 v25, v25, v89
    v_mfma_f32_16x16x32_bf16 a[44:47], v[192:195], a[176:179], a[44:47]
    v_mul_f32 v26, v26, v90
    v_mul_f32 v27, v27, v91
    v_mfma_f32_16x16x32_bf16 a[44:47], v[196:199], a[180:183], a[44:47]
    v_cvt_pk_bf16_f32 v72, v8, v9
    v_cvt_pk_bf16_f32 v73, v10, v11
    v_mfma_f32_16x16x32_bf16 a[44:47], v[200:203], a[184:187], a[44:47]
    v_cvt_pk_bf16_f32 v74, v24, v25
    v_cvt_pk_bf16_f32 v75, v26, v27
    v_mfma_f32_16x16x32_bf16 a[44:47], v[204:207], a[188:191], a[44:47]
    s_waitcnt lgkmcnt(0)
    v_mul_f32 v12, v12, v76
    v_mul_f32 v13, v13, v77
    v_mfma_f32_16x16x32_bf16 a[48:51], v[208:211], a[128:131], a[48:51]
    s_waitcnt vmcnt(20)
    s_barrier
    v_mul_f32 v14, v14, v78
    v_mfma_f32_16x16x32_bf16 a[48:51], v[212:215], a[132:135], a[48:51]
    ds_read_b64_tr_b16 v[192:193], v242 offset:16384
    ds_read_b64_tr_b16 v[194:195], v242 offset:16896
    v_mfma_f32_16x16x32_bf16 a[48:51], v[216:219], a[136:139], a[48:51]
    s_add_u32 m0, s40, 49152
    v_mul_f32 v15, v15, v79
    v_mul_f32 v28, v28, v92
    v_mfma_f32_16x16x32_bf16 a[48:51], v[220:223], a[140:143], a[48:51]
    s_mov_b32 s41, 49152
    ds_read_b64_tr_b16 v[196:197], v242 offset:20480
    ds_read_b64_tr_b16 v[198:199], v242 offset:20992
    v_mfma_f32_16x16x32_bf16 a[52:55], v[208:211], a[144:147], a[52:55]
    buffer_load_dwordx4 v236, s[8:11], s41 offen lds
    v_mfma_f32_16x16x32_bf16 a[52:55], v[212:215], a[148:151], a[52:55]
    ds_read_b64_tr_b16 v[200:201], v242 offset:24576
    ds_read_b64_tr_b16 v[202:203], v242 offset:25088
    v_mfma_f32_16x16x32_bf16 a[52:55], v[216:219], a[152:155], a[52:55]
    v_mul_f32 v29, v29, v93
    v_mul_f32 v30, v30, v94
    v_mfma_f32_16x16x32_bf16 a[52:55], v[220:223], a[156:159], a[52:55]
    ds_read_b64_tr_b16 v[204:205], v242 offset:28672
    ds_read_b64_tr_b16 v[206:207], v242 offset:29184
    v_mfma_f32_16x16x32_bf16 a[56:59], v[208:211], a[160:163], a[56:59]
    s_add_u32 m0, s40, 53248
    v_mul_f32 v31, v31, v95
    v_cvt_pk_bf16_f32 v76, v12, v13
    v_mfma_f32_16x16x32_bf16 a[56:59], v[212:215], a[164:167], a[56:59]
    s_mov_b32 s41, 53248
    v_cvt_pk_bf16_f32 v77, v14, v15
    v_cvt_pk_bf16_f32 v78, v28, v29
    v_mfma_f32_16x16x32_bf16 a[56:59], v[216:219], a[168:171], a[56:59]
    buffer_load_dwordx4 v236, s[8:11], s41 offen lds
    v_mfma_f32_16x16x32_bf16 a[56:59], v[220:223], a[172:175], a[56:59]
    v_cvt_pk_bf16_f32 v79, v30, v31
    v_mfma_f32_16x16x32_bf16 a[60:63], v[208:211], a[176:179], a[60:63]
    buffer_store_dwordx4 v[64:67], v247, s[32:35], s49 offen offset:0 sc1
    v_mfma_f32_16x16x32_bf16 a[60:63], v[212:215], a[180:183], a[60:63]
    s_add_u32 m0, s40, 57344
    v_mfma_f32_16x16x32_bf16 a[60:63], v[216:219], a[184:187], a[60:63]
    s_mov_b32 s41, 57344
    v_mfma_f32_16x16x32_bf16 a[60:63], v[220:223], a[188:191], a[60:63]
    s_waitcnt lgkmcnt(0)
    v_mfma_f32_16x16x32_bf16 v[128:131], v[192:195], a[192:195], v[128:131]
    buffer_load_dwordx4 v236, s[8:11], s41 offen lds
    v_mfma_f32_16x16x32_bf16 v[128:131], v[196:199], a[196:199], v[128:131]
    ds_read_b64_tr_b16 v[208:209], v243 offset:16384
    ds_read_b64_tr_b16 v[210:211], v243 offset:16896
    v_mfma_f32_16x16x32_bf16 v[128:131], v[200:203], a[200:203], v[128:131]
    buffer_store_dwordx4 v[68:71], v247, s[32:35], s49 offen offset:1024 sc1
    v_mfma_f32_16x16x32_bf16 v[128:131], v[204:207], a[204:207], v[128:131]
    ds_read_b64_tr_b16 v[212:213], v243 offset:20480
    ds_read_b64_tr_b16 v[214:215], v243 offset:20992
    v_mfma_f32_16x16x32_bf16 v[132:135], v[192:195], a[208:211], v[132:135]
    s_add_u32 m0, s40, 61440
    v_mfma_f32_16x16x32_bf16 v[132:135], v[196:199], a[212:215], v[132:135]
    s_mov_b32 s41, 61440
    ds_read_b64_tr_b16 v[216:217], v243 offset:24576
    ds_read_b64_tr_b16 v[218:219], v243 offset:25088
    v_mfma_f32_16x16x32_bf16 v[132:135], v[200:203], a[216:219], v[132:135]
    buffer_load_dwordx4 v236, s[8:11], s41 offen lds
    v_mfma_f32_16x16x32_bf16 v[132:135], v[204:207], a[220:223], v[132:135]
    ds_read_b64_tr_b16 v[220:221], v243 offset:28672
    ds_read_b64_tr_b16 v[222:223], v243 offset:29184
    v_mfma_f32_16x16x32_bf16 v[136:139], v[192:195], a[224:227], v[136:139]
    buffer_store_dwordx4 v[72:75], v247, s[32:35], s49 offen offset:2048 sc1
    v_mfma_f32_16x16x32_bf16 v[136:139], v[196:199], a[228:231], v[136:139]
    buffer_store_dwordx4 v[76:79], v247, s[32:35], s49 offen offset:3072 sc1
    v_mfma_f32_16x16x32_bf16 v[136:139], v[200:203], a[232:235], v[136:139]
    s_add_u32 m0, s40, 65536
    v_mul_f32 v248, s52, v32
    v_mul_f32 v249, s52, v33
    v_mfma_f32_16x16x32_bf16 v[136:139], v[204:207], a[236:239], v[136:139]
    s_mov_b32 s41, 0
    v_mul_f32 v250, s52, v34
    v_mul_f32 v251, s52, v35
    v_mfma_f32_16x16x32_bf16 v[140:143], v[192:195], a[240:243], v[140:143]
    buffer_load_dwordx4 v237, s[12:15], s41 offen lds
    v_mfma_f32_16x16x32_bf16 v[140:143], v[196:199], a[244:247], v[140:143]
    v_exp_f32 v248, v248
    v_mfma_f32_16x16x32_bf16 v[140:143], v[200:203], a[248:251], v[140:143]
    v_exp_f32 v249, v249
    v_mfma_f32_16x16x32_bf16 v[140:143], v[204:207], a[252:255], v[140:143]
    s_waitcnt lgkmcnt(0)
    v_exp_f32 v250, v250
    v_mfma_f32_16x16x32_bf16 v[144:147], v[208:211], a[192:195], v[144:147]
    s_add_u32 m0, s40, 69632
    v_exp_f32 v251, v251
    v_mfma_f32_16x16x32_bf16 v[144:147], v[212:215], a[196:199], v[144:147]
    s_mov_b32 s41, 4096
    ds_read_b64_tr_b16 v[192:193], v244 offset:16384
    ds_read_b64_tr_b16 v[194:195], v244 offset:16896
    v_mfma_f32_16x16x32_bf16 v[144:147], v[216:219], a[200:203], v[144:147]
    buffer_load_dwordx4 v237, s[12:15], s41 offen lds
    v_mfma_f32_16x16x32_bf16 v[144:147], v[220:223], a[204:207], v[144:147]
    ds_read_b64_tr_b16 v[196:197], v244 offset:20480
    ds_read_b64_tr_b16 v[198:199], v244 offset:20992
    v_mfma_f32_16x16x32_bf16 v[148:151], v[208:211], a[208:211], v[148:151]
    v_fma_f32 v248, v248, s51, s51
    v_fma_f32 v249, v249, s51, s51
    v_mfma_f32_16x16x32_bf16 v[148:151], v[212:215], a[212:215], v[148:151]
    ds_read_b64_tr_b16 v[200:201], v244 offset:24576
    ds_read_b64_tr_b16 v[202:203], v244 offset:25088
    v_mfma_f32_16x16x32_bf16 v[148:151], v[216:219], a[216:219], v[148:151]
    v_fma_f32 v250, v250, s51, s51
    v_fma_f32 v251, v251, s51, s51
    v_mfma_f32_16x16x32_bf16 v[148:151], v[220:223], a[220:223], v[148:151]
    ds_read_b64_tr_b16 v[204:205], v244 offset:28672
    ds_read_b64_tr_b16 v[206:207], v244 offset:29184
    v_mfma_f32_16x16x32_bf16 v[152:155], v[208:211], a[224:227], v[152:155]
    v_rcp_f32 v248, v248
    v_mfma_f32_16x16x32_bf16 v[152:155], v[212:215], a[228:231], v[152:155]
    v_rcp_f32 v249, v249
    v_mfma_f32_16x16x32_bf16 v[152:155], v[216:219], a[232:235], v[152:155]
    v_rcp_f32 v250, v250
    v_mfma_f32_16x16x32_bf16 v[152:155], v[220:223], a[236:239], v[152:155]
    v_rcp_f32 v251, v251
    v_mfma_f32_16x16x32_bf16 v[156:159], v[208:211], a[240:243], v[156:159]
    v_mul_f32 v32, v32, v248
    v_mul_f32 v33, v33, v249
    v_mfma_f32_16x16x32_bf16 v[156:159], v[212:215], a[244:247], v[156:159]
    v_mul_f32 v34, v34, v250
    v_mul_f32 v35, v35, v251
    v_mfma_f32_16x16x32_bf16 v[156:159], v[216:219], a[248:251], v[156:159]
    v_mul_f32 v248, s52, v36
    v_mul_f32 v249, s52, v37
    v_mfma_f32_16x16x32_bf16 v[156:159], v[220:223], a[252:255], v[156:159]
    s_waitcnt lgkmcnt(0)
    v_mul_f32 v250, s52, v38
    v_mul_f32 v251, s52, v39
    v_mfma_f32_16x16x32_bf16 v[160:163], v[192:195], a[192:195], v[160:163]
    v_exp_f32 v248, v248
    v_mfma_f32_16x16x32_bf16 v[160:163], v[196:199], a[196:199], v[160:163]
    ds_read_b64_tr_b16 v[208:209], v245 offset:16384
    ds_read_b64_tr_b16 v[210:211], v245 offset:16896
    v_mfma_f32_16x16x32_bf16 v[160:163], v[200:203], a[200:203], v[160:163]
    v_exp_f32 v249, v249
    v_mfma_f32_16x16x32_bf16 v[160:163], v[204:207], a[204:207], v[160:163]
    ds_read_b64_tr_b16 v[212:213], v245 offset:20480
    ds_read_b64_tr_b16 v[214:215], v245 offset:20992
    v_mfma_f32_16x16x32_bf16 v[164:167], v[192:195], a[208:211], v[164:167]
    v_exp_f32 v250, v250
    v_mfma_f32_16x16x32_bf16 v[164:167], v[196:199], a[212:215], v[164:167]
    ds_read_b64_tr_b16 v[216:217], v245 offset:24576
    ds_read_b64_tr_b16 v[218:219], v245 offset:25088
    v_mfma_f32_16x16x32_bf16 v[164:167], v[200:203], a[216:219], v[164:167]
    v_exp_f32 v251, v251
    v_mfma_f32_16x16x32_bf16 v[164:167], v[204:207], a[220:223], v[164:167]
    ds_read_b64_tr_b16 v[220:221], v245 offset:28672
    ds_read_b64_tr_b16 v[222:223], v245 offset:29184
    v_mfma_f32_16x16x32_bf16 v[168:171], v[192:195], a[224:227], v[168:171]
    v_fma_f32 v248, v248, s51, s51
    v_fma_f32 v249, v249, s51, s51
    v_mfma_f32_16x16x32_bf16 v[168:171], v[196:199], a[228:231], v[168:171]
    v_fma_f32 v250, v250, s51, s51
    v_fma_f32 v251, v251, s51, s51
    v_mfma_f32_16x16x32_bf16 v[168:171], v[200:203], a[232:235], v[168:171]
    v_rcp_f32 v248, v248
    v_mfma_f32_16x16x32_bf16 v[168:171], v[204:207], a[236:239], v[168:171]
    v_rcp_f32 v249, v249
    v_mfma_f32_16x16x32_bf16 v[172:175], v[192:195], a[240:243], v[172:175]
    v_rcp_f32 v250, v250
    v_mfma_f32_16x16x32_bf16 v[172:175], v[196:199], a[244:247], v[172:175]
    v_rcp_f32 v251, v251
    v_mfma_f32_16x16x32_bf16 v[172:175], v[200:203], a[248:251], v[172:175]
    v_mul_f32 v36, v36, v248
    v_mul_f32 v37, v37, v249
    v_mfma_f32_16x16x32_bf16 v[172:175], v[204:207], a[252:255], v[172:175]
    s_waitcnt lgkmcnt(0)
    v_mul_f32 v38, v38, v250
    v_mul_f32 v39, v39, v251
    v_mfma_f32_16x16x32_bf16 v[176:179], v[208:211], a[192:195], v[176:179]
    s_waitcnt vmcnt(24)
    s_barrier
    v_mul_f32 v248, s52, v40
    v_mfma_f32_16x16x32_bf16 v[176:179], v[212:215], a[196:199], v[176:179]
    ds_read_b64_tr_b16 v[192:193], v242 offset:32768
    ds_read_b64_tr_b16 v[194:195], v242 offset:33280
    v_mfma_f32_16x16x32_bf16 v[176:179], v[216:219], a[200:203], v[176:179]
    s_add_u32 m0, s40, 73728
    v_mul_f32 v249, s52, v41
    v_mul_f32 v250, s52, v42
    v_mfma_f32_16x16x32_bf16 v[176:179], v[220:223], a[204:207], v[176:179]
    s_mov_b32 s41, 8192
    ds_read_b64_tr_b16 v[196:197], v242 offset:36864
    ds_read_b64_tr_b16 v[198:199], v242 offset:37376
    v_mfma_f32_16x16x32_bf16 v[180:183], v[208:211], a[208:211], v[180:183]
    buffer_load_dwordx4 v237, s[12:15], s41 offen lds
    v_mfma_f32_16x16x32_bf16 v[180:183], v[212:215], a[212:215], v[180:183]
    ds_read_b64_tr_b16 v[200:201], v242 offset:40960
    ds_read_b64_tr_b16 v[202:203], v242 offset:41472
    v_mfma_f32_16x16x32_bf16 v[180:183], v[216:219], a[216:219], v[180:183]
    v_mul_f32 v251, s52, v43
    v_mfma_f32_16x16x32_bf16 v[180:183], v[220:223], a[220:223], v[180:183]
    ds_read_b64_tr_b16 v[204:205], v242 offset:45056
    ds_read_b64_tr_b16 v[206:207], v242 offset:45568
    v_mfma_f32_16x16x32_bf16 v[184:187], v[208:211], a[224:227], v[184:187]
    s_add_u32 m0, s40, 77824
    v_exp_f32 v248, v248
    v_mfma_f32_16x16x32_bf16 v[184:187], v[212:215], a[228:231], v[184:187]
    s_mov_b32 s41, 12288
    v_exp_f32 v249, v249
    v_mfma_f32_16x16x32_bf16 v[184:187], v[216:219], a[232:235], v[184:187]
    buffer_load_dwordx4 v237, s[12:15], s41 offen lds
    v_mfma_f32_16x16x32_bf16 v[184:187], v[220:223], a[236:239], v[184:187]
    v_exp_f32 v250, v250
    v_mfma_f32_16x16x32_bf16 v[188:191], v[208:211], a[240:243], v[188:191]
    v_exp_f32 v251, v251
    v_mfma_f32_16x16x32_bf16 v[188:191], v[212:215], a[244:247], v[188:191]
    s_add_u32 m0, s40, 81920
    v_fma_f32 v248, v248, s51, s51
    v_fma_f32 v249, v249, s51, s51
    v_mfma_f32_16x16x32_bf16 v[188:191], v[216:219], a[248:251], v[188:191]
    s_mov_b32 s41, 16384
    v_fma_f32 v250, v250, s51, s51
    v_fma_f32 v251, v251, s51, s51
    v_mfma_f32_16x16x32_bf16 v[188:191], v[220:223], a[252:255], v[188:191]
    s_waitcnt lgkmcnt(0)
    v_rcp_f32 v248, v248
    v_mfma_f32_16x16x32_bf16 v[128:131], v[192:195], a[64:67], v[128:131]
    buffer_load_dwordx4 v237, s[12:15], s41 offen lds
    v_mfma_f32_16x16x32_bf16 v[128:131], v[196:199], a[68:71], v[128:131]
    ds_read_b64_tr_b16 v[208:209], v243 offset:32768
    ds_read_b64_tr_b16 v[210:211], v243 offset:33280
    v_mfma_f32_16x16x32_bf16 v[128:131], v[200:203], a[72:75], v[128:131]
    v_rcp_f32 v249, v249
    v_mfma_f32_16x16x32_bf16 v[128:131], v[204:207], a[76:79], v[128:131]
    ds_read_b64_tr_b16 v[212:213], v243 offset:36864
    ds_read_b64_tr_b16 v[214:215], v243 offset:37376
    v_mfma_f32_16x16x32_bf16 v[132:135], v[192:195], a[80:83], v[132:135]
    s_add_u32 m0, s40, 86016
    v_rcp_f32 v250, v250
    v_mfma_f32_16x16x32_bf16 v[132:135], v[196:199], a[84:87], v[132:135]
    s_mov_b32 s41, 20480
    ds_read_b64_tr_b16 v[216:217], v243 offset:40960
    ds_read_b64_tr_b16 v[218:219], v243 offset:41472
    v_mfma_f32_16x16x32_bf16 v[132:135], v[200:203], a[88:91], v[132:135]
    buffer_load_dwordx4 v237, s[12:15], s41 offen lds
    v_mfma_f32_16x16x32_bf16 v[132:135], v[204:207], a[92:95], v[132:135]
    ds_read_b64_tr_b16 v[220:221], v243 offset:45056
    ds_read_b64_tr_b16 v[222:223], v243 offset:45568
    v_mfma_f32_16x16x32_bf16 v[136:139], v[192:195], a[96:99], v[136:139]
    v_rcp_f32 v251, v251
    v_mfma_f32_16x16x32_bf16 v[136:139], v[196:199], a[100:103], v[136:139]
    v_mul_f32 v40, v40, v248
    v_mul_f32 v41, v41, v249
    v_mfma_f32_16x16x32_bf16 v[136:139], v[200:203], a[104:107], v[136:139]
    s_add_u32 m0, s40, 90112
    v_mul_f32 v42, v42, v250
    v_mul_f32 v43, v43, v251
    v_mfma_f32_16x16x32_bf16 v[136:139], v[204:207], a[108:111], v[136:139]
    s_mov_b32 s41, 24576
    v_mul_f32 v248, s52, v44
    v_mul_f32 v249, s52, v45
    v_mfma_f32_16x16x32_bf16 v[140:143], v[192:195], a[112:115], v[140:143]
    buffer_load_dwordx4 v237, s[12:15], s41 offen lds
    v_mfma_f32_16x16x32_bf16 v[140:143], v[196:199], a[116:119], v[140:143]
    v_mul_f32 v250, s52, v46
    v_mul_f32 v251, s52, v47
    v_mfma_f32_16x16x32_bf16 v[140:143], v[200:203], a[120:123], v[140:143]
    v_exp_f32 v248, v248
    v_mfma_f32_16x16x32_bf16 v[140:143], v[204:207], a[124:127], v[140:143]
    s_waitcnt lgkmcnt(0)
    v_exp_f32 v249, v249
    v_mfma_f32_16x16x32_bf16 v[144:147], v[208:211], a[64:67], v[144:147]
    s_add_u32 m0, s40, 94208
    v_exp_f32 v250, v250
    v_mfma_f32_16x16x32_bf16 v[144:147], v[212:215], a[68:71], v[144:147]
    s_mov_b32 s41, 28672
    ds_read_b64_tr_b16 v[192:193], v244 offset:32768
    ds_read_b64_tr_b16 v[194:195], v244 offset:33280
    v_mfma_f32_16x16x32_bf16 v[144:147], v[216:219], a[72:75], v[144:147]
    buffer_load_dwordx4 v237, s[12:15], s41 offen lds
    v_mfma_f32_16x16x32_bf16 v[144:147], v[220:223], a[76:79], v[144:147]
    ds_read_b64_tr_b16 v[196:197], v244 offset:36864
    ds_read_b64_tr_b16 v[198:199], v244 offset:37376
    v_mfma_f32_16x16x32_bf16 v[148:151], v[208:211], a[80:83], v[148:151]
    v_exp_f32 v251, v251
    v_mfma_f32_16x16x32_bf16 v[148:151], v[212:215], a[84:87], v[148:151]
    ds_read_b64_tr_b16 v[200:201], v244 offset:40960
    ds_read_b64_tr_b16 v[202:203], v244 offset:41472
    v_mfma_f32_16x16x32_bf16 v[148:151], v[216:219], a[88:91], v[148:151]
    v_fma_f32 v248, v248, s51, s51
    v_fma_f32 v249, v249, s51, s51
    v_mfma_f32_16x16x32_bf16 v[148:151], v[220:223], a[92:95], v[148:151]
    ds_read_b64_tr_b16 v[204:205], v244 offset:45056
    ds_read_b64_tr_b16 v[206:207], v244 offset:45568
    v_mfma_f32_16x16x32_bf16 v[152:155], v[208:211], a[96:99], v[152:155]
    v_fma_f32 v250, v250, s51, s51
    v_fma_f32 v251, v251, s51, s51
    v_mfma_f32_16x16x32_bf16 v[152:155], v[212:215], a[100:103], v[152:155]
    v_rcp_f32 v248, v248
    v_mfma_f32_16x16x32_bf16 v[152:155], v[216:219], a[104:107], v[152:155]
    v_rcp_f32 v249, v249
    v_mfma_f32_16x16x32_bf16 v[152:155], v[220:223], a[108:111], v[152:155]
    v_rcp_f32 v250, v250
    v_mfma_f32_16x16x32_bf16 v[156:159], v[208:211], a[112:115], v[156:159]
    v_rcp_f32 v251, v251
    v_mfma_f32_16x16x32_bf16 v[156:159], v[212:215], a[116:119], v[156:159]
    v_mul_f32 v44, v44, v248
    v_mul_f32 v45, v45, v249
    v_mfma_f32_16x16x32_bf16 v[156:159], v[216:219], a[120:123], v[156:159]
    v_mul_f32 v46, v46, v250
    v_mul_f32 v47, v47, v251
    v_mfma_f32_16x16x32_bf16 v[156:159], v[220:223], a[124:127], v[156:159]
    s_waitcnt lgkmcnt(0)
    v_mul_f32 v32, v32, v96
    v_mul_f32 v33, v33, v97
    v_mfma_f32_16x16x32_bf16 v[160:163], v[192:195], a[64:67], v[160:163]
    v_mul_f32 v34, v34, v98
    v_mul_f32 v35, v35, v99
    v_mfma_f32_16x16x32_bf16 v[160:163], v[196:199], a[68:71], v[160:163]
    ds_read_b64_tr_b16 v[208:209], v245 offset:32768
    ds_read_b64_tr_b16 v[210:211], v245 offset:33280
    v_mfma_f32_16x16x32_bf16 v[160:163], v[200:203], a[72:75], v[160:163]
    v_cvt_pk_bf16_f32 v96, v32, v33
    v_cvt_pk_bf16_f32 v97, v34, v35
    v_mfma_f32_16x16x32_bf16 v[160:163], v[204:207], a[76:79], v[160:163]
    ds_read_b64_tr_b16 v[212:213], v245 offset:36864
    ds_read_b64_tr_b16 v[214:215], v245 offset:37376
    v_mfma_f32_16x16x32_bf16 v[164:167], v[192:195], a[80:83], v[164:167]
    v_mul_f32 v36, v36, v100
    v_mul_f32 v37, v37, v101
    v_mfma_f32_16x16x32_bf16 v[164:167], v[196:199], a[84:87], v[164:167]
    ds_read_b64_tr_b16 v[216:217], v245 offset:40960
    ds_read_b64_tr_b16 v[218:219], v245 offset:41472
    v_mfma_f32_16x16x32_bf16 v[164:167], v[200:203], a[88:91], v[164:167]
    v_mul_f32 v38, v38, v102
    v_mul_f32 v39, v39, v103
    v_mfma_f32_16x16x32_bf16 v[164:167], v[204:207], a[92:95], v[164:167]
    ds_read_b64_tr_b16 v[220:221], v245 offset:45056
    ds_read_b64_tr_b16 v[222:223], v245 offset:45568
    v_mfma_f32_16x16x32_bf16 v[168:171], v[192:195], a[96:99], v[168:171]
    v_cvt_pk_bf16_f32 v100, v36, v37
    v_cvt_pk_bf16_f32 v101, v38, v39
    v_mfma_f32_16x16x32_bf16 v[168:171], v[196:199], a[100:103], v[168:171]
    v_mul_f32 v40, v40, v104
    v_mul_f32 v41, v41, v105
    v_mfma_f32_16x16x32_bf16 v[168:171], v[200:203], a[104:107], v[168:171]
    v_mul_f32 v42, v42, v106
    v_mul_f32 v43, v43, v107
    v_mfma_f32_16x16x32_bf16 v[168:171], v[204:207], a[108:111], v[168:171]
    v_cvt_pk_bf16_f32 v104, v40, v41
    v_cvt_pk_bf16_f32 v105, v42, v43
    v_mfma_f32_16x16x32_bf16 v[172:175], v[192:195], a[112:115], v[172:175]
    v_mul_f32 v44, v44, v108
    v_mul_f32 v45, v45, v109
    v_mfma_f32_16x16x32_bf16 v[172:175], v[196:199], a[116:119], v[172:175]
    v_mul_f32 v46, v46, v110
    v_mul_f32 v47, v47, v111
    v_mfma_f32_16x16x32_bf16 v[172:175], v[200:203], a[120:123], v[172:175]
    v_cvt_pk_bf16_f32 v108, v44, v45
    v_cvt_pk_bf16_f32 v109, v46, v47
    v_mfma_f32_16x16x32_bf16 v[172:175], v[204:207], a[124:127], v[172:175]
    s_waitcnt lgkmcnt(0)
    v_mfma_f32_16x16x32_bf16 v[176:179], v[208:211], a[64:67], v[176:179]
    s_waitcnt vmcnt(21)
    s_barrier
    v_mfma_f32_16x16x32_bf16 v[176:179], v[212:215], a[68:71], v[176:179]
    ds_read_b64_tr_b16 v[192:193], v242 offset:49152
    ds_read_b64_tr_b16 v[194:195], v242 offset:49664
    v_mfma_f32_16x16x32_bf16 v[176:179], v[216:219], a[72:75], v[176:179]
    buffer_store_dwordx2 v[96:97], v247, s[32:35], s50 offen offset:0 sc1
    v_mfma_f32_16x16x32_bf16 v[176:179], v[220:223], a[76:79], v[176:179]
    ds_read_b64_tr_b16 v[196:197], v242 offset:53248
    ds_read_b64_tr_b16 v[198:199], v242 offset:53760
    v_mfma_f32_16x16x32_bf16 v[180:183], v[208:211], a[80:83], v[180:183]
    buffer_store_dwordx2 v[100:101], v247, s[32:35], s50 offen offset:1024 sc1
    v_mfma_f32_16x16x32_bf16 v[180:183], v[212:215], a[84:87], v[180:183]
    ds_read_b64_tr_b16 v[200:201], v242 offset:57344
    ds_read_b64_tr_b16 v[202:203], v242 offset:57856
    v_mfma_f32_16x16x32_bf16 v[180:183], v[216:219], a[88:91], v[180:183]
    buffer_store_dwordx2 v[104:105], v247, s[32:35], s50 offen offset:2048 sc1
    v_mfma_f32_16x16x32_bf16 v[180:183], v[220:223], a[92:95], v[180:183]
    ds_read_b64_tr_b16 v[204:205], v242 offset:61440
    ds_read_b64_tr_b16 v[206:207], v242 offset:61952
    v_mfma_f32_16x16x32_bf16 v[184:187], v[208:211], a[96:99], v[184:187]
    buffer_store_dwordx2 v[108:109], v247, s[32:35], s50 offen offset:3072 sc1
    v_mfma_f32_16x16x32_bf16 v[184:187], v[212:215], a[100:103], v[184:187]
    v_mov_b32 v120, 0xff800000
    v_mov_b32 v121, 0xff800000
    v_mfma_f32_16x16x32_bf16 v[184:187], v[216:219], a[104:107], v[184:187]
    v_mov_b32 v122, 0xff800000
    v_mov_b32 v123, 0xff800000
    v_accvgpr_read_b32 v248, a0
    v_mfma_f32_16x16x32_bf16 v[184:187], v[220:223], a[108:111], v[184:187]
    v_accvgpr_read_b32 v249, a1
    v_accvgpr_read_b32 v250, a2
    v_mfma_f32_16x16x32_bf16 v[188:191], v[208:211], a[112:115], v[188:191]
    v_accvgpr_read_b32 v251, a3
    v_cvt_pk_bf16_f32 v0, v248, v249
    v_cvt_pk_bf16_f32 v1, v250, v251
    v_mfma_f32_16x16x32_bf16 v[188:191], v[212:215], a[116:119], v[188:191]
    v_accvgpr_read_b32 v248, a16
    v_accvgpr_read_b32 v249, a17
    v_mfma_f32_16x16x32_bf16 v[188:191], v[216:219], a[120:123], v[188:191]
    v_accvgpr_read_b32 v250, a18
    v_accvgpr_read_b32 v251, a19
    v_cvt_pk_bf16_f32 v2, v248, v249
    v_mfma_f32_16x16x32_bf16 v[188:191], v[220:223], a[124:127], v[188:191]
    s_waitcnt lgkmcnt(0)
    v_cvt_pk_bf16_f32 v3, v250, v251
    v_accvgpr_read_b32 v248, a4
    v_mfma_f32_16x16x32_bf16 v[128:131], v[192:195], a[128:131], v[128:131]
L_padC_5:
    s_cbranch_execz L_padD_0
    v_accvgpr_read_b32 v249, a5
    v_accvgpr_read_b32 v250, a6
    v_accvgpr_read_b32 v251, a7
    v_mfma_f32_16x16x32_bf16 v[128:131], v[196:199], a[132:135], v[128:131]
    ds_read_b64_tr_b16 v[208:209], v243 offset:49152
    ds_read_b64_tr_b16 v[210:211], v243 offset:49664
    v_mfma_f32_16x16x32_bf16 v[128:131], v[200:203], a[136:139], v[128:131]
    v_cvt_pk_bf16_f32 v16, v248, v249
    v_cvt_pk_bf16_f32 v17, v250, v251
    v_accvgpr_read_b32 v248, a20
    v_mfma_f32_16x16x32_bf16 v[128:131], v[204:207], a[140:143], v[128:131]
    ds_read_b64_tr_b16 v[212:213], v243 offset:53248
    ds_read_b64_tr_b16 v[214:215], v243 offset:53760
    v_mfma_f32_16x16x32_bf16 v[132:135], v[192:195], a[144:147], v[132:135]
    v_accvgpr_read_b32 v249, a21
    v_accvgpr_read_b32 v250, a22
    v_accvgpr_read_b32 v251, a23
    v_mfma_f32_16x16x32_bf16 v[132:135], v[196:199], a[148:151], v[132:135]
    ds_read_b64_tr_b16 v[216:217], v243 offset:57344
    ds_read_b64_tr_b16 v[218:219], v243 offset:57856
    v_mfma_f32_16x16x32_bf16 v[132:135], v[200:203], a[152:155], v[132:135]
    v_cvt_pk_bf16_f32 v18, v248, v249
    v_cvt_pk_bf16_f32 v19, v250, v251
    v_mfma_f32_16x16x32_bf16 v[132:135], v[204:207], a[156:159], v[132:135]
    ds_read_b64_tr_b16 v[220:221], v243 offset:61440
    ds_read_b64_tr_b16 v[222:223], v243 offset:61952
    v_accvgpr_read_b32 v248, a8
    v_mfma_f32_16x16x32_bf16 v[136:139], v[192:195], a[160:163], v[136:139]
    v_accvgpr_read_b32 v249, a9
    v_accvgpr_read_b32 v250, a10
    v_mfma_f32_16x16x32_bf16 v[136:139], v[196:199], a[164:167], v[136:139]
    v_accvgpr_read_b32 v251, a11
    v_cvt_pk_bf16_f32 v32, v248, v249
    v_cvt_pk_bf16_f32 v33, v250, v251
    v_mfma_f32_16x16x32_bf16 v[136:139], v[200:203], a[168:171], v[136:139]
    v_accvgpr_read_b32 v248, a24
    v_accvgpr_read_b32 v249, a25
    v_mfma_f32_16x16x32_bf16 v[136:139], v[204:207], a[172:175], v[136:139]
    v_accvgpr_read_b32 v250, a26
    v_accvgpr_read_b32 v251, a27
    v_cvt_pk_bf16_f32 v34, v248, v249
    v_mfma_f32_16x16x32_bf16 v[140:143], v[192:195], a[176:179], v[140:143]
    v_cvt_pk_bf16_f32 v35, v250, v251
    v_accvgpr_read_b32 v248, a12
    v_mfma_f32_16x16x32_bf16 v[140:143], v[196:199], a[180:183], v[140:143]
    v_accvgpr_read_b32 v249, a13
    v_accvgpr_read_b32 v250, a14
    v_accvgpr_read_b32 v251, a15
    v_mfma_f32_16x16x32_bf16 v[140:143], v[200:203], a[184:187], v[140:143]
    v_cvt_pk_bf16_f32 v48, v248, v249
    v_cvt_pk_bf16_f32 v49, v250, v251
    v_mfma_f32_16x16x32_bf16 v[140:143], v[204:207], a[188:191], v[140:143]
    s_waitcnt lgkmcnt(0)
    v_accvgpr_read_b32 v248, a28
    v_accvgpr_read_b32 v249, a29
    v_accvgpr_read_b32 v250, a30
    v_mfma_f32_16x16x32_bf16 v[144:147], v[208:211], a[128:131], v[144:147]
    v_accvgpr_read_b32 v251, a31
    v_cvt_pk_bf16_f32 v50, v248, v249
    v_mfma_f32_16x16x32_bf16 v[144:147], v[212:215], a[132:135], v[144:147]
    ds_read_b64_tr_b16 v[192:193], v244 offset:49152
    ds_read_b64_tr_b16 v[194:195], v244 offset:49664
    v_cvt_pk_bf16_f32 v51, v250, v251
    v_mfma_f32_16x16x32_bf16 v[144:147], v[216:219], a[136:139], v[144:147]
    v_permlane16_swap_b32 v0, v2
    v_permlane16_swap_b32 v1, v3
    v_mfma_f32_16x16x32_bf16 v[144:147], v[220:223], a[140:143], v[144:147]
    ds_read_b64_tr_b16 v[196:197], v244 offset:53248
    ds_read_b64_tr_b16 v[198:199], v244 offset:53760
    v_permlane16_swap_b32 v16, v18
    v_mfma_f32_16x16x32_bf16 v[148:151], v[208:211], a[144:147], v[148:151]
    v_permlane16_swap_b32 v17, v19
    v_permlane16_swap_b32 v32, v34
    v_mfma_f32_16x16x32_bf16 v[148:151], v[212:215], a[148:151], v[148:151]
    ds_read_b64_tr_b16 v[200:201], v244 offset:57344
    ds_read_b64_tr_b16 v[202:203], v244 offset:57856
    v_mfma_f32_16x16x32_bf16 v[148:151], v[216:219], a[152:155], v[148:151]
    v_permlane16_swap_b32 v33, v35
    v_permlane16_swap_b32 v48, v50
    v_permlane16_swap_b32 v49, v51
    v_mfma_f32_16x16x32_bf16 v[148:151], v[220:223], a[156:159], v[148:151]
    ds_read_b64_tr_b16 v[204:205], v244 offset:61440
    ds_read_b64_tr_b16 v[206:207], v244 offset:61952
    v_mfma_f32_16x16x32_bf16 v[152:155], v[208:211], a[160:163], v[152:155]
    v_accvgpr_read_b32 v248, a32
    v_accvgpr_read_b32 v249, a33
    v_accvgpr_read_b32 v250, a34
    v_mfma_f32_16x16x32_bf16 v[152:155], v[212:215], a[164:167], v[152:155]
    v_accvgpr_read_b32 v251, a35
    v_cvt_pk_bf16_f32 v4, v248, v249
    v_mfma_f32_16x16x32_bf16 v[152:155], v[216:219], a[168:171], v[152:155]
    v_cvt_pk_bf16_f32 v5, v250, v251
    v_accvgpr_read_b32 v248, a48
    v_accvgpr_read_b32 v249, a49
    v_mfma_f32_16x16x32_bf16 v[152:155], v[220:223], a[172:175], v[152:155]
    v_accvgpr_read_b32 v250, a50
    v_accvgpr_read_b32 v251, a51
    v_mfma_f32_16x16x32_bf16 v[156:159], v[208:211], a[176:179], v[156:159]
    v_cvt_pk_bf16_f32 v6, v248, v249
    v_cvt_pk_bf16_f32 v7, v250, v251
    v_accvgpr_read_b32 v248, a36
    v_mfma_f32_16x16x32_bf16 v[156:159], v[212:215], a[180:183], v[156:159]
    v_accvgpr_read_b32 v249, a37
    v_accvgpr_read_b32 v250, a38
    v_mfma_f32_16x16x32_bf16 v[156:159], v[216:219], a[184:187], v[156:159]
    v_accvgpr_read_b32 v251, a39
    v_cvt_pk_bf16_f32 v20, v248, v249
    v_cvt_pk_bf16_f32 v21, v250, v251
    v_mfma_f32_16x16x32_bf16 v[156:159], v[220:223], a[188:191], v[156:159]
    s_waitcnt lgkmcnt(0)
    v_accvgpr_read_b32 v248, a52
    v_accvgpr_read_b32 v249, a53
    v_mfma_f32_16x16x32_bf16 v[160:163], v[192:195], a[128:131], v[160:163]
    v_accvgpr_read_b32 v250, a54
    v_accvgpr_read_b32 v251, a55
    v_cvt_pk_bf16_f32 v22, v248, v249
    v_mfma_f32_16x16x32_bf16 v[160:163], v[196:199], a[132:135], v[160:163]
    ds_read_b64_tr_b16 v[208:209], v245 offset:49152
    ds_read_b64_tr_b16 v[210:211], v245 offset:49664
    v_mfma_f32_16x16x32_bf16 v[160:163], v[200:203], a[136:139], v[160:163]
    v_cvt_pk_bf16_f32 v23, v250, v251
    v_accvgpr_read_b32 v248, a40
    v_accvgpr_read_b32 v249, a41
    v_mfma_f32_16x16x32_bf16 v[160:163], v[204:207], a[140:143], v[160:163]
    ds_read_b64_tr_b16 v[212:213], v245 offset:53248
    ds_read_b64_tr_b16 v[214:215], v245 offset:53760
    v_mfma_f32_16x16x32_bf16 v[164:167], v[192:195], a[144:147], v[164:167]
    v_accvgpr_read_b32 v250, a42
    v_accvgpr_read_b32 v251, a43
    v_mfma_f32_16x16x32_bf16 v[164:167], v[196:199], a[148:151], v[164:167]
    ds_read_b64_tr_b16 v[216:217], v245 offset:57344
    ds_read_b64_tr_b16 v[218:219], v245 offset:57856
    v_cvt_pk_bf16_f32 v36, v248, v249
    v_mfma_f32_16x16x32_bf16 v[164:167], v[200:203], a[152:155], v[164:167]
    v_cvt_pk_bf16_f32 v37, v250, v251
    v_accvgpr_read_b32 v248, a56
    v_mfma_f32_16x16x32_bf16 v[164:167], v[204:207], a[156:159], v[164:167]
    ds_read_b64_tr_b16 v[220:221], v245 offset:61440
    ds_read_b64_tr_b16 v[222:223], v245 offset:61952
    v_accvgpr_read_b32 v249, a57
    v_mfma_f32_16x16x32_bf16 v[168:171], v[192:195], a[160:163], v[168:171]
    v_accvgpr_read_b32 v250, a58
    v_accvgpr_read_b32 v251, a59
    v_mfma_f32_16x16x32_bf16 v[168:171], v[196:199], a[164:167], v[168:171]
    v_cvt_pk_bf16_f32 v38, v248, v249
    v_cvt_pk_bf16_f32 v39, v250, v251
    v_accvgpr_read_b32 v248, a44
    v_mfma_f32_16x16x32_bf16 v[168:171], v[200:203], a[168:171], v[168:171]
    v_accvgpr_read_b32 v249, a45
    v_accvgpr_read_b32 v250, a46
    v_mfma_f32_16x16x32_bf16 v[168:171], v[204:207], a[172:175], v[168:171]
    v_accvgpr_read_b32 v251, a47
    v_cvt_pk_bf16_f32 v52, v248, v249
    v_cvt_pk_bf16_f32 v53, v250, v251
    v_mfma_f32_16x16x32_bf16 v[172:175], v[192:195], a[176:179], v[172:175]
    v_accvgpr_read_b32 v248, a60
    v_accvgpr_read_b32 v249, a61
    v_mfma_f32_16x16x32_bf16 v[172:175], v[196:199], a[180:183], v[172:175]
    v_accvgpr_read_b32 v250, a62
    v_accvgpr_read_b32 v251, a63
    v_cvt_pk_bf16_f32 v54, v248, v249
    v_mfma_f32_16x16x32_bf16 v[172:175], v[200:203], a[184:187], v[172:175]
    v_cvt_pk_bf16_f32 v55, v250, v251
    v_permlane16_swap_b32 v4, v6
    v_mfma_f32_16x16x32_bf16 v[172:175], v[204:207], a[188:191], v[172:175]
    s_waitcnt lgkmcnt(0)
    v_permlane16_swap_b32 v5, v7
    v_permlane16_swap_b32 v20, v22
    v_permlane16_swap_b32 v21, v23
    v_mfma_f32_16x16x32_bf16 v[176:179], v[208:211], a[128:131], v[176:179]
    s_waitcnt vmcnt(24)
    s_barrier
    v_permlane16_swap_b32 v36, v38
    v_mfma_f32_16x16x32_bf16 v[176:179], v[212:215], a[132:135], v[176:179]
    v_permlane16_swap_b32 v37, v39
    v_permlane16_swap_b32 v52, v54
    v_permlane16_swap_b32 v53, v55
    v_mfma_f32_16x16x32_bf16 v[176:179], v[216:219], a[136:139], v[176:179]
    v_cvt_pk_bf16_f32 v8, v128, v129
    v_cvt_pk_bf16_f32 v9, v130, v131
    v_mfma_f32_16x16x32_bf16 v[176:179], v[220:223], a[140:143], v[176:179]
    v_cvt_pk_bf16_f32 v10, v144, v145
    v_cvt_pk_bf16_f32 v11, v146, v147
    v_mfma_f32_16x16x32_bf16 v[180:183], v[208:211], a[144:147], v[180:183]
    v_cvt_pk_bf16_f32 v24, v132, v133
    v_cvt_pk_bf16_f32 v25, v134, v135
    v_mfma_f32_16x16x32_bf16 v[180:183], v[212:215], a[148:151], v[180:183]
    v_cvt_pk_bf16_f32 v26, v148, v149
    v_cvt_pk_bf16_f32 v27, v150, v151
    v_mfma_f32_16x16x32_bf16 v[180:183], v[216:219], a[152:155], v[180:183]
    v_cvt_pk_bf16_f32 v40, v136, v137
    v_cvt_pk_bf16_f32 v41, v138, v139
    v_mfma_f32_16x16x32_bf16 v[180:183], v[220:223], a[156:159], v[180:183]
    v_cvt_pk_bf16_f32 v42, v152, v153
    v_cvt_pk_bf16_f32 v43, v154, v155
    v_mfma_f32_16x16x32_bf16 v[184:187], v[208:211], a[160:163], v[184:187]
    v_cvt_pk_bf16_f32 v56, v140, v141
    v_cvt_pk_bf16_f32 v57, v142, v143
    v_mfma_f32_16x16x32_bf16 v[184:187], v[212:215], a[164:167], v[184:187]
    v_cvt_pk_bf16_f32 v58, v156, v157
    v_cvt_pk_bf16_f32 v59, v158, v159
    v_mfma_f32_16x16x32_bf16 v[184:187], v[216:219], a[168:171], v[184:187]
    v_permlane16_swap_b32 v8, v10
    v_permlane16_swap_b32 v9, v11
    v_mfma_f32_16x16x32_bf16 v[184:187], v[220:223], a[172:175], v[184:187]
    v_permlane16_swap_b32 v24, v26
    v_permlane16_swap_b32 v25, v27
    v_mfma_f32_16x16x32_bf16 v[188:191], v[208:211], a[176:179], v[188:191]
    v_permlane16_swap_b32 v40, v42
    v_permlane16_swap_b32 v41, v43
    v_mfma_f32_16x16x32_bf16 v[188:191], v[212:215], a[180:183], v[188:191]
    v_permlane16_swap_b32 v56, v58
    v_permlane16_swap_b32 v57, v59
    v_mfma_f32_16x16x32_bf16 v[188:191], v[216:219], a[184:187], v[188:191]
    v_mfma_f32_16x16x32_bf16 v[188:191], v[220:223], a[188:191], v[188:191]
    ds_read_b128 a[144:147], v224 offset:0
    ds_read_b128 a[148:151], v225 offset:0
    ds_read_b128 a[152:155], v226 offset:0
    ds_read_b128 a[156:159], v227 offset:0
    s_nop 1
    v_cvt_pk_bf16_f32 v12, v160, v161
    v_cvt_pk_bf16_f32 v13, v162, v163
    v_cvt_pk_bf16_f32 v14, v176, v177
    v_cvt_pk_bf16_f32 v15, v178, v179
    v_cvt_pk_bf16_f32 v28, v164, v165
    v_cvt_pk_bf16_f32 v29, v166, v167
    v_cvt_pk_bf16_f32 v30, v180, v181
    v_cvt_pk_bf16_f32 v31, v182, v183
    v_cvt_pk_bf16_f32 v44, v168, v169
    v_cvt_pk_bf16_f32 v45, v170, v171
    v_cvt_pk_bf16_f32 v46, v184, v185
    v_cvt_pk_bf16_f32 v47, v186, v187
    v_cvt_pk_bf16_f32 v60, v172, v173
    v_cvt_pk_bf16_f32 v61, v174, v175
    v_cvt_pk_bf16_f32 v62, v188, v189
    v_cvt_pk_bf16_f32 v63, v190, v191
    v_permlane16_swap_b32 v12, v14
    v_permlane16_swap_b32 v13, v15
    v_permlane16_swap_b32 v28, v30
    v_permlane16_swap_b32 v29, v31
    v_permlane16_swap_b32 v44, v46
    v_permlane16_swap_b32 v45, v47
    v_permlane16_swap_b32 v60, v62
    v_permlane16_swap_b32 v61, v63
    s_branch L_a_attn
L_s2:
    s_mov_b32 s59, 262144
L_s2m:
    buffer_load_dword v245, off, s[88:91], 0 sc1
    s_waitcnt vmcnt(0)
    v_readfirstlane_b32 s3, v245
    s_nop 3
    s_cmp_ge_u32 s3, 256
    s_cbranch_scc1 L_s2m_ok
    s_sleep 1
    s_sub_u32 s59, s59, 1
    s_cmp_lg_u32 s59, 0
    s_cbranch_scc1 L_s2m
L_s2m_ok:
    s_branch L_s2_back
L_a_truemax:
    s_waitcnt vmcnt(0) lgkmcnt(0)
    s_mov_b32 s48, 1
    s_nop 7
    v_mov_b32 v120, 0xff800000
    v_mov_b32 v121, 0xff800000
    v_mov_b32 v122, 0xff800000
    v_mov_b32 v123, 0xff800000
    s_mov_b32 s42, 0
L_tm_tile:
    s_barrier
    s_add_u32 m0, s40, 0
    s_add_u32 s41, s42, 0
    buffer_load_dwordx4 v236, s[8:11], s41 offen lds
    s_add_u32 m0, s40, 4096
    s_add_u32 s41, s42, 4096
    buffer_load_dwordx4 v236, s[8:11], s41 offen lds
    s_add_u32 m0, s40, 8192
    s_add_u32 s41, s42, 8192
    buffer_load_dwordx4 v236, s[8:11], s41 offen lds
    s_add_u32 m0, s40, 12288
    s_add_u32 s41, s42, 12288
    buffer_load_dwordx4 v236, s[8:11], s41 offen lds
    s_add_u32 m0, s40, 16384
    s_add_u32 s41, s42, 16384
    buffer_load_dwordx4 v236, s[8:11], s41 offen lds
    s_add_u32 m0, s40, 20480
    s_add_u32 s41, s42, 20480
    buffer_load_dwordx4 v236, s[8:11], s41 offen lds
    s_add_u32 m0, s40, 24576
    s_add_u32 s41, s42, 24576
    buffer_load_dwordx4 v236, s[8:11], s41 offen lds
    s_add_u32 m0, s40, 28672
    s_add_u32 s41, s42, 28672
    buffer_load_dwordx4 v236, s[8:11], s41 offen lds
    s_waitcnt vmcnt(0)
    s_barrier
    v_mov_b32 v64, v224
    v_mov_b32 v65, v225
    v_mov_b32 v66, v226
    v_mov_b32 v67, v227
    s_mov_b32 s43, 8
L_tm_blk:
    ds_read_b128 a[144:147], v64
    ds_read_b128 a[148:151], v65
    ds_read_b128 a[152:155], v66
    ds_read_b128 a[156:159], v67
    v_add_u32 v64, 4096, v64
    v_add_u32 v65, 4096, v65
    v_add_u32 v66, 4096, v66
    v_add_u32 v67, 4096, v67
    s_waitcnt lgkmcnt(0)
    v_mfma_f32_16x16x32_bf16 v[192:195], a[144:147], v[0:3], 0
    v_mfma_f32_16x16x32_bf16 v[192:195], a[148:151], v[4:7], v[192:195]
    v_mfma_f32_16x16x32_bf16 v[192:195], a[152:155], v[8:11], v[192:195]
    v_mfma_f32_16x16x32_bf16 v[192:195], a[156:159], v[12:15], v[192:195]
    v_mfma_f32_16x16x32_bf16 v[196:199], a[144:147], v[16:19], 0
    v_mfma_f32_16x16x32_bf16 v[196:199], a[148:151], v[20:23], v[196:199]
    v_mfma_f32_16x16x32_bf16 v[196:199], a[152:155], v[24:27], v[196:199]
    v_mfma_f32_16x16x32_bf16 v[196:199], a[156:159], v[28:31], v[196:199]
    v_mfma_f32_16x16x32_bf16 v[200:203], a[144:147], v[32:35], 0
    v_mfma_f32_16x16x32_bf16 v[200:203], a[148:151], v[36:39], v[200:203]
    v_mfma_f32_16x16x32_bf16 v[200:203], a[152:155], v[40:43], v[200:203]
    v_mfma_f32_16x16x32_bf16 v[200:203], a[156:159], v[44:47], v[200:203]
    v_mfma_f32_16x16x32_bf16 v[204:207], a[144:147], v[48:51], 0
    v_mfma_f32_16x16x32_bf16 v[204:207], a[148:151], v[52:55], v[204:207]
    v_mfma_f32_16x16x32_bf16 v[204:207], a[152:155], v[56:59], v[204:207]
    v_mfma_f32_16x16x32_bf16 v[204:207], a[156:159], v[60:63], v[204:207]
    s_nop 7
    v_max3_f32 v120, v120, v192, v193
    v_max3_f32 v120, v120, v194, v195
    v_max3_f32 v121, v121, v196, v197
    v_max3_f32 v121, v121, v198, v199
    v_max3_f32 v122, v122, v200, v201
    v_max3_f32 v122, v122, v202, v203
    v_max3_f32 v123, v123, v204, v205
    v_max3_f32 v123, v123, v206, v207
    s_sub_u32 s43, s43, 1
    s_cmp_lg_u32 s43, 0
    s_cbranch_scc1 L_tm_blk
    s_add_u32 s42, s42, 32768
    s_cmp_lt_u32 s42, 524288
    s_cbranch_scc1 L_tm_tile
    s_barrier
    s_add_u32 m0, s40, 0
    s_mov_b32 s41, 0
    buffer_load_dwordx4 v236, s[8:11], s41 offen lds
    s_add_u32 m0, s40, 4096
    s_mov_b32 s41, 4096
    buffer_load_dwordx4 v236, s[8:11], s41 offen lds
    s_add_u32 m0, s40, 8192
    s_mov_b32 s41, 8192
    buffer_load_dwordx4 v236, s[8:11], s41 offen lds
    s_add_u32 m0, s40, 12288
    s_mov_b32 s41, 12288
    buffer_load_dwordx4 v236, s[8:11], s41 offen lds
    s_add_u32 m0, s40, 16384
    s_mov_b32 s41, 16384
    buffer_load_dwordx4 v236, s[8:11], s41 offen lds
    s_add_u32 m0, s40, 20480
    s_mov_b32 s41, 20480
    buffer_load_dwordx4 v236, s[8:11], s41 offen lds
    s_add_u32 m0, s40, 24576
    s_mov_b32 s41, 24576
    buffer_load_dwordx4 v236, s[8:11], s41 offen lds
    s_add_u32 m0, s40, 28672
    s_mov_b32 s41, 28672
    buffer_load_dwordx4 v236, s[8:11], s41 offen lds
    s_add_u32 m0, s40, 32768
    s_mov_b32 s41, 32768
    buffer_load_dwordx4 v236, s[8:11], s41 offen lds
    s_add_u32 m0, s40, 36864
    s_mov_b32 s41, 36864
    buffer_load_dwordx4 v236, s[8:11], s41 offen lds
    s_add_u32 m0, s40, 40960
    s_mov_b32 s41, 40960
    buffer_load_dwordx4 v236, s[8:11], s41 offen lds
    s_add_u32 m0, s40, 45056
    s_mov_b32 s41, 45056
    buffer_load_dwordx4 v236, s[8:11], s41 offen lds
    s_add_u32 m0, s40, 49152
    s_mov_b32 s41, 49152
    buffer_load_dwordx4 v236, s[8:11], s41 offen lds
    s_add_u32 m0, s40, 53248
    s_mov_b32 s41, 53248
    buffer_load_dwordx4 v236, s[8:11], s41 offen lds
    s_add_u32 m0, s40, 57344
    s_mov_b32 s41, 57344
    buffer_load_dwordx4 v236, s[8:11], s41 offen lds
    s_add_u32 m0, s40, 61440
    s_mov_b32 s41, 61440
    buffer_load_dwordx4 v236, s[8:11], s41 offen lds
    s_add_u32 m0, s40, 65536
    s_mov_b32 s41, 0
    buffer_load_dwordx4 v237, s[12:15], s41 offen lds
    s_add_u32 m0, s40, 69632
    s_mov_b32 s41, 4096
    buffer_load_dwordx4 v237, s[12:15], s41 offen lds
    s_add_u32 m0, s40, 73728
    s_mov_b32 s41, 8192
    buffer_load_dwordx4 v237, s[12:15], s41 offen lds
    s_add_u32 m0, s40, 77824
    s_mov_b32 s41, 12288
    buffer_load_dwordx4 v237, s[12:15], s41 offen lds
    s_add_u32 m0, s40, 81920
    s_mov_b32 s41, 16384
    buffer_load_dwordx4 v237, s[12:15], s41 offen lds
    s_add_u32 m0, s40, 86016
    s_mov_b32 s41, 20480
    buffer_load_dwordx4 v237, s[12:15], s41 offen lds
    s_add_u32 m0, s40, 90112
    s_mov_b32 s41, 24576
    buffer_load_dwordx4 v237, s[12:15], s41 offen lds
    s_add_u32 m0, s40, 94208
    s_mov_b32 s41, 28672
    buffer_load_dwordx4 v237, s[12:15], s41 offen lds
    v_lshrrev_b32 v248, 4, v238
    v_mul_u32_u24 v249, 6554, v248
    v_lshrrev_b32 v249, 16, v249
    v_mul_u32_u24 v249, 1120, v249
    v_lshl_add_u32 v239, v248, 4, v249
    v_add_u32 v248, 64, v248
    v_mul_u32_u24 v249, 6554, v248
    v_lshrrev_b32 v249, 16, v249
    v_mul_u32_u24 v249, 1120, v249
    v_lshl_add_u32 v241, v248, 4, v249
    v_add_u32 v248, 64, v248
    v_mul_u32_u24 v249, 6554, v248
    v_lshrrev_b32 v249, 16, v249
    v_mul_u32_u24 v249, 1120, v249
    v_lshl_add_u32 v253, v248, 4, v249
    v_and_b32 v248, 0x200, v238
    v_lshl_add_u32 v253, v248, 20, v253
    s_waitcnt vmcnt(0)
    s_barrier
    ds_read_b128 a[144:147], v224 offset:0
    ds_read_b128 a[148:151], v225 offset:0
    ds_read_b128 a[152:155], v226 offset:0
    ds_read_b128 a[156:159], v227 offset:0
    s_branch L_a_attn
L_code_end:
.section .rodata,"a"
.p2align 6
.amdhsa_kernel recurrent_scan__gqa_block_cached__glu_gated_swiglu__prompt_kernel
  .amdhsa_next_free_vgpr 512
  .amdhsa_next_free_sgpr 102
  .amdhsa_accum_offset 256
  .amdhsa_group_segment_fixed_size 0
  .amdhsa_kernarg_size 96
  .amdhsa_user_sgpr_count 2
  .amdhsa_user_sgpr_kernarg_segment_ptr 1
  .amdhsa_system_sgpr_workgroup_id_x 1
  .amdhsa_float_denorm_mode_32 3
.end_amdhsa_kernel
```
